```python
import torch

def _softmax(x, axis=-1):
    return torch.softmax(x, dim=axis)

def _gelu(x):
    return torch.nn.functional.gelu(x, approximate='tanh')

def _silu(x):
    return torch.nn.functional.silu(x)

def _sigmoid(x):
    return torch.sigmoid(x)

def _layernorm(x, axis=-1, eps=1e-05):
    m = x.mean(dim=axis, keepdim=True)
    v = x.var(dim=axis, keepdim=True, unbiased=False)
    return (x - m) / torch.sqrt(v + eps)

def _scatter_add(tgt, idx, src, axis=0):
    return tgt.clone().index_add_(axis, idx, src)

def _segment_sum(src, seg, n):
    out = torch.zeros((n,) + src.shape[1:], dtype=src.dtype)
    return out.index_add_(0, seg, src)

def _pad(x, pw):
    flat = tuple((v for pair in reversed(pw) for v in pair))
    return torch.nn.functional.pad(x, flat)
kernel_name = 'sequential_preLN__linear_kernel_hedgehog__mixer_gmlp__prompt'

def setup_inputs():

    _w = lambda a: (lambda t: t.to(torch.bfloat16) if t.is_floating_point() else t)(torch.as_tensor(a))

    def _A_setup():
        B, S, D, H = (1, 2048, 512, 32)
        Dh = D // H
        return {'x': _w((lambda *s: torch.randn(*s, dtype=torch.bfloat16) * 0.05)(B, S, D)), 'wqkv': _w((lambda *s: torch.randn(*s, dtype=torch.bfloat16) * 0.2)(D, 3 * D)), 'w_phi': _w((lambda *s: torch.randn(*s, dtype=torch.bfloat16) * 0.2)(H, Dh, Dh) * Dh ** (-0.5)), 'wo': _w((lambda *s: torch.randn(*s, dtype=torch.bfloat16) * 0.05)(D, D))}
    _A_in = _A_setup()

    def _B_setup():
        B, S, D, F = (1, 2048, 512, 1792)
        Fh = F // 2
        return {'x': _w((lambda *s: torch.randn(*s, dtype=torch.bfloat16) * 0.05)(B, S, D)), 'w_in': _w((lambda *s: torch.randn(*s, dtype=torch.bfloat16) * 0.2)(D, 2 * Fh)), 'w_sp': _w(0.01 * (lambda *s: torch.randn(*s, dtype=torch.bfloat16) * 0.2)(S, S)), 'b_sp': _w(1.0 + 0.01 * (lambda *s: torch.randn(*s, dtype=torch.bfloat16) * 0.05)(S)), 'w_out': _w((lambda *s: torch.randn(*s, dtype=torch.bfloat16) * 0.05)(Fh, D))}
    _B_in = _B_setup()
    return {'A_x': _A_in['x'], 'A_wqkv': _A_in['wqkv'], 'A_w_phi': _A_in['w_phi'], 'A_wo': _A_in['wo'], 'B_x': _B_in['x'], 'B_w_in': _B_in['w_in'], 'B_w_sp': _B_in['w_sp'], 'B_b_sp': _B_in['b_sp'], 'B_w_out': _B_in['w_out']}

def reference(A_x, A_wqkv, A_w_phi, A_wo, B_x, B_w_in, B_w_sp, B_b_sp, B_w_out):

    def _A_ref(x, wqkv, w_phi, wo):
        B, S, D = x.shape
        H = 32
        Dh = D // H
        qkv = (lambda x, *d: x.permute(*d))((x @ wqkv).reshape(B, S, 3, H, Dh), 2, 0, 3, 1, 4)
        q, k, v = (qkv[0], qkv[1], qkv[2])
        pq = torch.einsum('bhsd,hdf->bhsf', q, w_phi)
        pk = torch.einsum('bhsd,hdf->bhsf', k, w_phi)
        phi_q = torch.concatenate([_softmax(pq, axis=-1), _softmax(-pq, axis=-1)], axis=-1)
        phi_k = torch.concatenate([_softmax(pk, axis=-1), _softmax(-pk, axis=-1)], axis=-1)
        kv = torch.einsum('bhsf,bhsd->bhfd', phi_k, v)
        z = torch.einsum('bhsf->bhf', phi_k)
        num = torch.einsum('bhqf,bhfd->bhqd', phi_q, kv)
        den = torch.einsum('bhqf,bhf->bhq', phi_q, z)[..., None] + 1e-06
        o = num / den
        return (lambda x, *d: x.permute(*d))(o, 0, 2, 1, 3).reshape(B, S, D) @ wo

    def _B_ref(x, w_in, w_sp, b_sp, w_out):
        B, S, D = x.shape
        F = w_in.shape[-1]
        Fh = F // 2
        z = _gelu(torch.einsum('bsd,df->bsf', x, w_in))
        z1 = z[..., :Fh].clone()
        z2 = _layernorm(z[..., Fh:], axis=-1)
        g = torch.einsum('ts,bsf->btf', w_sp, z2) + b_sp[None, :, None]
        return torch.einsum('bsf,fd->bsd', z1 * g, w_out)
    x = A_x
    h = x + _A_ref(_layernorm(x, axis=-1), A_wqkv, A_w_phi, A_wo)
    h2 = h + _B_ref(_layernorm(h, axis=-1), B_w_in, B_w_sp, B_b_sp, B_w_out)
    return h2
```

```asm
; @launch grid=(256,1,1) block=(256,1,1) lds=163840
.amdgcn_target "amdgcn-amd-amdhsa--gfx950"
.text
.p2align 12
.fill 832, 4, 0xbf810000
.globl sequential_preLN__linear_kernel_hedgehog__mixer_gmlp__prompt_kernel
.p2align 8
.type sequential_preLN__linear_kernel_hedgehog__mixer_gmlp__prompt_kernel,@function
sequential_preLN__linear_kernel_hedgehog__mixer_gmlp__prompt_kernel:
    s_cmp_ge_u32 s2, 256
    s_cbranch_scc1 L_end
    s_load_dwordx2 s[4:5], s[0:1], 0
    s_load_dwordx2 s[8:9], s[0:1], 8
    s_load_dwordx2 s[32:33], s[0:1], 88
    s_load_dwordx2 s[36:37], s[0:1], 16
    s_load_dwordx2 s[12:13], s[0:1], 24
    s_load_dwordx2 s[16:17], s[0:1], 40
    v_lshrrev_b32 v1, 6, v0
    v_and_b32 v0, 63, v0
    v_readfirstlane_b32 s54, v1
    v_lshlrev_b32 v1, 4, v0
    v_and_b32 v3, 15, v0
    v_lshrrev_b32 v4, 4, v0
    v_mov_b32 v2, 0
    s_and_b32 s48, s2, 7
    s_lshr_b32 s49, s2, 3
    s_lshr_b32 s59, s49, 4
    s_lshl_b32 s50, s48, 1
    s_add_u32 s50, s50, s59
    s_and_b32 s51, s49, 15
    s_and_b32 s59, s49, 1
    s_lshl_b32 s52, s50, 1
    s_add_u32 s52, s52, s59
    s_lshr_b32 s53, s51, 1
    s_lshl_b32 s57, s50, 2
    s_add_u32 s57, s57, s54
    s_lshl_b32 s58, s52, 2
    s_add_u32 s58, s58, s54
    s_lshl_b32 s94, s48, 5
    s_add_u32 s94, s94, s49
    s_lshl_b32 s94, s94, 2
    s_add_u32 s94, s94, s54
    s_mov_b32 s56, 0x80000
    s_getpc_b64 s[60:61]
    s_and_b32 s59, s94, 127
    s_mul_i32 s59, s59, 384
    s_min_u32 s59, s59, L_slow-sequential_preLN__linear_kernel_hedgehog__mixer_gmlp__prompt_kernel-640
    v_min_u32 v36, 2, v0
    v_lshl_add_u32 v36, v36, 7, s59
    v_mov_b32 v159, s61
    v_add_co_u32 v158, vcc, s60, v36
    s_nop 1
    v_addc_co_u32 v159, vcc, 0, v159, vcc
    global_load_dword v19, v[158:159], off
    s_mov_b32 s6, 2097152
    s_mov_b32 s7, 0x20000
    s_mov_b32 s10, 1572864
    s_mov_b32 s11, 0x20000
    s_mov_b32 s34, 16777216
    s_mov_b32 s35, 0x20000
    s_mov_b32 s38, 16384
    s_mov_b32 s39, 0x20000
    v_lshrrev_b32 v36, 5, v0
    v_bfe_u32 v37, v0, 3, 2
    v_lshl_add_u32 v36, v36, 3, v37
    v_mul_u32_u24 v36, 1024, v36
    v_xor_b32 v37, v4, v0
    v_and_b32 v37, 7, v37
    v_lshl_add_u32 v5, v37, 4, v36
    v_xor_b32 v37, 64, v5
    v_add_u32 v6, 15360, v37
    v_add_u32 v7, 2048, v5
    v_add_u32 v8, 17408, v37
    s_lshl_b32 s87, s52, 16
    s_and_b32 s59, s54, 1
    s_lshl_b32 s60, s59, 15
    s_add_u32 s87, s87, s60
    s_lshr_b32 s61, s54, 1
    s_lshl_b32 s60, s61, 7
    s_add_u32 s87, s87, s60
    s_lshl_b32 s90, s54, 12
    s_add_u32 s91, s48, s53
    s_and_b32 s60, s52, 1
    s_lshl_b32 s60, s60, 1
    s_add_u32 s91, s91, s60
    s_and_b32 s91, s91, 3
    v_lshrrev_b32 v36, 3, v0
    v_and_b32 v37, 1, v4
    v_lshlrev_b32 v37, 1, v37
    v_xor_b32 v37, v37, v0
    v_and_b32 v37, 7, v37
    v_mul_u32_u24 v36, 3072, v36
    v_lshl_add_u32 v9, v37, 4, v36
    v_xor_b32 v37, 64, v9
    v_add_u32 v10, 23552, v37
    v_add_u32 v11, 47104, v9
    v_add_u32 v12, 70656, v37
    s_lshl_b32 s62, s53, 7
    s_mul_i32 s89, s61, 98304
    s_lshl_b32 s59, s59, 10
    s_add_u32 s89, s89, s59
    s_add_u32 s89, s89, s62
    s_add_u32 s89, s89, 1024
    s_add_u32 s93, s91, 0
    s_and_b32 s93, s93, 3
    s_mul_i32 s95, s93, 393216
    s_lshl_b32 s93, s93, 8
    s_add_u32 m0, s90, 32768
    s_add_u32 s86, s87, s93
    s_waitcnt lgkmcnt(0)
    buffer_load_dwordx4 v5, s[4:7], s86 offen lds
    buffer_load_dwordx4 v6, s[4:7], s86 offen offset:1024 lds
    buffer_load_dwordx4 v7, s[4:7], s86 offen offset:2048 lds
    buffer_load_dwordx4 v8, s[4:7], s86 offen offset:3072 lds
    s_add_u32 m0, s90, 98304
    s_add_u32 s86, s89, s95
    buffer_load_dwordx4 v9, s[8:11], s86 offen lds
    buffer_load_dwordx4 v10, s[8:11], s86 offen offset:1024 lds
    buffer_load_dwordx4 v11, s[8:11], s86 offen offset:2048 lds
    buffer_load_dwordx4 v12, s[8:11], s86 offen offset:3072 lds
    s_load_dwordx2 s[20:21], s[0:1], 48
    s_load_dwordx2 s[40:41], s[0:1], 56
    s_load_dwordx2 s[24:25], s[0:1], 64
    s_load_dwordx2 s[28:29], s[0:1], 72
    s_load_dwordx2 s[44:45], s[0:1], 80
    s_mov_b32 s14, 524288
    s_mov_b32 s15, 0x20000
    s_mov_b32 s18, 1835008
    s_mov_b32 s19, 0x20000
    s_mov_b32 s22, 8388608
    s_mov_b32 s23, 0x20000
    s_mov_b32 s42, 4096
    s_mov_b32 s43, 0x20000
    s_mov_b32 s26, 917504
    s_mov_b32 s27, 0x20000
    s_mov_b32 s30, 2097152
    s_mov_b32 s31, 0x20000
    s_mov_b32 s46, 256
    s_mov_b32 s47, 0x20000
    s_waitcnt lgkmcnt(0)
    s_add_u32 s55, s89, 196608
    s_mul_i32 s92, s54, 98304
    s_add_u32 s92, s92, s62
    s_mov_b32 s80, 0x3fb8aa3b
    s_mov_b32 s81, 0x3fb8aa3b
    s_mov_b32 s82, 0xbdd2d3e8
    s_mov_b32 s83, 0xbdd2d3e8
    s_mov_b32 s84, 1.0
    s_mov_b32 s85, 1.0
    s_add_u32 s51, s51, 8
    s_and_b32 s51, s51, 15
    s_mul_i32 s3, s48, 57344
    s_add_u32 s3, s3, 10784768
    s_mul_i32 s0, s58, 34816
    s_mul_i32 s1, s57, 69632
    s_mul_i32 s59, s53, 7
    s_and_b32 s60, s53, 1
    s_add_u32 s65, s59, s60
    s_add_u32 s66, s65, 1
    s_add_u32 s67, s65, 2
    s_add_u32 s68, s65, 3
    s_add_u32 s69, s65, 4
    s_add_u32 s70, s65, 5
    s_xor_b32 s60, s60, 1
    s_mul_i32 s60, s60, 6
    s_add_u32 s64, s59, s60
    s_add_u32 s59, s54, 1
    s_and_b32 s59, s59, 3
    s_lshl_b32 s72, s59, 11
    s_lshl_b32 s76, s59, 7
    s_add_u32 s59, s54, 2
    s_and_b32 s59, s59, 3
    s_lshl_b32 s73, s59, 11
    s_lshl_b32 s77, s59, 7
    s_add_u32 s59, s54, 3
    s_and_b32 s59, s59, 3
    s_lshl_b32 s74, s59, 11
    s_lshl_b32 s78, s59, 7
    s_add_u32 s59, s54, 0
    s_and_b32 s59, s59, 3
    s_lshl_b32 s75, s59, 11
    s_lshl_b32 s79, s59, 7
    v_mov_b32 v24, 0x3f803f80
    v_mov_b32 v25, 0x3f803f80
    v_mov_b32 v26, 0x3f803f80
    v_mov_b32 v27, 0x3f803f80
    v_lshrrev_b32 v17, 1, v3
    v_xor_b32 v17, v17, v4
    v_lshlrev_b32 v17, 4, v17
    v_lshl_add_u32 v17, v3, 7, v17
    s_add_u32 s59, s54, 0
    s_and_b32 s59, s59, 3
    s_lshl_b32 s59, s59, 11
    s_add_u32 s59, s59, 32768
    v_add_u32 v176, s59, v17
    v_xor_b32 v177, 64, v176
    s_add_u32 s59, s54, 1
    s_and_b32 s59, s59, 3
    s_lshl_b32 s59, s59, 11
    s_add_u32 s59, s59, 32768
    v_add_u32 v178, s59, v17
    v_xor_b32 v179, 64, v178
    s_add_u32 s59, s54, 2
    s_and_b32 s59, s59, 3
    s_lshl_b32 s59, s59, 11
    s_add_u32 s59, s59, 32768
    v_add_u32 v180, s59, v17
    v_xor_b32 v181, 64, v180
    s_add_u32 s59, s54, 3
    s_and_b32 s59, s59, 3
    s_lshl_b32 s59, s59, 11
    s_add_u32 s59, s59, 32768
    v_add_u32 v182, s59, v17
    v_xor_b32 v183, 64, v182
    v_bfe_u32 v17, v0, 2, 2
    v_lshl_add_u32 v17, v4, 3, v17
    v_and_b32 v18, 3, v0
    v_lshlrev_b32 v18, 3, v18
    v_lshl_add_u32 v18, v17, 7, v18
    v_bfe_u32 v17, v0, 3, 2
    v_xor_b32 v17, s54, v17
    v_lshl_add_u32 v15, v17, 5, v18
    v_add_u32 v14, 98304, v15
    v_add_u32 v13, 32768, v15
    v_lshlrev_b32 v17, 2, v4
    v_sub_u32 v17, v3, v17
    v_mov_b32 v18, 0x3f80
    v_mov_b32 v130, 0x3f800000
    v_cmp_eq_u32 vcc, 0, v17
    s_nop 1
    v_cndmask_b32 v60, 0, v18, vcc
    v_cmp_eq_u32 vcc, 1, v17
    s_nop 1
    v_cndmask_b32 v60, v60, v130, vcc
    v_cmp_eq_u32 vcc, 2, v17
    s_nop 1
    v_cndmask_b32 v61, 0, v18, vcc
    v_cmp_eq_u32 vcc, 3, v17
    s_nop 1
    v_cndmask_b32 v61, v61, v130, vcc
    v_mov_b32 v28, 0
    v_mov_b32 v29, 0
    v_mov_b32 v30, 0
    v_mov_b32 v31, 0
    s_lshl_b32 s59, s54, 7
    v_lshl_add_u32 v144, v4, 13, s59
    v_lshl_add_u32 v144, v3, 3, v144
    s_lshl_b32 s60, s54, 13
    s_add_u32 s59, s54, 0
    s_and_b32 s59, s59, 3
    s_lshl_b32 s59, s59, 7
    s_add_u32 s59, s59, s60
    v_lshl_add_u32 v145, v3, 3, s59
    s_add_u32 s59, s54, 1
    s_and_b32 s59, s59, 3
    s_lshl_b32 s59, s59, 7
    s_add_u32 s59, s59, s60
    v_lshl_add_u32 v146, v3, 3, s59
    s_add_u32 s59, s54, 2
    s_and_b32 s59, s59, 3
    s_lshl_b32 s59, s59, 7
    s_add_u32 s59, s59, s60
    v_lshl_add_u32 v147, v3, 3, s59
    s_add_u32 s59, s54, 3
    s_and_b32 s59, s59, 3
    s_lshl_b32 s59, s59, 7
    s_add_u32 s59, s59, s60
    v_lshl_add_u32 v148, v3, 3, s59
    s_getreg_b32 s59, hwreg(HW_REG_XCC_ID)
    s_and_b32 s59, s59, 7
    s_lshl_b32 s59, s59, 3
    s_mov_b64 s[60:61], 1
    s_lshl_b64 s[60:61], s[60:61], s59
    v_mov_b32 v128, s60
    v_mov_b32 v129, s61
    s_lshr_b32 s59, s53, 1
    s_sub_u32 s59, s59, s91
    s_and_b32 s59, s59, 3
    s_lshl_b32 s59, s59, 14
    s_and_b32 s60, s53, 1
    s_lshl_b32 s60, s60, 13
    s_add_u32 s59, s59, s60
    s_lshl_b32 s60, s54, 11
    s_add_u32 s59, s59, s60
    s_add_u32 s59, s59, 32768
    v_xor_b32 v17, v3, v4
    v_lshrrev_b32 v17, 1, v17
    v_lshlrev_b32 v17, 4, v17
    v_lshl_add_u32 v17, v3, 7, v17
    v_and_b32 v18, 1, v4
    v_lshl_add_u32 v17, v18, 3, v17
    v_add_u32 v154, s59, v17
    v_xor_b32 v155, 32, v154
    v_xor_b32 v156, 64, v154
    v_xor_b32 v157, 96, v154
    v_and_b32 v184, 7, v0
    v_lshlrev_b32 v184, 5, v184
    s_add_u32 m0, s90, 114688
    s_add_u32 s86, s55, s95
    buffer_load_dwordx4 v9, s[8:11], s86 offen lds
    buffer_load_dwordx4 v10, s[8:11], s86 offen offset:1024 lds
    buffer_load_dwordx4 v11, s[8:11], s86 offen offset:2048 lds
    buffer_load_dwordx4 v12, s[8:11], s86 offen offset:3072 lds
    v_mov_b32 v140, -1
    v_mov_b32 v141, -1
    v_mov_b32 v142, -1
    v_mov_b32 v143, -1
    s_lshl_b32 s59, s94, 10
    s_add_u32 s59, s59, 10485760
    buffer_store_dwordx4 v[140:143], v1, s[32:35], s59 offen sc1
    s_lshl_b32 s71, s53, 2
    s_add_u32 s71, s71, s54
    v_lshlrev_b32 v36, 7, v4
    v_lshl_add_u32 v36, v3, 1, v36
    s_lshl_b32 s60, s71, 9
    buffer_load_ushort v132, v36, s[36:39], s60 offen offset:0
    buffer_load_ushort v133, v36, s[36:39], s60 offen offset:32
    buffer_load_ushort v134, v36, s[36:39], s60 offen offset:64
    buffer_load_ushort v135, v36, s[36:39], s60 offen offset:96
    s_add_u32 s93, s91, 1
    s_and_b32 s93, s93, 3
    s_mul_i32 s96, s93, 393216
    s_lshl_b32 s93, s93, 8
    s_add_u32 m0, s90, 49152
    s_add_u32 s86, s87, s93
    buffer_load_dwordx4 v5, s[4:7], s86 offen lds
    buffer_load_dwordx4 v6, s[4:7], s86 offen offset:1024 lds
    buffer_load_dwordx4 v7, s[4:7], s86 offen offset:2048 lds
    buffer_load_dwordx4 v8, s[4:7], s86 offen offset:3072 lds
    s_waitcnt vmcnt(13)
    s_barrier
    ds_read_b64_tr_b16 v[96:97], v14 offset:0
    ds_read_b64_tr_b16 v[98:99], v14 offset:512
    ds_read_b128 v[192:195], v176 offset:0
    ds_read_b128 a[0:3], v178 offset:0
    ds_read_b128 a[64:67], v180 offset:0
    ds_read_b128 a[128:131], v182 offset:0
    ds_read_b64_tr_b16 v[100:101], v14 offset:4096
    ds_read_b64_tr_b16 v[102:103], v14 offset:4608
    ds_read_b64_tr_b16 v[104:105], v14 offset:8192
    ds_read_b64_tr_b16 v[106:107], v14 offset:8704
    ds_read_b128 v[196:199], v177 offset:0
    ds_read_b128 a[4:7], v179 offset:0
    ds_read_b128 a[68:71], v181 offset:0
    ds_read_b128 a[132:135], v183 offset:0
    ds_read_b64_tr_b16 v[108:109], v14 offset:12288
    ds_read_b64_tr_b16 v[110:111], v14 offset:12800
    s_waitcnt lgkmcnt(8)
    s_add_u32 m0, s90, 131072
    s_add_u32 s86, s89, s96
    buffer_load_dwordx4 v9, s[8:11], s86 offen lds
    buffer_load_dwordx4 v10, s[8:11], s86 offen offset:1024 lds
    buffer_load_dwordx4 v11, s[8:11], s86 offen offset:2048 lds
    buffer_load_dwordx4 v12, s[8:11], s86 offen offset:3072 lds
    s_waitcnt vmcnt(13)
    s_barrier
    v_mfma_f32_16x16x32_bf16 v[64:67], v[96:99], v[192:195], 0
    ds_read_b64_tr_b16 v[112:113], v14 offset:16384
    v_mfma_f32_16x16x32_bf16 v[68:71], v[96:99], a[0:3], 0
    s_add_u32 m0, s90, 147456
    s_add_u32 s86, s55, s96
    ds_read_b64_tr_b16 v[114:115], v14 offset:16896
    v_mfma_f32_16x16x32_bf16 v[72:75], v[96:99], a[64:67], 0
    buffer_load_dwordx4 v9, s[8:11], s86 offen lds
    ds_read_b128 v[200:203], v176 offset:8192
    v_mfma_f32_16x16x32_bf16 v[76:79], v[96:99], a[128:131], 0
    ds_read_b128 a[8:11], v178 offset:8192
    v_mfma_f32_16x16x32_bf16 v[40:43], v[96:99], v[24:27], 0
    ds_read_b128 a[72:75], v180 offset:8192
    v_mfma_f32_16x16x32_bf16 v[80:83], v[100:103], v[192:195], 0
    buffer_load_dwordx4 v10, s[8:11], s86 offen offset:1024 lds
    ds_read_b128 a[136:139], v182 offset:8192
    v_mfma_f32_16x16x32_bf16 v[84:87], v[100:103], a[0:3], 0
    ds_read_b64_tr_b16 v[116:117], v14 offset:20480
    v_mfma_f32_16x16x32_bf16 v[88:91], v[100:103], a[64:67], 0
    ds_read_b64_tr_b16 v[118:119], v14 offset:20992
    v_mfma_f32_16x16x32_bf16 v[92:95], v[100:103], a[128:131], 0
    buffer_load_dwordx4 v11, s[8:11], s86 offen offset:2048 lds
    v_mfma_f32_16x16x32_bf16 v[44:47], v[100:103], v[24:27], 0
    s_waitcnt lgkmcnt(8)
    v_mfma_f32_16x16x32_bf16 v[64:67], v[104:107], v[196:199], v[64:67]
    ds_read_b64_tr_b16 v[96:97], v14 offset:24576
    v_mfma_f32_16x16x32_bf16 v[68:71], v[104:107], a[4:7], v[68:71]
    buffer_load_dwordx4 v12, s[8:11], s86 offen offset:3072 lds
    ds_read_b64_tr_b16 v[98:99], v14 offset:25088
    v_mfma_f32_16x16x32_bf16 v[72:75], v[104:107], a[68:71], v[72:75]
    ds_read_b128 v[204:207], v177 offset:8192
    v_mfma_f32_16x16x32_bf16 v[76:79], v[104:107], a[132:135], v[76:79]
    s_add_u32 s93, s91, 2
    s_and_b32 s93, s93, 3
    s_mul_i32 s97, s93, 393216
    s_lshl_b32 s93, s93, 8
    s_add_u32 m0, s90, 65536
    s_add_u32 s86, s87, s93
    ds_read_b128 a[12:15], v179 offset:8192
    v_mfma_f32_16x16x32_bf16 v[40:43], v[104:107], v[24:27], v[40:43]
    buffer_load_dwordx4 v5, s[4:7], s86 offen lds
    ds_read_b128 a[76:79], v181 offset:8192
    v_mfma_f32_16x16x32_bf16 v[80:83], v[108:111], v[196:199], v[80:83]
    ds_read_b128 a[140:143], v183 offset:8192
    v_mfma_f32_16x16x32_bf16 v[84:87], v[108:111], a[4:7], v[84:87]
    ds_read_b64_tr_b16 v[100:101], v14 offset:28672
    v_mfma_f32_16x16x32_bf16 v[88:91], v[108:111], a[68:71], v[88:91]
    buffer_load_dwordx4 v6, s[4:7], s86 offen offset:1024 lds
    ds_read_b64_tr_b16 v[102:103], v14 offset:29184
    v_mfma_f32_16x16x32_bf16 v[92:95], v[108:111], a[132:135], v[92:95]
    v_mfma_f32_16x16x32_bf16 v[44:47], v[108:111], v[24:27], v[44:47]
    s_waitcnt lgkmcnt(8)
    v_dot2c_f32_bf16 v28, v192, v24
    v_dot2c_f32_bf16 v29, v192, v192
    v_dot2c_f32_bf16 v30, v193, v24
    v_dot2c_f32_bf16 v31, v193, v193
    v_dot2c_f32_bf16 v28, v194, v24
    v_dot2c_f32_bf16 v29, v194, v194
    v_dot2c_f32_bf16 v30, v195, v24
    v_dot2c_f32_bf16 v31, v195, v195
    v_dot2c_f32_bf16 v28, v196, v24
    v_dot2c_f32_bf16 v29, v196, v196
    v_dot2c_f32_bf16 v30, v197, v24
    v_dot2c_f32_bf16 v31, v197, v197
    v_dot2c_f32_bf16 v28, v198, v24
    v_dot2c_f32_bf16 v29, v198, v198
    v_dot2c_f32_bf16 v30, v199, v24
    v_dot2c_f32_bf16 v31, v199, v199
    buffer_load_dwordx4 v7, s[4:7], s86 offen offset:2048 lds
    buffer_load_dwordx4 v8, s[4:7], s86 offen offset:3072 lds
    s_waitcnt vmcnt(8)
    s_barrier
    v_mfma_f32_16x16x32_bf16 v[64:67], v[112:115], v[200:203], v[64:67]
    ds_read_b64_tr_b16 v[104:105], v14 offset:32768
    v_mfma_f32_16x16x32_bf16 v[68:71], v[112:115], a[8:11], v[68:71]
    s_add_u32 m0, s90, 0
    s_add_u32 s86, s89, s97
    ds_read_b64_tr_b16 v[106:107], v14 offset:33280
    v_mfma_f32_16x16x32_bf16 v[72:75], v[112:115], a[72:75], v[72:75]
    buffer_load_dwordx4 v9, s[8:11], s86 offen lds
    ds_read_b128 v[208:211], v176 offset:16384
    v_mfma_f32_16x16x32_bf16 v[76:79], v[112:115], a[136:139], v[76:79]
    ds_read_b128 a[16:19], v178 offset:16384
    v_mfma_f32_16x16x32_bf16 v[40:43], v[112:115], v[24:27], v[40:43]
    ds_read_b128 a[80:83], v180 offset:16384
    v_mfma_f32_16x16x32_bf16 v[80:83], v[116:119], v[200:203], v[80:83]
    buffer_load_dwordx4 v10, s[8:11], s86 offen offset:1024 lds
    ds_read_b128 a[144:147], v182 offset:16384
    v_mfma_f32_16x16x32_bf16 v[84:87], v[116:119], a[8:11], v[84:87]
    ds_read_b64_tr_b16 v[108:109], v14 offset:36864
    v_mfma_f32_16x16x32_bf16 v[88:91], v[116:119], a[72:75], v[88:91]
    ds_read_b64_tr_b16 v[110:111], v14 offset:37376
    v_mfma_f32_16x16x32_bf16 v[92:95], v[116:119], a[136:139], v[92:95]
    buffer_load_dwordx4 v11, s[8:11], s86 offen offset:2048 lds
    v_mfma_f32_16x16x32_bf16 v[44:47], v[116:119], v[24:27], v[44:47]
    s_waitcnt lgkmcnt(8)
    v_mfma_f32_16x16x32_bf16 v[64:67], v[96:99], v[204:207], v[64:67]
    ds_read_b64_tr_b16 v[112:113], v14 offset:40960
    v_mfma_f32_16x16x32_bf16 v[68:71], v[96:99], a[12:15], v[68:71]
    buffer_load_dwordx4 v12, s[8:11], s86 offen offset:3072 lds
    ds_read_b64_tr_b16 v[114:115], v14 offset:41472
    v_mfma_f32_16x16x32_bf16 v[72:75], v[96:99], a[76:79], v[72:75]
    ds_read_b128 v[212:215], v177 offset:16384
    v_mfma_f32_16x16x32_bf16 v[76:79], v[96:99], a[140:143], v[76:79]
    s_add_u32 s93, s91, 3
    s_and_b32 s93, s93, 3
    s_mul_i32 s50, s93, 393216
    s_lshl_b32 s93, s93, 8
    s_add_u32 m0, s90, 81920
    s_add_u32 s86, s87, s93
    ds_read_b128 a[20:23], v179 offset:16384
    v_mfma_f32_16x16x32_bf16 v[40:43], v[96:99], v[24:27], v[40:43]
    buffer_load_dwordx4 v5, s[4:7], s86 offen lds
    ds_read_b128 a[84:87], v181 offset:16384
    v_mfma_f32_16x16x32_bf16 v[80:83], v[100:103], v[204:207], v[80:83]
    ds_read_b128 a[148:151], v183 offset:16384
    v_mfma_f32_16x16x32_bf16 v[84:87], v[100:103], a[12:15], v[84:87]
    ds_read_b64_tr_b16 v[116:117], v14 offset:45056
    v_mfma_f32_16x16x32_bf16 v[88:91], v[100:103], a[76:79], v[88:91]
    buffer_load_dwordx4 v6, s[4:7], s86 offen offset:1024 lds
    ds_read_b64_tr_b16 v[118:119], v14 offset:45568
    v_mfma_f32_16x16x32_bf16 v[92:95], v[100:103], a[140:143], v[92:95]
    v_mfma_f32_16x16x32_bf16 v[44:47], v[100:103], v[24:27], v[44:47]
    s_waitcnt lgkmcnt(8)
    v_dot2c_f32_bf16 v28, v200, v24
    v_dot2c_f32_bf16 v29, v200, v200
    v_dot2c_f32_bf16 v30, v201, v24
    v_dot2c_f32_bf16 v31, v201, v201
    v_dot2c_f32_bf16 v28, v202, v24
    v_dot2c_f32_bf16 v29, v202, v202
    v_dot2c_f32_bf16 v30, v203, v24
    v_dot2c_f32_bf16 v31, v203, v203
    v_dot2c_f32_bf16 v28, v204, v24
    v_dot2c_f32_bf16 v29, v204, v204
    v_dot2c_f32_bf16 v30, v205, v24
    v_dot2c_f32_bf16 v31, v205, v205
    v_dot2c_f32_bf16 v28, v206, v24
    v_dot2c_f32_bf16 v29, v206, v206
    v_dot2c_f32_bf16 v30, v207, v24
    v_dot2c_f32_bf16 v31, v207, v207
    buffer_load_dwordx4 v7, s[4:7], s86 offen offset:2048 lds
    buffer_load_dwordx4 v8, s[4:7], s86 offen offset:3072 lds
    s_waitcnt vmcnt(12)
    s_barrier
    v_mfma_f32_16x16x32_bf16 v[64:67], v[104:107], v[208:211], v[64:67]
    ds_read_b64_tr_b16 v[96:97], v14 offset:49152
    v_mfma_f32_16x16x32_bf16 v[68:71], v[104:107], a[16:19], v[68:71]
    s_add_u32 m0, s90, 16384
    s_add_u32 s86, s55, s97
    ds_read_b64_tr_b16 v[98:99], v14 offset:49664
    v_mfma_f32_16x16x32_bf16 v[72:75], v[104:107], a[80:83], v[72:75]
    buffer_load_dwordx4 v9, s[8:11], s86 offen lds
    ds_read_b128 v[216:219], v176 offset:24576
    v_mfma_f32_16x16x32_bf16 v[76:79], v[104:107], a[144:147], v[76:79]
    ds_read_b128 a[24:27], v178 offset:24576
    v_mfma_f32_16x16x32_bf16 v[40:43], v[104:107], v[24:27], v[40:43]
    ds_read_b128 a[88:91], v180 offset:24576
    v_mfma_f32_16x16x32_bf16 v[80:83], v[108:111], v[208:211], v[80:83]
    buffer_load_dwordx4 v10, s[8:11], s86 offen offset:1024 lds
    ds_read_b128 a[152:155], v182 offset:24576
    v_mfma_f32_16x16x32_bf16 v[84:87], v[108:111], a[16:19], v[84:87]
    ds_read_b64_tr_b16 v[100:101], v14 offset:53248
    v_mfma_f32_16x16x32_bf16 v[88:91], v[108:111], a[80:83], v[88:91]
    ds_read_b64_tr_b16 v[102:103], v14 offset:53760
    v_mfma_f32_16x16x32_bf16 v[92:95], v[108:111], a[144:147], v[92:95]
    buffer_load_dwordx4 v11, s[8:11], s86 offen offset:2048 lds
    v_mfma_f32_16x16x32_bf16 v[44:47], v[108:111], v[24:27], v[44:47]
    s_waitcnt lgkmcnt(8)
    v_mfma_f32_16x16x32_bf16 v[64:67], v[112:115], v[212:215], v[64:67]
    ds_read_b64_tr_b16 v[104:105], v14 offset:57344
    v_mfma_f32_16x16x32_bf16 v[68:71], v[112:115], a[20:23], v[68:71]
    buffer_load_dwordx4 v12, s[8:11], s86 offen offset:3072 lds
    ds_read_b64_tr_b16 v[106:107], v14 offset:57856
    v_mfma_f32_16x16x32_bf16 v[72:75], v[112:115], a[84:87], v[72:75]
    ds_read_b128 v[220:223], v177 offset:24576
    v_mfma_f32_16x16x32_bf16 v[76:79], v[112:115], a[148:151], v[76:79]
    s_add_u32 m0, s90, 98304
    s_add_u32 s86, s89, s50
    ds_read_b128 a[28:31], v179 offset:24576
    v_mfma_f32_16x16x32_bf16 v[40:43], v[112:115], v[24:27], v[40:43]
    buffer_load_dwordx4 v9, s[8:11], s86 offen lds
    ds_read_b128 a[92:95], v181 offset:24576
    v_mfma_f32_16x16x32_bf16 v[80:83], v[116:119], v[212:215], v[80:83]
    ds_read_b128 a[156:159], v183 offset:24576
    v_mfma_f32_16x16x32_bf16 v[84:87], v[116:119], a[20:23], v[84:87]
    ds_read_b64_tr_b16 v[108:109], v14 offset:61440
    v_mfma_f32_16x16x32_bf16 v[88:91], v[116:119], a[84:87], v[88:91]
    buffer_load_dwordx4 v10, s[8:11], s86 offen offset:1024 lds
    ds_read_b64_tr_b16 v[110:111], v14 offset:61952
    v_mfma_f32_16x16x32_bf16 v[92:95], v[116:119], a[148:151], v[92:95]
    v_mfma_f32_16x16x32_bf16 v[44:47], v[116:119], v[24:27], v[44:47]
    s_waitcnt lgkmcnt(8)
    v_dot2c_f32_bf16 v28, v208, v24
    v_dot2c_f32_bf16 v29, v208, v208
    v_dot2c_f32_bf16 v30, v209, v24
    v_dot2c_f32_bf16 v31, v209, v209
    v_dot2c_f32_bf16 v28, v210, v24
    v_dot2c_f32_bf16 v29, v210, v210
    v_dot2c_f32_bf16 v30, v211, v24
    v_dot2c_f32_bf16 v31, v211, v211
    v_dot2c_f32_bf16 v28, v212, v24
    v_dot2c_f32_bf16 v29, v212, v212
    v_dot2c_f32_bf16 v30, v213, v24
    v_dot2c_f32_bf16 v31, v213, v213
    v_dot2c_f32_bf16 v28, v214, v24
    v_dot2c_f32_bf16 v29, v214, v214
    v_dot2c_f32_bf16 v30, v215, v24
    v_dot2c_f32_bf16 v31, v215, v215
    buffer_load_dwordx4 v11, s[8:11], s86 offen offset:2048 lds
    buffer_load_dwordx4 v12, s[8:11], s86 offen offset:3072 lds
    s_waitcnt vmcnt(12)
    s_barrier
    v_mfma_f32_16x16x32_bf16 v[64:67], v[96:99], v[216:219], v[64:67]
    ds_read_b64_tr_b16 v[112:113], v15 offset:0
    v_mfma_f32_16x16x32_bf16 v[68:71], v[96:99], a[24:27], v[68:71]
    s_add_u32 m0, s90, 114688
    s_add_u32 s86, s55, s50
    ds_read_b64_tr_b16 v[114:115], v15 offset:512
    v_mfma_f32_16x16x32_bf16 v[72:75], v[96:99], a[88:91], v[72:75]
    buffer_load_dwordx4 v9, s[8:11], s86 offen lds
    ds_read_b128 v[224:227], v176 offset:32768
    v_mfma_f32_16x16x32_bf16 v[76:79], v[96:99], a[152:155], v[76:79]
    ds_read_b128 a[32:35], v178 offset:32768
    v_mfma_f32_16x16x32_bf16 v[40:43], v[96:99], v[24:27], v[40:43]
    ds_read_b128 a[96:99], v180 offset:32768
    v_mfma_f32_16x16x32_bf16 v[80:83], v[100:103], v[216:219], v[80:83]
    buffer_load_dwordx4 v10, s[8:11], s86 offen offset:1024 lds
    ds_read_b128 a[160:163], v182 offset:32768
    v_mfma_f32_16x16x32_bf16 v[84:87], v[100:103], a[24:27], v[84:87]
    ds_read_b64_tr_b16 v[116:117], v15 offset:4096
    v_mfma_f32_16x16x32_bf16 v[88:91], v[100:103], a[88:91], v[88:91]
    ds_read_b64_tr_b16 v[118:119], v15 offset:4608
    v_mfma_f32_16x16x32_bf16 v[92:95], v[100:103], a[152:155], v[92:95]
    buffer_load_dwordx4 v11, s[8:11], s86 offen offset:2048 lds
    v_mfma_f32_16x16x32_bf16 v[44:47], v[100:103], v[24:27], v[44:47]
    s_waitcnt lgkmcnt(8)
    v_mfma_f32_16x16x32_bf16 v[64:67], v[104:107], v[220:223], v[64:67]
    ds_read_b64_tr_b16 v[96:97], v15 offset:8192
    v_mfma_f32_16x16x32_bf16 v[68:71], v[104:107], a[28:31], v[68:71]
    buffer_load_dwordx4 v12, s[8:11], s86 offen offset:3072 lds
    ds_read_b64_tr_b16 v[98:99], v15 offset:8704
    v_mfma_f32_16x16x32_bf16 v[72:75], v[104:107], a[92:95], v[72:75]
    s_lshl_b32 s59, s48, 5
    s_lshl_b32 s60, s54, 8
    s_add_u32 s59, s59, s60
    s_mov_b64 exec, 1
    buffer_atomic_add_x2 v[128:129], off, s[44:47], s59
    s_mov_b64 exec, -1
    ds_read_b128 v[228:231], v177 offset:32768
    v_mfma_f32_16x16x32_bf16 v[76:79], v[104:107], a[156:159], v[76:79]
    ds_read_b128 a[36:39], v179 offset:32768
    v_mfma_f32_16x16x32_bf16 v[40:43], v[104:107], v[24:27], v[40:43]
    ds_read_b128 a[100:103], v181 offset:32768
    v_mfma_f32_16x16x32_bf16 v[80:83], v[108:111], v[220:223], v[80:83]
    ds_read_b128 a[164:167], v183 offset:32768
    v_mfma_f32_16x16x32_bf16 v[84:87], v[108:111], a[28:31], v[84:87]
    ds_read_b64_tr_b16 v[100:101], v15 offset:12288
    v_mfma_f32_16x16x32_bf16 v[88:91], v[108:111], a[92:95], v[88:91]
    ds_read_b64_tr_b16 v[102:103], v15 offset:12800
    v_mfma_f32_16x16x32_bf16 v[92:95], v[108:111], a[156:159], v[92:95]
    v_mfma_f32_16x16x32_bf16 v[44:47], v[108:111], v[24:27], v[44:47]
    s_waitcnt lgkmcnt(8)
    v_dot2c_f32_bf16 v28, v216, v24
    v_dot2c_f32_bf16 v29, v216, v216
    v_dot2c_f32_bf16 v30, v217, v24
    v_dot2c_f32_bf16 v31, v217, v217
    v_dot2c_f32_bf16 v28, v218, v24
    v_dot2c_f32_bf16 v29, v218, v218
    v_dot2c_f32_bf16 v30, v219, v24
    v_dot2c_f32_bf16 v31, v219, v219
    v_dot2c_f32_bf16 v28, v220, v24
    v_dot2c_f32_bf16 v29, v220, v220
    v_dot2c_f32_bf16 v30, v221, v24
    v_dot2c_f32_bf16 v31, v221, v221
    v_dot2c_f32_bf16 v28, v222, v24
    v_dot2c_f32_bf16 v29, v222, v222
    v_dot2c_f32_bf16 v30, v223, v24
    v_dot2c_f32_bf16 v31, v223, v223
    s_waitcnt vmcnt(9)
    s_barrier
    v_mfma_f32_16x16x32_bf16 v[64:67], v[112:115], v[224:227], v[64:67]
    s_mul_i32 s93, s94, 4
    v_min_u32 v36, 3, v0
    v_add_lshl_u32 v36, v36, s93, 7
    buffer_load_dword v19, v36, s[12:15], 0 offen sc1
    ds_read_b64_tr_b16 v[104:105], v15 offset:16384
    ds_read_b64 v[32:33], v154
    v_mfma_f32_16x16x32_bf16 v[68:71], v[112:115], a[32:35], v[68:71]
    s_mul_i32 s93, s94, 14
    v_min_u32 v36, 13, v0
    v_add_lshl_u32 v36, v36, s93, 7
    buffer_load_dword v19, v36, s[16:19], 0 offen sc1
    ds_read_b64_tr_b16 v[106:107], v15 offset:16896
    ds_read_b64 v[34:35], v155
    v_mfma_f32_16x16x32_bf16 v[72:75], v[112:115], a[96:99], v[72:75]
    s_mul_i32 s93, s94, 7
    v_min_u32 v36, 6, v0
    v_add_lshl_u32 v36, v36, s93, 7
    buffer_load_dword v19, v36, s[24:27], 0 offen sc1
    ds_read_b128 v[232:235], v176 offset:40960
    ds_read_b64 v[48:49], v156
    v_mfma_f32_16x16x32_bf16 v[76:79], v[112:115], a[160:163], v[76:79]
    s_and_b32 s86, s94, 31
    s_mul_i32 s93, s86, 1
    v_min_u32 v36, 0, v0
    v_add_lshl_u32 v36, v36, s93, 7
    buffer_load_dword v19, v36, s[40:43], 0 offen sc1
    ds_read_b128 a[40:43], v178 offset:40960
    ds_read_b64 v[50:51], v157
    v_mfma_f32_16x16x32_bf16 v[40:43], v[112:115], v[24:27], v[40:43]
    s_and_b32 s93, s94, 127
    s_mul_i32 s93, s93, 4096
    s_add_u32 s93, s93, 384
    v_min_u32 v36, 3, v0
    v_mul_u32_u24 v36, 1024, v36
    buffer_load_dword v19, v36, s[12:15], s93 offen sc1
    ds_read_b128 a[104:107], v180 offset:40960
    v_mfma_f32_16x16x32_bf16 v[80:83], v[116:119], v[224:227], v[80:83]
    s_and_b32 s93, s94, 127
    s_lshl_b32 s93, s93, 14
    s_lshr_b32 s86, s48, 1
    s_lshl_b32 s86, s86, 21
    s_add_u32 s93, s93, s86
    s_andn2_b32 s86, 1, s48
    s_lshl_b32 s86, s86, 9
    s_add_u32 s93, s93, s86
    v_min_u32 v37, 0, v4
    v_add3_u32 v37, v37, v3, 0
    v_and_b32 v37, 3, v37
    v_lshl_add_u32 v36, v3, 3, v37
    v_lshlrev_b32 v36, 7, v36
    buffer_load_dword v19, v36, s[20:23], s93 offen sc1
    ds_read_b128 a[168:171], v182 offset:40960
    v_mfma_f32_16x16x32_bf16 v[84:87], v[116:119], a[32:35], v[84:87]
    ds_read_b128 v[240:243], v176 offset:49152
    v_mfma_f32_16x16x32_bf16 v[88:91], v[116:119], a[96:99], v[88:91]
    ds_read_b128 v[244:247], v177 offset:49152
    v_mfma_f32_16x16x32_bf16 v[92:95], v[116:119], a[160:163], v[92:95]
    ds_read_b64_tr_b16 v[108:109], v15 offset:20480
    v_mfma_f32_16x16x32_bf16 v[44:47], v[116:119], v[24:27], v[44:47]
    ds_read_b64_tr_b16 v[110:111], v15 offset:20992
    s_waitcnt lgkmcnt(14)
    v_mfma_f32_16x16x32_bf16 v[64:67], v[96:99], v[228:231], v[64:67]
    ds_read_b64_tr_b16 v[112:113], v15 offset:24576
    v_mfma_f32_16x16x32_bf16 v[68:71], v[96:99], a[36:39], v[68:71]
    ds_read_b64_tr_b16 v[114:115], v15 offset:25088
    v_mfma_f32_16x16x32_bf16 v[72:75], v[96:99], a[100:103], v[72:75]
    ds_read_b128 v[236:239], v177 offset:40960
    v_mfma_f32_16x16x32_bf16 v[76:79], v[96:99], a[164:167], v[76:79]
    ds_read_b128 a[44:47], v179 offset:40960
    v_mfma_f32_16x16x32_bf16 v[40:43], v[96:99], v[24:27], v[40:43]
    ds_read_b128 a[108:111], v181 offset:40960
    v_mfma_f32_16x16x32_bf16 v[80:83], v[100:103], v[228:231], v[80:83]
    ds_read_b128 a[172:175], v183 offset:40960
    v_mfma_f32_16x16x32_bf16 v[84:87], v[100:103], a[36:39], v[84:87]
    ds_read_b128 v[248:251], v176 offset:57344
    v_mfma_f32_16x16x32_bf16 v[88:91], v[100:103], a[100:103], v[88:91]
    ds_read_b128 v[252:255], v177 offset:57344
    v_mfma_f32_16x16x32_bf16 v[92:95], v[100:103], a[164:167], v[92:95]
    ds_read_b64_tr_b16 v[116:117], v15 offset:28672
    v_mfma_f32_16x16x32_bf16 v[44:47], v[100:103], v[24:27], v[44:47]
    ds_read_b64_tr_b16 v[118:119], v15 offset:29184
    s_waitcnt lgkmcnt(10)
    v_dot2c_f32_bf16 v28, v224, v24
    v_dot2c_f32_bf16 v29, v224, v224
    v_dot2c_f32_bf16 v30, v225, v24
    v_dot2c_f32_bf16 v31, v225, v225
    v_dot2c_f32_bf16 v28, v226, v24
    v_dot2c_f32_bf16 v29, v226, v226
    v_dot2c_f32_bf16 v30, v227, v24
    v_dot2c_f32_bf16 v31, v227, v227
    v_dot2c_f32_bf16 v28, v228, v24
    v_dot2c_f32_bf16 v29, v228, v228
    v_dot2c_f32_bf16 v30, v229, v24
    v_dot2c_f32_bf16 v31, v229, v229
    v_dot2c_f32_bf16 v28, v230, v24
    v_dot2c_f32_bf16 v29, v230, v230
    v_dot2c_f32_bf16 v30, v231, v24
    v_dot2c_f32_bf16 v31, v231, v231
    s_waitcnt vmcnt(11)
    s_barrier
    v_mfma_f32_16x16x32_bf16 v[64:67], v[104:107], v[232:235], v[64:67]
    ds_read_b64_tr_b16 v[96:97], v14 offset:0
    v_mfma_f32_16x16x32_bf16 v[68:71], v[104:107], a[40:43], v[68:71]
    ds_read_b64_tr_b16 v[98:99], v14 offset:512
    v_mfma_f32_16x16x32_bf16 v[72:75], v[104:107], a[104:107], v[72:75]
    ds_read_b128 a[48:51], v178 offset:49152
    v_mfma_f32_16x16x32_bf16 v[76:79], v[104:107], a[168:171], v[76:79]
    ds_read_b128 a[112:115], v180 offset:49152
    v_mfma_f32_16x16x32_bf16 v[40:43], v[104:107], v[24:27], v[40:43]
    s_add_u32 m0, s90, 32768
    s_add_u32 s86, s92, s95
    ds_read_b128 a[176:179], v182 offset:49152
    v_mfma_f32_16x16x32_bf16 v[80:83], v[108:111], v[232:235], v[80:83]
    buffer_load_dwordx4 v9, s[8:11], s86 offen lds
    ds_read_b64_tr_b16 v[100:101], v14 offset:4096
    v_mfma_f32_16x16x32_bf16 v[84:87], v[108:111], a[40:43], v[84:87]
    ds_read_b64_tr_b16 v[102:103], v14 offset:4608
    v_mfma_f32_16x16x32_bf16 v[88:91], v[108:111], a[104:107], v[88:91]
    v_mfma_f32_16x16x32_bf16 v[92:95], v[108:111], a[168:171], v[92:95]
    v_mfma_f32_16x16x32_bf16 v[44:47], v[108:111], v[24:27], v[44:47]
    s_waitcnt lgkmcnt(7)
    v_mfma_f32_16x16x32_bf16 v[64:67], v[112:115], v[236:239], v[64:67]
    ds_read_b64_tr_b16 v[104:105], v14 offset:8192
    v_mfma_f32_16x16x32_bf16 v[68:71], v[112:115], a[44:47], v[68:71]
    buffer_load_dwordx4 v10, s[8:11], s86 offen offset:1024 lds
    ds_read_b64_tr_b16 v[106:107], v14 offset:8704
    v_mfma_f32_16x16x32_bf16 v[72:75], v[112:115], a[108:111], v[72:75]
    ds_read_b128 a[52:55], v179 offset:49152
    v_mfma_f32_16x16x32_bf16 v[76:79], v[112:115], a[172:175], v[76:79]
    ds_read_b128 a[116:119], v181 offset:49152
    v_mfma_f32_16x16x32_bf16 v[40:43], v[112:115], v[24:27], v[40:43]
    ds_read_b128 a[180:183], v183 offset:49152
    v_mfma_f32_16x16x32_bf16 v[80:83], v[116:119], v[236:239], v[80:83]
    ds_read_b64_tr_b16 v[108:109], v14 offset:12288
    v_mfma_f32_16x16x32_bf16 v[84:87], v[116:119], a[44:47], v[84:87]
    ds_read_b64_tr_b16 v[110:111], v14 offset:12800
    v_mfma_f32_16x16x32_bf16 v[88:91], v[116:119], a[108:111], v[88:91]
    buffer_load_dwordx4 v11, s[8:11], s86 offen offset:2048 lds
    v_mfma_f32_16x16x32_bf16 v[92:95], v[116:119], a[172:175], v[92:95]
    v_mfma_f32_16x16x32_bf16 v[44:47], v[116:119], v[24:27], v[44:47]
    s_waitcnt lgkmcnt(7)
    v_dot2c_f32_bf16 v28, v232, v24
    v_dot2c_f32_bf16 v29, v232, v232
    v_dot2c_f32_bf16 v30, v233, v24
    v_dot2c_f32_bf16 v31, v233, v233
    v_dot2c_f32_bf16 v28, v234, v24
    v_dot2c_f32_bf16 v29, v234, v234
    v_dot2c_f32_bf16 v30, v235, v24
    v_dot2c_f32_bf16 v31, v235, v235
    v_dot2c_f32_bf16 v28, v236, v24
    v_dot2c_f32_bf16 v29, v236, v236
    v_dot2c_f32_bf16 v30, v237, v24
    v_dot2c_f32_bf16 v31, v237, v237
    v_dot2c_f32_bf16 v28, v238, v24
    v_dot2c_f32_bf16 v29, v238, v238
    v_dot2c_f32_bf16 v30, v239, v24
    v_dot2c_f32_bf16 v31, v239, v239
    v_dot2c_f32_bf16 v28, v240, v24
    v_dot2c_f32_bf16 v29, v240, v240
    v_dot2c_f32_bf16 v30, v241, v24
    v_dot2c_f32_bf16 v31, v241, v241
    v_dot2c_f32_bf16 v28, v242, v24
    v_dot2c_f32_bf16 v29, v242, v242
    v_dot2c_f32_bf16 v30, v243, v24
    v_dot2c_f32_bf16 v31, v243, v243
    v_dot2c_f32_bf16 v28, v244, v24
    v_dot2c_f32_bf16 v29, v244, v244
    v_dot2c_f32_bf16 v30, v245, v24
    v_dot2c_f32_bf16 v31, v245, v245
    v_dot2c_f32_bf16 v28, v246, v24
    v_dot2c_f32_bf16 v29, v246, v246
    v_dot2c_f32_bf16 v30, v247, v24
    v_dot2c_f32_bf16 v31, v247, v247
    v_dot2c_f32_bf16 v28, v248, v24
    v_dot2c_f32_bf16 v29, v248, v248
    v_dot2c_f32_bf16 v30, v249, v24
    v_dot2c_f32_bf16 v31, v249, v249
    v_dot2c_f32_bf16 v28, v250, v24
    v_dot2c_f32_bf16 v29, v250, v250
    v_dot2c_f32_bf16 v30, v251, v24
    v_dot2c_f32_bf16 v31, v251, v251
    v_dot2c_f32_bf16 v28, v252, v24
    v_dot2c_f32_bf16 v29, v252, v252
    v_dot2c_f32_bf16 v30, v253, v24
    v_dot2c_f32_bf16 v31, v253, v253
    v_dot2c_f32_bf16 v28, v254, v24
    v_dot2c_f32_bf16 v29, v254, v254
    v_dot2c_f32_bf16 v30, v255, v24
    v_dot2c_f32_bf16 v31, v255, v255
    buffer_load_dwordx4 v12, s[8:11], s86 offen offset:3072 lds
    s_and_b32 s93, s94, 127
    s_mul_i32 s93, s93, 12288
    s_add_u32 s93, s93, 384
    v_min_u32 v36, 3, v0
    v_mul_u32_u24 v36, 3072, v36
    buffer_load_dword v19, v36, s[8:11], s93 offen sc1
    s_waitcnt vmcnt(12)
    s_barrier
    v_mfma_f32_16x16x32_bf16 v[64:67], v[96:99], v[240:243], v[64:67]
    ds_read_b64_tr_b16 v[112:113], v14 offset:16384
    v_mfma_f32_16x16x32_bf16 v[68:71], v[96:99], a[48:51], v[68:71]
    ds_read_b64_tr_b16 v[114:115], v14 offset:16896
    v_mfma_f32_16x16x32_bf16 v[72:75], v[96:99], a[112:115], v[72:75]
    ds_read_b128 a[56:59], v178 offset:57344
    v_mfma_f32_16x16x32_bf16 v[76:79], v[96:99], a[176:179], v[76:79]
    ds_read_b128 a[120:123], v180 offset:57344
    v_mfma_f32_16x16x32_bf16 v[40:43], v[96:99], v[24:27], v[40:43]
    s_add_u32 m0, s90, 49152
    s_add_u32 s86, s92, s96
    ds_read_b128 a[184:187], v182 offset:57344
    v_mfma_f32_16x16x32_bf16 v[80:83], v[100:103], v[240:243], v[80:83]
    buffer_load_dwordx4 v9, s[8:11], s86 offen lds
    ds_read_b64_tr_b16 v[116:117], v14 offset:20480
    v_mfma_f32_16x16x32_bf16 v[84:87], v[100:103], a[48:51], v[84:87]
    ds_read_b64_tr_b16 v[118:119], v14 offset:20992
    v_mfma_f32_16x16x32_bf16 v[88:91], v[100:103], a[112:115], v[88:91]
    v_mfma_f32_16x16x32_bf16 v[92:95], v[100:103], a[176:179], v[92:95]
    v_mfma_f32_16x16x32_bf16 v[44:47], v[100:103], v[24:27], v[44:47]
    s_waitcnt lgkmcnt(7)
    v_mfma_f32_16x16x32_bf16 v[64:67], v[104:107], v[244:247], v[64:67]
    ds_read_b64_tr_b16 v[96:97], v14 offset:24576
    v_add_f32 v28, v28, v30
    v_mfma_f32_16x16x32_bf16 v[68:71], v[104:107], a[52:55], v[68:71]
    buffer_load_dwordx4 v10, s[8:11], s86 offen offset:1024 lds
    ds_read_b64_tr_b16 v[98:99], v14 offset:25088
    v_add_f32 v29, v29, v31
    v_mfma_f32_16x16x32_bf16 v[72:75], v[104:107], a[116:119], v[72:75]
    ds_read_b128 a[60:63], v179 offset:57344
    v_permlane32_swap_b32 v28, v29
    v_mfma_f32_16x16x32_bf16 v[76:79], v[104:107], a[180:183], v[76:79]
    ds_read_b128 a[124:127], v181 offset:57344
    v_add_f32 v28, v28, v29
    v_mfma_f32_16x16x32_bf16 v[40:43], v[104:107], v[24:27], v[40:43]
    ds_read_b128 a[188:191], v183 offset:57344
    v_mov_b32 v30, v28
    v_mfma_f32_16x16x32_bf16 v[80:83], v[108:111], v[244:247], v[80:83]
    ds_read_b64_tr_b16 v[100:101], v14 offset:28672
    v_permlane16_swap_b32 v28, v30
    v_mfma_f32_16x16x32_bf16 v[84:87], v[108:111], a[52:55], v[84:87]
    ds_read_b64_tr_b16 v[102:103], v14 offset:29184
    v_add_f32 v28, v28, v30
    v_mfma_f32_16x16x32_bf16 v[88:91], v[108:111], a[116:119], v[88:91]
    buffer_load_dwordx4 v11, s[8:11], s86 offen offset:2048 lds
    v_mov_b32 v29, v28
    v_mfma_f32_16x16x32_bf16 v[92:95], v[108:111], a[180:183], v[92:95]
    s_nop 0
    v_permlane32_swap_b32 v28, v29
    v_mfma_f32_16x16x32_bf16 v[44:47], v[108:111], v[24:27], v[44:47]
    v_mul_f32 v28, 0xbb000000, v28
    s_waitcnt lgkmcnt(7)
    v_mfma_f32_16x16x32_bf16 v[64:67], v[112:115], v[248:251], v[64:67]
    v_mul_f32 v29, 0x3b000000, v29
    v_mfma_f32_16x16x32_bf16 v[68:71], v[112:115], a[56:59], v[68:71]
    v_fma_f32 v29, -v28, v28, v29
    v_mfma_f32_16x16x32_bf16 v[72:75], v[112:115], a[120:123], v[72:75]
    v_max_f32 v29, 0, v29
    v_mfma_f32_16x16x32_bf16 v[76:79], v[112:115], a[184:187], v[76:79]
    buffer_load_dwordx4 v12, s[8:11], s86 offen offset:3072 lds
    v_add_f32 v29, 0x3727c5ac, v29
    v_mfma_f32_16x16x32_bf16 v[40:43], v[112:115], v[24:27], v[40:43]
    v_rsq_f32 v29, v29
    v_mfma_f32_16x16x32_bf16 v[80:83], v[116:119], v[248:251], v[80:83]
    v_lshl_or_b32 v62, v133, 16, v132
    v_mfma_f32_16x16x32_bf16 v[84:87], v[116:119], a[56:59], v[84:87]
    v_lshl_or_b32 v63, v135, 16, v134
    v_mfma_f32_16x16x32_bf16 v[88:91], v[116:119], a[120:123], v[88:91]
    ds_write_b64 v144, v[28:29]
    v_mfma_f32_16x16x32_bf16 v[92:95], v[116:119], a[184:187], v[92:95]
    v_mfma_f32_16x16x32_bf16 v[44:47], v[116:119], v[24:27], v[44:47]
    s_waitcnt lgkmcnt(1)
    s_waitcnt lgkmcnt(0)
    s_barrier
    v_mfma_f32_16x16x32_bf16 v[64:67], v[96:99], v[252:255], v[64:67]
    ds_read_b64 v[52:53], v145
    v_mfma_f32_16x16x32_bf16 v[68:71], v[96:99], a[60:63], v[68:71]
    ds_read_b64 v[54:55], v146
    v_mfma_f32_16x16x32_bf16 v[72:75], v[96:99], a[124:127], v[72:75]
    ds_read_b64 v[56:57], v147
    v_mfma_f32_16x16x32_bf16 v[76:79], v[96:99], a[188:191], v[76:79]
    ds_read_b64 v[58:59], v148
    v_mfma_f32_16x16x32_bf16 v[40:43], v[96:99], v[24:27], v[40:43]
    v_mfma_f32_16x16x32_bf16 v[80:83], v[100:103], v[252:255], v[80:83]
    v_mfma_f32_16x16x32_bf16 v[84:87], v[100:103], a[60:63], v[84:87]
    v_mfma_f32_16x16x32_bf16 v[88:91], v[100:103], a[124:127], v[88:91]
    v_mfma_f32_16x16x32_bf16 v[92:95], v[100:103], a[188:191], v[92:95]
    v_mfma_f32_16x16x32_bf16 v[44:47], v[100:103], v[24:27], v[44:47]
    s_waitcnt lgkmcnt(3)
    s_nop 1
    v_pk_fma_f32 v[64:65], v[40:41], v[52:53], v[64:65] op_sel_hi:[1,0,1]
    s_add_u32 m0, s90, 65536
    s_add_u32 s86, s92, s97
    buffer_load_dwordx4 v9, s[8:11], s86 offen lds
    buffer_load_dwordx4 v10, s[8:11], s86 offen offset:1024 lds
    v_pk_fma_f32 v[66:67], v[42:43], v[52:53], v[66:67] op_sel_hi:[1,0,1]
    s_waitcnt lgkmcnt(2)
    v_pk_fma_f32 v[68:69], v[40:41], v[54:55], v[68:69] op_sel_hi:[1,0,1]
    v_pk_fma_f32 v[70:71], v[42:43], v[54:55], v[70:71] op_sel_hi:[1,0,1]
    s_waitcnt lgkmcnt(1)
    v_pk_fma_f32 v[72:73], v[40:41], v[56:57], v[72:73] op_sel_hi:[1,0,1]
    v_pk_fma_f32 v[74:75], v[42:43], v[56:57], v[74:75] op_sel_hi:[1,0,1]
    s_waitcnt lgkmcnt(0)
    v_pk_fma_f32 v[76:77], v[40:41], v[58:59], v[76:77] op_sel_hi:[1,0,1]
    v_pk_fma_f32 v[78:79], v[42:43], v[58:59], v[78:79] op_sel_hi:[1,0,1]
    buffer_load_dwordx4 v11, s[8:11], s86 offen offset:2048 lds
    v_pk_mul_f32 v[64:65], v[64:65], v[52:53] op_sel:[0,1] op_sel_hi:[1,1]
    v_pk_mul_f32 v[66:67], v[66:67], v[52:53] op_sel:[0,1] op_sel_hi:[1,1]
    v_pk_mul_f32 v[68:69], v[68:69], v[54:55] op_sel:[0,1] op_sel_hi:[1,1]
    v_pk_mul_f32 v[70:71], v[70:71], v[54:55] op_sel:[0,1] op_sel_hi:[1,1]
    v_pk_mul_f32 v[72:73], v[72:73], v[56:57] op_sel:[0,1] op_sel_hi:[1,1]
    v_pk_mul_f32 v[74:75], v[74:75], v[56:57] op_sel:[0,1] op_sel_hi:[1,1]
    v_pk_mul_f32 v[76:77], v[76:77], v[58:59] op_sel:[0,1] op_sel_hi:[1,1]
    v_pk_mul_f32 v[78:79], v[78:79], v[58:59] op_sel:[0,1] op_sel_hi:[1,1]
    v_cvt_pk_bf16_f32 v112, v64, v65
    v_cvt_pk_bf16_f32 v113, v66, v67
    v_cvt_pk_bf16_f32 v114, v68, v69
    v_cvt_pk_bf16_f32 v115, v70, v71
    v_cvt_pk_bf16_f32 v116, v72, v73
    v_cvt_pk_bf16_f32 v117, v74, v75
    v_cvt_pk_bf16_f32 v118, v76, v77
    v_cvt_pk_bf16_f32 v119, v78, v79
    v_mfma_f32_16x16x16_bf16 v[64:67], v[62:63], v[112:113], 0
    v_mfma_f32_16x16x16_bf16 v[68:71], v[62:63], v[114:115], 0
    v_mfma_f32_16x16x16_bf16 v[72:75], v[62:63], v[116:117], 0
    v_mfma_f32_16x16x16_bf16 v[76:79], v[62:63], v[118:119], 0
    buffer_load_dwordx4 v12, s[8:11], s86 offen offset:3072 lds
    v_pk_fma_f32 v[80:81], v[44:45], v[52:53], v[80:81] op_sel_hi:[1,0,1]
    v_pk_fma_f32 v[82:83], v[46:47], v[52:53], v[82:83] op_sel_hi:[1,0,1]
    v_pk_fma_f32 v[84:85], v[44:45], v[54:55], v[84:85] op_sel_hi:[1,0,1]
    v_pk_fma_f32 v[86:87], v[46:47], v[54:55], v[86:87] op_sel_hi:[1,0,1]
    v_pk_fma_f32 v[88:89], v[44:45], v[56:57], v[88:89] op_sel_hi:[1,0,1]
    v_pk_fma_f32 v[90:91], v[46:47], v[56:57], v[90:91] op_sel_hi:[1,0,1]
    v_pk_fma_f32 v[92:93], v[44:45], v[58:59], v[92:93] op_sel_hi:[1,0,1]
    v_pk_fma_f32 v[94:95], v[46:47], v[58:59], v[94:95] op_sel_hi:[1,0,1]
    v_pk_mul_f32 v[80:81], v[80:81], v[52:53] op_sel:[0,1] op_sel_hi:[1,1]
    v_pk_mul_f32 v[82:83], v[82:83], v[52:53] op_sel:[0,1] op_sel_hi:[1,1]
    v_pk_mul_f32 v[84:85], v[84:85], v[54:55] op_sel:[0,1] op_sel_hi:[1,1]
    v_pk_mul_f32 v[86:87], v[86:87], v[54:55] op_sel:[0,1] op_sel_hi:[1,1]
    v_pk_mul_f32 v[88:89], v[88:89], v[56:57] op_sel:[0,1] op_sel_hi:[1,1]
    v_pk_mul_f32 v[90:91], v[90:91], v[56:57] op_sel:[0,1] op_sel_hi:[1,1]
    v_pk_mul_f32 v[92:93], v[92:93], v[58:59] op_sel:[0,1] op_sel_hi:[1,1]
    v_pk_mul_f32 v[94:95], v[94:95], v[58:59] op_sel:[0,1] op_sel_hi:[1,1]
    v_cvt_pk_bf16_f32 v96, v80, v81
    v_cvt_pk_bf16_f32 v97, v82, v83
    v_cvt_pk_bf16_f32 v98, v84, v85
    v_cvt_pk_bf16_f32 v99, v86, v87
    s_add_u32 m0, s90, 81920
    s_add_u32 s86, s92, s50
    v_cvt_pk_bf16_f32 v100, v88, v89
    v_cvt_pk_bf16_f32 v101, v90, v91
    v_cvt_pk_bf16_f32 v102, v92, v93
    v_cvt_pk_bf16_f32 v103, v94, v95
    buffer_load_dwordx4 v9, s[8:11], s86 offen lds
    v_mfma_f32_16x16x16_bf16 v[160:163], v[96:97], v[60:61], 0
    v_mfma_f32_16x16x16_bf16 v[164:167], v[98:99], v[60:61], 0
    v_mfma_f32_16x16x16_bf16 v[168:171], v[100:101], v[60:61], 0
    v_mfma_f32_16x16x16_bf16 v[172:175], v[102:103], v[60:61], 0
    v_max3_f32 v120, v64, v65, v66
    v_max3_f32 v121, -v64, -v65, -v66
    v_max3_f32 v122, v68, v69, v70
    v_max3_f32 v123, -v68, -v69, -v70
    v_max3_f32 v124, v72, v73, v74
    v_max3_f32 v125, -v72, -v73, -v74
    v_max3_f32 v126, v76, v77, v78
    v_max3_f32 v127, -v76, -v77, -v78
    v_max_f32 v120, v120, v67
    v_max_f32_e64 v121, v121, -v67
    v_max_f32 v122, v122, v71
    v_max_f32_e64 v123, v123, -v71
    v_max_f32 v124, v124, v75
    v_max_f32_e64 v125, v125, -v75
    v_max_f32 v126, v126, v79
    v_max_f32_e64 v127, v127, -v79
    buffer_load_dwordx4 v10, s[8:11], s86 offen offset:1024 lds
    v_permlane32_swap_b32 v120, v121
    v_permlane32_swap_b32 v122, v123
    v_permlane32_swap_b32 v124, v125
    v_permlane32_swap_b32 v126, v127
    v_max_f32 v120, v120, v121
    v_max_f32 v122, v122, v123
    v_max_f32 v124, v124, v125
    v_max_f32 v126, v126, v127
    v_permlane16_swap_b32 v120, v122
    s_nop 0
    v_permlane16_swap_b32 v124, v126
    v_max_f32 v120, v120, v122
    v_max_f32 v124, v124, v126
    v_mul_f32 v120, s80, v120
    v_mul_f32 v124, s80, v124
    v_mov_b32 v122, v120
    v_mov_b32 v126, v124
    s_nop 0
    v_permlane16_swap_b32 v120, v122
    buffer_load_dwordx4 v11, s[8:11], s86 offen offset:2048 lds
    v_permlane16_swap_b32 v124, v126
    v_mov_b32 v121, v120
    v_mov_b32 v123, v122
    v_mov_b32 v125, v124
    v_mov_b32 v127, v126
    v_permlane32_swap_b32 v120, v121
    v_permlane32_swap_b32 v122, v123
    v_permlane32_swap_b32 v124, v125
    v_permlane32_swap_b32 v126, v127
    v_pk_fma_f32 v[80:81], v[64:65], s[80:81], v[120:121] op_sel_hi:[1,1,0] neg_lo:[0,0,1] neg_hi:[0,0,1]
    v_pk_fma_f32 v[82:83], v[66:67], s[80:81], v[120:121] op_sel_hi:[1,1,0] neg_lo:[0,0,1] neg_hi:[0,0,1]
    v_pk_fma_f32 v[64:65], v[64:65], s[80:81], v[120:121] op_sel:[0,0,1] op_sel_hi:[1,1,1] neg_lo:[1,0,1] neg_hi:[1,0,1]
    v_pk_fma_f32 v[66:67], v[66:67], s[80:81], v[120:121] op_sel:[0,0,1] op_sel_hi:[1,1,1] neg_lo:[1,0,1] neg_hi:[1,0,1]
    v_pk_fma_f32 v[84:85], v[68:69], s[80:81], v[122:123] op_sel_hi:[1,1,0] neg_lo:[0,0,1] neg_hi:[0,0,1]
    v_pk_fma_f32 v[86:87], v[70:71], s[80:81], v[122:123] op_sel_hi:[1,1,0] neg_lo:[0,0,1] neg_hi:[0,0,1]
    v_pk_fma_f32 v[68:69], v[68:69], s[80:81], v[122:123] op_sel:[0,0,1] op_sel_hi:[1,1,1] neg_lo:[1,0,1] neg_hi:[1,0,1]
    v_pk_fma_f32 v[70:71], v[70:71], s[80:81], v[122:123] op_sel:[0,0,1] op_sel_hi:[1,1,1] neg_lo:[1,0,1] neg_hi:[1,0,1]
    v_pk_fma_f32 v[88:89], v[72:73], s[80:81], v[124:125] op_sel_hi:[1,1,0] neg_lo:[0,0,1] neg_hi:[0,0,1]
    v_pk_fma_f32 v[90:91], v[74:75], s[80:81], v[124:125] op_sel_hi:[1,1,0] neg_lo:[0,0,1] neg_hi:[0,0,1]
    buffer_load_dwordx4 v12, s[8:11], s86 offen offset:3072 lds
    v_pk_fma_f32 v[72:73], v[72:73], s[80:81], v[124:125] op_sel:[0,0,1] op_sel_hi:[1,1,1] neg_lo:[1,0,1] neg_hi:[1,0,1]
    v_pk_fma_f32 v[74:75], v[74:75], s[80:81], v[124:125] op_sel:[0,0,1] op_sel_hi:[1,1,1] neg_lo:[1,0,1] neg_hi:[1,0,1]
    v_pk_fma_f32 v[92:93], v[76:77], s[80:81], v[126:127] op_sel_hi:[1,1,0] neg_lo:[0,0,1] neg_hi:[0,0,1]
    v_pk_fma_f32 v[94:95], v[78:79], s[80:81], v[126:127] op_sel_hi:[1,1,0] neg_lo:[0,0,1] neg_hi:[0,0,1]
    buffer_load_dwordx2 v[186:187], v184, s[44:47], 0 offen sc1
    v_pk_fma_f32 v[76:77], v[76:77], s[80:81], v[126:127] op_sel:[0,0,1] op_sel_hi:[1,1,1] neg_lo:[1,0,1] neg_hi:[1,0,1]
    v_pk_fma_f32 v[78:79], v[78:79], s[80:81], v[126:127] op_sel:[0,0,1] op_sel_hi:[1,1,1] neg_lo:[1,0,1] neg_hi:[1,0,1]
    v_exp_f32 v80, v80
    s_mul_i32 s93, s53, 17
    s_add_u32 s93, s93, 128
    v_min_u32 v36, 16, v0
    v_add_lshl_u32 v36, v36, s93, 7
    buffer_load_dword v19, v36, s[32:35], s0 offen sc1
    v_exp_f32 v64, v64
    v_exp_f32 v81, v81
    s_mul_i32 s93, s53, 16
    v_min_u32 v36, 15, v0
    v_add_lshl_u32 v36, v36, s93, 7
    buffer_load_dword v19, v36, s[32:35], s0 offen sc1
    v_exp_f32 v65, v65
    v_exp_f32 v82, v82
    s_and_b32 s93, s94, 127
    s_lshl_b32 s93, s93, 14
    s_lshr_b32 s86, s48, 1
    s_lshl_b32 s86, s86, 21
    s_add_u32 s93, s93, s86
    s_andn2_b32 s86, 1, s48
    s_lshl_b32 s86, s86, 9
    s_add_u32 s93, s93, s86
    v_min_u32 v37, 0, v4
    v_add3_u32 v37, v37, v3, 1
    v_and_b32 v37, 3, v37
    v_lshl_add_u32 v36, v3, 3, v37
    v_lshlrev_b32 v36, 7, v36
    buffer_load_dword v19, v36, s[20:23], s93 offen sc1
    v_exp_f32 v66, v66
    v_exp_f32 v83, v83
    v_exp_f32 v67, v67
    v_exp_f32 v84, v84
    v_exp_f32 v68, v68
    v_exp_f32 v85, v85
    v_exp_f32 v69, v69
    v_exp_f32 v86, v86
    v_exp_f32 v70, v70
    v_exp_f32 v87, v87
    v_exp_f32 v71, v71
    v_exp_f32 v88, v88
    v_exp_f32 v72, v72
    v_exp_f32 v89, v89
    v_exp_f32 v73, v73
    v_exp_f32 v90, v90
    v_exp_f32 v74, v74
    v_exp_f32 v91, v91
    v_exp_f32 v75, v75
    v_exp_f32 v92, v92
    v_exp_f32 v76, v76
    v_exp_f32 v93, v93
    v_exp_f32 v77, v77
    v_exp_f32 v94, v94
    v_exp_f32 v78, v78
    v_exp_f32 v95, v95
    v_exp_f32 v79, v79
    v_pk_add_f32 v[128:129], v[80:81], v[82:83]
    v_pk_add_f32 v[130:131], v[64:65], v[66:67]
    v_pk_add_f32 v[132:133], v[84:85], v[86:87]
    v_pk_add_f32 v[134:135], v[68:69], v[70:71]
    v_pk_add_f32 v[136:137], v[88:89], v[90:91]
    v_pk_add_f32 v[138:139], v[72:73], v[74:75]
    v_pk_add_f32 v[140:141], v[92:93], v[94:95]
    v_pk_add_f32 v[142:143], v[76:77], v[78:79]
    v_add_f32 v120, v128, v129
    v_add_f32 v121, v130, v131
    v_add_f32 v122, v132, v133
    v_add_f32 v123, v134, v135
    v_add_f32 v124, v136, v137
    v_add_f32 v125, v138, v139
    v_add_f32 v126, v140, v141
    v_add_f32 v127, v142, v143
    v_permlane32_swap_b32 v120, v121
    v_permlane32_swap_b32 v122, v123
    v_permlane32_swap_b32 v124, v125
    v_permlane32_swap_b32 v126, v127
    v_add_f32 v120, v120, v121
    v_add_f32 v122, v122, v123
    v_add_f32 v124, v124, v125
    v_add_f32 v126, v126, v127
    v_permlane16_swap_b32 v120, v122
    s_nop 0
    v_permlane16_swap_b32 v124, v126
    v_add_f32 v120, v120, v122
    v_add_f32 v124, v124, v126
    v_rcp_f32 v120, v120
    v_rcp_f32 v124, v124
    v_mov_b32 v122, v120
    v_mov_b32 v126, v124
    s_nop 0
    v_permlane16_swap_b32 v120, v122
    v_permlane16_swap_b32 v124, v126
    v_mov_b32 v121, v120
    v_mov_b32 v123, v122
    v_mov_b32 v125, v124
    v_mov_b32 v127, v126
    v_permlane32_swap_b32 v120, v121
    v_permlane32_swap_b32 v122, v123
    v_permlane32_swap_b32 v124, v125
    v_permlane32_swap_b32 v126, v127
    v_pk_mul_f32 v[80:81], v[80:81], v[120:121] op_sel_hi:[1,0]
    v_pk_mul_f32 v[64:65], v[64:65], v[120:121] op_sel:[0,1] op_sel_hi:[1,1]
    v_pk_mul_f32 v[82:83], v[82:83], v[120:121] op_sel_hi:[1,0]
    v_pk_mul_f32 v[66:67], v[66:67], v[120:121] op_sel:[0,1] op_sel_hi:[1,1]
    v_pk_mul_f32 v[84:85], v[84:85], v[122:123] op_sel_hi:[1,0]
    v_pk_mul_f32 v[68:69], v[68:69], v[122:123] op_sel:[0,1] op_sel_hi:[1,1]
    v_pk_mul_f32 v[86:87], v[86:87], v[122:123] op_sel_hi:[1,0]
    v_pk_mul_f32 v[70:71], v[70:71], v[122:123] op_sel:[0,1] op_sel_hi:[1,1]
    v_pk_mul_f32 v[88:89], v[88:89], v[124:125] op_sel_hi:[1,0]
    v_pk_mul_f32 v[72:73], v[72:73], v[124:125] op_sel:[0,1] op_sel_hi:[1,1]
    v_pk_mul_f32 v[90:91], v[90:91], v[124:125] op_sel_hi:[1,0]
    v_pk_mul_f32 v[74:75], v[74:75], v[124:125] op_sel:[0,1] op_sel_hi:[1,1]
    v_pk_mul_f32 v[92:93], v[92:93], v[126:127] op_sel_hi:[1,0]
    v_pk_mul_f32 v[76:77], v[76:77], v[126:127] op_sel:[0,1] op_sel_hi:[1,1]
    v_pk_mul_f32 v[94:95], v[94:95], v[126:127] op_sel_hi:[1,0]
    v_pk_mul_f32 v[78:79], v[78:79], v[126:127] op_sel:[0,1] op_sel_hi:[1,1]
    v_cvt_pk_bf16_f32 v80, v80, v81
    v_cvt_pk_bf16_f32 v81, v82, v83
    v_cvt_pk_bf16_f32 v84, v84, v85
    v_cvt_pk_bf16_f32 v85, v86, v87
    v_cvt_pk_bf16_f32 v88, v88, v89
    v_cvt_pk_bf16_f32 v89, v90, v91
    v_cvt_pk_bf16_f32 v92, v92, v93
    v_cvt_pk_bf16_f32 v93, v94, v95
    v_cvt_pk_bf16_f32 v64, v64, v65
    v_cvt_pk_bf16_f32 v65, v66, v67
    v_cvt_pk_bf16_f32 v68, v68, v69
    v_cvt_pk_bf16_f32 v69, v70, v71
    v_cvt_pk_bf16_f32 v72, v72, v73
    v_cvt_pk_bf16_f32 v73, v74, v75
    v_cvt_pk_bf16_f32 v76, v76, v77
    v_cvt_pk_bf16_f32 v77, v78, v79
    v_mfma_f32_16x16x16_bf16 v[128:131], v[80:81], v[60:61], 0
    v_mfma_f32_16x16x16_bf16 v[132:135], v[84:85], v[60:61], 0
    v_mfma_f32_16x16x16_bf16 v[136:139], v[88:89], v[60:61], 0
    v_mfma_f32_16x16x16_bf16 v[140:143], v[92:93], v[60:61], 0
    v_mfma_f32_16x16x16_bf16 v[144:147], v[64:65], v[60:61], 0
    v_mfma_f32_16x16x16_bf16 v[148:151], v[68:69], v[60:61], 0
    v_mfma_f32_16x16x16_bf16 v[152:155], v[72:73], v[60:61], 0
    v_mfma_f32_16x16x16_bf16 v[156:159], v[76:77], v[60:61], 0
    v_cvt_pk_bf16_f32 v104, v160, v161
    v_cvt_pk_bf16_f32 v105, v162, v163
    v_cvt_pk_bf16_f32 v106, v164, v165
    v_cvt_pk_bf16_f32 v107, v166, v167
    v_cvt_pk_bf16_f32 v108, v168, v169
    v_cvt_pk_bf16_f32 v109, v170, v171
    v_cvt_pk_bf16_f32 v110, v172, v173
    v_cvt_pk_bf16_f32 v111, v174, v175
    v_cvt_pk_bf16_f32 v64, v128, v129
    v_cvt_pk_bf16_f32 v65, v130, v131
    v_cvt_pk_bf16_f32 v66, v132, v133
    v_cvt_pk_bf16_f32 v67, v134, v135
    v_cvt_pk_bf16_f32 v68, v136, v137
    v_cvt_pk_bf16_f32 v69, v138, v139
    v_cvt_pk_bf16_f32 v70, v140, v141
    v_cvt_pk_bf16_f32 v71, v142, v143
    v_cvt_pk_bf16_f32 v72, v144, v145
    v_cvt_pk_bf16_f32 v73, v146, v147
    v_cvt_pk_bf16_f32 v74, v148, v149
    v_cvt_pk_bf16_f32 v75, v150, v151
    v_cvt_pk_bf16_f32 v76, v152, v153
    v_cvt_pk_bf16_f32 v77, v154, v155
    v_cvt_pk_bf16_f32 v78, v156, v157
    v_cvt_pk_bf16_f32 v79, v158, v159
    v_mfma_f32_16x16x32_bf16 v[80:83], v[64:67], v[104:107], 0
    v_mfma_f32_16x16x32_bf16 v[88:91], v[64:67], v[24:27], 0
    v_mfma_f32_16x16x32_bf16 v[84:87], v[72:75], v[104:107], 0
    v_mfma_f32_16x16x32_bf16 v[92:95], v[72:75], v[24:27], 0
    v_mfma_f32_16x16x32_bf16 v[80:83], v[68:71], v[108:111], v[80:83]
    v_mfma_f32_16x16x32_bf16 v[88:91], v[68:71], v[24:27], v[88:91]
    v_mfma_f32_16x16x32_bf16 v[84:87], v[76:79], v[108:111], v[84:87]
    v_mfma_f32_16x16x32_bf16 v[92:95], v[76:79], v[24:27], v[92:95]
    s_lshr_b32 s63, s71, 3
    s_mul_i32 s63, s63, 34816
    s_and_b32 s62, s71, 7
    s_mul_i32 s62, s62, 2176
    s_add_u32 s63, s63, s62
    s_add_u32 s63, s63, 16384
    s_mul_i32 s62, s52, 139264
    s_add_u32 s62, s62, s63
    s_waitcnt vmcnt(3)
    v_sad_u8 v185, v186, 0, 0
    v_sad_u8 v185, v187, 0, v185
    v_cmp_gt_u32 vcc, 32, v185
    s_cbranch_vccnz Lrt_1
Lrtd_2:
    v_or_b32 v186, v186, v187
    v_and_b32 v186, 0x20202020, v186
    v_cmp_eq_u32 vcc, 1, v3
    v_readlane_b32 s55, v186, s48
    v_lshlrev_b32 v18, 5, v4
    v_lshl_add_u32 v18, v3, 4, v18
    v_cndmask_b32 v88, v88, v92, vcc
    v_cndmask_b32 v89, v89, v93, vcc
    v_cndmask_b32 v90, v90, v94, vcc
    v_cndmask_b32 v91, v91, v95, vcc
    s_cmp_eq_u32 s55, 0
    s_cbranch_scc1 L_slow
    buffer_store_dwordx4 v[80:83], v1, s[32:35], s62 offen
    buffer_store_dwordx4 v[84:87], v1, s[32:35], s62 offen offset:1024
    s_mov_b32 exec_lo, 0x00030003
    s_mov_b32 exec_hi, 0x00030003
    buffer_store_dwordx4 v[88:91], v18, s[32:35], s62 offen offset:2048
    s_mov_b64 exec, -1
    s_and_b32 s59, s94, 127
    s_min_u32 s59, s59, 111
    s_mul_i32 s93, s59, 4
    v_min_u32 v36, 3, v0
    v_add_lshl_u32 v36, v36, s93, 7
    buffer_load_dword v19, v36, s[32:35], s3 offen sc1
    s_waitcnt lgkmcnt(0)
    s_barrier
    ds_read_b64_tr_b16 v[96:97], v13 offset:0
    ds_read_b64_tr_b16 v[98:99], v13 offset:512
    ds_read_b64_tr_b16 v[100:101], v13 offset:4096
    ds_read_b64_tr_b16 v[102:103], v13 offset:4608
    ds_read_b64_tr_b16 v[104:105], v13 offset:8192
    ds_read_b64_tr_b16 v[106:107], v13 offset:8704
    s_waitcnt lgkmcnt(4)
    v_mfma_f32_16x16x32_bf16 v[64:67], v[96:99], v[192:195], 0
    s_bfe_u32 s91, s71, 327680
    ds_read_b64_tr_b16 v[108:109], v13 offset:12288
    ds_read_b64_tr_b16 v[110:111], v13 offset:12800
    v_mfma_f32_16x16x32_bf16 v[68:71], v[96:99], a[0:3], 0
    s_lshl_b32 s91, s91, 4
    s_add_u32 s91, s91, s3
    s_add_u32 s91, s91, 49152
    v_mfma_f32_16x16x32_bf16 v[72:75], v[96:99], a[64:67], 0
    v_and_b32 v176, 3, v0
    v_lshl_add_u32 v176, v176, 2, s91
    v_mfma_f32_16x16x32_bf16 v[76:79], v[96:99], a[128:131], 0
    s_and_b32 s60, s52, 3
    s_lshl_b32 s61, s60, 2
    s_add_u32 s91, s91, s61
    v_mfma_f32_16x16x32_bf16 v[40:43], v[96:99], v[24:27], 0
    s_waitcnt lgkmcnt(4)
    v_lshrrev_b32 v36, 5, v0
    v_bfe_u32 v37, v0, 3, 2
    v_mfma_f32_16x16x32_bf16 v[64:67], v[100:103], v[196:199], v[64:67]
    ds_read_b64_tr_b16 v[96:97], v13 offset:16384
    ds_read_b64_tr_b16 v[98:99], v13 offset:16896
    v_mfma_f32_16x16x32_bf16 v[68:71], v[100:103], a[4:7], v[68:71]
    v_lshl_add_u32 v36, v36, 3, v37
    v_mul_u32_u24 v36, 4096, v36
    v_mfma_f32_16x16x32_bf16 v[72:75], v[100:103], a[68:71], v[72:75]
    v_xor_b32 v37, v4, v0
    v_and_b32 v37, 7, v37
    v_mfma_f32_16x16x32_bf16 v[76:79], v[100:103], a[132:135], v[76:79]
    v_lshl_add_u32 v5, v37, 4, v36
    v_xor_b32 v37, 64, v5
    v_mfma_f32_16x16x32_bf16 v[40:43], v[100:103], v[24:27], v[40:43]
    s_waitcnt lgkmcnt(4)
    v_add_u32 v6, 64512, v37
    v_add_u32 v7, 14336, v5
    v_add_u32 v8, 78848, v37
    v_lshrrev_b32 v36, 1, v3
    v_xor_b32 v36, v36, v4
    v_lshlrev_b32 v36, 4, v36
    v_lshl_add_u32 v36, v3, 7, v36
    s_lshl_b32 s88, s54, 13
    s_and_b32 s93, s54, 1
    s_lshl_b32 s93, s93, 11
    s_add_u32 s93, s93, s88
    v_add_u32 v20, s93, v36
    v_xor_b32 v21, 64, v20
    v_xor_b32 v22, 2048, v20
    v_xor_b32 v23, 2048, v21
    s_lshr_b32 s87, s58, 1
    s_lshl_b32 s87, s87, 17
    s_andn2_b32 s93, 1, s48
    s_lshl_b32 s93, s93, 9
    s_add_u32 s87, s87, s93
    s_lshl_b32 s93, s54, 10
    s_add_u32 s87, s87, s93
    s_mov_b64 exec, 2
    s_waitcnt vmcnt(1)
    buffer_store_dword v0, off, s[32:35], s91 offset:0
    s_mov_b64 exec, -1
    v_mfma_f32_16x16x32_bf16 v[64:67], v[104:107], v[200:203], v[64:67]
    v_lshrrev_b32 v36, 3, v0
    v_lshlrev_b32 v37, 1, v4
    v_xor_b32 v37, v37, v0
    v_and_b32 v37, 7, v37
    v_mul_u32_u24 v36, 1024, v36
    v_lshl_add_u32 v9, v37, 4, v36
    v_add_u32 v10, 7168, v9
    v_add_u32 v11, 14336, v9
    v_add_u32 v12, 21504, v9
    s_lshl_b32 s89, s53, 7
    s_mul_i32 s93, s54, 32768
    s_add_u32 s89, s89, s93
    s_add_u32 m0, s90, 98304
    s_add_u32 s86, s89, 0
    v_mfma_f32_16x16x32_bf16 v[68:71], v[104:107], a[8:11], v[68:71]
    buffer_load_dwordx4 v9, s[12:15], s86 offen lds
    v_mfma_f32_16x16x32_bf16 v[72:75], v[104:107], a[72:75], v[72:75]
    s_mul_i32 s61, s48, 557056
    ds_read_b64_tr_b16 v[100:101], v13 offset:20480
    ds_read_b64_tr_b16 v[102:103], v13 offset:20992
    v_mfma_f32_16x16x32_bf16 v[76:79], v[104:107], a[136:139], v[76:79]
    s_add_u32 s61, s61, s63
    s_lshl_b32 s59, s60, 8
    v_lshl_add_u32 v178, v3, 4, s59
    v_mfma_f32_16x16x32_bf16 v[40:43], v[104:107], v[24:27], v[40:43]
    s_waitcnt lgkmcnt(4)
    v_lshl_add_u32 v179, v4, 3, v178
    v_lshl_add_u32 v178, v4, 10, v178
    v_mfma_f32_16x16x32_bf16 v[64:67], v[108:111], v[204:207], v[64:67]
    buffer_load_dwordx4 v10, s[12:15], s86 offen offset:1024 lds
    v_mfma_f32_16x16x32_bf16 v[68:71], v[108:111], a[12:15], v[68:71]
    s_lshl_b32 s59, s60, 4
    ds_read_b64_tr_b16 v[104:105], v13 offset:24576
    ds_read_b64_tr_b16 v[106:107], v13 offset:25088
    v_mfma_f32_16x16x32_bf16 v[72:75], v[108:111], a[76:79], v[72:75]
    s_add_u32 s59, s59, 1024
    v_lshl_add_u32 v180, v3, 3, s59
    v_cmp_lt_u32 vcc, 31, v0
    v_mfma_f32_16x16x32_bf16 v[76:79], v[108:111], a[140:143], v[76:79]
    buffer_load_dwordx4 v11, s[12:15], s86 offen offset:2048 lds
    v_mfma_f32_16x16x32_bf16 v[40:43], v[108:111], v[24:27], v[40:43]
    s_waitcnt lgkmcnt(4)
    v_lshlrev_b32 v181, 1, v180
    s_mul_i32 s62, s71, 9216
    v_mfma_f32_16x16x32_bf16 v[64:67], v[96:99], v[208:211], v[64:67]
    ds_read_b64_tr_b16 v[108:109], v13 offset:28672
    ds_read_b64_tr_b16 v[110:111], v13 offset:29184
    v_mfma_f32_16x16x32_bf16 v[68:71], v[96:99], a[16:19], v[68:71]
    v_cndmask_b32 v179, v179, v180, vcc
    v_cndmask_b32 v178, v178, v181, vcc
    v_mfma_f32_16x16x32_bf16 v[72:75], v[96:99], a[80:83], v[72:75]
    buffer_load_dwordx4 v12, s[12:15], s86 offen offset:3072 lds
    v_mfma_f32_16x16x32_bf16 v[76:79], v[96:99], a[144:147], v[76:79]
    s_add_u32 s62, s62, 10485760
    s_mul_i32 s59, s48, 1152
    s_add_u32 s92, s59, s62
    v_mfma_f32_16x16x32_bf16 v[40:43], v[96:99], v[24:27], v[40:43]
    s_waitcnt lgkmcnt(4)
    s_lshr_b32 s4, s71, 1
    s_lshl_b32 s4, s4, 10
    v_mfma_f32_16x16x32_bf16 v[64:67], v[100:103], v[212:215], v[64:67]
    s_add_u32 m0, s90, 114688
    s_add_u32 s86, s89, 131072
    ds_read_b64_tr_b16 v[96:97], v13 offset:32768
    v_mfma_f32_16x16x32_bf16 v[68:71], v[100:103], a[20:23], v[68:71]
    buffer_load_dwordx4 v9, s[12:15], s86 offen lds
    v_mfma_f32_16x16x32_bf16 v[72:75], v[100:103], a[84:87], v[72:75]
    s_and_b32 s5, s71, 1
    ds_read_b64_tr_b16 v[98:99], v13 offset:33280
    s_lshl_b32 s5, s5, 3
    v_mfma_f32_16x16x32_bf16 v[76:79], v[100:103], a[148:151], v[76:79]
    s_add_u32 s4, s4, s5
    s_mul_i32 s5, s52, 139264
    s_add_u32 s4, s4, s5
    v_mfma_f32_16x16x32_bf16 v[40:43], v[100:103], v[24:27], v[40:43]
    s_waitcnt lgkmcnt(4)
    s_add_u32 s36, s54, 0
    s_and_b32 s36, s36, 3
    buffer_load_dword v177, v176, s[32:35], 0 offen sc1
    v_mfma_f32_16x16x32_bf16 v[64:67], v[104:107], v[216:219], v[64:67]
    s_mul_i32 s36, s36, 34816
    ds_read_b64_tr_b16 v[100:101], v13 offset:36864
    ds_read_b64_tr_b16 v[102:103], v13 offset:37376
    v_mfma_f32_16x16x32_bf16 v[68:71], v[104:107], a[24:27], v[68:71]
    buffer_load_dwordx4 v10, s[12:15], s86 offen offset:1024 lds
    v_mfma_f32_16x16x32_bf16 v[72:75], v[104:107], a[88:91], v[72:75]
    s_add_u32 s36, s36, s4
    s_add_u32 s37, s54, 1
    s_and_b32 s37, s37, 3
    v_mfma_f32_16x16x32_bf16 v[76:79], v[104:107], a[152:155], v[76:79]
    s_mul_i32 s37, s37, 34816
    s_add_u32 s37, s37, s4
    s_add_u32 s38, s54, 2
    v_mfma_f32_16x16x32_bf16 v[40:43], v[104:107], v[24:27], v[40:43]
    s_waitcnt lgkmcnt(4)
    s_and_b32 s38, s38, 3
    s_mul_i32 s38, s38, 34816
    v_mfma_f32_16x16x32_bf16 v[64:67], v[108:111], v[220:223], v[64:67]
    buffer_load_dwordx4 v11, s[12:15], s86 offen offset:2048 lds
    v_mfma_f32_16x16x32_bf16 v[68:71], v[108:111], a[28:31], v[68:71]
    s_add_u32 s38, s38, s4
    ds_read_b64_tr_b16 v[104:105], v13 offset:40960
    ds_read_b64_tr_b16 v[106:107], v13 offset:41472
    v_mfma_f32_16x16x32_bf16 v[72:75], v[108:111], a[92:95], v[72:75]
    s_add_u32 s39, s54, 3
    s_and_b32 s39, s39, 3
    s_mul_i32 s39, s39, 34816
    v_mfma_f32_16x16x32_bf16 v[76:79], v[108:111], a[156:159], v[76:79]
    s_add_u32 s39, s39, s4
    s_bfe_u32 s4, s52, 131072
    s_lshl_b32 s4, s4, 7
    v_mfma_f32_16x16x32_bf16 v[40:43], v[108:111], v[24:27], v[40:43]
    s_waitcnt lgkmcnt(4)
    s_add_u32 s4, s4, s3
    s_add_u32 s4, s4, 49664
    v_mfma_f32_16x16x32_bf16 v[64:67], v[96:99], v[224:227], v[64:67]
    buffer_load_dwordx4 v12, s[12:15], s86 offen offset:3072 lds
    v_mfma_f32_16x16x32_bf16 v[68:71], v[96:99], a[32:35], v[68:71]
    s_lshl_b32 s5, s71, 2
    ds_read_b64_tr_b16 v[108:109], v13 offset:45056
    ds_read_b64_tr_b16 v[110:111], v13 offset:45568
    v_mfma_f32_16x16x32_bf16 v[72:75], v[96:99], a[96:99], v[72:75]
    s_add_u32 m0, s90, 131072
    s_add_u32 s86, s89, 262144
    s_add_u32 s5, s5, s4
    v_mfma_f32_16x16x32_bf16 v[76:79], v[96:99], a[160:163], v[76:79]
    buffer_load_dwordx4 v9, s[12:15], s86 offen lds
    v_mfma_f32_16x16x32_bf16 v[40:43], v[96:99], v[24:27], v[40:43]
    s_waitcnt lgkmcnt(4)
    s_bfe_u32 s6, s58, 262144
    s_lshl_b32 s6, s6, 10
    v_mfma_f32_16x16x32_bf16 v[64:67], v[100:103], v[228:231], v[64:67]
    s_add_u32 s6, s6, s3
    ds_read_b64_tr_b16 v[96:97], v13 offset:49152
    ds_read_b64_tr_b16 v[98:99], v13 offset:49664
    v_mfma_f32_16x16x32_bf16 v[68:71], v[100:103], a[36:39], v[68:71]
    s_add_u32 s6, s6, 32768
    s_lshr_b32 s7, s53, 1
    s_lshl_b32 s7, s7, 8
    v_mfma_f32_16x16x32_bf16 v[72:75], v[100:103], a[100:103], v[72:75]
    s_add_u32 s7, s7, s6
    s_and_b32 s8, s53, 1
    s_lshl_b32 s8, s8, 3
    v_mfma_f32_16x16x32_bf16 v[76:79], v[100:103], a[164:167], v[76:79]
    buffer_load_dwordx4 v10, s[12:15], s86 offen offset:1024 lds
    v_mfma_f32_16x16x32_bf16 v[40:43], v[100:103], v[24:27], v[40:43]
    s_waitcnt lgkmcnt(4)
    s_add_u32 s7, s7, s8
    s_lshl_b32 s8, s53, 11
    s_add_u32 s8, s8, s0
    s_bfe_u32 s10, s58, 196609
    s_lshl_b32 s10, s10, 7
    s_add_u32 s10, s10, s3
    s_add_u32 s10, s10, 50176
    s_and_b32 s9, s58, 1
    s_lshl_b32 s9, s9, 3
    s_add_u32 s9, s9, s53
    s_lshl_b32 s9, s9, 2
    s_add_u32 s10, s10, s9
    s_bfe_u32 s9, s57, 196608
    s_lshl_b32 s9, s9, 7
    s_add_u32 s9, s9, s3
    s_add_u32 s9, s9, 50176
    v_and_b32 v182, 7, v3
    v_mul_u32_u24 v182, 1152, v182
    v_lshl_add_u32 v182, v4, 4, v182
    v_mov_b32 v158, 0
    v_mov_b32 v159, 0
    v_mov_b32 v162, 0
    v_mov_b32 v163, 0
    v_mov_b32 v160, v60
    v_mov_b32 v161, v61
    s_waitcnt vmcnt(5)
    v_cmp_ne_u32 vcc, 1, v177
    s_cbranch_vccnz Lrt_4
Lrtd_5:
    s_mov_b32 exec_hi, 3
    buffer_load_dwordx4 v[128:131], v178, s[32:35], s61 offen sc1
    s_add_u32 s61, s61, 139264
    buffer_load_dwordx4 v[132:135], v178, s[32:35], s61 offen sc1
    s_add_u32 s61, s61, 139264
    buffer_load_dwordx4 v[136:139], v178, s[32:35], s61 offen sc1
    s_add_u32 s61, s61, 139264
    buffer_load_dwordx4 v[140:143], v178, s[32:35], s61 offen sc1
    s_mov_b64 exec, -1
    v_mfma_f32_16x16x32_bf16 v[64:67], v[104:107], v[232:235], v[64:67]
    ds_read_b64_tr_b16 v[100:101], v13 offset:53248
    ds_read_b64_tr_b16 v[102:103], v13 offset:53760
    v_mfma_f32_16x16x32_bf16 v[68:71], v[104:107], a[40:43], v[68:71]
    v_mfma_f32_16x16x32_bf16 v[72:75], v[104:107], a[104:107], v[72:75]
    buffer_load_dwordx4 v11, s[12:15], s86 offen offset:2048 lds
    v_mfma_f32_16x16x32_bf16 v[76:79], v[104:107], a[168:171], v[76:79]
    v_mfma_f32_16x16x32_bf16 v[40:43], v[104:107], v[24:27], v[40:43]
    s_waitcnt lgkmcnt(4)
    v_mfma_f32_16x16x32_bf16 v[64:67], v[108:111], v[236:239], v[64:67]
    ds_read_b64_tr_b16 v[104:105], v13 offset:57344
    ds_read_b64_tr_b16 v[106:107], v13 offset:57856
    v_mfma_f32_16x16x32_bf16 v[68:71], v[108:111], a[44:47], v[68:71]
    buffer_load_dwordx4 v12, s[12:15], s86 offen offset:3072 lds
    v_mfma_f32_16x16x32_bf16 v[72:75], v[108:111], a[108:111], v[72:75]
    v_mfma_f32_16x16x32_bf16 v[76:79], v[108:111], a[172:175], v[76:79]
    v_mfma_f32_16x16x32_bf16 v[40:43], v[108:111], v[24:27], v[40:43]
    s_waitcnt lgkmcnt(4)
    v_mfma_f32_16x16x32_bf16 v[64:67], v[96:99], v[240:243], v[64:67]
    s_add_u32 m0, s90, 147456
    s_add_u32 s86, s89, 393216
    ds_read_b64_tr_b16 v[108:109], v13 offset:61440
    v_mfma_f32_16x16x32_bf16 v[68:71], v[96:99], a[48:51], v[68:71]
    buffer_load_dwordx4 v9, s[12:15], s86 offen lds
    v_mfma_f32_16x16x32_bf16 v[72:75], v[96:99], a[112:115], v[72:75]
    ds_read_b64_tr_b16 v[110:111], v13 offset:61952
    v_mfma_f32_16x16x32_bf16 v[76:79], v[96:99], a[176:179], v[76:79]
    v_mfma_f32_16x16x32_bf16 v[40:43], v[96:99], v[24:27], v[40:43]
    s_waitcnt lgkmcnt(4)
    v_mfma_f32_16x16x32_bf16 v[64:67], v[100:103], v[244:247], v[64:67]
    buffer_load_dwordx4 v10, s[12:15], s86 offen offset:1024 lds
    v_mfma_f32_16x16x32_bf16 v[68:71], v[100:103], a[52:55], v[68:71]
    v_mfma_f32_16x16x32_bf16 v[72:75], v[100:103], a[116:119], v[72:75]
    v_mfma_f32_16x16x32_bf16 v[76:79], v[100:103], a[180:183], v[76:79]
    v_mfma_f32_16x16x32_bf16 v[40:43], v[100:103], v[24:27], v[40:43]
    s_waitcnt lgkmcnt(2)
    v_mfma_f32_16x16x32_bf16 v[64:67], v[104:107], v[248:251], v[64:67]
    buffer_load_dwordx4 v11, s[12:15], s86 offen offset:2048 lds
    v_mfma_f32_16x16x32_bf16 v[68:71], v[104:107], a[56:59], v[68:71]
    v_mfma_f32_16x16x32_bf16 v[72:75], v[104:107], a[120:123], v[72:75]
    v_mfma_f32_16x16x32_bf16 v[76:79], v[104:107], a[184:187], v[76:79]
    buffer_load_dwordx4 v12, s[12:15], s86 offen offset:3072 lds
    v_mfma_f32_16x16x32_bf16 v[40:43], v[104:107], v[24:27], v[40:43]
    s_waitcnt lgkmcnt(0)
    v_mfma_f32_16x16x32_bf16 v[64:67], v[108:111], v[252:255], v[64:67]
    v_mov_b32 v28, -1
    v_mov_b32 v29, -1
    v_mfma_f32_16x16x32_bf16 v[68:71], v[108:111], a[60:63], v[68:71]
    v_mov_b32 v30, -1
    v_mov_b32 v31, -1
    v_mfma_f32_16x16x32_bf16 v[72:75], v[108:111], a[124:127], v[72:75]
    s_lshl_b32 s11, s94, 12
    s_add_u32 s11, s11, 11534336
    v_mfma_f32_16x16x32_bf16 v[76:79], v[108:111], a[188:191], v[76:79]
    v_mfma_f32_16x16x32_bf16 v[40:43], v[108:111], v[24:27], v[40:43]
    s_waitcnt vmcnt(8)
    v_pk_add_f32 v[128:129], v[128:129], v[132:133]
    s_waitcnt vmcnt(6)
    v_pk_add_f32 v[136:137], v[136:137], v[140:141]
    v_pk_add_f32 v[130:131], v[130:131], v[134:135]
    v_pk_add_f32 v[138:139], v[138:139], v[142:143]
    v_pk_add_f32 v[128:129], v[128:129], v[136:137]
    v_pk_add_f32 v[130:131], v[130:131], v[138:139]
    v_cvt_pk_bf16_f32 v144, v128, v129
    v_cvt_pk_bf16_f32 v145, v130, v131
    s_mov_b32 exec_hi, 3
    buffer_store_dwordx2 v[144:145], v179, s[32:35], s92 offen sc1
    s_mov_b64 exec, -1
    buffer_store_dwordx4 v[28:31], v1, s[32:35], s11 offen offset:0 sc1
    buffer_store_dwordx4 v[28:31], v1, s[32:35], s11 offen offset:1024 sc1
    buffer_store_dwordx4 v[28:31], v1, s[32:35], s11 offen offset:2048 sc1
    buffer_store_dwordx4 v[28:31], v1, s[32:35], s11 offen offset:3072 sc1
    s_waitcnt vmcnt(5)
    s_barrier
    v_pk_fma_f32 v[64:65], v[40:41], v[52:53], v[64:65] op_sel_hi:[1,0,1]
    v_pk_fma_f32 v[66:67], v[42:43], v[52:53], v[66:67] op_sel_hi:[1,0,1]
    v_pk_fma_f32 v[68:69], v[40:41], v[54:55], v[68:69] op_sel_hi:[1,0,1]
    v_pk_fma_f32 v[70:71], v[42:43], v[54:55], v[70:71] op_sel_hi:[1,0,1]
    v_pk_fma_f32 v[72:73], v[40:41], v[56:57], v[72:73] op_sel_hi:[1,0,1]
    v_pk_fma_f32 v[74:75], v[42:43], v[56:57], v[74:75] op_sel_hi:[1,0,1]
    v_pk_fma_f32 v[76:77], v[40:41], v[58:59], v[76:77] op_sel_hi:[1,0,1]
    v_pk_fma_f32 v[78:79], v[42:43], v[58:59], v[78:79] op_sel_hi:[1,0,1]
    v_pk_mul_f32 v[64:65], v[64:65], v[52:53] op_sel:[0,1] op_sel_hi:[1,1]
    v_pk_mul_f32 v[66:67], v[66:67], v[52:53] op_sel:[0,1] op_sel_hi:[1,1]
    v_pk_mul_f32 v[68:69], v[68:69], v[54:55] op_sel:[0,1] op_sel_hi:[1,1]
    v_pk_mul_f32 v[70:71], v[70:71], v[54:55] op_sel:[0,1] op_sel_hi:[1,1]
    v_pk_mul_f32 v[72:73], v[72:73], v[56:57] op_sel:[0,1] op_sel_hi:[1,1]
    v_lshrrev_b32 v36, 3, v0
    v_lshlrev_b32 v37, 1, v4
    v_xor_b32 v37, v37, v0
    v_and_b32 v37, 7, v37
    v_mul_u32_u24 v36, 3584, v36
    v_lshl_add_u32 v9, v37, 4, v36
    v_add_u32 v10, 27648, v9
    v_add_u32 v11, 55296, v9
    v_add_u32 v12, 82944, v9
    s_lshl_b32 s89, s51, 7
    s_add_u32 s89, s89, 1792
    s_cmp_ge_u32 s51, 14
    s_cselect_b32 s89, 0x10000000, s89
    s_mul_i32 s93, s54, 114688
    s_add_u32 s89, s89, s93
    s_add_u32 m0, s90, 32768
    s_add_u32 s86, s89, 0
    v_pk_mul_f32 v[74:75], v[74:75], v[56:57] op_sel:[0,1] op_sel_hi:[1,1]
    v_pk_mul_f32 v[76:77], v[76:77], v[58:59] op_sel:[0,1] op_sel_hi:[1,1]
    v_pk_mul_f32 v[78:79], v[78:79], v[58:59] op_sel:[0,1] op_sel_hi:[1,1]
    v_cvt_pk_bf16_f32 v112, v64, v65
    buffer_load_dwordx4 v9, s[16:19], s86 offen lds
    v_cvt_pk_bf16_f32 v113, v66, v67
    v_cvt_pk_bf16_f32 v114, v68, v69
    v_cvt_pk_bf16_f32 v115, v70, v71
    v_cvt_pk_bf16_f32 v116, v72, v73
    v_cvt_pk_bf16_f32 v117, v74, v75
    v_cvt_pk_bf16_f32 v118, v76, v77
    v_cvt_pk_bf16_f32 v119, v78, v79
    v_mfma_f32_16x16x16_bf16 v[64:67], v[62:63], v[112:113], 0
    v_mfma_f32_16x16x16_bf16 v[68:71], v[62:63], v[114:115], 0
    v_mfma_f32_16x16x16_bf16 v[72:75], v[62:63], v[116:117], 0
    v_mfma_f32_16x16x16_bf16 v[76:79], v[62:63], v[118:119], 0
    s_nop 4
    v_max3_f32 v120, v64, v65, v66
    v_max3_f32 v121, -v64, -v65, -v66
    buffer_load_dwordx4 v10, s[16:19], s86 offen offset:1024 lds
    v_max3_f32 v122, v68, v69, v70
    v_max3_f32 v123, -v68, -v69, -v70
    v_max3_f32 v124, v72, v73, v74
    v_max3_f32 v125, -v72, -v73, -v74
    v_max3_f32 v126, v76, v77, v78
    v_max3_f32 v127, -v76, -v77, -v78
    v_max_f32 v120, v120, v67
    v_max_f32_e64 v121, v121, -v67
    v_max_f32 v122, v122, v71
    v_max_f32_e64 v123, v123, -v71
    v_max_f32 v124, v124, v75
    v_max_f32_e64 v125, v125, -v75
    v_max_f32 v126, v126, v79
    v_max_f32_e64 v127, v127, -v79
    v_permlane32_swap_b32 v120, v121
    v_permlane32_swap_b32 v122, v123
    buffer_load_dwordx4 v11, s[16:19], s86 offen offset:2048 lds
    v_permlane32_swap_b32 v124, v125
    v_permlane32_swap_b32 v126, v127
    v_max_f32 v120, v120, v121
    v_max_f32 v122, v122, v123
    v_max_f32 v124, v124, v125
    v_max_f32 v126, v126, v127
    v_permlane16_swap_b32 v120, v122
    s_nop 0
    v_permlane16_swap_b32 v124, v126
    v_max_f32 v120, v120, v122
    v_max_f32 v124, v124, v126
    v_mul_f32 v120, s80, v120
    v_mul_f32 v124, s80, v124
    buffer_load_dwordx4 v12, s[16:19], s86 offen offset:3072 lds
    v_mov_b32 v122, v120
    v_mov_b32 v126, v124
    s_nop 0
    v_permlane16_swap_b32 v120, v122
    v_permlane16_swap_b32 v124, v126
    v_mov_b32 v121, v120
    v_mov_b32 v123, v122
    v_mov_b32 v125, v124
    v_mov_b32 v127, v126
    v_permlane32_swap_b32 v120, v121
    v_permlane32_swap_b32 v122, v123
    s_xor_b32 s93, s87, 0
    s_add_u32 m0, s88, 0
    s_add_u32 s86, s93, s79
    v_permlane32_swap_b32 v124, v125
    v_permlane32_swap_b32 v126, v127
    buffer_load_dwordx4 v5, s[20:23], s86 offen lds
    v_pk_fma_f32 v[80:81], v[64:65], s[80:81], v[120:121] op_sel_hi:[1,1,0] neg_lo:[0,0,1] neg_hi:[0,0,1]
    v_pk_fma_f32 v[82:83], v[66:67], s[80:81], v[120:121] op_sel_hi:[1,1,0] neg_lo:[0,0,1] neg_hi:[0,0,1]
    v_pk_fma_f32 v[64:65], v[64:65], s[80:81], v[120:121] op_sel:[0,0,1] op_sel_hi:[1,1,1] neg_lo:[1,0,1] neg_hi:[1,0,1]
    v_pk_fma_f32 v[66:67], v[66:67], s[80:81], v[120:121] op_sel:[0,0,1] op_sel_hi:[1,1,1] neg_lo:[1,0,1] neg_hi:[1,0,1]
    v_pk_fma_f32 v[84:85], v[68:69], s[80:81], v[122:123] op_sel_hi:[1,1,0] neg_lo:[0,0,1] neg_hi:[0,0,1]
    v_pk_fma_f32 v[86:87], v[70:71], s[80:81], v[122:123] op_sel_hi:[1,1,0] neg_lo:[0,0,1] neg_hi:[0,0,1]
    v_pk_fma_f32 v[68:69], v[68:69], s[80:81], v[122:123] op_sel:[0,0,1] op_sel_hi:[1,1,1] neg_lo:[1,0,1] neg_hi:[1,0,1]
    v_pk_fma_f32 v[70:71], v[70:71], s[80:81], v[122:123] op_sel:[0,0,1] op_sel_hi:[1,1,1] neg_lo:[1,0,1] neg_hi:[1,0,1]
    v_pk_fma_f32 v[88:89], v[72:73], s[80:81], v[124:125] op_sel_hi:[1,1,0] neg_lo:[0,0,1] neg_hi:[0,0,1]
    v_pk_fma_f32 v[90:91], v[74:75], s[80:81], v[124:125] op_sel_hi:[1,1,0] neg_lo:[0,0,1] neg_hi:[0,0,1]
    v_pk_fma_f32 v[72:73], v[72:73], s[80:81], v[124:125] op_sel:[0,0,1] op_sel_hi:[1,1,1] neg_lo:[1,0,1] neg_hi:[1,0,1]
    v_pk_fma_f32 v[74:75], v[74:75], s[80:81], v[124:125] op_sel:[0,0,1] op_sel_hi:[1,1,1] neg_lo:[1,0,1] neg_hi:[1,0,1]
    v_pk_fma_f32 v[92:93], v[76:77], s[80:81], v[126:127] op_sel_hi:[1,1,0] neg_lo:[0,0,1] neg_hi:[0,0,1]
    v_pk_fma_f32 v[94:95], v[78:79], s[80:81], v[126:127] op_sel_hi:[1,1,0] neg_lo:[0,0,1] neg_hi:[0,0,1]
    v_pk_fma_f32 v[76:77], v[76:77], s[80:81], v[126:127] op_sel:[0,0,1] op_sel_hi:[1,1,1] neg_lo:[1,0,1] neg_hi:[1,0,1]
    v_pk_fma_f32 v[78:79], v[78:79], s[80:81], v[126:127] op_sel:[0,0,1] op_sel_hi:[1,1,1] neg_lo:[1,0,1] neg_hi:[1,0,1]
    buffer_load_dwordx4 v6, s[20:23], s86 offen offset:1024 lds
    v_exp_f32 v80, v80
    v_exp_f32 v64, v64
    v_exp_f32 v81, v81
    v_exp_f32 v65, v65
    v_exp_f32 v82, v82
    v_exp_f32 v66, v66
    v_exp_f32 v83, v83
    v_exp_f32 v67, v67
    v_exp_f32 v84, v84
    buffer_load_dwordx4 v7, s[20:23], s86 offen offset:2048 lds
    v_exp_f32 v68, v68
    v_exp_f32 v85, v85
    v_exp_f32 v69, v69
    v_exp_f32 v86, v86
    v_exp_f32 v70, v70
    v_exp_f32 v87, v87
    v_exp_f32 v71, v71
    v_exp_f32 v88, v88
    buffer_load_dwordx4 v8, s[20:23], s86 offen offset:3072 lds
    v_exp_f32 v72, v72
    v_exp_f32 v89, v89
    v_exp_f32 v73, v73
    v_exp_f32 v90, v90
    v_exp_f32 v74, v74
    v_exp_f32 v91, v91
    v_exp_f32 v75, v75
    v_exp_f32 v92, v92
    v_exp_f32 v76, v76
    v_exp_f32 v93, v93
    v_exp_f32 v77, v77
    v_exp_f32 v94, v94
    v_exp_f32 v78, v78
    v_exp_f32 v95, v95
    v_exp_f32 v79, v79
    v_pk_add_f32 v[224:225], v[80:81], v[82:83]
    v_pk_add_f32 v[226:227], v[64:65], v[66:67]
    v_pk_add_f32 v[228:229], v[84:85], v[86:87]
    v_pk_add_f32 v[230:231], v[68:69], v[70:71]
    v_pk_add_f32 v[232:233], v[88:89], v[90:91]
    v_pk_add_f32 v[234:235], v[72:73], v[74:75]
    v_pk_add_f32 v[236:237], v[92:93], v[94:95]
    v_pk_add_f32 v[238:239], v[76:77], v[78:79]
    buffer_load_dwordx4 v[188:191], v182, s[32:35], s62 offen offset:1024 sc1
    s_add_u32 s91, s62, 3456
    s_add_u32 s92, s62, 6912
    v_add_f32 v120, v224, v225
    v_add_f32 v121, v226, v227
    v_add_f32 v122, v228, v229
    v_add_f32 v123, v230, v231
    v_add_f32 v124, v232, v233
    v_add_f32 v125, v234, v235
    v_add_f32 v126, v236, v237
    v_add_f32 v127, v238, v239
    buffer_load_dwordx4 v[192:195], v1, s[32:35], s62 offen offset:0 sc1
    v_permlane32_swap_b32 v120, v121
    v_permlane32_swap_b32 v122, v123
    v_permlane32_swap_b32 v124, v125
    v_permlane32_swap_b32 v126, v127
    buffer_load_dwordx4 v[196:199], v1, s[32:35], s62 offen offset:1152 sc1
    v_add_f32 v120, v120, v121
    v_add_f32 v122, v122, v123
    v_add_f32 v124, v124, v125
    v_add_f32 v126, v126, v127
    v_permlane16_swap_b32 v120, v122
    s_nop 0
    v_permlane16_swap_b32 v124, v126
    buffer_load_dwordx4 v[200:203], v1, s[32:35], s62 offen offset:2304 sc1
    v_add_f32 v120, v120, v122
    v_add_f32 v124, v124, v126
    v_rcp_f32 v120, v120
    v_rcp_f32 v124, v124
    v_mov_b32 v122, v120
    v_mov_b32 v126, v124
    buffer_load_dwordx4 v[204:207], v1, s[32:35], s91 offen offset:0 sc1
    v_permlane16_swap_b32 v120, v122
    v_permlane16_swap_b32 v124, v126
    v_mov_b32 v121, v120
    v_mov_b32 v123, v122
    v_mov_b32 v125, v124
    v_mov_b32 v127, v126
    buffer_load_dwordx4 v[208:211], v1, s[32:35], s91 offen offset:1152 sc1
    v_permlane32_swap_b32 v120, v121
    v_permlane32_swap_b32 v122, v123
    v_permlane32_swap_b32 v124, v125
    v_permlane32_swap_b32 v126, v127
    buffer_load_dwordx4 v[212:215], v1, s[32:35], s91 offen offset:2304 sc1
    v_pk_mul_f32 v[80:81], v[80:81], v[120:121] op_sel_hi:[1,0]
    v_pk_mul_f32 v[64:65], v[64:65], v[120:121] op_sel:[0,1] op_sel_hi:[1,1]
    v_pk_mul_f32 v[82:83], v[82:83], v[120:121] op_sel_hi:[1,0]
    v_pk_mul_f32 v[66:67], v[66:67], v[120:121] op_sel:[0,1] op_sel_hi:[1,1]
    v_pk_mul_f32 v[84:85], v[84:85], v[122:123] op_sel_hi:[1,0]
    v_pk_mul_f32 v[68:69], v[68:69], v[122:123] op_sel:[0,1] op_sel_hi:[1,1]
    v_pk_mul_f32 v[86:87], v[86:87], v[122:123] op_sel_hi:[1,0]
    v_pk_mul_f32 v[70:71], v[70:71], v[122:123] op_sel:[0,1] op_sel_hi:[1,1]
    buffer_load_dwordx4 v[216:219], v1, s[32:35], s92 offen offset:0 sc1
    v_pk_mul_f32 v[88:89], v[88:89], v[124:125] op_sel_hi:[1,0]
    v_pk_mul_f32 v[72:73], v[72:73], v[124:125] op_sel:[0,1] op_sel_hi:[1,1]
    v_pk_mul_f32 v[90:91], v[90:91], v[124:125] op_sel_hi:[1,0]
    v_pk_mul_f32 v[74:75], v[74:75], v[124:125] op_sel:[0,1] op_sel_hi:[1,1]
    v_pk_mul_f32 v[92:93], v[92:93], v[126:127] op_sel_hi:[1,0]
    v_pk_mul_f32 v[76:77], v[76:77], v[126:127] op_sel:[0,1] op_sel_hi:[1,1]
    v_pk_mul_f32 v[94:95], v[94:95], v[126:127] op_sel_hi:[1,0]
    v_pk_mul_f32 v[78:79], v[78:79], v[126:127] op_sel:[0,1] op_sel_hi:[1,1]
    buffer_load_dwordx4 v[220:223], v1, s[32:35], s92 offen offset:1152 sc1
    v_cvt_pk_bf16_f32 v96, v80, v81
    v_cvt_pk_bf16_f32 v98, v64, v65
    v_cvt_pk_bf16_f32 v97, v82, v83
    v_cvt_pk_bf16_f32 v99, v66, v67
    v_cvt_pk_bf16_f32 v100, v84, v85
    v_cvt_pk_bf16_f32 v102, v68, v69
    v_cvt_pk_bf16_f32 v101, v86, v87
    v_cvt_pk_bf16_f32 v103, v70, v71
    v_cvt_pk_bf16_f32 v104, v88, v89
    v_cvt_pk_bf16_f32 v106, v72, v73
    v_cvt_pk_bf16_f32 v105, v90, v91
    v_cvt_pk_bf16_f32 v107, v74, v75
    v_cvt_pk_bf16_f32 v108, v92, v93
    v_cvt_pk_bf16_f32 v110, v76, v77
    v_cvt_pk_bf16_f32 v109, v94, v95
    v_cvt_pk_bf16_f32 v111, v78, v79
    s_add_u32 m0, s90, 49152
    s_add_u32 s86, s89, 458752
    buffer_load_dwordx4 v9, s[16:19], s86 offen lds
    buffer_load_dwordx4 v10, s[16:19], s86 offen offset:1024 lds
    buffer_load_dwordx4 v11, s[16:19], s86 offen offset:2048 lds
    buffer_load_dwordx4 v12, s[16:19], s86 offen offset:3072 lds
    s_add_u32 m0, s90, 65536
    s_add_u32 s86, s89, 917504
    buffer_load_dwordx4 v9, s[16:19], s86 offen lds
    buffer_load_dwordx4 v10, s[16:19], s86 offen offset:1024 lds
    buffer_load_dwordx4 v11, s[16:19], s86 offen offset:2048 lds
    buffer_load_dwordx4 v12, s[16:19], s86 offen offset:3072 lds
    s_waitcnt vmcnt(16)
    v_mfma_f32_16x16x32_bf16 v[80:83], v[188:191], v[96:99], 0
    v_max_u32 v17, v188, v189
    v_mfma_f32_16x16x32_bf16 v[84:87], v[188:191], v[100:103], 0
    v_max3_u32 v17, v17, v190, v191
    v_mfma_f32_16x16x32_bf16 v[88:91], v[188:191], v[104:107], 0
    v_mfma_f32_16x16x32_bf16 v[92:95], v[188:191], v[108:111], 0
    s_waitcnt vmcnt(15)
    v_mfma_f32_16x16x32_bf16 v[164:167], v[160:163], v[192:195], 0
    v_max3_u32 v17, v17, v192, v193
    v_mfma_f32_16x16x32_bf16 v[168:171], v[158:161], v[192:195], 0
    v_max3_u32 v17, v17, v194, v195
    s_waitcnt vmcnt(14)
    v_mfma_f32_16x16x32_bf16 v[164:167], v[160:163], v[196:199], v[164:167]
    v_max3_u32 v17, v17, v196, v197
    v_mfma_f32_16x16x32_bf16 v[168:171], v[158:161], v[196:199], v[168:171]
    v_max3_u32 v17, v17, v198, v199
    s_waitcnt vmcnt(13)
    v_mfma_f32_16x16x32_bf16 v[164:167], v[160:163], v[200:203], v[164:167]
    v_max3_u32 v17, v17, v200, v201
    v_add_f32 v80, v80, v81
    v_mfma_f32_16x16x32_bf16 v[168:171], v[158:161], v[200:203], v[168:171]
    v_max3_u32 v17, v17, v202, v203
    v_add_f32 v82, v82, v83
    s_waitcnt vmcnt(12)
    v_mfma_f32_16x16x32_bf16 v[164:167], v[160:163], v[204:207], v[164:167]
    v_max3_u32 v17, v17, v204, v205
    v_add_f32 v84, v84, v85
    v_mfma_f32_16x16x32_bf16 v[168:171], v[158:161], v[204:207], v[168:171]
    v_max3_u32 v17, v17, v206, v207
    v_add_f32 v86, v86, v87
    s_waitcnt vmcnt(11)
    v_mfma_f32_16x16x32_bf16 v[164:167], v[160:163], v[208:211], v[164:167]
    v_max3_u32 v17, v17, v208, v209
    v_add_f32 v88, v88, v89
    v_mfma_f32_16x16x32_bf16 v[168:171], v[158:161], v[208:211], v[168:171]
    v_max3_u32 v17, v17, v210, v211
    v_add_f32 v90, v90, v91
    s_waitcnt vmcnt(10)
    v_mfma_f32_16x16x32_bf16 v[164:167], v[160:163], v[212:215], v[164:167]
    v_max3_u32 v17, v17, v212, v213
    v_add_f32 v92, v92, v93
    v_mfma_f32_16x16x32_bf16 v[168:171], v[158:161], v[212:215], v[168:171]
    v_max3_u32 v17, v17, v214, v215
    v_add_f32 v94, v94, v95
    s_waitcnt vmcnt(9)
    v_mfma_f32_16x16x32_bf16 v[164:167], v[160:163], v[216:219], v[164:167]
    v_max3_u32 v17, v17, v216, v217
    v_add_f32 v80, v80, v82
    v_mfma_f32_16x16x32_bf16 v[168:171], v[158:161], v[216:219], v[168:171]
    v_max3_u32 v17, v17, v218, v219
    v_add_f32 v84, v84, v86
    s_waitcnt vmcnt(8)
    v_mfma_f32_16x16x32_bf16 v[164:167], v[160:163], v[220:223], v[164:167]
    v_max3_u32 v17, v17, v220, v221
    v_add_f32 v88, v88, v90
    v_mfma_f32_16x16x32_bf16 v[168:171], v[158:161], v[220:223], v[168:171]
    v_max3_u32 v17, v17, v222, v223
    v_add_f32 v92, v92, v94
    v_cmp_eq_u32 vcc, -1, v17
    s_cbranch_vccnz Lrt_7
Lrtd_8:
    v_mov_b32 v81, v80
    v_mov_b32 v85, v84
    v_mov_b32 v89, v88
    v_mov_b32 v93, v92
    v_permlane16_swap_b32 v80, v81
    v_permlane16_swap_b32 v84, v85
    v_cvt_pk_bf16_f32 v172, v164, v165
    v_cvt_pk_bf16_f32 v173, v166, v167
    v_cvt_pk_bf16_f32 v174, v168, v169
    v_cvt_pk_bf16_f32 v175, v170, v171
    v_permlane16_swap_b32 v88, v89
    v_permlane16_swap_b32 v92, v93
    v_mfma_f32_16x16x32_bf16 v[64:67], v[172:175], v[96:99], 0
    v_add_f32 v80, v80, v81
    v_add_f32 v80, 0x358637bd, v80
    v_mfma_f32_16x16x32_bf16 v[68:71], v[172:175], v[100:103], 0
    v_add_f32 v84, v84, v85
    v_add_f32 v84, 0x358637bd, v84
    v_mfma_f32_16x16x32_bf16 v[72:75], v[172:175], v[104:107], 0
    v_add_f32 v88, v88, v89
    v_add_f32 v88, 0x358637bd, v88
    v_mfma_f32_16x16x32_bf16 v[76:79], v[172:175], v[108:111], 0
    v_add_f32 v92, v92, v93
    v_add_f32 v92, 0x358637bd, v92
    v_rcp_f32 v80, v80
    v_rcp_f32 v84, v84
    v_rcp_f32 v88, v88
    v_rcp_f32 v92, v92
    v_pk_mul_f32 v[64:65], v[64:65], v[80:81] op_sel_hi:[1,0]
    v_pk_mul_f32 v[66:67], v[66:67], v[80:81] op_sel_hi:[1,0]
    v_cvt_pk_bf16_f32 v112, v64, v65
    v_cvt_pk_bf16_f32 v113, v66, v67
    buffer_store_dwordx2 v[112:113], v1, s[32:35], s36 offen
    v_pk_mul_f32 v[68:69], v[68:69], v[84:85] op_sel_hi:[1,0]
    v_pk_mul_f32 v[70:71], v[70:71], v[84:85] op_sel_hi:[1,0]
    v_cvt_pk_bf16_f32 v114, v68, v69
    v_cvt_pk_bf16_f32 v115, v70, v71
    buffer_store_dwordx2 v[114:115], v1, s[32:35], s37 offen
    v_pk_mul_f32 v[72:73], v[72:73], v[88:89] op_sel_hi:[1,0]
    v_pk_mul_f32 v[74:75], v[74:75], v[88:89] op_sel_hi:[1,0]
    v_cvt_pk_bf16_f32 v116, v72, v73
    v_cvt_pk_bf16_f32 v117, v74, v75
    buffer_store_dwordx2 v[116:117], v1, s[32:35], s38 offen
    v_pk_mul_f32 v[76:77], v[76:77], v[92:93] op_sel_hi:[1,0]
    v_pk_mul_f32 v[78:79], v[78:79], v[92:93] op_sel_hi:[1,0]
    v_cvt_pk_bf16_f32 v118, v76, v77
    v_cvt_pk_bf16_f32 v119, v78, v79
    buffer_store_dwordx2 v[118:119], v1, s[32:35], s39 offen
    v_lshrrev_b32 v17, 2, v0
    v_and_b32 v18, 3, v0
    v_lshlrev_b32 v18, 3, v18
    v_lshl_add_u32 v18, v17, 7, v18
    v_bfe_u32 v17, v17, 1, 2
    v_lshl_add_u32 v18, v17, 5, v18
    v_add_u32 v13, 98304, v18
    v_xor_b32 v14, 32, v13
    v_xor_b32 v15, 64, v13
    v_xor_b32 v16, 96, v13
    v_and_b32 v38, 31, v0
    v_lshl_add_u32 v38, v38, 2, s4
    v_mov_b32 v24, v48
    v_mov_b32 v25, v49
    v_mov_b32 v26, v50
    v_mov_b32 v27, v51
    v_lshlrev_b32 v40, 16, v32
    v_and_b32 v41, 0xffff0000, v32
    v_lshlrev_b32 v42, 16, v33
    v_and_b32 v43, 0xffff0000, v33
    v_lshlrev_b32 v44, 16, v34
    v_and_b32 v45, 0xffff0000, v34
    v_lshlrev_b32 v46, 16, v35
    v_and_b32 v47, 0xffff0000, v35
    v_lshlrev_b32 v48, 16, v24
    v_and_b32 v49, 0xffff0000, v24
    v_lshlrev_b32 v50, 16, v25
    v_and_b32 v51, 0xffff0000, v25
    v_lshlrev_b32 v52, 16, v26
    v_and_b32 v53, 0xffff0000, v26
    v_lshlrev_b32 v54, 16, v27
    v_and_b32 v55, 0xffff0000, v27
    s_mov_b64 exec, 2
    s_waitcnt vmcnt(0)
    buffer_store_dword v0, off, s[32:35], s5 offset:0
    s_mov_b64 exec, -1
    s_xor_b32 s93, s87, 131072
    s_add_u32 m0, s88, 4096
    s_add_u32 s86, s93, s79
    buffer_load_dwordx4 v5, s[20:23], s86 offen lds
    buffer_load_dwordx4 v6, s[20:23], s86 offen offset:1024 lds
    buffer_load_dwordx4 v7, s[20:23], s86 offen offset:2048 lds
    buffer_load_dwordx4 v8, s[20:23], s86 offen offset:3072 lds
    v_lshrrev_b32 v37, 2, v3
    v_lshlrev_b32 v37, 3, v37
    v_and_or_b32 v37, v3, 3, v37
    s_lshr_b32 s62, s58, 1
    s_lshl_b32 s62, s62, 5
    s_and_b32 s63, s58, 1
    s_lshl_b32 s63, s63, 2
    s_add_u32 s62, s62, s63
    v_add_u32 v36, s62, v37
    v_lshlrev_b32 v36, 1, v36
    buffer_load_ushort v34, v36, s[40:43], 0 offen
    ds_read_b128 a[192:195], v20 offset:0
    ds_read_b128 a[196:199], v22 offset:0
    ds_read_b128 a[224:227], v21 offset:0
    ds_read_b128 a[228:231], v23 offset:0
    s_waitcnt lgkmcnt(0)
    s_xor_b32 s93, s87, 1048576
    s_add_u32 m0, s88, 0
    s_add_u32 s86, s93, s79
    buffer_load_dwordx4 v5, s[20:23], s86 offen lds
    buffer_load_dwordx4 v6, s[20:23], s86 offen offset:1024 lds
    buffer_load_dwordx4 v7, s[20:23], s86 offen offset:2048 lds
    buffer_load_dwordx4 v8, s[20:23], s86 offen offset:3072 lds
    ds_read_b64_tr_b16 v[128:129], v13 offset:0
    ds_read_b64_tr_b16 v[130:131], v13 offset:2048
    ds_read_b64_tr_b16 v[132:133], v14 offset:0
    ds_read_b64_tr_b16 v[134:135], v14 offset:2048
    ds_read_b64_tr_b16 v[136:137], v13 offset:4096
    ds_read_b64_tr_b16 v[138:139], v13 offset:6144
    ds_read_b64_tr_b16 v[140:141], v14 offset:4096
    ds_read_b64_tr_b16 v[142:143], v14 offset:6144
    s_mov_b32 s59, s0
    buffer_load_dword v39, v38, s[32:35], 0 offen sc1
    s_waitcnt vmcnt(6)
    ds_read_b128 a[200:203], v20 offset:4096
    ds_read_b128 a[204:207], v22 offset:4096
    ds_read_b128 a[232:235], v21 offset:4096
    ds_read_b128 a[236:239], v23 offset:4096
    s_waitcnt lgkmcnt(0)
    s_xor_b32 s93, s87, 1179648
    s_add_u32 m0, s88, 4096
    s_add_u32 s86, s93, s79
    buffer_load_dwordx4 v5, s[20:23], s86 offen lds
    buffer_load_dwordx4 v6, s[20:23], s86 offen offset:1024 lds
    buffer_load_dwordx4 v7, s[20:23], s86 offen offset:2048 lds
    buffer_load_dwordx4 v8, s[20:23], s86 offen offset:3072 lds
    ds_read_b64_tr_b16 v[144:145], v13 offset:8192
    ds_read_b64_tr_b16 v[146:147], v13 offset:10240
    ds_read_b64_tr_b16 v[148:149], v14 offset:8192
    ds_read_b64_tr_b16 v[150:151], v14 offset:10240
    ds_read_b64_tr_b16 v[152:153], v13 offset:12288
    ds_read_b64_tr_b16 v[154:155], v13 offset:14336
    ds_read_b64_tr_b16 v[156:157], v14 offset:12288
    ds_read_b64_tr_b16 v[158:159], v14 offset:14336
    ds_read_b64_tr_b16 v[160:161], v13 offset:16384
    ds_read_b64_tr_b16 v[162:163], v13 offset:18432
    ds_read_b64_tr_b16 v[164:165], v14 offset:16384
    ds_read_b64_tr_b16 v[166:167], v14 offset:18432
    ds_read_b64_tr_b16 v[168:169], v13 offset:20480
    ds_read_b64_tr_b16 v[170:171], v13 offset:22528
    ds_read_b64_tr_b16 v[172:173], v14 offset:20480
    ds_read_b64_tr_b16 v[174:175], v14 offset:22528
    ds_read_b64_tr_b16 v[176:177], v13 offset:24576
    ds_read_b64_tr_b16 v[178:179], v13 offset:26624
    ds_read_b64_tr_b16 v[180:181], v14 offset:24576
    ds_read_b64_tr_b16 v[182:183], v14 offset:26624
    ds_read_b64_tr_b16 v[184:185], v13 offset:28672
    ds_read_b64_tr_b16 v[186:187], v13 offset:30720
    ds_read_b64_tr_b16 v[188:189], v14 offset:28672
    ds_read_b64_tr_b16 v[190:191], v14 offset:30720
    s_waitcnt vmcnt(4)
    v_cmp_ne_u32 vcc, 1, v39
    s_cbranch_vccnz Lrt_10
Lrtd_11:
    buffer_load_dwordx4 v[80:83], v1, s[32:35], s59 offen offset:0 sc1
    buffer_load_dwordx4 v[84:87], v1, s[32:35], s59 offen offset:1024 sc1
    buffer_load_dwordx4 v[88:91], v1, s[32:35], s59 offen offset:2048 sc1
    buffer_load_dwordx4 v[92:95], v1, s[32:35], s59 offen offset:3072 sc1
    s_add_u32 s59, s59, 4096
    buffer_load_dwordx4 v[96:99], v1, s[32:35], s59 offen offset:0 sc1
    buffer_load_dwordx4 v[100:103], v1, s[32:35], s59 offen offset:1024 sc1
    buffer_load_dwordx4 v[104:107], v1, s[32:35], s59 offen offset:2048 sc1
    buffer_load_dwordx4 v[108:111], v1, s[32:35], s59 offen offset:3072 sc1
    ds_read_b64_tr_b16 v[192:193], v13 offset:32768
    ds_read_b64_tr_b16 v[194:195], v13 offset:34816
    ds_read_b64_tr_b16 v[196:197], v14 offset:32768
    ds_read_b64_tr_b16 v[198:199], v14 offset:34816
    ds_read_b64_tr_b16 v[200:201], v13 offset:36864
    ds_read_b64_tr_b16 v[202:203], v13 offset:38912
    ds_read_b64_tr_b16 v[204:205], v14 offset:36864
    ds_read_b64_tr_b16 v[206:207], v14 offset:38912
    ds_read_b64_tr_b16 v[208:209], v13 offset:40960
    ds_read_b64_tr_b16 v[210:211], v13 offset:43008
    ds_read_b64_tr_b16 v[212:213], v14 offset:40960
    ds_read_b64_tr_b16 v[214:215], v14 offset:43008
    ds_read_b64_tr_b16 v[216:217], v13 offset:45056
    ds_read_b64_tr_b16 v[218:219], v13 offset:47104
    ds_read_b64_tr_b16 v[220:221], v14 offset:45056
    ds_read_b64_tr_b16 v[222:223], v14 offset:47104
    ds_read_b64_tr_b16 v[224:225], v13 offset:49152
    ds_read_b64_tr_b16 v[226:227], v13 offset:51200
    ds_read_b64_tr_b16 v[228:229], v14 offset:49152
    ds_read_b64_tr_b16 v[230:231], v14 offset:51200
    ds_read_b64_tr_b16 v[232:233], v13 offset:53248
    ds_read_b64_tr_b16 v[234:235], v13 offset:55296
    ds_read_b64_tr_b16 v[236:237], v14 offset:53248
    ds_read_b64_tr_b16 v[238:239], v14 offset:55296
    ds_read_b64_tr_b16 v[240:241], v13 offset:57344
    ds_read_b64_tr_b16 v[242:243], v13 offset:59392
    ds_read_b64_tr_b16 v[244:245], v14 offset:57344
    ds_read_b64_tr_b16 v[246:247], v14 offset:59392
    ds_read_b64_tr_b16 v[248:249], v13 offset:61440
    ds_read_b64_tr_b16 v[250:251], v13 offset:63488
    ds_read_b64_tr_b16 v[252:253], v14 offset:61440
    ds_read_b64_tr_b16 v[254:255], v14 offset:63488
    ds_read_b64_tr_b16 v[56:57], v15 offset:0
    ds_read_b64_tr_b16 v[58:59], v15 offset:2048
    ds_read_b64_tr_b16 v[60:61], v16 offset:0
    ds_read_b64_tr_b16 v[62:63], v16 offset:2048
    ds_read_b64_tr_b16 v[64:65], v15 offset:4096
    ds_read_b64_tr_b16 v[66:67], v15 offset:6144
    ds_read_b64_tr_b16 v[68:69], v16 offset:4096
    ds_read_b64_tr_b16 v[70:71], v16 offset:6144
    ds_read_b64_tr_b16 v[72:73], v15 offset:8192
    ds_read_b64_tr_b16 v[74:75], v15 offset:10240
    s_waitcnt vmcnt(7) lgkmcnt(6)
    v_mfma_f32_16x16x32_bf16 v[48:51], v[56:59], v[80:83], v[48:51]
    s_add_u32 s59, s59, 4096
    ds_read_b64_tr_b16 v[76:77], v16 offset:8192
    ds_read_b64_tr_b16 v[78:79], v16 offset:10240
    v_mfma_f32_16x16x32_bf16 v[52:55], v[60:63], v[80:83], v[52:55]
    buffer_load_dwordx4 v[112:115], v1, s[32:35], s59 offen offset:0 sc1
    v_mfma_f32_16x16x32_bf16 v[40:43], v[128:131], v[80:83], v[40:43]
    ds_read_b64_tr_b16 v[56:57], v15 offset:12288
    ds_read_b64_tr_b16 v[58:59], v15 offset:14336
    v_mfma_f32_16x16x32_bf16 v[44:47], v[132:135], v[80:83], v[44:47]
    s_waitcnt vmcnt(7) lgkmcnt(6)
    v_mfma_f32_16x16x32_bf16 v[48:51], v[64:67], v[84:87], v[48:51]
    buffer_load_dwordx4 v[116:119], v1, s[32:35], s59 offen offset:1024 sc1
    v_mfma_f32_16x16x32_bf16 v[52:55], v[68:71], v[84:87], v[52:55]
    ds_read_b64_tr_b16 v[60:61], v16 offset:12288
    ds_read_b64_tr_b16 v[62:63], v16 offset:14336
    v_mfma_f32_16x16x32_bf16 v[40:43], v[136:139], v[84:87], v[40:43]
    ds_read_b64_tr_b16 v[64:65], v15 offset:16384
    ds_read_b64_tr_b16 v[66:67], v15 offset:18432
    v_mfma_f32_16x16x32_bf16 v[44:47], v[140:143], v[84:87], v[44:47]
    s_waitcnt vmcnt(7) lgkmcnt(6)
    v_mfma_f32_16x16x32_bf16 v[48:51], v[72:75], v[88:91], v[48:51]
    buffer_load_dwordx4 v[120:123], v1, s[32:35], s59 offen offset:2048 sc1
    v_mfma_f32_16x16x32_bf16 v[52:55], v[76:79], v[88:91], v[52:55]
    ds_read_b64_tr_b16 v[68:69], v16 offset:16384
    ds_read_b64_tr_b16 v[70:71], v16 offset:18432
    v_mfma_f32_16x16x32_bf16 v[40:43], v[144:147], v[88:91], v[40:43]
    ds_read_b64_tr_b16 v[72:73], v15 offset:20480
    ds_read_b64_tr_b16 v[74:75], v15 offset:22528
    v_mfma_f32_16x16x32_bf16 v[44:47], v[148:151], v[88:91], v[44:47]
    s_waitcnt vmcnt(7) lgkmcnt(6)
    v_mfma_f32_16x16x32_bf16 v[48:51], v[56:59], v[92:95], v[48:51]
    buffer_load_dwordx4 v[124:127], v1, s[32:35], s59 offen offset:3072 sc1
    v_mfma_f32_16x16x32_bf16 v[52:55], v[60:63], v[92:95], v[52:55]
    ds_read_b64_tr_b16 v[76:77], v16 offset:20480
    ds_read_b64_tr_b16 v[78:79], v16 offset:22528
    v_mfma_f32_16x16x32_bf16 v[40:43], v[152:155], v[92:95], v[40:43]
    ds_read_b64_tr_b16 v[56:57], v15 offset:24576
    ds_read_b64_tr_b16 v[58:59], v15 offset:26624
    v_mfma_f32_16x16x32_bf16 v[44:47], v[156:159], v[92:95], v[44:47]
    s_waitcnt vmcnt(7) lgkmcnt(6)
    v_mfma_f32_16x16x32_bf16 v[48:51], v[64:67], v[96:99], v[48:51]
    s_add_u32 s59, s59, 4096
    ds_read_b64_tr_b16 v[60:61], v16 offset:24576
    ds_read_b64_tr_b16 v[62:63], v16 offset:26624
    v_mfma_f32_16x16x32_bf16 v[52:55], v[68:71], v[96:99], v[52:55]
    buffer_load_dwordx4 v[80:83], v1, s[32:35], s59 offen offset:0 sc1
    v_mfma_f32_16x16x32_bf16 v[40:43], v[160:163], v[96:99], v[40:43]
    ds_read_b64_tr_b16 v[64:65], v15 offset:28672
    ds_read_b64_tr_b16 v[66:67], v15 offset:30720
    v_mfma_f32_16x16x32_bf16 v[44:47], v[164:167], v[96:99], v[44:47]
    s_waitcnt vmcnt(7) lgkmcnt(6)
    v_mfma_f32_16x16x32_bf16 v[48:51], v[72:75], v[100:103], v[48:51]
    buffer_load_dwordx4 v[84:87], v1, s[32:35], s59 offen offset:1024 sc1
    v_mfma_f32_16x16x32_bf16 v[52:55], v[76:79], v[100:103], v[52:55]
    ds_read_b64_tr_b16 v[68:69], v16 offset:28672
    ds_read_b64_tr_b16 v[70:71], v16 offset:30720
    v_mfma_f32_16x16x32_bf16 v[40:43], v[168:171], v[100:103], v[40:43]
    ds_read_b64_tr_b16 v[72:73], v15 offset:32768
    ds_read_b64_tr_b16 v[74:75], v15 offset:34816
    v_mfma_f32_16x16x32_bf16 v[44:47], v[172:175], v[100:103], v[44:47]
    s_waitcnt vmcnt(7) lgkmcnt(6)
    v_mfma_f32_16x16x32_bf16 v[48:51], v[56:59], v[104:107], v[48:51]
    buffer_load_dwordx4 v[88:91], v1, s[32:35], s59 offen offset:2048 sc1
    v_mfma_f32_16x16x32_bf16 v[52:55], v[60:63], v[104:107], v[52:55]
    ds_read_b64_tr_b16 v[76:77], v16 offset:32768
    ds_read_b64_tr_b16 v[78:79], v16 offset:34816
    v_mfma_f32_16x16x32_bf16 v[40:43], v[176:179], v[104:107], v[40:43]
    ds_read_b64_tr_b16 v[56:57], v15 offset:36864
    ds_read_b64_tr_b16 v[58:59], v15 offset:38912
    v_mfma_f32_16x16x32_bf16 v[44:47], v[180:183], v[104:107], v[44:47]
    s_waitcnt vmcnt(7) lgkmcnt(6)
    v_mfma_f32_16x16x32_bf16 v[48:51], v[64:67], v[108:111], v[48:51]
    buffer_load_dwordx4 v[92:95], v1, s[32:35], s59 offen offset:3072 sc1
    v_mfma_f32_16x16x32_bf16 v[52:55], v[68:71], v[108:111], v[52:55]
    ds_read_b64_tr_b16 v[60:61], v16 offset:36864
    ds_read_b64_tr_b16 v[62:63], v16 offset:38912
    v_mfma_f32_16x16x32_bf16 v[40:43], v[184:187], v[108:111], v[40:43]
    ds_read_b64_tr_b16 v[64:65], v15 offset:40960
    ds_read_b64_tr_b16 v[66:67], v15 offset:43008
    v_mfma_f32_16x16x32_bf16 v[44:47], v[188:191], v[108:111], v[44:47]
    s_waitcnt vmcnt(7) lgkmcnt(6)
    v_mfma_f32_16x16x32_bf16 v[48:51], v[72:75], v[112:115], v[48:51]
    ds_read_b64_tr_b16 v[68:69], v16 offset:40960
    ds_read_b64_tr_b16 v[70:71], v16 offset:43008
    v_mfma_f32_16x16x32_bf16 v[52:55], v[76:79], v[112:115], v[52:55]
    ds_read_b64_tr_b16 v[72:73], v15 offset:45056
    ds_read_b64_tr_b16 v[74:75], v15 offset:47104
    v_mfma_f32_16x16x32_bf16 v[40:43], v[192:195], v[112:115], v[40:43]
    v_mfma_f32_16x16x32_bf16 v[44:47], v[196:199], v[112:115], v[44:47]
    s_waitcnt vmcnt(6) lgkmcnt(6)
    v_mfma_f32_16x16x32_bf16 v[48:51], v[56:59], v[116:119], v[48:51]
    ds_read_b64_tr_b16 v[76:77], v16 offset:45056
    ds_read_b64_tr_b16 v[78:79], v16 offset:47104
    v_mfma_f32_16x16x32_bf16 v[52:55], v[60:63], v[116:119], v[52:55]
    s_add_u32 m0, s90, 81920
    s_add_u32 s86, s89, 1376256
    ds_read_b64_tr_b16 v[56:57], v15 offset:49152
    v_mfma_f32_16x16x32_bf16 v[40:43], v[200:203], v[116:119], v[40:43]
    buffer_load_dwordx4 v9, s[16:19], s86 offen lds
    v_mfma_f32_16x16x32_bf16 v[44:47], v[204:207], v[116:119], v[44:47]
    s_waitcnt vmcnt(6) lgkmcnt(5)
    ds_read_b64_tr_b16 v[58:59], v15 offset:51200
    v_mfma_f32_16x16x32_bf16 v[48:51], v[64:67], v[120:123], v[48:51]
    ds_read_b64_tr_b16 v[60:61], v16 offset:49152
    ds_read_b64_tr_b16 v[62:63], v16 offset:51200
    v_mfma_f32_16x16x32_bf16 v[52:55], v[68:71], v[120:123], v[52:55]
    ds_read_b64_tr_b16 v[64:65], v15 offset:53248
    ds_read_b64_tr_b16 v[66:67], v15 offset:55296
    v_mfma_f32_16x16x32_bf16 v[40:43], v[208:211], v[120:123], v[40:43]
    buffer_load_dwordx4 v10, s[16:19], s86 offen offset:1024 lds
    v_mfma_f32_16x16x32_bf16 v[44:47], v[212:215], v[120:123], v[44:47]
    s_waitcnt vmcnt(6) lgkmcnt(6)
    v_mfma_f32_16x16x32_bf16 v[48:51], v[72:75], v[124:127], v[48:51]
    ds_read_b64_tr_b16 v[68:69], v16 offset:53248
    ds_read_b64_tr_b16 v[70:71], v16 offset:55296
    v_mfma_f32_16x16x32_bf16 v[52:55], v[76:79], v[124:127], v[52:55]
    ds_read_b64_tr_b16 v[72:73], v15 offset:57344
    ds_read_b64_tr_b16 v[74:75], v15 offset:59392
    v_mfma_f32_16x16x32_bf16 v[40:43], v[216:219], v[124:127], v[40:43]
    buffer_load_dwordx4 v11, s[16:19], s86 offen offset:2048 lds
    v_mfma_f32_16x16x32_bf16 v[44:47], v[220:223], v[124:127], v[44:47]
    s_waitcnt vmcnt(6) lgkmcnt(6)
    v_mfma_f32_16x16x32_bf16 v[48:51], v[56:59], v[80:83], v[48:51]
    ds_read_b64_tr_b16 v[76:77], v16 offset:57344
    ds_read_b64_tr_b16 v[78:79], v16 offset:59392
    v_mfma_f32_16x16x32_bf16 v[52:55], v[60:63], v[80:83], v[52:55]
    ds_read_b64_tr_b16 v[56:57], v15 offset:61440
    ds_read_b64_tr_b16 v[58:59], v15 offset:63488
    v_mfma_f32_16x16x32_bf16 v[40:43], v[224:227], v[80:83], v[40:43]
    buffer_load_dwordx4 v12, s[16:19], s86 offen offset:3072 lds
    v_mfma_f32_16x16x32_bf16 v[44:47], v[228:231], v[80:83], v[44:47]
    s_waitcnt vmcnt(6) lgkmcnt(6)
    v_mfma_f32_16x16x32_bf16 v[48:51], v[64:67], v[84:87], v[48:51]
    ds_read_b64_tr_b16 v[60:61], v16 offset:61440
    ds_read_b64_tr_b16 v[62:63], v16 offset:63488
    v_mfma_f32_16x16x32_bf16 v[52:55], v[68:71], v[84:87], v[52:55]
    v_mfma_f32_16x16x32_bf16 v[40:43], v[232:235], v[84:87], v[40:43]
    v_mfma_f32_16x16x32_bf16 v[44:47], v[236:239], v[84:87], v[44:47]
    s_waitcnt vmcnt(5) lgkmcnt(4)
    v_mfma_f32_16x16x32_bf16 v[48:51], v[72:75], v[88:91], v[48:51]
    v_mfma_f32_16x16x32_bf16 v[52:55], v[76:79], v[88:91], v[52:55]
    v_mfma_f32_16x16x32_bf16 v[40:43], v[240:243], v[88:91], v[40:43]
    v_mfma_f32_16x16x32_bf16 v[44:47], v[244:247], v[88:91], v[44:47]
    s_waitcnt vmcnt(4) lgkmcnt(0)
    v_mfma_f32_16x16x32_bf16 v[48:51], v[56:59], v[92:95], v[48:51]
    v_mfma_f32_16x16x32_bf16 v[52:55], v[60:63], v[92:95], v[52:55]
    v_mfma_f32_16x16x32_bf16 v[40:43], v[248:251], v[92:95], v[40:43]
    v_mfma_f32_16x16x32_bf16 v[44:47], v[252:255], v[92:95], v[44:47]
    v_lshlrev_b32 v38, 4, v3
    s_nop 5
    v_pk_add_f32 v[80:81], v[40:41], v[42:43]
    v_pk_mul_f32 v[82:83], v[40:41], v[40:41]
    v_pk_add_f32 v[84:85], v[44:45], v[46:47]
    v_pk_mul_f32 v[86:87], v[44:45], v[44:45]
    v_pk_fma_f32 v[82:83], v[42:43], v[42:43], v[82:83]
    v_pk_fma_f32 v[86:87], v[46:47], v[46:47], v[86:87]
    v_pk_add_f32 v[80:81], v[80:81], v[48:49]
    v_pk_fma_f32 v[82:83], v[48:49], v[48:49], v[82:83]
    v_pk_add_f32 v[84:85], v[84:85], v[50:51]
    v_pk_fma_f32 v[86:87], v[50:51], v[50:51], v[86:87]
    v_pk_add_f32 v[80:81], v[80:81], v[52:53]
    v_pk_fma_f32 v[82:83], v[52:53], v[52:53], v[82:83]
    v_pk_add_f32 v[84:85], v[84:85], v[54:55]
    v_pk_fma_f32 v[86:87], v[54:55], v[54:55], v[86:87]
    v_pk_add_f32 v[80:81], v[80:81], v[84:85]
    v_pk_add_f32 v[82:83], v[82:83], v[86:87]
    v_add_f32 v80, v80, v81
    v_add_f32 v81, v82, v83
    s_nop 1
    v_permlane32_swap_b32 v80, v81
    v_add_f32 v80, v80, v81
    v_mov_b32 v82, v80
    s_nop 1
    v_permlane16_swap_b32 v80, v82
    v_add_f32 v80, v80, v82
    v_mov_b32 v81, v80
    s_nop 1
    v_permlane32_swap_b32 v80, v81
    s_mov_b64 exec, 0xffff
    v_max_f32 v81, 0, v81
    buffer_store_dwordx2 v[80:81], v38, s[32:35], s7 offen
    s_mov_b64 exec, -1
    s_mov_b64 exec, 0
    s_cmp_eq_u32 s54, 0
    s_cbranch_scc1 Lstub6
    s_cmp_eq_u32 s54, 1
    s_cbranch_scc1 Lstub7
    s_cmp_eq_u32 s54, 2
    s_cbranch_scc1 Lstub8
    s_branch Lstub9
Lwarmb:
    s_mov_b64 exec, -1
    v_cvt_pk_bf16_f32 v24, v40, v41
    v_cvt_pk_bf16_f32 v25, v42, v43
    v_cvt_pk_bf16_f32 v26, v44, v45
    v_cvt_pk_bf16_f32 v27, v46, v47
    v_cvt_pk_bf16_f32 v28, v48, v49
    v_cvt_pk_bf16_f32 v29, v50, v51
    v_cvt_pk_bf16_f32 v30, v52, v53
    v_cvt_pk_bf16_f32 v31, v54, v55
    v_mov_b32 v32, 0xc0135761
    v_mov_b32 v33, 0xc0135761
    v_subrev_u32 v13, 65536, v13
    v_subrev_u32 v14, 65536, v14
    v_subrev_u32 v15, 65536, v15
    v_subrev_u32 v16, 65536, v16
    v_lshl_add_u32 v38, v3, 2, s9
    buffer_load_dwordx4 v[84:87], v1, s[32:35], s6 offen sc1
    ds_read_b128 a[208:211], v20 offset:0
    ds_read_b128 a[212:215], v22 offset:0
    ds_read_b128 a[240:243], v21 offset:0
    ds_read_b128 a[244:247], v23 offset:0
    s_waitcnt lgkmcnt(0)
    s_xor_b32 s93, s87, 0
    s_add_u32 m0, s88, 0
    s_add_u32 s86, s93, s76
    buffer_load_dwordx4 v5, s[20:23], s86 offen lds
    buffer_load_dwordx4 v6, s[20:23], s86 offen offset:1024 lds
    buffer_load_dwordx4 v7, s[20:23], s86 offen offset:2048 lds
    buffer_load_dwordx4 v8, s[20:23], s86 offen offset:3072 lds
    s_bfe_u32 s44, s57, 196608
    s_lshl_b32 s44, s44, 12
    s_add_u32 s44, s44, s3
    s_bfe_u32 s45, s51, 131073
    s_lshl_b32 s45, s45, 10
    s_add_u32 s45, s45, s44
    s_lshr_b32 s59, s51, 3
    s_lshl_b32 s59, s59, 4
    s_add_u32 s45, s45, s59
    s_and_b32 s59, s51, 1
    s_lshl_b32 s59, s59, 3
    s_add_u32 s45, s45, s59
    s_lshl_b32 s46, s51, 8
    s_add_u32 s46, s46, s57
    s_lshl_b32 s46, s46, 10
    s_add_u32 s46, s46, 6291456
    s_and_b32 s60, s48, 1
    s_lshl_b32 s47, s51, 1
    s_add_u32 s47, s47, s60
    s_lshl_b32 s47, s47, 7
    s_add_u32 s47, s47, 10780672
    s_lshl_b32 s60, s54, 28
    s_add_u32 s47, s47, s60
    s_waitcnt vmcnt(4)
    v_max_u32 v39, v85, v87
    v_cmp_eq_u32 vcc, -1, v39
    s_cbranch_vccnz Lrt_13
Lrtd_14:
    v_pk_add_f32 v[80:81], v[84:85], v[86:87]
    s_nop 1
    v_permlane32_swap_b32 v80, v81
    v_add_f32 v80, v80, v81
    v_mov_b32 v82, v80
    s_nop 1
    v_permlane16_swap_b32 v80, v82
    v_add_f32 v80, v80, v82
    v_mov_b32 v81, v80
    s_nop 1
    v_permlane32_swap_b32 v80, v81
    v_mul_f32 v80, 0xbb000000, v80
    v_mul_f32 v81, 0x3b000000, v81
    v_fma_f32 v81, -v80, v80, v81
    v_max_f32 v81, 0, v81
    v_add_f32 v81, 0x3727c5ac, v81
    v_rsq_f32 v81, v81
    s_nop 0
    v_mul_f32 v80, v80, v81
    v_pk_fma_f32 v[40:41], v[40:41], v[80:81], v[80:81] op_sel:[0,1,0] op_sel_hi:[1,1,0]
    v_pk_fma_f32 v[42:43], v[42:43], v[80:81], v[80:81] op_sel:[0,1,0] op_sel_hi:[1,1,0]
    v_pk_fma_f32 v[44:45], v[44:45], v[80:81], v[80:81] op_sel:[0,1,0] op_sel_hi:[1,1,0]
    v_pk_fma_f32 v[46:47], v[46:47], v[80:81], v[80:81] op_sel:[0,1,0] op_sel_hi:[1,1,0]
    v_cvt_pk_bf16_f32 v84, v40, v41
    v_cvt_pk_bf16_f32 v85, v42, v43
    v_cvt_pk_bf16_f32 v86, v44, v45
    v_cvt_pk_bf16_f32 v87, v46, v47
    buffer_store_dwordx4 v[84:87], v1, s[32:35], s8 offen offset:0
    v_pk_fma_f32 v[48:49], v[48:49], v[80:81], v[80:81] op_sel:[0,1,0] op_sel_hi:[1,1,0]
    v_pk_fma_f32 v[50:51], v[50:51], v[80:81], v[80:81] op_sel:[0,1,0] op_sel_hi:[1,1,0]
    v_pk_fma_f32 v[52:53], v[52:53], v[80:81], v[80:81] op_sel:[0,1,0] op_sel_hi:[1,1,0]
    v_pk_fma_f32 v[54:55], v[54:55], v[80:81], v[80:81] op_sel:[0,1,0] op_sel_hi:[1,1,0]
    v_cvt_pk_bf16_f32 v88, v48, v49
    v_cvt_pk_bf16_f32 v89, v50, v51
    v_cvt_pk_bf16_f32 v90, v52, v53
    v_cvt_pk_bf16_f32 v91, v54, v55
    buffer_store_dwordx4 v[88:91], v1, s[32:35], s8 offen offset:1024
    ds_read_b128 a[216:219], v20 offset:4096
    ds_read_b128 a[220:223], v22 offset:4096
    ds_read_b128 a[248:251], v21 offset:4096
    ds_read_b128 a[252:255], v23 offset:4096
    s_waitcnt lgkmcnt(0)
    s_xor_b32 s93, s87, 131072
    s_add_u32 m0, s88, 4096
    s_add_u32 s86, s93, s76
    buffer_load_dwordx4 v5, s[20:23], s86 offen lds
    buffer_load_dwordx4 v6, s[20:23], s86 offen offset:1024 lds
    buffer_load_dwordx4 v7, s[20:23], s86 offen offset:2048 lds
    buffer_load_dwordx4 v8, s[20:23], s86 offen offset:3072 lds
    s_mov_b64 exec, 2
    s_waitcnt vmcnt(4)
    buffer_store_dword v0, off, s[32:35], s10 offset:0
    s_mov_b64 exec, -1
    s_barrier
    s_cmp_ge_u32 s51, 14
    s_cbranch_scc1 Lidle_16
    ds_read_b128 a[0:3], v20 offset:0
    ds_read_b128 a[4:7], v22 offset:0
    ds_read_b128 a[32:35], v21 offset:0
    ds_read_b128 a[36:39], v23 offset:0
    s_waitcnt lgkmcnt(0)
    s_xor_b32 s93, s87, 1048576
    s_add_u32 m0, s88, 0
    s_add_u32 s86, s93, s76
    buffer_load_dwordx4 v5, s[20:23], s86 offen lds
    buffer_load_dwordx4 v6, s[20:23], s86 offen offset:1024 lds
    buffer_load_dwordx4 v7, s[20:23], s86 offen offset:2048 lds
    buffer_load_dwordx4 v8, s[20:23], s86 offen offset:3072 lds
    s_mov_b32 s59, s1
    s_add_u32 s60, s1, 34816
    buffer_load_dword v39, v38, s[32:35], 0 offen sc1
    s_waitcnt vmcnt(6)
    ds_read_b128 a[8:11], v20 offset:4096
    ds_read_b128 a[12:15], v22 offset:4096
    ds_read_b128 a[40:43], v21 offset:4096
    ds_read_b128 a[44:47], v23 offset:4096
    s_waitcnt lgkmcnt(0)
    s_xor_b32 s93, s87, 1179648
    s_add_u32 m0, s88, 4096
    s_add_u32 s86, s93, s76
    buffer_load_dwordx4 v5, s[20:23], s86 offen lds
    buffer_load_dwordx4 v6, s[20:23], s86 offen offset:1024 lds
    buffer_load_dwordx4 v7, s[20:23], s86 offen offset:2048 lds
    buffer_load_dwordx4 v8, s[20:23], s86 offen offset:3072 lds
    s_waitcnt vmcnt(4)
    v_cmp_ne_u32 vcc, 1, v39
    s_cbranch_vccnz Lrt_18
Lrtd_19:
    buffer_load_dwordx4 v[128:131], v1, s[32:35], s59 offen offset:0 sc1
    buffer_load_dwordx4 v[132:135], v1, s[32:35], s60 offen offset:0 sc1
    buffer_load_dwordx4 v[136:139], v1, s[32:35], s59 offen offset:1024 sc1
    buffer_load_dwordx4 v[140:143], v1, s[32:35], s60 offen offset:1024 sc1
    buffer_load_dwordx4 v[144:147], v1, s[32:35], s59 offen offset:2048 sc1
    buffer_load_dwordx4 v[148:151], v1, s[32:35], s60 offen offset:2048 sc1
    buffer_load_dwordx4 v[152:155], v1, s[32:35], s59 offen offset:3072 sc1
    buffer_load_dwordx4 v[156:159], v1, s[32:35], s60 offen offset:3072 sc1
    ds_read_b64_tr_b16 v[104:105], v13 offset:0
    ds_read_b64_tr_b16 v[106:107], v13 offset:2048
    ds_read_b64_tr_b16 v[108:109], v14 offset:0
    ds_read_b64_tr_b16 v[110:111], v14 offset:2048
    ds_read_b64_tr_b16 v[112:113], v15 offset:0
    ds_read_b64_tr_b16 v[114:115], v15 offset:2048
    ds_read_b64_tr_b16 v[116:117], v16 offset:0
    ds_read_b64_tr_b16 v[118:119], v16 offset:2048
    ds_read_b64_tr_b16 v[120:121], v13 offset:4096
    ds_read_b64_tr_b16 v[122:123], v13 offset:6144
    s_waitcnt vmcnt(6) lgkmcnt(6)
    v_mfma_f32_16x16x32_bf16 v[40:43], v[128:131], v[104:107], 0
    s_add_u32 s59, s59, 4096
    ds_read_b64_tr_b16 v[124:125], v14 offset:4096
    ds_read_b64_tr_b16 v[126:127], v14 offset:6144
    v_mfma_f32_16x16x32_bf16 v[44:47], v[132:135], v[104:107], 0
    buffer_load_dwordx4 v[160:163], v1, s[32:35], s59 offen offset:0 sc1
    v_mfma_f32_16x16x32_bf16 v[48:51], v[128:131], v[108:111], 0
    s_add_u32 s60, s60, 4096
    ds_read_b64_tr_b16 v[104:105], v15 offset:4096
    ds_read_b64_tr_b16 v[106:107], v15 offset:6144
    v_mfma_f32_16x16x32_bf16 v[52:55], v[132:135], v[108:111], 0
    s_waitcnt lgkmcnt(6)
    v_mfma_f32_16x16x32_bf16 v[56:59], v[128:131], v[112:115], 0
    buffer_load_dwordx4 v[164:167], v1, s[32:35], s60 offen offset:0 sc1
    v_mfma_f32_16x16x32_bf16 v[60:63], v[132:135], v[112:115], 0
    ds_read_b64_tr_b16 v[108:109], v16 offset:4096
    ds_read_b64_tr_b16 v[110:111], v16 offset:6144
    v_mfma_f32_16x16x32_bf16 v[64:67], v[128:131], v[116:119], 0
    ds_read_b64_tr_b16 v[112:113], v13 offset:8192
    ds_read_b64_tr_b16 v[114:115], v13 offset:10240
    v_mfma_f32_16x16x32_bf16 v[68:71], v[132:135], v[116:119], 0
    s_waitcnt vmcnt(6) lgkmcnt(6)
    v_mfma_f32_16x16x32_bf16 v[40:43], v[136:139], v[120:123], v[40:43]
    buffer_load_dwordx4 v[168:171], v1, s[32:35], s59 offen offset:1024 sc1
    v_mfma_f32_16x16x32_bf16 v[44:47], v[140:143], v[120:123], v[44:47]
    ds_read_b64_tr_b16 v[116:117], v14 offset:8192
    ds_read_b64_tr_b16 v[118:119], v14 offset:10240
    v_mfma_f32_16x16x32_bf16 v[48:51], v[136:139], v[124:127], v[48:51]
    ds_read_b64_tr_b16 v[120:121], v15 offset:8192
    ds_read_b64_tr_b16 v[122:123], v15 offset:10240
    v_mfma_f32_16x16x32_bf16 v[52:55], v[140:143], v[124:127], v[52:55]
    s_waitcnt lgkmcnt(6)
    v_mfma_f32_16x16x32_bf16 v[56:59], v[136:139], v[104:107], v[56:59]
    buffer_load_dwordx4 v[172:175], v1, s[32:35], s60 offen offset:1024 sc1
    v_mfma_f32_16x16x32_bf16 v[60:63], v[140:143], v[104:107], v[60:63]
    ds_read_b64_tr_b16 v[124:125], v16 offset:8192
    ds_read_b64_tr_b16 v[126:127], v16 offset:10240
    v_mfma_f32_16x16x32_bf16 v[64:67], v[136:139], v[108:111], v[64:67]
    ds_read_b64_tr_b16 v[104:105], v13 offset:12288
    ds_read_b64_tr_b16 v[106:107], v13 offset:14336
    v_mfma_f32_16x16x32_bf16 v[68:71], v[140:143], v[108:111], v[68:71]
    s_waitcnt vmcnt(6) lgkmcnt(6)
    v_mfma_f32_16x16x32_bf16 v[40:43], v[144:147], v[112:115], v[40:43]
    buffer_load_dwordx4 v[176:179], v1, s[32:35], s59 offen offset:2048 sc1
    v_mfma_f32_16x16x32_bf16 v[44:47], v[148:151], v[112:115], v[44:47]
    ds_read_b64_tr_b16 v[108:109], v14 offset:12288
    ds_read_b64_tr_b16 v[110:111], v14 offset:14336
    v_mfma_f32_16x16x32_bf16 v[48:51], v[144:147], v[116:119], v[48:51]
    ds_read_b64_tr_b16 v[112:113], v15 offset:12288
    ds_read_b64_tr_b16 v[114:115], v15 offset:14336
    v_mfma_f32_16x16x32_bf16 v[52:55], v[148:151], v[116:119], v[52:55]
    s_waitcnt lgkmcnt(6)
    v_mfma_f32_16x16x32_bf16 v[56:59], v[144:147], v[120:123], v[56:59]
    buffer_load_dwordx4 v[180:183], v1, s[32:35], s60 offen offset:2048 sc1
    v_mfma_f32_16x16x32_bf16 v[60:63], v[148:151], v[120:123], v[60:63]
    ds_read_b64_tr_b16 v[116:117], v16 offset:12288
    ds_read_b64_tr_b16 v[118:119], v16 offset:14336
    v_mfma_f32_16x16x32_bf16 v[64:67], v[144:147], v[124:127], v[64:67]
    ds_read_b64_tr_b16 v[120:121], v13 offset:16384
    ds_read_b64_tr_b16 v[122:123], v13 offset:18432
    v_mfma_f32_16x16x32_bf16 v[68:71], v[148:151], v[124:127], v[68:71]
    s_waitcnt vmcnt(6) lgkmcnt(6)
    v_mfma_f32_16x16x32_bf16 v[40:43], v[152:155], v[104:107], v[40:43]
    buffer_load_dwordx4 v[184:187], v1, s[32:35], s59 offen offset:3072 sc1
    v_mfma_f32_16x16x32_bf16 v[44:47], v[156:159], v[104:107], v[44:47]
    ds_read_b64_tr_b16 v[124:125], v14 offset:16384
    ds_read_b64_tr_b16 v[126:127], v14 offset:18432
    v_mfma_f32_16x16x32_bf16 v[48:51], v[152:155], v[108:111], v[48:51]
    ds_read_b64_tr_b16 v[104:105], v15 offset:16384
    ds_read_b64_tr_b16 v[106:107], v15 offset:18432
    v_mfma_f32_16x16x32_bf16 v[52:55], v[156:159], v[108:111], v[52:55]
    s_waitcnt lgkmcnt(6)
    v_mfma_f32_16x16x32_bf16 v[56:59], v[152:155], v[112:115], v[56:59]
    buffer_load_dwordx4 v[188:191], v1, s[32:35], s60 offen offset:3072 sc1
    v_mfma_f32_16x16x32_bf16 v[60:63], v[156:159], v[112:115], v[60:63]
    ds_read_b64_tr_b16 v[108:109], v16 offset:16384
    ds_read_b64_tr_b16 v[110:111], v16 offset:18432
    v_mfma_f32_16x16x32_bf16 v[64:67], v[152:155], v[116:119], v[64:67]
    s_add_u32 s59, s59, 4096
    ds_read_b64_tr_b16 v[112:113], v13 offset:20480
    ds_read_b64_tr_b16 v[114:115], v13 offset:22528
    v_mfma_f32_16x16x32_bf16 v[68:71], v[156:159], v[116:119], v[68:71]
    s_waitcnt vmcnt(6) lgkmcnt(6)
    v_mfma_f32_16x16x32_bf16 v[40:43], v[160:163], v[120:123], v[40:43]
    buffer_load_dwordx4 v[192:195], v1, s[32:35], s59 offen offset:0 sc1
    v_mfma_f32_16x16x32_bf16 v[44:47], v[164:167], v[120:123], v[44:47]
    ds_read_b64_tr_b16 v[116:117], v14 offset:20480
    ds_read_b64_tr_b16 v[118:119], v14 offset:22528
    v_mfma_f32_16x16x32_bf16 v[48:51], v[160:163], v[124:127], v[48:51]
    s_add_u32 s60, s60, 4096
    ds_read_b64_tr_b16 v[120:121], v15 offset:20480
    ds_read_b64_tr_b16 v[122:123], v15 offset:22528
    v_mfma_f32_16x16x32_bf16 v[52:55], v[164:167], v[124:127], v[52:55]
    s_waitcnt lgkmcnt(6)
    v_mfma_f32_16x16x32_bf16 v[56:59], v[160:163], v[104:107], v[56:59]
    buffer_load_dwordx4 v[196:199], v1, s[32:35], s60 offen offset:0 sc1
    v_mfma_f32_16x16x32_bf16 v[60:63], v[164:167], v[104:107], v[60:63]
    ds_read_b64_tr_b16 v[124:125], v16 offset:20480
    ds_read_b64_tr_b16 v[126:127], v16 offset:22528
    v_mfma_f32_16x16x32_bf16 v[64:67], v[160:163], v[108:111], v[64:67]
    ds_read_b64_tr_b16 v[104:105], v13 offset:24576
    ds_read_b64_tr_b16 v[106:107], v13 offset:26624
    v_mfma_f32_16x16x32_bf16 v[68:71], v[164:167], v[108:111], v[68:71]
    s_waitcnt vmcnt(6) lgkmcnt(6)
    v_mfma_f32_16x16x32_bf16 v[40:43], v[168:171], v[112:115], v[40:43]
    buffer_load_dwordx4 v[200:203], v1, s[32:35], s59 offen offset:1024 sc1
    v_mfma_f32_16x16x32_bf16 v[44:47], v[172:175], v[112:115], v[44:47]
    ds_read_b64_tr_b16 v[108:109], v14 offset:24576
    ds_read_b64_tr_b16 v[110:111], v14 offset:26624
    v_mfma_f32_16x16x32_bf16 v[48:51], v[168:171], v[116:119], v[48:51]
    ds_read_b64_tr_b16 v[112:113], v15 offset:24576
    ds_read_b64_tr_b16 v[114:115], v15 offset:26624
    v_mfma_f32_16x16x32_bf16 v[52:55], v[172:175], v[116:119], v[52:55]
    s_waitcnt lgkmcnt(6)
    v_mfma_f32_16x16x32_bf16 v[56:59], v[168:171], v[120:123], v[56:59]
    buffer_load_dwordx4 v[204:207], v1, s[32:35], s60 offen offset:1024 sc1
    v_mfma_f32_16x16x32_bf16 v[60:63], v[172:175], v[120:123], v[60:63]
    ds_read_b64_tr_b16 v[116:117], v16 offset:24576
    ds_read_b64_tr_b16 v[118:119], v16 offset:26624
    v_mfma_f32_16x16x32_bf16 v[64:67], v[168:171], v[124:127], v[64:67]
    ds_read_b64_tr_b16 v[120:121], v13 offset:28672
    ds_read_b64_tr_b16 v[122:123], v13 offset:30720
    v_mfma_f32_16x16x32_bf16 v[68:71], v[172:175], v[124:127], v[68:71]
    s_waitcnt vmcnt(6) lgkmcnt(6)
    v_mfma_f32_16x16x32_bf16 v[40:43], v[176:179], v[104:107], v[40:43]
    buffer_load_dwordx4 v[208:211], v1, s[32:35], s59 offen offset:2048 sc1
    v_mfma_f32_16x16x32_bf16 v[44:47], v[180:183], v[104:107], v[44:47]
    ds_read_b64_tr_b16 v[124:125], v14 offset:28672
    ds_read_b64_tr_b16 v[126:127], v14 offset:30720
    v_mfma_f32_16x16x32_bf16 v[48:51], v[176:179], v[108:111], v[48:51]
    ds_read_b64_tr_b16 v[104:105], v15 offset:28672
    ds_read_b64_tr_b16 v[106:107], v15 offset:30720
    v_mfma_f32_16x16x32_bf16 v[52:55], v[180:183], v[108:111], v[52:55]
    s_waitcnt lgkmcnt(6)
    v_mfma_f32_16x16x32_bf16 v[56:59], v[176:179], v[112:115], v[56:59]
    buffer_load_dwordx4 v[212:215], v1, s[32:35], s60 offen offset:2048 sc1
    v_mfma_f32_16x16x32_bf16 v[60:63], v[180:183], v[112:115], v[60:63]
    ds_read_b64_tr_b16 v[108:109], v16 offset:28672
    ds_read_b64_tr_b16 v[110:111], v16 offset:30720
    v_mfma_f32_16x16x32_bf16 v[64:67], v[176:179], v[116:119], v[64:67]
    ds_read_b64_tr_b16 v[112:113], v13 offset:32768
    ds_read_b64_tr_b16 v[114:115], v13 offset:34816
    v_mfma_f32_16x16x32_bf16 v[68:71], v[180:183], v[116:119], v[68:71]
    s_waitcnt vmcnt(6) lgkmcnt(6)
    v_mfma_f32_16x16x32_bf16 v[40:43], v[184:187], v[120:123], v[40:43]
    buffer_load_dwordx4 v[216:219], v1, s[32:35], s59 offen offset:3072 sc1
    v_mfma_f32_16x16x32_bf16 v[44:47], v[188:191], v[120:123], v[44:47]
    ds_read_b64_tr_b16 v[116:117], v14 offset:32768
    ds_read_b64_tr_b16 v[118:119], v14 offset:34816
    v_mfma_f32_16x16x32_bf16 v[48:51], v[184:187], v[124:127], v[48:51]
    ds_read_b64_tr_b16 v[120:121], v15 offset:32768
    ds_read_b64_tr_b16 v[122:123], v15 offset:34816
    v_mfma_f32_16x16x32_bf16 v[52:55], v[188:191], v[124:127], v[52:55]
    s_waitcnt lgkmcnt(6)
    v_mfma_f32_16x16x32_bf16 v[56:59], v[184:187], v[104:107], v[56:59]
    buffer_load_dwordx4 v[220:223], v1, s[32:35], s60 offen offset:3072 sc1
    v_mfma_f32_16x16x32_bf16 v[60:63], v[188:191], v[104:107], v[60:63]
    ds_read_b64_tr_b16 v[124:125], v16 offset:32768
    ds_read_b64_tr_b16 v[126:127], v16 offset:34816
    v_mfma_f32_16x16x32_bf16 v[64:67], v[184:187], v[108:111], v[64:67]
    s_add_u32 s59, s59, 4096
    ds_read_b64_tr_b16 v[104:105], v13 offset:36864
    ds_read_b64_tr_b16 v[106:107], v13 offset:38912
    v_mfma_f32_16x16x32_bf16 v[68:71], v[188:191], v[108:111], v[68:71]
    s_waitcnt vmcnt(6) lgkmcnt(6)
    v_mfma_f32_16x16x32_bf16 v[40:43], v[192:195], v[112:115], v[40:43]
    buffer_load_dwordx4 v[224:227], v1, s[32:35], s59 offen offset:0 sc1
    v_mfma_f32_16x16x32_bf16 v[44:47], v[196:199], v[112:115], v[44:47]
    ds_read_b64_tr_b16 v[108:109], v14 offset:36864
    ds_read_b64_tr_b16 v[110:111], v14 offset:38912
    v_mfma_f32_16x16x32_bf16 v[48:51], v[192:195], v[116:119], v[48:51]
    s_add_u32 s60, s60, 4096
    ds_read_b64_tr_b16 v[112:113], v15 offset:36864
    ds_read_b64_tr_b16 v[114:115], v15 offset:38912
    v_mfma_f32_16x16x32_bf16 v[52:55], v[196:199], v[116:119], v[52:55]
    s_waitcnt lgkmcnt(6)
    v_mfma_f32_16x16x32_bf16 v[56:59], v[192:195], v[120:123], v[56:59]
    buffer_load_dwordx4 v[228:231], v1, s[32:35], s60 offen offset:0 sc1
    v_mfma_f32_16x16x32_bf16 v[60:63], v[196:199], v[120:123], v[60:63]
    ds_read_b64_tr_b16 v[116:117], v16 offset:36864
    ds_read_b64_tr_b16 v[118:119], v16 offset:38912
    v_mfma_f32_16x16x32_bf16 v[64:67], v[192:195], v[124:127], v[64:67]
    ds_read_b64_tr_b16 v[120:121], v13 offset:40960
    ds_read_b64_tr_b16 v[122:123], v13 offset:43008
    v_mfma_f32_16x16x32_bf16 v[68:71], v[196:199], v[124:127], v[68:71]
    s_waitcnt vmcnt(6) lgkmcnt(6)
    v_mfma_f32_16x16x32_bf16 v[40:43], v[200:203], v[104:107], v[40:43]
    buffer_load_dwordx4 v[232:235], v1, s[32:35], s59 offen offset:1024 sc1
    v_mfma_f32_16x16x32_bf16 v[44:47], v[204:207], v[104:107], v[44:47]
    ds_read_b64_tr_b16 v[124:125], v14 offset:40960
    ds_read_b64_tr_b16 v[126:127], v14 offset:43008
    v_mfma_f32_16x16x32_bf16 v[48:51], v[200:203], v[108:111], v[48:51]
    ds_read_b64_tr_b16 v[104:105], v15 offset:40960
    ds_read_b64_tr_b16 v[106:107], v15 offset:43008
    v_mfma_f32_16x16x32_bf16 v[52:55], v[204:207], v[108:111], v[52:55]
    s_waitcnt lgkmcnt(6)
    v_mfma_f32_16x16x32_bf16 v[56:59], v[200:203], v[112:115], v[56:59]
    buffer_load_dwordx4 v[236:239], v1, s[32:35], s60 offen offset:1024 sc1
    v_mfma_f32_16x16x32_bf16 v[60:63], v[204:207], v[112:115], v[60:63]
    ds_read_b64_tr_b16 v[108:109], v16 offset:40960
    ds_read_b64_tr_b16 v[110:111], v16 offset:43008
    v_mfma_f32_16x16x32_bf16 v[64:67], v[200:203], v[116:119], v[64:67]
    ds_read_b64_tr_b16 v[112:113], v13 offset:45056
    ds_read_b64_tr_b16 v[114:115], v13 offset:47104
    v_mfma_f32_16x16x32_bf16 v[68:71], v[204:207], v[116:119], v[68:71]
    s_waitcnt vmcnt(6) lgkmcnt(6)
    v_mfma_f32_16x16x32_bf16 v[40:43], v[208:211], v[120:123], v[40:43]
    buffer_load_dwordx4 v[240:243], v1, s[32:35], s59 offen offset:2048 sc1
    v_mfma_f32_16x16x32_bf16 v[44:47], v[212:215], v[120:123], v[44:47]
    ds_read_b64_tr_b16 v[116:117], v14 offset:45056
    ds_read_b64_tr_b16 v[118:119], v14 offset:47104
    v_mfma_f32_16x16x32_bf16 v[48:51], v[208:211], v[124:127], v[48:51]
    ds_read_b64_tr_b16 v[120:121], v15 offset:45056
    ds_read_b64_tr_b16 v[122:123], v15 offset:47104
    v_mfma_f32_16x16x32_bf16 v[52:55], v[212:215], v[124:127], v[52:55]
    s_waitcnt lgkmcnt(6)
    v_mfma_f32_16x16x32_bf16 v[56:59], v[208:211], v[104:107], v[56:59]
    buffer_load_dwordx4 v[244:247], v1, s[32:35], s60 offen offset:2048 sc1
    v_mfma_f32_16x16x32_bf16 v[60:63], v[212:215], v[104:107], v[60:63]
    ds_read_b64_tr_b16 v[124:125], v16 offset:45056
    ds_read_b64_tr_b16 v[126:127], v16 offset:47104
    v_mfma_f32_16x16x32_bf16 v[64:67], v[208:211], v[108:111], v[64:67]
    ds_read_b64_tr_b16 v[104:105], v13 offset:49152
    ds_read_b64_tr_b16 v[106:107], v13 offset:51200
    v_mfma_f32_16x16x32_bf16 v[68:71], v[212:215], v[108:111], v[68:71]
    s_waitcnt vmcnt(6) lgkmcnt(6)
    v_mfma_f32_16x16x32_bf16 v[40:43], v[216:219], v[112:115], v[40:43]
    buffer_load_dwordx4 v[248:251], v1, s[32:35], s59 offen offset:3072 sc1
    v_mfma_f32_16x16x32_bf16 v[44:47], v[220:223], v[112:115], v[44:47]
    ds_read_b64_tr_b16 v[108:109], v14 offset:49152
    ds_read_b64_tr_b16 v[110:111], v14 offset:51200
    v_mfma_f32_16x16x32_bf16 v[48:51], v[216:219], v[116:119], v[48:51]
    ds_read_b64_tr_b16 v[112:113], v15 offset:49152
    ds_read_b64_tr_b16 v[114:115], v15 offset:51200
    v_mfma_f32_16x16x32_bf16 v[52:55], v[220:223], v[116:119], v[52:55]
    s_waitcnt lgkmcnt(6)
    v_mfma_f32_16x16x32_bf16 v[56:59], v[216:219], v[120:123], v[56:59]
    buffer_load_dwordx4 v[252:255], v1, s[32:35], s60 offen offset:3072 sc1
    v_mfma_f32_16x16x32_bf16 v[60:63], v[220:223], v[120:123], v[60:63]
    ds_read_b64_tr_b16 v[116:117], v16 offset:49152
    ds_read_b64_tr_b16 v[118:119], v16 offset:51200
    v_mfma_f32_16x16x32_bf16 v[64:67], v[216:219], v[124:127], v[64:67]
    ds_read_b64_tr_b16 v[120:121], v13 offset:53248
    ds_read_b64_tr_b16 v[122:123], v13 offset:55296
    v_mfma_f32_16x16x32_bf16 v[68:71], v[220:223], v[124:127], v[68:71]
    s_waitcnt vmcnt(6) lgkmcnt(6)
    v_mfma_f32_16x16x32_bf16 v[40:43], v[224:227], v[104:107], v[40:43]
    ds_read_b64_tr_b16 v[124:125], v14 offset:53248
    ds_read_b64_tr_b16 v[126:127], v14 offset:55296
    v_mfma_f32_16x16x32_bf16 v[44:47], v[228:231], v[104:107], v[44:47]
    v_mfma_f32_16x16x32_bf16 v[48:51], v[224:227], v[108:111], v[48:51]
    ds_read_b64_tr_b16 v[104:105], v15 offset:53248
    ds_read_b64_tr_b16 v[106:107], v15 offset:55296
    v_mfma_f32_16x16x32_bf16 v[52:55], v[228:231], v[108:111], v[52:55]
    s_waitcnt lgkmcnt(6)
    v_mfma_f32_16x16x32_bf16 v[56:59], v[224:227], v[112:115], v[56:59]
    ds_read_b64_tr_b16 v[108:109], v16 offset:53248
    ds_read_b64_tr_b16 v[110:111], v16 offset:55296
    v_mfma_f32_16x16x32_bf16 v[60:63], v[228:231], v[112:115], v[60:63]
    v_and_b32 v17, 1, v0
    v_cmp_eq_u32 s[60:61], 1, v17
    v_mfma_f32_16x16x32_bf16 v[64:67], v[224:227], v[116:119], v[64:67]
    ds_read_b64_tr_b16 v[112:113], v13 offset:57344
    ds_read_b64_tr_b16 v[114:115], v13 offset:59392
    v_mfma_f32_16x16x32_bf16 v[68:71], v[228:231], v[116:119], v[68:71]
    s_waitcnt vmcnt(4) lgkmcnt(6)
    v_lshrrev_b32 v38, 2, v0
    v_lshl_or_b32 v38, v38, 1, v17
    v_mfma_f32_16x16x32_bf16 v[40:43], v[232:235], v[120:123], v[40:43]
    s_lshl_b32 s89, s51, 7
    s_mul_i32 s93, s54, 114688
    s_add_u32 s89, s89, s93
    s_add_u32 m0, s90, 98304
    s_add_u32 s86, s89, 0
    v_mfma_f32_16x16x32_bf16 v[44:47], v[236:239], v[120:123], v[44:47]
    buffer_load_dwordx4 v9, s[16:19], s86 offen lds
    v_mfma_f32_16x16x32_bf16 v[48:51], v[232:235], v[124:127], v[48:51]
    ds_read_b64_tr_b16 v[116:117], v14 offset:57344
    ds_read_b64_tr_b16 v[118:119], v14 offset:59392
    v_mfma_f32_16x16x32_bf16 v[52:55], v[236:239], v[124:127], v[52:55]
    s_waitcnt lgkmcnt(4)
    ds_read_b64_tr_b16 v[120:121], v15 offset:57344
    ds_read_b64_tr_b16 v[122:123], v15 offset:59392
    v_mfma_f32_16x16x32_bf16 v[56:59], v[232:235], v[104:107], v[56:59]
    buffer_load_dwordx4 v10, s[16:19], s86 offen offset:1024 lds
    v_mfma_f32_16x16x32_bf16 v[60:63], v[236:239], v[104:107], v[60:63]
    ds_read_b64_tr_b16 v[124:125], v16 offset:57344
    ds_read_b64_tr_b16 v[126:127], v16 offset:59392
    v_mfma_f32_16x16x32_bf16 v[64:67], v[232:235], v[108:111], v[64:67]
    ds_read_b64_tr_b16 v[104:105], v13 offset:61440
    ds_read_b64_tr_b16 v[106:107], v13 offset:63488
    v_mfma_f32_16x16x32_bf16 v[68:71], v[236:239], v[108:111], v[68:71]
    s_waitcnt vmcnt(4) lgkmcnt(6)
    v_lshlrev_b32 v38, 5, v38
    s_lshl_b32 s62, s54, 8
    v_mfma_f32_16x16x32_bf16 v[40:43], v[240:243], v[112:115], v[40:43]
    buffer_load_dwordx4 v11, s[16:19], s86 offen offset:2048 lds
    v_mfma_f32_16x16x32_bf16 v[44:47], v[244:247], v[112:115], v[44:47]
    s_add_u32 s62, s62, 81920
    ds_read_b64_tr_b16 v[108:109], v14 offset:61440
    ds_read_b64_tr_b16 v[110:111], v14 offset:63488
    v_mfma_f32_16x16x32_bf16 v[48:51], v[240:243], v[116:119], v[48:51]
    ds_read_b64_tr_b16 v[112:113], v15 offset:61440
    ds_read_b64_tr_b16 v[114:115], v15 offset:63488
    v_mfma_f32_16x16x32_bf16 v[52:55], v[244:247], v[116:119], v[52:55]
    s_waitcnt lgkmcnt(6)
    v_lshlrev_b32 v17, 7, v17
    v_lshrrev_b32 v35, 1, v0
    v_mfma_f32_16x16x32_bf16 v[56:59], v[240:243], v[120:123], v[56:59]
    buffer_load_dwordx4 v12, s[16:19], s86 offen offset:3072 lds
    v_mfma_f32_16x16x32_bf16 v[60:63], v[244:247], v[120:123], v[60:63]
    ds_read_b64_tr_b16 v[116:117], v16 offset:61440
    ds_read_b64_tr_b16 v[118:119], v16 offset:63488
    v_mfma_f32_16x16x32_bf16 v[64:67], v[240:243], v[124:127], v[64:67]
    v_lshl_add_u32 v17, v35, 2, v17
    v_add_u32 v17, s62, v17
    v_mfma_f32_16x16x32_bf16 v[68:71], v[244:247], v[124:127], v[68:71]
    s_waitcnt vmcnt(4) lgkmcnt(4)
    v_lshl_add_u32 v35, v4, 5, s62
    v_mfma_f32_16x16x32_bf16 v[40:43], v[248:251], v[104:107], v[40:43]
    s_add_u32 m0, s90, 114688
    s_add_u32 s86, s89, 458752
    v_mfma_f32_16x16x32_bf16 v[44:47], v[252:255], v[104:107], v[44:47]
    buffer_load_dwordx4 v9, s[16:19], s86 offen lds
    v_mfma_f32_16x16x32_bf16 v[48:51], v[248:251], v[108:111], v[48:51]
    v_mfma_f32_16x16x32_bf16 v[52:55], v[252:255], v[108:111], v[52:55]
    s_waitcnt lgkmcnt(0)
    v_mfma_f32_16x16x32_bf16 v[56:59], v[248:251], v[112:115], v[56:59]
    v_mfma_f32_16x16x32_bf16 v[60:63], v[252:255], v[112:115], v[60:63]
    buffer_load_dwordx4 v10, s[16:19], s86 offen offset:1024 lds
    v_mfma_f32_16x16x32_bf16 v[64:67], v[248:251], v[116:119], v[64:67]
    v_mfma_f32_16x16x32_bf16 v[68:71], v[252:255], v[116:119], v[68:71]
    v_pk_mul_f32 v[104:105], v[40:41], v[40:41]
    v_pk_mul_f32 v[106:107], v[42:43], v[42:43]
    v_pk_mul_f32 v[108:109], v[44:45], v[44:45]
    v_pk_mul_f32 v[110:111], v[46:47], v[46:47]
    v_pk_mul_f32 v[112:113], v[48:49], v[48:49]
    v_pk_mul_f32 v[114:115], v[50:51], v[50:51]
    v_pk_mul_f32 v[116:117], v[52:53], v[52:53]
    buffer_load_dwordx4 v11, s[16:19], s86 offen offset:2048 lds
    v_pk_mul_f32 v[118:119], v[54:55], v[54:55]
    v_pk_fma_f32 v[104:105], v[104:105], s[82:83], v[32:33]
    v_pk_fma_f32 v[106:107], v[106:107], s[82:83], v[32:33]
    v_pk_fma_f32 v[108:109], v[108:109], s[82:83], v[32:33]
    v_pk_fma_f32 v[110:111], v[110:111], s[82:83], v[32:33]
    v_pk_fma_f32 v[112:113], v[112:113], s[82:83], v[32:33]
    v_pk_fma_f32 v[114:115], v[114:115], s[82:83], v[32:33]
    v_pk_fma_f32 v[116:117], v[116:117], s[82:83], v[32:33]
    v_pk_fma_f32 v[118:119], v[118:119], s[82:83], v[32:33]
    v_pk_mul_f32 v[104:105], v[104:105], v[40:41]
    v_pk_mul_f32 v[106:107], v[106:107], v[42:43]
    v_pk_mul_f32 v[108:109], v[108:109], v[44:45]
    v_pk_mul_f32 v[110:111], v[110:111], v[46:47]
    v_pk_mul_f32 v[112:113], v[112:113], v[48:49]
    v_pk_mul_f32 v[114:115], v[114:115], v[50:51]
    v_pk_mul_f32 v[116:117], v[116:117], v[52:53]
    v_pk_mul_f32 v[118:119], v[118:119], v[54:55]
    buffer_load_dwordx4 v12, s[16:19], s86 offen offset:3072 lds
    v_exp_f32 v104, v104
    v_exp_f32 v105, v105
    v_exp_f32 v106, v106
    v_exp_f32 v107, v107
    v_exp_f32 v108, v108
    v_exp_f32 v109, v109
    v_exp_f32 v110, v110
    s_add_u32 m0, s90, 131072
    s_add_u32 s86, s89, 917504
    v_exp_f32 v111, v111
    v_exp_f32 v112, v112
    buffer_load_dwordx4 v9, s[16:19], s86 offen lds
    v_exp_f32 v113, v113
    v_exp_f32 v114, v114
    v_exp_f32 v115, v115
    v_exp_f32 v116, v116
    v_exp_f32 v117, v117
    v_exp_f32 v118, v118
    v_exp_f32 v119, v119
    v_pk_add_f32 v[104:105], v[104:105], s[84:85]
    v_pk_add_f32 v[106:107], v[106:107], s[84:85]
    buffer_load_dwordx4 v10, s[16:19], s86 offen offset:1024 lds
    v_pk_add_f32 v[108:109], v[108:109], s[84:85]
    v_pk_add_f32 v[110:111], v[110:111], s[84:85]
    v_pk_add_f32 v[112:113], v[112:113], s[84:85]
    v_pk_add_f32 v[114:115], v[114:115], s[84:85]
    v_pk_add_f32 v[116:117], v[116:117], s[84:85]
    v_pk_add_f32 v[118:119], v[118:119], s[84:85]
    v_rcp_f32 v104, v104
    v_rcp_f32 v105, v105
    v_rcp_f32 v106, v106
    v_rcp_f32 v107, v107
    v_rcp_f32 v108, v108
    v_rcp_f32 v109, v109
    buffer_load_dwordx4 v11, s[16:19], s86 offen offset:2048 lds
    v_rcp_f32 v110, v110
    v_rcp_f32 v111, v111
    v_rcp_f32 v112, v112
    v_rcp_f32 v113, v113
    v_rcp_f32 v114, v114
    v_rcp_f32 v115, v115
    v_rcp_f32 v116, v116
    v_rcp_f32 v117, v117
    buffer_load_dwordx4 v12, s[16:19], s86 offen offset:3072 lds
    v_rcp_f32 v118, v118
    v_rcp_f32 v119, v119
    v_pk_mul_f32 v[40:41], v[40:41], v[104:105]
    v_pk_mul_f32 v[42:43], v[42:43], v[106:107]
    v_pk_mul_f32 v[44:45], v[44:45], v[108:109]
    v_pk_mul_f32 v[46:47], v[46:47], v[110:111]
    v_pk_mul_f32 v[48:49], v[48:49], v[112:113]
    v_pk_mul_f32 v[50:51], v[50:51], v[114:115]
    v_pk_mul_f32 v[52:53], v[52:53], v[116:117]
    v_pk_mul_f32 v[54:55], v[54:55], v[118:119]
    v_pk_mul_f32 v[104:105], v[56:57], v[56:57]
    v_pk_mul_f32 v[106:107], v[58:59], v[58:59]
    v_pk_mul_f32 v[108:109], v[60:61], v[60:61]
    v_pk_mul_f32 v[110:111], v[62:63], v[62:63]
    v_pk_mul_f32 v[112:113], v[64:65], v[64:65]
    v_pk_mul_f32 v[114:115], v[66:67], v[66:67]
    v_pk_mul_f32 v[116:117], v[68:69], v[68:69]
    v_pk_mul_f32 v[118:119], v[70:71], v[70:71]
    v_pk_fma_f32 v[104:105], v[104:105], s[82:83], v[32:33]
    v_pk_fma_f32 v[106:107], v[106:107], s[82:83], v[32:33]
    v_pk_fma_f32 v[108:109], v[108:109], s[82:83], v[32:33]
    v_pk_fma_f32 v[110:111], v[110:111], s[82:83], v[32:33]
    v_pk_fma_f32 v[112:113], v[112:113], s[82:83], v[32:33]
    v_pk_fma_f32 v[114:115], v[114:115], s[82:83], v[32:33]
    v_pk_fma_f32 v[116:117], v[116:117], s[82:83], v[32:33]
    v_pk_fma_f32 v[118:119], v[118:119], s[82:83], v[32:33]
    v_pk_mul_f32 v[104:105], v[104:105], v[56:57]
    v_pk_mul_f32 v[106:107], v[106:107], v[58:59]
    v_pk_mul_f32 v[108:109], v[108:109], v[60:61]
    v_pk_mul_f32 v[110:111], v[110:111], v[62:63]
    v_pk_mul_f32 v[112:113], v[112:113], v[64:65]
    v_pk_mul_f32 v[114:115], v[114:115], v[66:67]
    v_pk_mul_f32 v[116:117], v[116:117], v[68:69]
    v_pk_mul_f32 v[118:119], v[118:119], v[70:71]
    v_exp_f32 v104, v104
    v_exp_f32 v105, v105
    v_exp_f32 v106, v106
    v_exp_f32 v107, v107
    v_exp_f32 v108, v108
    v_exp_f32 v109, v109
    v_exp_f32 v110, v110
    v_exp_f32 v111, v111
    v_exp_f32 v112, v112
    v_exp_f32 v113, v113
    v_exp_f32 v114, v114
    v_exp_f32 v115, v115
    v_exp_f32 v116, v116
    v_exp_f32 v117, v117
    v_exp_f32 v118, v118
    v_exp_f32 v119, v119
    v_pk_add_f32 v[104:105], v[104:105], s[84:85]
    v_pk_add_f32 v[106:107], v[106:107], s[84:85]
    v_pk_add_f32 v[108:109], v[108:109], s[84:85]
    v_pk_add_f32 v[110:111], v[110:111], s[84:85]
    v_pk_add_f32 v[112:113], v[112:113], s[84:85]
    v_pk_add_f32 v[114:115], v[114:115], s[84:85]
    v_pk_add_f32 v[116:117], v[116:117], s[84:85]
    v_pk_add_f32 v[118:119], v[118:119], s[84:85]
    v_rcp_f32 v104, v104
    v_rcp_f32 v105, v105
    v_rcp_f32 v106, v106
    v_rcp_f32 v107, v107
    v_rcp_f32 v108, v108
    v_rcp_f32 v109, v109
    v_rcp_f32 v110, v110
    v_rcp_f32 v111, v111
    v_rcp_f32 v112, v112
    v_rcp_f32 v113, v113
    v_rcp_f32 v114, v114
    v_rcp_f32 v115, v115
    v_rcp_f32 v116, v116
    v_rcp_f32 v117, v117
    v_rcp_f32 v118, v118
    v_rcp_f32 v119, v119
    v_pk_mul_f32 v[56:57], v[56:57], v[104:105]
    v_pk_mul_f32 v[58:59], v[58:59], v[106:107]
    v_pk_mul_f32 v[60:61], v[60:61], v[108:109]
    v_pk_mul_f32 v[62:63], v[62:63], v[110:111]
    v_pk_mul_f32 v[64:65], v[64:65], v[112:113]
    v_pk_mul_f32 v[66:67], v[66:67], v[114:115]
    v_pk_mul_f32 v[68:69], v[68:69], v[116:117]
    v_pk_mul_f32 v[70:71], v[70:71], v[118:119]
    v_pk_add_f32 v[104:105], v[40:41], v[48:49]
    v_pk_mul_f32 v[112:113], v[40:41], v[40:41]
    v_pk_add_f32 v[106:107], v[42:43], v[50:51]
    v_pk_mul_f32 v[114:115], v[42:43], v[42:43]
    v_pk_add_f32 v[108:109], v[44:45], v[52:53]
    v_pk_mul_f32 v[116:117], v[44:45], v[44:45]
    v_pk_add_f32 v[110:111], v[46:47], v[54:55]
    v_pk_mul_f32 v[118:119], v[46:47], v[46:47]
    v_pk_fma_f32 v[112:113], v[48:49], v[48:49], v[112:113]
    v_pk_fma_f32 v[114:115], v[50:51], v[50:51], v[114:115]
    v_pk_fma_f32 v[116:117], v[52:53], v[52:53], v[116:117]
    v_pk_fma_f32 v[118:119], v[54:55], v[54:55], v[118:119]
    v_pk_add_f32 v[104:105], v[104:105], v[56:57]
    v_pk_fma_f32 v[112:113], v[56:57], v[56:57], v[112:113]
    v_pk_add_f32 v[106:107], v[106:107], v[58:59]
    v_pk_fma_f32 v[114:115], v[58:59], v[58:59], v[114:115]
    v_pk_add_f32 v[108:109], v[108:109], v[60:61]
    v_pk_fma_f32 v[116:117], v[60:61], v[60:61], v[116:117]
    v_pk_add_f32 v[110:111], v[110:111], v[62:63]
    v_pk_fma_f32 v[118:119], v[62:63], v[62:63], v[118:119]
    v_pk_add_f32 v[104:105], v[104:105], v[64:65]
    v_pk_fma_f32 v[112:113], v[64:65], v[64:65], v[112:113]
    v_pk_add_f32 v[106:107], v[106:107], v[66:67]
    v_pk_fma_f32 v[114:115], v[66:67], v[66:67], v[114:115]
    v_pk_add_f32 v[108:109], v[108:109], v[68:69]
    v_pk_fma_f32 v[116:117], v[68:69], v[68:69], v[116:117]
    v_pk_add_f32 v[110:111], v[110:111], v[70:71]
    v_pk_fma_f32 v[118:119], v[70:71], v[70:71], v[118:119]
    v_add_f32_dpp v104, v104, v104 row_ror:8 row_mask:0xf bank_mask:0x3
    v_add_f32_dpp v105, v105, v105 row_ror:8 row_mask:0xf bank_mask:0x3
    v_add_f32_dpp v106, v106, v106 row_ror:8 row_mask:0xf bank_mask:0x3
    v_add_f32_dpp v107, v107, v107 row_ror:8 row_mask:0xf bank_mask:0x3
    v_add_f32_dpp v104, v108, v108 row_ror:8 row_mask:0xf bank_mask:0xc
    v_add_f32_dpp v105, v109, v109 row_ror:8 row_mask:0xf bank_mask:0xc
    v_add_f32_dpp v106, v110, v110 row_ror:8 row_mask:0xf bank_mask:0xc
    v_add_f32_dpp v107, v111, v111 row_ror:8 row_mask:0xf bank_mask:0xc
    v_add_f32_dpp v112, v112, v112 row_ror:8 row_mask:0xf bank_mask:0x3
    v_add_f32_dpp v113, v113, v113 row_ror:8 row_mask:0xf bank_mask:0x3
    v_add_f32_dpp v114, v114, v114 row_ror:8 row_mask:0xf bank_mask:0x3
    v_add_f32_dpp v115, v115, v115 row_ror:8 row_mask:0xf bank_mask:0x3
    v_add_f32_dpp v112, v116, v116 row_ror:8 row_mask:0xf bank_mask:0xc
    v_add_f32_dpp v113, v117, v117 row_ror:8 row_mask:0xf bank_mask:0xc
    v_add_f32_dpp v114, v118, v118 row_ror:8 row_mask:0xf bank_mask:0xc
    v_add_f32_dpp v115, v119, v119 row_ror:8 row_mask:0xf bank_mask:0xc
    v_add_f32_dpp v104, v104, v104 row_half_mirror row_mask:0xf bank_mask:0x5
    v_add_f32_dpp v105, v105, v105 row_half_mirror row_mask:0xf bank_mask:0x5
    v_add_f32_dpp v112, v112, v112 row_half_mirror row_mask:0xf bank_mask:0x5
    v_add_f32_dpp v113, v113, v113 row_half_mirror row_mask:0xf bank_mask:0x5
    v_add_f32_dpp v104, v106, v106 row_half_mirror row_mask:0xf bank_mask:0xa
    v_add_f32_dpp v105, v107, v107 row_half_mirror row_mask:0xf bank_mask:0xa
    v_add_f32_dpp v112, v114, v114 row_half_mirror row_mask:0xf bank_mask:0xa
    v_add_f32_dpp v113, v115, v115 row_half_mirror row_mask:0xf bank_mask:0xa
    v_add_f32_dpp v104, v104, v104 quad_perm:[1,0,3,2] row_mask:0xf bank_mask:0xf
    v_add_f32_dpp v105, v105, v105 quad_perm:[1,0,3,2] row_mask:0xf bank_mask:0xf
    v_add_f32_dpp v112, v112, v112 quad_perm:[1,0,3,2] row_mask:0xf bank_mask:0xf
    v_add_f32_dpp v113, v113, v113 quad_perm:[1,0,3,2] row_mask:0xf bank_mask:0xf
    v_add_f32_dpp v104, v104, v104 quad_perm:[2,3,0,1] row_mask:0xf bank_mask:0xf
    v_add_f32_dpp v105, v105, v105 quad_perm:[2,3,0,1] row_mask:0xf bank_mask:0xf
    v_add_f32_dpp v112, v112, v112 quad_perm:[2,3,0,1] row_mask:0xf bank_mask:0xf
    v_add_f32_dpp v113, v113, v113 quad_perm:[2,3,0,1] row_mask:0xf bank_mask:0xf
    v_cndmask_b32 v112, v112, v113, s[60:61]
    v_cndmask_b32 v104, v104, v105, s[60:61]
    s_mov_b32 exec_lo, 0x33333333
    s_mov_b32 exec_hi, 0x33333333
    v_max_f32 v105, 0, v112
    buffer_store_dwordx2 v[104:105], v38, s[32:35], s45 offen
    s_mov_b64 exec, -1
    v_add_u32 v13, 65536, v13
    v_add_u32 v14, 65536, v14
    v_add_u32 v15, 65536, v15
    v_add_u32 v16, 65536, v16
    s_waitcnt vmcnt(1)
    s_waitcnt lgkmcnt(0)
    s_barrier
    ds_read_b64_tr_b16 v[104:105], v13 offset:0
    ds_read_b64_tr_b16 v[106:107], v13 offset:2048
    ds_read_b64_tr_b16 v[108:109], v14 offset:0
    ds_read_b64_tr_b16 v[110:111], v14 offset:2048
    ds_read_b64_tr_b16 v[112:113], v15 offset:0
    ds_read_b64_tr_b16 v[114:115], v15 offset:2048
    ds_read_b64_tr_b16 v[116:117], v16 offset:0
    ds_read_b64_tr_b16 v[118:119], v16 offset:2048
    ds_read_b64_tr_b16 v[120:121], v13 offset:4096
    ds_read_b64_tr_b16 v[122:123], v13 offset:6144
    s_waitcnt lgkmcnt(6)
    v_mfma_f32_16x16x32_bf16 v[72:75], v[104:107], v[128:131], 0
    ds_read_b64_tr_b16 v[124:125], v14 offset:4096
    ds_read_b64_tr_b16 v[126:127], v14 offset:6144
    v_mfma_f32_16x16x32_bf16 v[76:79], v[104:107], v[132:135], 0
    v_mfma_f32_16x16x32_bf16 v[80:83], v[108:111], v[128:131], 0
    ds_read_b64_tr_b16 v[104:105], v15 offset:4096
    ds_read_b64_tr_b16 v[106:107], v15 offset:6144
    v_mfma_f32_16x16x32_bf16 v[84:87], v[108:111], v[132:135], 0
    s_waitcnt lgkmcnt(6)
    v_mfma_f32_16x16x32_bf16 v[88:91], v[112:115], v[128:131], 0
    s_xor_b32 s93, s87, 0
    s_add_u32 m0, s88, 32768
    s_add_u32 s86, s93, s77
    v_mfma_f32_16x16x32_bf16 v[92:95], v[112:115], v[132:135], 0
    buffer_load_dwordx4 v5, s[20:23], s86 offen lds
    v_mfma_f32_16x16x32_bf16 v[96:99], v[116:119], v[128:131], 0
    ds_read_b64_tr_b16 v[108:109], v16 offset:4096
    ds_read_b64_tr_b16 v[110:111], v16 offset:6144
    v_mfma_f32_16x16x32_bf16 v[100:103], v[116:119], v[132:135], 0
    s_waitcnt lgkmcnt(4)
    ds_read_b64_tr_b16 v[112:113], v13 offset:8192
    ds_read_b64_tr_b16 v[114:115], v13 offset:10240
    v_mfma_f32_16x16x32_bf16 v[72:75], v[120:123], v[136:139], v[72:75]
    buffer_load_dwordx4 v6, s[20:23], s86 offen offset:1024 lds
    v_mfma_f32_16x16x32_bf16 v[76:79], v[120:123], v[140:143], v[76:79]
    ds_read_b64_tr_b16 v[116:117], v14 offset:8192
    ds_read_b64_tr_b16 v[118:119], v14 offset:10240
    v_mfma_f32_16x16x32_bf16 v[80:83], v[124:127], v[136:139], v[80:83]
    ds_read_b64_tr_b16 v[120:121], v15 offset:8192
    ds_read_b64_tr_b16 v[122:123], v15 offset:10240
    v_mfma_f32_16x16x32_bf16 v[84:87], v[124:127], v[140:143], v[84:87]
    s_waitcnt lgkmcnt(6)
    v_mfma_f32_16x16x32_bf16 v[88:91], v[104:107], v[136:139], v[88:91]
    buffer_load_dwordx4 v7, s[20:23], s86 offen offset:2048 lds
    v_mfma_f32_16x16x32_bf16 v[92:95], v[104:107], v[140:143], v[92:95]
    ds_read_b64_tr_b16 v[124:125], v16 offset:8192
    ds_read_b64_tr_b16 v[126:127], v16 offset:10240
    v_mfma_f32_16x16x32_bf16 v[96:99], v[108:111], v[136:139], v[96:99]
    ds_read_b64_tr_b16 v[104:105], v13 offset:12288
    ds_read_b64_tr_b16 v[106:107], v13 offset:14336
    v_mfma_f32_16x16x32_bf16 v[100:103], v[108:111], v[140:143], v[100:103]
    s_waitcnt lgkmcnt(6)
    buffer_load_dwordx4 v[128:131], v1, s[32:35], s44 offen offset:0 sc1
    buffer_load_dwordx4 v[132:135], v1, s[32:35], s44 offen offset:1024 sc1
    buffer_load_dwordx4 v[136:139], v1, s[32:35], s44 offen offset:2048 sc1
    buffer_load_dwordx4 v[140:143], v1, s[32:35], s44 offen offset:3072 sc1
    v_mfma_f32_16x16x32_bf16 v[72:75], v[112:115], v[144:147], v[72:75]
    buffer_load_dwordx4 v8, s[20:23], s86 offen offset:3072 lds
    v_mfma_f32_16x16x32_bf16 v[76:79], v[112:115], v[148:151], v[76:79]
    ds_read_b64_tr_b16 v[108:109], v14 offset:12288
    ds_read_b64_tr_b16 v[110:111], v14 offset:14336
    v_mfma_f32_16x16x32_bf16 v[80:83], v[116:119], v[144:147], v[80:83]
    ds_read_b64_tr_b16 v[112:113], v15 offset:12288
    ds_read_b64_tr_b16 v[114:115], v15 offset:14336
    v_mfma_f32_16x16x32_bf16 v[84:87], v[116:119], v[148:151], v[84:87]
    s_waitcnt lgkmcnt(6)
    v_mfma_f32_16x16x32_bf16 v[88:91], v[120:123], v[144:147], v[88:91]
    s_add_u32 m0, s90, 147456
    s_add_u32 s86, s89, 1376256
    ds_read_b64_tr_b16 v[116:117], v16 offset:12288
    v_mfma_f32_16x16x32_bf16 v[92:95], v[120:123], v[148:151], v[92:95]
    buffer_load_dwordx4 v9, s[16:19], s86 offen lds
    v_mfma_f32_16x16x32_bf16 v[96:99], v[124:127], v[144:147], v[96:99]
    ds_read_b64_tr_b16 v[118:119], v16 offset:14336
    ds_read_b64_tr_b16 v[120:121], v13 offset:16384
    v_mfma_f32_16x16x32_bf16 v[100:103], v[124:127], v[148:151], v[100:103]
    s_waitcnt lgkmcnt(5)
    ds_read_b64_tr_b16 v[122:123], v13 offset:18432
    v_mfma_f32_16x16x32_bf16 v[72:75], v[104:107], v[152:155], v[72:75]
    ds_read_b64_tr_b16 v[124:125], v14 offset:16384
    ds_read_b64_tr_b16 v[126:127], v14 offset:18432
    v_mfma_f32_16x16x32_bf16 v[76:79], v[104:107], v[156:159], v[76:79]
    buffer_load_dwordx4 v10, s[16:19], s86 offen offset:1024 lds
    v_mfma_f32_16x16x32_bf16 v[80:83], v[108:111], v[152:155], v[80:83]
    ds_read_b64_tr_b16 v[104:105], v15 offset:16384
    ds_read_b64_tr_b16 v[106:107], v15 offset:18432
    v_mfma_f32_16x16x32_bf16 v[84:87], v[108:111], v[156:159], v[84:87]
    s_waitcnt lgkmcnt(6)
    v_mfma_f32_16x16x32_bf16 v[88:91], v[112:115], v[152:155], v[88:91]
Lstub6:
    s_cbranch_execz Lwarmb
    ds_read_b64_tr_b16 v[108:109], v16 offset:16384
    ds_read_b64_tr_b16 v[110:111], v16 offset:18432
    v_mfma_f32_16x16x32_bf16 v[92:95], v[112:115], v[156:159], v[92:95]
    buffer_load_dwordx4 v11, s[16:19], s86 offen offset:2048 lds
    v_mfma_f32_16x16x32_bf16 v[96:99], v[116:119], v[152:155], v[96:99]
    ds_read_b64_tr_b16 v[112:113], v13 offset:20480
    ds_read_b64_tr_b16 v[114:115], v13 offset:22528
    v_mfma_f32_16x16x32_bf16 v[100:103], v[116:119], v[156:159], v[100:103]
    s_waitcnt lgkmcnt(6)
    s_waitcnt vmcnt(7)
    v_max_u32 v39, v129, v131
    s_waitcnt vmcnt(4)
    v_cndmask_b32_e64 v140, v140, 0, s[60:61]
    v_cndmask_b32_e64 v141, v141, 0, s[60:61]
    v_cndmask_b32_e64 v142, v142, 0, s[60:61]
    v_cndmask_b32_e64 v143, v143, 0, s[60:61]
    v_max3_u32 v39, v39, v133, v135
    v_max3_u32 v39, v39, v137, v139
    v_max3_u32 v39, v39, v141, v143
    v_cmp_eq_u32 vcc, -1, v39
    s_cbranch_vccnz Lrt_21
Lrtd_22:
    v_mfma_f32_16x16x32_bf16 v[72:75], v[120:123], v[160:163], v[72:75]
    ds_read_b64_tr_b16 v[116:117], v14 offset:20480
    ds_read_b64_tr_b16 v[118:119], v14 offset:22528
    v_add_f32 v128, v128, v136
    v_mfma_f32_16x16x32_bf16 v[76:79], v[120:123], v[164:167], v[76:79]
    buffer_load_dwordx4 v12, s[16:19], s86 offen offset:3072 lds
    v_mfma_f32_16x16x32_bf16 v[80:83], v[124:127], v[160:163], v[80:83]
    ds_read_b64_tr_b16 v[120:121], v15 offset:20480
    ds_read_b64_tr_b16 v[122:123], v15 offset:22528
    v_add_f32 v129, v129, v137
    v_mfma_f32_16x16x32_bf16 v[84:87], v[124:127], v[164:167], v[84:87]
    s_waitcnt lgkmcnt(6)
    v_add_f32 v130, v130, v138
    v_add_f32 v131, v131, v139
    v_add_f32 v132, v132, v140
    v_mfma_f32_16x16x32_bf16 v[88:91], v[104:107], v[160:163], v[88:91]
    ds_read_b64_tr_b16 v[124:125], v16 offset:20480
    ds_read_b64_tr_b16 v[126:127], v16 offset:22528
    v_add_f32 v133, v133, v141
    v_mfma_f32_16x16x32_bf16 v[92:95], v[104:107], v[164:167], v[92:95]
    s_xor_b32 s93, s87, 131072
    s_add_u32 m0, s88, 36864
    s_add_u32 s86, s93, s77
    v_add_f32 v134, v134, v142
    v_mfma_f32_16x16x32_bf16 v[96:99], v[108:111], v[160:163], v[96:99]
    buffer_load_dwordx4 v5, s[20:23], s86 offen lds
    v_mfma_f32_16x16x32_bf16 v[100:103], v[108:111], v[164:167], v[100:103]
    s_waitcnt lgkmcnt(4)
    ds_read_b64_tr_b16 v[104:105], v13 offset:24576
    ds_read_b64_tr_b16 v[106:107], v13 offset:26624
    v_add_f32 v135, v135, v143
    v_mfma_f32_16x16x32_bf16 v[72:75], v[112:115], v[168:171], v[72:75]
    ds_read_b64_tr_b16 v[108:109], v14 offset:24576
    ds_read_b64_tr_b16 v[110:111], v14 offset:26624
    v_add_f32 v128, v128, v132
    v_mfma_f32_16x16x32_bf16 v[76:79], v[112:115], v[172:175], v[76:79]
    v_add_f32 v129, v129, v133
    v_add_f32 v130, v130, v134
    v_add_f32 v131, v131, v135
    v_mfma_f32_16x16x32_bf16 v[80:83], v[116:119], v[168:171], v[80:83]
    buffer_load_dwordx4 v6, s[20:23], s86 offen offset:1024 lds
    v_mfma_f32_16x16x32_bf16 v[84:87], v[116:119], v[172:175], v[84:87]
    s_waitcnt lgkmcnt(4)
    ds_read_b64_tr_b16 v[112:113], v15 offset:24576
    ds_read_b64_tr_b16 v[114:115], v15 offset:26624
    v_add_f32 v128, v128, v130
    v_mfma_f32_16x16x32_bf16 v[88:91], v[120:123], v[168:171], v[88:91]
    ds_read_b64_tr_b16 v[116:117], v16 offset:24576
    ds_read_b64_tr_b16 v[118:119], v16 offset:26624
    v_add_f32 v129, v129, v131
    v_mfma_f32_16x16x32_bf16 v[92:95], v[120:123], v[172:175], v[92:95]
    v_add_f32_dpp v128, v128, v128 quad_perm:[1,0,3,2] row_mask:0xf bank_mask:0xf
    v_add_f32_dpp v129, v129, v129 quad_perm:[1,0,3,2] row_mask:0xf bank_mask:0xf
    v_mul_f32 v128, 0xba924925, v128
    v_mfma_f32_16x16x32_bf16 v[96:99], v[124:127], v[168:171], v[96:99]
    buffer_load_dwordx4 v7, s[20:23], s86 offen offset:2048 lds
    v_mfma_f32_16x16x32_bf16 v[100:103], v[124:127], v[172:175], v[100:103]
    s_waitcnt lgkmcnt(4)
    ds_read_b64_tr_b16 v[120:121], v13 offset:28672
    ds_read_b64_tr_b16 v[122:123], v13 offset:30720
    v_mul_f32 v129, 0x3a924925, v129
    v_fma_f32 v129, -v128, v128, v129
    v_max_f32 v129, 0, v129
    v_add_f32 v129, 0x3727c5ac, v129
    v_rsq_f32 v129, v129
    s_nop 0
    v_mul_f32 v128, v128, v129
    v_cndmask_b32 v128, v128, v129, s[60:61]
    ds_write_b32 v17, v128
    ds_read_b128 v[132:135], v35 offset:0
    ds_read_b128 v[140:143], v35 offset:128
    ds_read_b128 v[136:139], v35 offset:16
    ds_read_b128 v[144:147], v35 offset:144
    s_waitcnt lgkmcnt(2)
    v_pk_fma_f32 v[40:41], v[40:41], v[140:141], v[132:133]
    v_pk_fma_f32 v[42:43], v[42:43], v[142:143], v[134:135]
    s_waitcnt lgkmcnt(0)
    v_pk_fma_f32 v[44:45], v[44:45], v[144:145], v[136:137]
    v_pk_fma_f32 v[46:47], v[46:47], v[146:147], v[138:139]
    v_cvt_pk_bf16_f32 v148, v40, v41
    v_cvt_pk_bf16_f32 v149, v42, v43
    v_cvt_pk_bf16_f32 v150, v44, v45
    v_cvt_pk_bf16_f32 v151, v46, v47
    buffer_store_dwordx4 v[148:151], v1, s[32:35], s46 offen sc1
    s_add_u32 s46, s46, 65536
    v_pk_fma_f32 v[48:49], v[48:49], v[140:141], v[132:133]
    v_pk_fma_f32 v[50:51], v[50:51], v[142:143], v[134:135]
    v_pk_fma_f32 v[52:53], v[52:53], v[144:145], v[136:137]
    v_pk_fma_f32 v[54:55], v[54:55], v[146:147], v[138:139]
    v_cvt_pk_bf16_f32 v152, v48, v49
    v_cvt_pk_bf16_f32 v153, v50, v51
    v_cvt_pk_bf16_f32 v154, v52, v53
    v_cvt_pk_bf16_f32 v155, v54, v55
    buffer_store_dwordx4 v[152:155], v1, s[32:35], s46 offen sc1
    s_add_u32 s46, s46, 65536
    v_pk_fma_f32 v[56:57], v[56:57], v[140:141], v[132:133]
    v_pk_fma_f32 v[58:59], v[58:59], v[142:143], v[134:135]
    v_pk_fma_f32 v[60:61], v[60:61], v[144:145], v[136:137]
    v_pk_fma_f32 v[62:63], v[62:63], v[146:147], v[138:139]
    v_cvt_pk_bf16_f32 v156, v56, v57
    v_cvt_pk_bf16_f32 v157, v58, v59
    v_cvt_pk_bf16_f32 v158, v60, v61
    v_cvt_pk_bf16_f32 v159, v62, v63
    buffer_store_dwordx4 v[156:159], v1, s[32:35], s46 offen sc1
    s_add_u32 s46, s46, 65536
    v_pk_fma_f32 v[64:65], v[64:65], v[140:141], v[132:133]
    v_pk_fma_f32 v[66:67], v[66:67], v[142:143], v[134:135]
    v_pk_fma_f32 v[68:69], v[68:69], v[144:145], v[136:137]
    v_pk_fma_f32 v[70:71], v[70:71], v[146:147], v[138:139]
    v_cvt_pk_bf16_f32 v160, v64, v65
    v_cvt_pk_bf16_f32 v161, v66, v67
    v_cvt_pk_bf16_f32 v162, v68, v69
    v_cvt_pk_bf16_f32 v163, v70, v71
    buffer_store_dwordx4 v[160:163], v1, s[32:35], s46 offen sc1
    v_mfma_f32_16x16x32_bf16 v[72:75], v[104:107], v[176:179], v[72:75]
    s_mul_i32 s59, s53, 7
    ds_read_b64_tr_b16 v[124:125], v14 offset:28672
    ds_read_b64_tr_b16 v[126:127], v14 offset:30720
    v_mfma_f32_16x16x32_bf16 v[76:79], v[104:107], v[180:183], v[76:79]
    v_min_u32 v46, 6, v0
    v_add_u32 v46, s59, v46
    v_mfma_f32_16x16x32_bf16 v[80:83], v[108:111], v[176:179], v[80:83]
    buffer_load_dwordx4 v8, s[20:23], s86 offen offset:3072 lds
    v_mfma_f32_16x16x32_bf16 v[84:87], v[108:111], v[180:183], v[84:87]
    ds_read_b64_tr_b16 v[104:105], v15 offset:28672
    ds_read_b64_tr_b16 v[106:107], v15 offset:30720
    v_mfma_f32_16x16x32_bf16 v[88:91], v[112:115], v[176:179], v[88:91]
    ds_read_b128 a[16:19], v20 offset:0
    ds_read_b64_tr_b16 v[108:109], v16 offset:28672
    v_mfma_f32_16x16x32_bf16 v[92:95], v[112:115], v[180:183], v[92:95]
    ds_read_b128 a[20:23], v22 offset:0
    ds_read_b64_tr_b16 v[110:111], v16 offset:30720
    v_mfma_f32_16x16x32_bf16 v[96:99], v[116:119], v[176:179], v[96:99]
    ds_read_b128 a[48:51], v21 offset:0
    ds_read_b64_tr_b16 v[112:113], v13 offset:32768
    v_mfma_f32_16x16x32_bf16 v[100:103], v[116:119], v[180:183], v[100:103]
    s_waitcnt lgkmcnt(8)
    ds_read_b64_tr_b16 v[114:115], v13 offset:34816
    v_lshrrev_b32 v46, 2, v46
    v_mfma_f32_16x16x32_bf16 v[72:75], v[120:123], v[184:187], v[72:75]
    ds_read_b128 a[52:55], v23 offset:0
    ds_read_b64_tr_b16 v[116:117], v14 offset:32768
    v_mfma_f32_16x16x32_bf16 v[76:79], v[120:123], v[188:191], v[76:79]
    s_andn2_b32 s63, 1, s48
    ds_read_b64_tr_b16 v[118:119], v14 offset:34816
    s_lshl_b32 s59, s63, 7
    v_mfma_f32_16x16x32_bf16 v[80:83], v[124:127], v[184:187], v[80:83]
    s_waitcnt lgkmcnt(2)
    s_xor_b32 s93, s87, 1048576
    s_add_u32 m0, s88, 0
    s_add_u32 s86, s93, s77
    v_mfma_f32_16x16x32_bf16 v[84:87], v[124:127], v[188:191], v[84:87]
    ds_read_b64_tr_b16 v[120:121], v15 offset:32768
    ds_read_b64_tr_b16 v[122:123], v15 offset:34816
    v_mfma_f32_16x16x32_bf16 v[88:91], v[104:107], v[184:187], v[88:91]
    buffer_load_dwordx4 v5, s[20:23], s86 offen lds
    v_mfma_f32_16x16x32_bf16 v[92:95], v[104:107], v[188:191], v[92:95]
    s_add_u32 s59, s59, 10780672
    ds_read_b64_tr_b16 v[124:125], v16 offset:32768
    ds_read_b64_tr_b16 v[126:127], v16 offset:34816
    v_mfma_f32_16x16x32_bf16 v[96:99], v[108:111], v[184:187], v[96:99]
    s_lshl_b32 s62, s54, 28
    ds_read_b64_tr_b16 v[104:105], v13 offset:36864
    ds_read_b64_tr_b16 v[106:107], v13 offset:38912
    v_mfma_f32_16x16x32_bf16 v[100:103], v[108:111], v[188:191], v[100:103]
    s_waitcnt lgkmcnt(6)
    s_add_u32 s59, s59, s62
    v_lshl_add_u32 v57, v46, 8, s59
    v_mfma_f32_16x16x32_bf16 v[72:75], v[112:115], v[192:195], v[72:75]
    buffer_load_dwordx4 v6, s[20:23], s86 offen offset:1024 lds
    v_mfma_f32_16x16x32_bf16 v[76:79], v[112:115], v[196:199], v[76:79]
    s_min_u32 s5, s54, 1
    ds_read_b64_tr_b16 v[108:109], v14 offset:36864
    ds_read_b64_tr_b16 v[110:111], v14 offset:38912
    v_mfma_f32_16x16x32_bf16 v[80:83], v[116:119], v[192:195], v[80:83]
    s_xor_b32 s5, s5, 1
    ds_read_b64_tr_b16 v[112:113], v15 offset:36864
    ds_read_b64_tr_b16 v[114:115], v15 offset:38912
    v_mfma_f32_16x16x32_bf16 v[84:87], v[116:119], v[196:199], v[84:87]
    s_waitcnt lgkmcnt(6)
    s_mul_i32 s5, s5, 7
    s_bfe_u32 s59, s58, 196609
    v_mfma_f32_16x16x32_bf16 v[88:91], v[120:123], v[192:195], v[88:91]
    buffer_load_dwordx4 v7, s[20:23], s86 offen offset:2048 lds
    v_mfma_f32_16x16x32_bf16 v[92:95], v[120:123], v[196:199], v[92:95]
    s_lshl_b32 s59, s59, 7
    ds_read_b64_tr_b16 v[116:117], v16 offset:36864
    ds_read_b64_tr_b16 v[118:119], v16 offset:38912
    v_mfma_f32_16x16x32_bf16 v[96:99], v[124:127], v[192:195], v[96:99]
    s_add_u32 s59, s59, s3
    ds_read_b64_tr_b16 v[120:121], v13 offset:40960
    ds_read_b64_tr_b16 v[122:123], v13 offset:43008
    v_mfma_f32_16x16x32_bf16 v[100:103], v[124:127], v[196:199], v[100:103]
    s_waitcnt lgkmcnt(6)
    s_add_u32 s59, s59, 51200
    v_lshl_add_u32 v40, v46, 2, s59
    v_mfma_f32_16x16x32_bf16 v[72:75], v[104:107], v[200:203], v[72:75]
    buffer_load_dwordx4 v8, s[20:23], s86 offen offset:3072 lds
    v_mfma_f32_16x16x32_bf16 v[76:79], v[104:107], v[204:207], v[76:79]
    ds_read_b128 a[24:27], v20 offset:4096
    ds_read_b64_tr_b16 v[124:125], v14 offset:40960
    v_mfma_f32_16x16x32_bf16 v[80:83], v[108:111], v[200:203], v[80:83]
    ds_read_b128 a[28:31], v22 offset:4096
    ds_read_b64_tr_b16 v[126:127], v14 offset:43008
    v_mfma_f32_16x16x32_bf16 v[84:87], v[108:111], v[204:207], v[84:87]
    s_waitcnt lgkmcnt(6)
    ds_read_b64_tr_b16 v[104:105], v15 offset:40960
    ds_read_b64_tr_b16 v[106:107], v15 offset:43008
    v_mfma_f32_16x16x32_bf16 v[88:91], v[112:115], v[200:203], v[88:91]
    ds_read_b128 a[56:59], v21 offset:4096
    ds_read_b64_tr_b16 v[108:109], v16 offset:40960
    v_mfma_f32_16x16x32_bf16 v[92:95], v[112:115], v[204:207], v[92:95]
    ds_read_b128 a[60:63], v23 offset:4096
    ds_read_b64_tr_b16 v[110:111], v16 offset:43008
    v_mfma_f32_16x16x32_bf16 v[96:99], v[116:119], v[200:203], v[96:99]
    s_lshl_b32 s4, s63, 13
    ds_read_b64_tr_b16 v[112:113], v13 offset:45056
    ds_read_b64_tr_b16 v[114:115], v13 offset:47104
    v_mfma_f32_16x16x32_bf16 v[100:103], v[116:119], v[204:207], v[100:103]
    s_waitcnt lgkmcnt(8)
    s_lshl_b32 s59, s54, 14
    s_add_u32 s4, s4, s59
    v_mfma_f32_16x16x32_bf16 v[72:75], v[120:123], v[208:211], v[72:75]
    s_waitcnt lgkmcnt(3)
    s_xor_b32 s93, s87, 1179648
    s_add_u32 m0, s88, 4096
    s_add_u32 s86, s93, s77
    v_mfma_f32_16x16x32_bf16 v[76:79], v[120:123], v[212:215], v[76:79]
    buffer_load_dwordx4 v5, s[20:23], s86 offen lds
    v_mfma_f32_16x16x32_bf16 v[80:83], v[124:127], v[208:211], v[80:83]
    s_add_u32 s4, s4, 6291456
    ds_read_b64_tr_b16 v[116:117], v14 offset:45056
    ds_read_b64_tr_b16 v[118:119], v14 offset:47104
    v_mfma_f32_16x16x32_bf16 v[84:87], v[124:127], v[212:215], v[84:87]
    s_waitcnt lgkmcnt(4)
    ds_read_b64_tr_b16 v[120:121], v15 offset:45056
    ds_read_b64_tr_b16 v[122:123], v15 offset:47104
    v_mfma_f32_16x16x32_bf16 v[88:91], v[104:107], v[208:211], v[88:91]
    buffer_load_dwordx4 v6, s[20:23], s86 offen offset:1024 lds
    v_mfma_f32_16x16x32_bf16 v[92:95], v[104:107], v[212:215], v[92:95]
    s_lshl_b32 s59, s64, 16
    ds_read_b64_tr_b16 v[124:125], v16 offset:45056
    ds_read_b64_tr_b16 v[126:127], v16 offset:47104
    s_waitcnt vmcnt(14)
    s_barrier
    v_mfma_f32_16x16x32_bf16 v[96:99], v[108:111], v[208:211], v[96:99]
    s_add_u32 s59, s59, s4
    ds_read_b64_tr_b16 v[104:105], v13 offset:49152
    ds_read_b64_tr_b16 v[106:107], v13 offset:51200
    v_mfma_f32_16x16x32_bf16 v[100:103], v[108:111], v[212:215], v[100:103]
    s_waitcnt lgkmcnt(6)
    v_add_u32 v56, s59, v1
    s_xor_b32 s59, s54, 1
    v_mfma_f32_16x16x32_bf16 v[72:75], v[112:115], v[216:219], v[72:75]
    s_mul_i32 s59, s59, 3072
    ds_read_b64_tr_b16 v[108:109], v14 offset:49152
    ds_read_b64_tr_b16 v[110:111], v14 offset:51200
    v_mfma_f32_16x16x32_bf16 v[76:79], v[112:115], v[220:223], v[76:79]
    s_add_u32 s59, s59, 0
    v_add_u32 v41, s59, v1
    s_xor_b32 s59, s54, 2
    v_mfma_f32_16x16x32_bf16 v[80:83], v[116:119], v[216:219], v[80:83]
    buffer_load_dwordx4 v7, s[20:23], s86 offen offset:2048 lds
    v_mfma_f32_16x16x32_bf16 v[84:87], v[116:119], v[220:223], v[84:87]
    s_waitcnt lgkmcnt(4)
    ds_read_b64_tr_b16 v[112:113], v15 offset:49152
    ds_read_b64_tr_b16 v[114:115], v15 offset:51200
    v_mfma_f32_16x16x32_bf16 v[88:91], v[120:123], v[216:219], v[88:91]
    s_mul_i32 s59, s59, 3072
    ds_read_b64_tr_b16 v[116:117], v16 offset:49152
    ds_read_b64_tr_b16 v[118:119], v16 offset:51200
    v_mfma_f32_16x16x32_bf16 v[92:95], v[120:123], v[220:223], v[92:95]
    s_add_u32 s59, s59, 1024
    v_add_u32 v42, s59, v1
    s_xor_b32 s59, s54, 3
    v_mfma_f32_16x16x32_bf16 v[96:99], v[124:127], v[216:219], v[96:99]
    buffer_load_dwordx4 v8, s[20:23], s86 offen offset:3072 lds
    v_mfma_f32_16x16x32_bf16 v[100:103], v[124:127], v[220:223], v[100:103]
    s_waitcnt lgkmcnt(4)
    ds_read_b64_tr_b16 v[120:121], v13 offset:53248
    ds_read_b64_tr_b16 v[122:123], v13 offset:55296
    s_waitcnt vmcnt(9)
    s_barrier
    s_mov_b64 exec, 2
    buffer_atomic_add v0, off, s[32:35], s47
    s_mov_b64 exec, -1
    v_mfma_f32_16x16x32_bf16 v[72:75], v[104:107], v[224:227], v[72:75]
    ds_read_b128 a[64:67], v20 offset:32768
    ds_read_b64_tr_b16 v[124:125], v14 offset:53248
    v_mfma_f32_16x16x32_bf16 v[76:79], v[104:107], v[228:231], v[76:79]
    ds_read_b128 a[68:71], v22 offset:32768
    ds_read_b64_tr_b16 v[126:127], v14 offset:55296
    v_mfma_f32_16x16x32_bf16 v[80:83], v[108:111], v[224:227], v[80:83]
    ds_read_b128 a[96:99], v21 offset:32768
    ds_read_b64_tr_b16 v[104:105], v15 offset:53248
    v_mfma_f32_16x16x32_bf16 v[84:87], v[108:111], v[228:231], v[84:87]
    s_waitcnt lgkmcnt(8)
    ds_read_b64_tr_b16 v[106:107], v15 offset:55296
    s_mul_i32 s59, s59, 3072
    v_mfma_f32_16x16x32_bf16 v[88:91], v[112:115], v[224:227], v[88:91]
    ds_read_b128 a[100:103], v23 offset:32768
    ds_read_b64_tr_b16 v[108:109], v16 offset:53248
    v_mfma_f32_16x16x32_bf16 v[92:95], v[112:115], v[228:231], v[92:95]
    s_add_u32 s59, s59, 2048
    ds_read_b64_tr_b16 v[110:111], v16 offset:55296
    v_add_u32 v43, s59, v1
    v_mfma_f32_16x16x32_bf16 v[96:99], v[116:119], v[224:227], v[96:99]
    s_waitcnt lgkmcnt(2)
    s_xor_b32 s93, s87, 0
    s_add_u32 m0, s88, 32768
    s_add_u32 s86, s93, s78
    v_mfma_f32_16x16x32_bf16 v[100:103], v[116:119], v[228:231], v[100:103]
    ds_read_b64_tr_b16 v[112:113], v13 offset:57344
    ds_read_b64_tr_b16 v[114:115], v13 offset:59392
    v_mfma_f32_16x16x32_bf16 v[72:75], v[120:123], v[232:235], v[72:75]
    buffer_load_dwordx4 v5, s[20:23], s86 offen lds
    v_mfma_f32_16x16x32_bf16 v[76:79], v[120:123], v[236:239], v[76:79]
    s_mul_i32 s59, s54, 3072
    ds_read_b64_tr_b16 v[116:117], v14 offset:57344
    ds_read_b64_tr_b16 v[118:119], v14 offset:59392
    v_mfma_f32_16x16x32_bf16 v[80:83], v[124:127], v[232:235], v[80:83]
    ds_read_b64_tr_b16 v[120:121], v15 offset:57344
    ds_read_b64_tr_b16 v[122:123], v15 offset:59392
    v_mfma_f32_16x16x32_bf16 v[84:87], v[124:127], v[236:239], v[84:87]
    s_waitcnt lgkmcnt(6)
    v_add_u32 v44, s59, v1
    v_lshlrev_b32 v45, 3, v0
    v_mfma_f32_16x16x32_bf16 v[88:91], v[104:107], v[232:235], v[88:91]
    buffer_load_dwordx4 v6, s[20:23], s86 offen offset:1024 lds
    v_mfma_f32_16x16x32_bf16 v[92:95], v[104:107], v[236:239], v[92:95]
    ds_read_b64_tr_b16 v[124:125], v16 offset:57344
    ds_read_b64_tr_b16 v[126:127], v16 offset:59392
    v_mfma_f32_16x16x32_bf16 v[96:99], v[108:111], v[232:235], v[96:99]
    ds_read_b64_tr_b16 v[104:105], v13 offset:61440
    ds_read_b64_tr_b16 v[106:107], v13 offset:63488
    v_mfma_f32_16x16x32_bf16 v[100:103], v[108:111], v[236:239], v[100:103]
    s_waitcnt lgkmcnt(6)
    v_lshlrev_b32 v48, 16, v34
    v_lshlrev_b32 v49, 16, v34
    v_mfma_f32_16x16x32_bf16 v[72:75], v[112:115], v[240:243], v[72:75]
    buffer_load_dwordx4 v7, s[20:23], s86 offen offset:2048 lds
    v_mfma_f32_16x16x32_bf16 v[76:79], v[112:115], v[244:247], v[76:79]
    ds_read_b64_tr_b16 v[108:109], v14 offset:61440
    ds_read_b64_tr_b16 v[110:111], v14 offset:63488
    v_mfma_f32_16x16x32_bf16 v[80:83], v[116:119], v[240:243], v[80:83]
    ds_read_b64_tr_b16 v[112:113], v15 offset:61440
    ds_read_b64_tr_b16 v[114:115], v15 offset:63488
    v_mfma_f32_16x16x32_bf16 v[84:87], v[116:119], v[244:247], v[84:87]
    s_waitcnt lgkmcnt(6)
    v_lshlrev_b32 v50, 16, v34
    v_lshlrev_b32 v51, 16, v34
    v_mfma_f32_16x16x32_bf16 v[88:91], v[120:123], v[240:243], v[88:91]
    buffer_load_dwordx4 v8, s[20:23], s86 offen offset:3072 lds
    v_mfma_f32_16x16x32_bf16 v[92:95], v[120:123], v[244:247], v[92:95]
    s_waitcnt vmcnt(13)
    ds_read_b128 a[72:75], v20 offset:36864
    ds_read_b64_tr_b16 v[116:117], v16 offset:61440
    v_mfma_f32_16x16x32_bf16 v[96:99], v[124:127], v[240:243], v[96:99]
    ds_read_b128 a[76:79], v22 offset:36864
    ds_read_b64_tr_b16 v[118:119], v16 offset:63488
    v_mfma_f32_16x16x32_bf16 v[100:103], v[124:127], v[244:247], v[100:103]
    s_waitcnt lgkmcnt(6)
    s_lshr_b32 s91, s64, 1
    s_lshl_b32 s91, s91, 10
    v_mfma_f32_16x16x32_bf16 v[72:75], v[104:107], v[248:251], v[72:75]
    ds_read_b128 a[104:107], v21 offset:36864
    s_and_b32 s59, s64, 1
    v_mfma_f32_16x16x32_bf16 v[76:79], v[104:107], v[252:255], v[76:79]
    ds_read_b128 a[108:111], v23 offset:36864
    s_lshl_b32 s59, s59, 3
    v_mfma_f32_16x16x32_bf16 v[80:83], v[108:111], v[248:251], v[80:83]
    s_add_u32 s91, s91, s59
    s_add_u32 s91, s91, s0
    s_lshl_b32 s92, s65, 9
    v_mfma_f32_16x16x32_bf16 v[84:87], v[108:111], v[252:255], v[84:87]
    s_waitcnt lgkmcnt(2)
    s_add_u32 s92, s92, s0
    s_lshl_b32 s36, s94, 12
    v_mfma_f32_16x16x32_bf16 v[88:91], v[112:115], v[248:251], v[88:91]
    s_waitcnt lgkmcnt(0)
    s_xor_b32 s93, s87, 131072
    s_add_u32 m0, s88, 36864
    s_add_u32 s86, s93, s78
    v_mfma_f32_16x16x32_bf16 v[92:95], v[112:115], v[252:255], v[92:95]
    buffer_load_dwordx4 v5, s[20:23], s86 offen lds
    v_mfma_f32_16x16x32_bf16 v[96:99], v[116:119], v[248:251], v[96:99]
    s_xor_b32 s37, s36, 524288
    s_add_u32 s36, s36, 11534336
    s_add_u32 s37, s37, 11534336
    v_mfma_f32_16x16x32_bf16 v[100:103], v[116:119], v[252:255], v[100:103]
    s_bfe_u32 s38, s57, 196608
    s_lshl_b32 s38, s38, 7
    s_add_u32 s38, s38, s3
    s_add_u32 s38, s38, 51200
    s_lshl_b32 s59, s51, 2
    s_add_u32 s38, s38, s59
    s_bfe_u32 s39, s58, 262144
    s_lshl_b32 s39, s39, 7
    s_add_u32 s39, s39, s3
    s_add_u32 s39, s39, 52224
    s_lshl_b32 s6, s53, 2
    s_add_u32 s6, s6, s39
    v_pk_mul_f32 v[104:105], v[72:73], v[72:73]
    v_pk_mul_f32 v[106:107], v[74:75], v[74:75]
    buffer_load_dwordx4 v6, s[20:23], s86 offen offset:1024 lds
    v_pk_mul_f32 v[108:109], v[76:77], v[76:77]
    v_pk_mul_f32 v[110:111], v[78:79], v[78:79]
    v_pk_mul_f32 v[112:113], v[80:81], v[80:81]
    v_pk_mul_f32 v[114:115], v[82:83], v[82:83]
    v_pk_mul_f32 v[116:117], v[84:85], v[84:85]
    v_pk_mul_f32 v[118:119], v[86:87], v[86:87]
    v_pk_fma_f32 v[104:105], v[104:105], s[82:83], v[32:33]
    v_pk_fma_f32 v[106:107], v[106:107], s[82:83], v[32:33]
    v_pk_fma_f32 v[108:109], v[108:109], s[82:83], v[32:33]
    v_pk_fma_f32 v[110:111], v[110:111], s[82:83], v[32:33]
    v_pk_fma_f32 v[112:113], v[112:113], s[82:83], v[32:33]
    v_pk_fma_f32 v[114:115], v[114:115], s[82:83], v[32:33]
    v_pk_fma_f32 v[116:117], v[116:117], s[82:83], v[32:33]
    v_pk_fma_f32 v[118:119], v[118:119], s[82:83], v[32:33]
    v_pk_mul_f32 v[104:105], v[104:105], v[72:73]
    v_pk_mul_f32 v[106:107], v[106:107], v[74:75]
    v_pk_mul_f32 v[108:109], v[108:109], v[76:77]
    buffer_load_dwordx4 v7, s[20:23], s86 offen offset:2048 lds
    v_pk_mul_f32 v[110:111], v[110:111], v[78:79]
    v_pk_mul_f32 v[112:113], v[112:113], v[80:81]
    v_pk_mul_f32 v[114:115], v[114:115], v[82:83]
    v_pk_mul_f32 v[116:117], v[116:117], v[84:85]
    v_pk_mul_f32 v[118:119], v[118:119], v[86:87]
    v_exp_f32 v104, v104
    v_exp_f32 v105, v105
    v_exp_f32 v106, v106
    v_exp_f32 v107, v107
    v_exp_f32 v108, v108
    v_exp_f32 v109, v109
    buffer_load_dwordx4 v8, s[20:23], s86 offen offset:3072 lds
    v_exp_f32 v110, v110
    v_exp_f32 v111, v111
    s_waitcnt vmcnt(13)
    ds_read_b128 a[80:83], v20 offset:0
    v_exp_f32 v112, v112
    v_exp_f32 v113, v113
    ds_read_b128 a[84:87], v22 offset:0
    v_exp_f32 v114, v114
    v_exp_f32 v115, v115
    ds_read_b128 a[112:115], v21 offset:0
    v_exp_f32 v116, v116
    v_exp_f32 v117, v117
    ds_read_b128 a[116:119], v23 offset:0
    v_exp_f32 v118, v118
    v_exp_f32 v119, v119
    v_pk_add_f32 v[104:105], v[104:105], s[84:85]
    v_pk_add_f32 v[106:107], v[106:107], s[84:85]
    v_pk_add_f32 v[108:109], v[108:109], s[84:85]
    v_pk_add_f32 v[110:111], v[110:111], s[84:85]
    v_pk_add_f32 v[112:113], v[112:113], s[84:85]
    v_pk_add_f32 v[114:115], v[114:115], s[84:85]
    v_pk_add_f32 v[116:117], v[116:117], s[84:85]
    v_pk_add_f32 v[118:119], v[118:119], s[84:85]
    v_rcp_f32 v104, v104
    s_waitcnt lgkmcnt(0)
    s_xor_b32 s93, s87, 1048576
    s_add_u32 m0, s88, 0
    s_add_u32 s86, s93, s78
    v_rcp_f32 v105, v105
    v_rcp_f32 v106, v106
    buffer_load_dwordx4 v5, s[20:23], s86 offen lds
    v_rcp_f32 v107, v107
    v_rcp_f32 v108, v108
    v_rcp_f32 v109, v109
    v_rcp_f32 v110, v110
    v_rcp_f32 v111, v111
    v_rcp_f32 v112, v112
    v_rcp_f32 v113, v113
    v_rcp_f32 v114, v114
    buffer_load_dwordx4 v6, s[20:23], s86 offen offset:1024 lds
    v_rcp_f32 v115, v115
    v_rcp_f32 v116, v116
    v_rcp_f32 v117, v117
    v_rcp_f32 v118, v118
    v_rcp_f32 v119, v119
    v_pk_mul_f32 v[72:73], v[72:73], v[104:105]
    v_pk_mul_f32 v[74:75], v[74:75], v[106:107]
    v_pk_mul_f32 v[76:77], v[76:77], v[108:109]
    v_pk_mul_f32 v[78:79], v[78:79], v[110:111]
    v_pk_mul_f32 v[80:81], v[80:81], v[112:113]
    v_pk_mul_f32 v[82:83], v[82:83], v[114:115]
    v_pk_mul_f32 v[84:85], v[84:85], v[116:117]
    buffer_load_dwordx4 v7, s[20:23], s86 offen offset:2048 lds
    v_pk_mul_f32 v[86:87], v[86:87], v[118:119]
    buffer_load_dwordx4 v8, s[20:23], s86 offen offset:3072 lds
    s_waitcnt vmcnt(13)
    ds_read_b128 a[88:91], v20 offset:4096
    ds_read_b128 a[92:95], v22 offset:4096
    ds_read_b128 a[120:123], v21 offset:4096
    ds_read_b128 a[124:127], v23 offset:4096
    s_waitcnt lgkmcnt(0)
    s_xor_b32 s93, s87, 1179648
    s_add_u32 m0, s88, 4096
    s_add_u32 s86, s93, s78
    buffer_load_dwordx4 v5, s[20:23], s86 offen lds
    buffer_load_dwordx4 v6, s[20:23], s86 offen offset:1024 lds
    buffer_load_dwordx4 v7, s[20:23], s86 offen offset:2048 lds
    buffer_load_dwordx4 v8, s[20:23], s86 offen offset:3072 lds
    buffer_load_dword v39, v57, s[32:35], 0 offen sc1
    s_waitcnt vmcnt(13)
    ds_read_b128 a[128:131], v20 offset:32768
    ds_read_b128 a[132:135], v22 offset:32768
    ds_read_b128 a[160:163], v21 offset:32768
    ds_read_b128 a[164:167], v23 offset:32768
    s_waitcnt vmcnt(9)
    ds_read_b128 a[136:139], v20 offset:36864
    ds_read_b128 a[140:143], v22 offset:36864
    ds_read_b128 a[168:171], v21 offset:36864
    ds_read_b128 a[172:175], v23 offset:36864
    s_waitcnt vmcnt(5)
    ds_read_b128 a[144:147], v20 offset:0
    ds_read_b128 a[148:151], v22 offset:0
    ds_read_b128 a[176:179], v21 offset:0
    ds_read_b128 a[180:183], v23 offset:0
    s_waitcnt vmcnt(1)
    ds_read_b128 a[152:155], v20 offset:4096
    ds_read_b128 a[156:159], v22 offset:4096
    ds_read_b128 a[184:187], v21 offset:4096
    ds_read_b128 a[188:191], v23 offset:4096
    s_waitcnt vmcnt(0)
    v_cmp_ne_u32 vcc, s5, v39
    s_cbranch_vccnz Lrt_24
Lrtd_25:
    s_waitcnt lgkmcnt(0)
    s_barrier
    buffer_load_dwordx4 v[128:131], v56, s[32:35], s72 offen offset:0 sc1
    buffer_load_dwordx4 v[132:135], v56, s[32:35], s72 offen offset:1024 sc1
    buffer_load_dwordx4 v[136:139], v56, s[32:35], s73 offen offset:0 sc1
    buffer_load_dwordx4 v[140:143], v56, s[32:35], s73 offen offset:1024 sc1
    buffer_load_dwordx4 v[144:147], v56, s[32:35], s74 offen offset:0 sc1
    buffer_load_dwordx4 v[148:151], v56, s[32:35], s74 offen offset:1024 sc1
    buffer_load_dwordx4 v[152:155], v56, s[32:35], s75 offen offset:0 sc1
    buffer_load_dwordx4 v[156:159], v56, s[32:35], s75 offen offset:1024 sc1
    v_pk_mul_f32 v[104:105], v[88:89], v[88:89]
    v_pk_mul_f32 v[106:107], v[90:91], v[90:91]
    v_pk_mul_f32 v[108:109], v[92:93], v[92:93]
    v_pk_mul_f32 v[110:111], v[94:95], v[94:95]
    v_pk_mul_f32 v[112:113], v[96:97], v[96:97]
    v_pk_mul_f32 v[114:115], v[98:99], v[98:99]
    v_pk_mul_f32 v[116:117], v[100:101], v[100:101]
    v_pk_mul_f32 v[118:119], v[102:103], v[102:103]
    v_pk_fma_f32 v[104:105], v[104:105], s[82:83], v[32:33]
    v_pk_fma_f32 v[106:107], v[106:107], s[82:83], v[32:33]
    v_pk_fma_f32 v[108:109], v[108:109], s[82:83], v[32:33]
    v_pk_fma_f32 v[110:111], v[110:111], s[82:83], v[32:33]
    v_pk_fma_f32 v[112:113], v[112:113], s[82:83], v[32:33]
    v_pk_fma_f32 v[114:115], v[114:115], s[82:83], v[32:33]
    v_pk_fma_f32 v[116:117], v[116:117], s[82:83], v[32:33]
    v_pk_fma_f32 v[118:119], v[118:119], s[82:83], v[32:33]
    v_pk_mul_f32 v[104:105], v[104:105], v[88:89]
    v_pk_mul_f32 v[106:107], v[106:107], v[90:91]
    v_pk_mul_f32 v[108:109], v[108:109], v[92:93]
    v_pk_mul_f32 v[110:111], v[110:111], v[94:95]
    v_pk_mul_f32 v[112:113], v[112:113], v[96:97]
    v_pk_mul_f32 v[114:115], v[114:115], v[98:99]
    v_pk_mul_f32 v[116:117], v[116:117], v[100:101]
    v_pk_mul_f32 v[118:119], v[118:119], v[102:103]
    s_lshl_b32 s7, s65, 16
    s_add_u32 s7, s7, s4
    v_add_u32 v56, s7, v1
    buffer_load_dwordx4 v[160:163], v56, s[32:35], s72 offen offset:0 sc1
    v_exp_f32 v104, v104
    v_exp_f32 v105, v105
    v_exp_f32 v106, v106
    v_exp_f32 v107, v107
    v_exp_f32 v108, v108
    v_exp_f32 v109, v109
    v_exp_f32 v110, v110
    v_exp_f32 v111, v111
    v_exp_f32 v112, v112
    v_exp_f32 v113, v113
    v_exp_f32 v114, v114
    v_exp_f32 v115, v115
    buffer_load_dwordx4 v[164:167], v56, s[32:35], s72 offen offset:1024 sc1
    v_exp_f32 v116, v116
Lstub7:
    s_cbranch_execz Lwarmb
    v_exp_f32 v117, v117
    v_exp_f32 v118, v118
    v_exp_f32 v119, v119
    v_pk_add_f32 v[104:105], v[104:105], s[84:85]
    v_pk_add_f32 v[106:107], v[106:107], s[84:85]
    v_pk_add_f32 v[108:109], v[108:109], s[84:85]
    v_pk_add_f32 v[110:111], v[110:111], s[84:85]
    v_pk_add_f32 v[112:113], v[112:113], s[84:85]
    v_pk_add_f32 v[114:115], v[114:115], s[84:85]
    v_pk_add_f32 v[116:117], v[116:117], s[84:85]
    v_pk_add_f32 v[118:119], v[118:119], s[84:85]
    v_rcp_f32 v104, v104
    v_rcp_f32 v105, v105
    v_rcp_f32 v106, v106
    v_rcp_f32 v107, v107
    buffer_load_dwordx4 v[168:171], v56, s[32:35], s73 offen offset:0 sc1
    v_rcp_f32 v108, v108
    v_rcp_f32 v109, v109
    v_rcp_f32 v110, v110
    v_rcp_f32 v111, v111
    v_rcp_f32 v112, v112
    v_rcp_f32 v113, v113
    v_rcp_f32 v114, v114
    v_rcp_f32 v115, v115
    v_rcp_f32 v116, v116
    v_rcp_f32 v117, v117
    v_rcp_f32 v118, v118
    v_rcp_f32 v119, v119
    buffer_load_dwordx4 v[172:175], v56, s[32:35], s73 offen offset:1024 sc1
    v_pk_mul_f32 v[88:89], v[88:89], v[104:105]
    v_pk_mul_f32 v[90:91], v[90:91], v[106:107]
    v_pk_mul_f32 v[92:93], v[92:93], v[108:109]
    v_pk_mul_f32 v[94:95], v[94:95], v[110:111]
    v_pk_mul_f32 v[96:97], v[96:97], v[112:113]
    v_pk_mul_f32 v[98:99], v[98:99], v[114:115]
    v_pk_mul_f32 v[100:101], v[100:101], v[116:117]
    v_pk_mul_f32 v[102:103], v[102:103], v[118:119]
    buffer_load_dwordx4 v[176:179], v56, s[32:35], s74 offen offset:0 sc1
    s_lshl_b32 s59, s51, 11
    s_add_u32 s59, s59, s1
    s_add_u32 s60, s59, 34816
    v_cvt_pk_bf16_f32 v240, v72, v73
    v_cvt_pk_bf16_f32 v241, v74, v75
    v_cvt_pk_bf16_f32 v242, v80, v81
    v_cvt_pk_bf16_f32 v243, v82, v83
    buffer_store_dwordx4 v[240:243], v1, s[32:35], s59 offen offset:0
    v_cvt_pk_bf16_f32 v244, v88, v89
    v_cvt_pk_bf16_f32 v245, v90, v91
    v_cvt_pk_bf16_f32 v246, v96, v97
    v_cvt_pk_bf16_f32 v247, v98, v99
    buffer_store_dwordx4 v[244:247], v1, s[32:35], s59 offen offset:1024
    v_cvt_pk_bf16_f32 v248, v76, v77
    v_cvt_pk_bf16_f32 v249, v78, v79
    v_cvt_pk_bf16_f32 v250, v84, v85
    v_cvt_pk_bf16_f32 v251, v86, v87
    buffer_store_dwordx4 v[248:251], v1, s[32:35], s60 offen offset:0
    v_cvt_pk_bf16_f32 v252, v92, v93
    v_cvt_pk_bf16_f32 v253, v94, v95
    v_cvt_pk_bf16_f32 v254, v100, v101
    v_cvt_pk_bf16_f32 v255, v102, v103
    buffer_store_dwordx4 v[252:255], v1, s[32:35], s60 offen offset:1024
Lp3_17:
    s_waitcnt vmcnt(16)
    v_mfma_f32_16x16x32_bf16 v[64:67], v[128:131], a[20:23], 0
    buffer_load_dwordx4 v[180:183], v56, s[32:35], s74 offen offset:1024 sc1
    s_waitcnt vmcnt(16)
    v_mfma_f32_16x16x32_bf16 v[64:67], v[132:135], a[52:55], v[64:67]
    s_waitcnt vmcnt(15)
    v_mfma_f32_16x16x32_bf16 v[64:67], v[136:139], a[84:87], v[64:67]
    s_waitcnt vmcnt(14)
    v_mfma_f32_16x16x32_bf16 v[64:67], v[140:143], a[116:119], v[64:67]
    v_lshrrev_b32 v36, 3, v0
    v_lshlrev_b32 v37, 1, v4
    v_xor_b32 v37, v37, v0
    v_and_b32 v37, 7, v37
    v_mul_u32_u24 v36, 1024, v36
    v_lshl_add_u32 v9, v37, 4, v36
    v_add_u32 v10, 7168, v9
    v_add_u32 v11, 14336, v9
    v_add_u32 v12, 21504, v9
    s_lshl_b32 s89, s53, 7
    s_mul_i32 s93, s54, 229376
    s_add_u32 s89, s89, s93
    s_mul_i32 s90, s54, 28672
    s_add_u32 m0, s90, 49152
    s_add_u32 s86, s89, 0
    s_waitcnt vmcnt(13)
    v_mfma_f32_16x16x32_bf16 v[64:67], v[144:147], a[148:151], v[64:67]
    buffer_load_dwordx4 v[184:187], v56, s[32:35], s75 offen offset:0 sc1
    s_waitcnt vmcnt(13)
    v_mfma_f32_16x16x32_bf16 v[64:67], v[148:151], a[180:183], v[64:67]
    s_waitcnt vmcnt(12)
    v_mfma_f32_16x16x32_bf16 v[64:67], v[152:155], a[212:215], v[64:67]
    s_waitcnt vmcnt(11)
    v_mfma_f32_16x16x32_bf16 v[64:67], v[156:159], a[244:247], v[64:67]
    v_mfma_f32_16x16x32_bf16 v[68:71], v[128:131], a[24:27], 0
    buffer_load_dwordx4 v[188:191], v56, s[32:35], s75 offen offset:1024 sc1
    v_mfma_f32_16x16x32_bf16 v[68:71], v[132:135], a[56:59], v[68:71]
    v_mfma_f32_16x16x32_bf16 v[68:71], v[136:139], a[88:91], v[68:71]
    v_mfma_f32_16x16x32_bf16 v[68:71], v[140:143], a[120:123], v[68:71]
    v_mfma_f32_16x16x32_bf16 v[68:71], v[144:147], a[152:155], v[68:71]
    s_lshl_b32 s7, s66, 16
    s_add_u32 s7, s7, s4
    v_add_u32 v56, s7, v1
    buffer_load_dwordx4 v[192:195], v56, s[32:35], s72 offen offset:0 sc1
    v_mfma_f32_16x16x32_bf16 v[68:71], v[148:151], a[184:187], v[68:71]
    v_mfma_f32_16x16x32_bf16 v[68:71], v[152:155], a[216:219], v[68:71]
    ds_write_b128 v41, v[64:67] offset:0
    v_mfma_f32_16x16x32_bf16 v[68:71], v[156:159], a[248:251], v[68:71]
    v_mfma_f32_16x16x32_bf16 v[72:75], v[128:131], a[28:31], 0
    buffer_load_dwordx4 v[196:199], v56, s[32:35], s72 offen offset:1024 sc1
    v_mfma_f32_16x16x32_bf16 v[72:75], v[132:135], a[60:63], v[72:75]
    v_mfma_f32_16x16x32_bf16 v[72:75], v[136:139], a[92:95], v[72:75]
    v_mfma_f32_16x16x32_bf16 v[72:75], v[140:143], a[124:127], v[72:75]
    v_mfma_f32_16x16x32_bf16 v[72:75], v[144:147], a[156:159], v[72:75]
    buffer_load_dwordx4 v[200:203], v56, s[32:35], s73 offen offset:0 sc1
    v_mfma_f32_16x16x32_bf16 v[72:75], v[148:151], a[188:191], v[72:75]
    v_mfma_f32_16x16x32_bf16 v[72:75], v[152:155], a[220:223], v[72:75]
    ds_write_b128 v42, v[68:71] offset:0
    v_mfma_f32_16x16x32_bf16 v[72:75], v[156:159], a[252:255], v[72:75]
    v_mfma_f32_16x16x32_bf16 v[76:79], v[128:131], a[16:19], 0
    buffer_load_dwordx4 v[204:207], v56, s[32:35], s73 offen offset:1024 sc1
    v_mfma_f32_16x16x32_bf16 v[76:79], v[132:135], a[48:51], v[76:79]
    v_mfma_f32_16x16x32_bf16 v[76:79], v[136:139], a[80:83], v[76:79]
    v_mfma_f32_16x16x32_bf16 v[76:79], v[140:143], a[112:115], v[76:79]
    v_mfma_f32_16x16x32_bf16 v[76:79], v[144:147], a[144:147], v[76:79]
    buffer_load_dwordx4 v9, s[24:27], s86 offen lds
    v_mfma_f32_16x16x32_bf16 v[76:79], v[148:151], a[176:179], v[76:79]
    v_mfma_f32_16x16x32_bf16 v[76:79], v[152:155], a[208:211], v[76:79]
    ds_write_b128 v43, v[72:75] offset:0
    v_mfma_f32_16x16x32_bf16 v[76:79], v[156:159], a[240:243], v[76:79]
    v_mfma_f32_16x16x32_bf16 v[84:87], v[128:131], a[4:7], 0
    buffer_load_dwordx4 v[208:211], v56, s[32:35], s74 offen offset:0 sc1
    v_mfma_f32_16x16x32_bf16 v[84:87], v[132:135], a[36:39], v[84:87]
    v_mfma_f32_16x16x32_bf16 v[84:87], v[136:139], a[68:71], v[84:87]
    v_mfma_f32_16x16x32_bf16 v[84:87], v[140:143], a[100:103], v[84:87]
    s_waitcnt lgkmcnt(0)
    s_barrier
    v_mfma_f32_16x16x32_bf16 v[84:87], v[144:147], a[132:135], v[84:87]
    ds_read_b128 v[104:107], v44 offset:0
    ds_read_b128 v[108:111], v44 offset:1024
    v_mfma_f32_16x16x32_bf16 v[84:87], v[148:151], a[164:167], v[84:87]
    ds_read_b128 v[112:115], v44 offset:2048
    v_mfma_f32_16x16x32_bf16 v[84:87], v[152:155], a[196:199], v[84:87]
    v_mfma_f32_16x16x32_bf16 v[84:87], v[156:159], a[228:231], v[84:87]
    v_mfma_f32_16x16x32_bf16 v[88:91], v[128:131], a[8:11], 0
    buffer_load_dwordx4 v[212:215], v56, s[32:35], s74 offen offset:1024 sc1
    v_mfma_f32_16x16x32_bf16 v[88:91], v[132:135], a[40:43], v[88:91]
    v_mfma_f32_16x16x32_bf16 v[88:91], v[136:139], a[72:75], v[88:91]
    v_mfma_f32_16x16x32_bf16 v[88:91], v[140:143], a[104:107], v[88:91]
    v_mfma_f32_16x16x32_bf16 v[88:91], v[144:147], a[136:139], v[88:91]
    buffer_load_dwordx4 v10, s[24:27], s86 offen offset:1024 lds
    v_mfma_f32_16x16x32_bf16 v[88:91], v[148:151], a[168:171], v[88:91]
    s_waitcnt lgkmcnt(1)
    v_add_f32 v104, v104, v108
    v_add_f32 v105, v105, v109
    v_mfma_f32_16x16x32_bf16 v[88:91], v[152:155], a[200:203], v[88:91]
    ds_write_b128 v41, v[84:87] offset:12288
    v_mfma_f32_16x16x32_bf16 v[88:91], v[156:159], a[232:235], v[88:91]
    v_add_f32 v106, v106, v110
    v_add_f32 v107, v107, v111
    v_mfma_f32_16x16x32_bf16 v[92:95], v[128:131], a[12:15], 0
    buffer_load_dwordx4 v[216:219], v56, s[32:35], s75 offen offset:0 sc1
    v_mfma_f32_16x16x32_bf16 v[92:95], v[132:135], a[44:47], v[92:95]
    s_waitcnt lgkmcnt(1)
    v_add_f32 v112, v112, v76
    v_add_f32 v113, v113, v77
    v_mfma_f32_16x16x32_bf16 v[92:95], v[136:139], a[76:79], v[92:95]
    v_add_f32 v114, v114, v78
    v_add_f32 v115, v115, v79
    v_mfma_f32_16x16x32_bf16 v[92:95], v[140:143], a[108:111], v[92:95]
    v_add_f32 v104, v104, v112
    v_add_f32 v105, v105, v113
    v_mfma_f32_16x16x32_bf16 v[92:95], v[144:147], a[140:143], v[92:95]
    v_add_f32 v106, v106, v114
    v_add_f32 v107, v107, v115
    v_mfma_f32_16x16x32_bf16 v[92:95], v[148:151], a[172:175], v[92:95]
    v_cvt_pk_bf16_f32 v62, v104, v105
    v_cvt_pk_bf16_f32 v63, v106, v107
    v_mfma_f32_16x16x32_bf16 v[92:95], v[152:155], a[204:207], v[92:95]
    ds_write_b128 v42, v[88:91] offset:12288
    v_mfma_f32_16x16x32_bf16 v[92:95], v[156:159], a[236:239], v[92:95]
    buffer_store_dwordx2 v[62:63], v45, s[32:35], s37 offen offset:0 sc1
    v_mfma_f32_16x16x32_bf16 v[80:83], v[128:131], a[0:3], v[48:51]
    buffer_load_dwordx4 v[220:223], v56, s[32:35], s75 offen offset:1024 sc1
    v_mfma_f32_16x16x32_bf16 v[80:83], v[132:135], a[32:35], v[80:83]
    v_mfma_f32_16x16x32_bf16 v[80:83], v[136:139], a[64:67], v[80:83]
    v_mfma_f32_16x16x32_bf16 v[80:83], v[140:143], a[96:99], v[80:83]
    v_mfma_f32_16x16x32_bf16 v[80:83], v[144:147], a[128:131], v[80:83]
    buffer_load_dwordx4 v11, s[24:27], s86 offen offset:2048 lds
    v_mfma_f32_16x16x32_bf16 v[80:83], v[148:151], a[160:163], v[80:83]
    v_mfma_f32_16x16x32_bf16 v[80:83], v[152:155], a[192:195], v[80:83]
    ds_write_b128 v43, v[92:95] offset:12288
    v_mfma_f32_16x16x32_bf16 v[80:83], v[156:159], a[224:227], v[80:83]
    s_waitcnt vmcnt(20)
    v_mfma_f32_16x16x32_bf16 v[64:67], v[160:163], a[20:23], 0
    s_lshl_b32 s7, s67, 16
    s_add_u32 s7, s7, s4
    v_add_u32 v56, s7, v1
    buffer_load_dwordx4 v[128:131], v56, s[32:35], s72 offen offset:0 sc1
    v_mfma_f32_16x16x32_bf16 v[64:67], v[164:167], a[52:55], v[64:67]
    v_mfma_f32_16x16x32_bf16 v[64:67], v[168:171], a[84:87], v[64:67]
    v_mfma_f32_16x16x32_bf16 v[64:67], v[172:175], a[116:119], v[64:67]
    s_waitcnt vmcnt(13)
    s_mov_b64 exec, 2
    buffer_store_dword v0, off, s[32:35], s38 offset:0
    s_mov_b64 exec, -1
    v_mfma_f32_16x16x32_bf16 v[64:67], v[176:179], a[148:151], v[64:67]
    v_mfma_f32_16x16x32_bf16 v[64:67], v[180:183], a[180:183], v[64:67]
    v_mfma_f32_16x16x32_bf16 v[64:67], v[184:187], a[212:215], v[64:67]
    v_mfma_f32_16x16x32_bf16 v[64:67], v[188:191], a[244:247], v[64:67]
    v_mfma_f32_16x16x32_bf16 v[68:71], v[160:163], a[24:27], 0
    buffer_load_dwordx4 v[132:135], v56, s[32:35], s72 offen offset:1024 sc1
    v_mfma_f32_16x16x32_bf16 v[68:71], v[164:167], a[56:59], v[68:71]
    v_mfma_f32_16x16x32_bf16 v[68:71], v[168:171], a[88:91], v[68:71]
    v_mfma_f32_16x16x32_bf16 v[68:71], v[172:175], a[120:123], v[68:71]
    v_mfma_f32_16x16x32_bf16 v[68:71], v[176:179], a[152:155], v[68:71]
    buffer_load_dwordx4 v12, s[24:27], s86 offen offset:3072 lds
    v_mfma_f32_16x16x32_bf16 v[68:71], v[180:183], a[184:187], v[68:71]
    v_mfma_f32_16x16x32_bf16 v[68:71], v[184:187], a[216:219], v[68:71]
    ds_write_b128 v41, v[64:67] offset:24576
    v_mfma_f32_16x16x32_bf16 v[68:71], v[188:191], a[248:251], v[68:71]
    s_add_u32 m0, s90, 61440
    s_add_u32 s86, s89, 98304
    v_mfma_f32_16x16x32_bf16 v[72:75], v[160:163], a[28:31], 0
    buffer_load_dwordx4 v[136:139], v56, s[32:35], s73 offen offset:0 sc1
    v_mfma_f32_16x16x32_bf16 v[72:75], v[164:167], a[60:63], v[72:75]
    v_mfma_f32_16x16x32_bf16 v[72:75], v[168:171], a[92:95], v[72:75]
    v_mfma_f32_16x16x32_bf16 v[72:75], v[172:175], a[124:127], v[72:75]
    v_mfma_f32_16x16x32_bf16 v[72:75], v[176:179], a[156:159], v[72:75]
    v_mfma_f32_16x16x32_bf16 v[72:75], v[180:183], a[188:191], v[72:75]
    v_mfma_f32_16x16x32_bf16 v[72:75], v[184:187], a[220:223], v[72:75]
    ds_write_b128 v42, v[68:71] offset:24576
    v_mfma_f32_16x16x32_bf16 v[72:75], v[188:191], a[252:255], v[72:75]
    v_mfma_f32_16x16x32_bf16 v[96:99], v[160:163], a[16:19], 0
    buffer_load_dwordx4 v[140:143], v56, s[32:35], s73 offen offset:1024 sc1
    v_mfma_f32_16x16x32_bf16 v[96:99], v[164:167], a[48:51], v[96:99]
    v_mfma_f32_16x16x32_bf16 v[96:99], v[168:171], a[80:83], v[96:99]
    v_mfma_f32_16x16x32_bf16 v[96:99], v[172:175], a[112:115], v[96:99]
    v_mfma_f32_16x16x32_bf16 v[96:99], v[176:179], a[144:147], v[96:99]
    v_mfma_f32_16x16x32_bf16 v[96:99], v[180:183], a[176:179], v[96:99]
    v_mfma_f32_16x16x32_bf16 v[96:99], v[184:187], a[208:211], v[96:99]
    ds_write_b128 v43, v[72:75] offset:24576
    v_mfma_f32_16x16x32_bf16 v[96:99], v[188:191], a[240:243], v[96:99]
    v_mfma_f32_16x16x32_bf16 v[84:87], v[160:163], a[4:7], 0
    buffer_load_dwordx4 v[144:147], v56, s[32:35], s74 offen offset:0 sc1
    v_mfma_f32_16x16x32_bf16 v[84:87], v[164:167], a[36:39], v[84:87]
    v_mfma_f32_16x16x32_bf16 v[84:87], v[168:171], a[68:71], v[84:87]
    v_mfma_f32_16x16x32_bf16 v[84:87], v[172:175], a[100:103], v[84:87]
    s_waitcnt lgkmcnt(0)
    s_barrier
    v_mfma_f32_16x16x32_bf16 v[84:87], v[176:179], a[132:135], v[84:87]
    buffer_load_dwordx4 v9, s[24:27], s86 offen lds
    v_mfma_f32_16x16x32_bf16 v[84:87], v[180:183], a[164:167], v[84:87]
    ds_read_b128 v[104:107], v44 offset:24576
    ds_read_b128 v[108:111], v44 offset:25600
    v_mfma_f32_16x16x32_bf16 v[84:87], v[184:187], a[196:199], v[84:87]
    ds_read_b128 v[112:115], v44 offset:26624
    ds_read_b128 v[116:119], v44 offset:12288
    v_mfma_f32_16x16x32_bf16 v[84:87], v[188:191], a[228:231], v[84:87]
    ds_read_b128 v[120:123], v44 offset:13312
    ds_read_b128 v[124:127], v44 offset:14336
    v_mfma_f32_16x16x32_bf16 v[88:91], v[160:163], a[8:11], 0
    buffer_load_dwordx4 v[148:151], v56, s[32:35], s74 offen offset:1024 sc1
    v_mfma_f32_16x16x32_bf16 v[88:91], v[164:167], a[40:43], v[88:91]
    buffer_load_dword v39, v40, s[32:35], 0 offen sc1
    v_mfma_f32_16x16x32_bf16 v[88:91], v[168:171], a[72:75], v[88:91]
    v_mfma_f32_16x16x32_bf16 v[88:91], v[172:175], a[104:107], v[88:91]
    v_mfma_f32_16x16x32_bf16 v[88:91], v[176:179], a[136:139], v[88:91]
    s_waitcnt lgkmcnt(4)
    v_add_f32 v104, v104, v108
    v_add_f32 v105, v105, v109
    v_mfma_f32_16x16x32_bf16 v[88:91], v[180:183], a[168:171], v[88:91]
    v_add_f32 v106, v106, v110
    v_add_f32 v107, v107, v111
    v_mfma_f32_16x16x32_bf16 v[88:91], v[184:187], a[200:203], v[88:91]
    ds_write_b128 v41, v[84:87] offset:36864
    v_mfma_f32_16x16x32_bf16 v[88:91], v[188:191], a[232:235], v[88:91]
    s_waitcnt lgkmcnt(4)
    v_add_f32 v112, v112, v96
    v_add_f32 v113, v113, v97
    v_mfma_f32_16x16x32_bf16 v[92:95], v[160:163], a[12:15], 0
    buffer_load_dwordx4 v[152:155], v56, s[32:35], s75 offen offset:0 sc1
    v_mfma_f32_16x16x32_bf16 v[92:95], v[164:167], a[44:47], v[92:95]
    v_add_f32 v114, v114, v98
    v_add_f32 v115, v115, v99
    v_mfma_f32_16x16x32_bf16 v[92:95], v[168:171], a[76:79], v[92:95]
    v_add_f32 v104, v104, v112
    v_add_f32 v105, v105, v113
    v_mfma_f32_16x16x32_bf16 v[92:95], v[172:175], a[108:111], v[92:95]
    v_add_f32 v106, v106, v114
    v_add_f32 v107, v107, v115
    v_mfma_f32_16x16x32_bf16 v[92:95], v[176:179], a[140:143], v[92:95]
    buffer_load_dwordx4 v10, s[24:27], s86 offen offset:1024 lds
    v_mfma_f32_16x16x32_bf16 v[92:95], v[180:183], a[172:175], v[92:95]
    v_cvt_pk_bf16_f32 v62, v104, v105
    v_cvt_pk_bf16_f32 v63, v106, v107
    v_mfma_f32_16x16x32_bf16 v[92:95], v[184:187], a[204:207], v[92:95]
    ds_write_b128 v42, v[88:91] offset:36864
    v_mfma_f32_16x16x32_bf16 v[92:95], v[188:191], a[236:239], v[92:95]
    buffer_store_dwordx2 v[62:63], v45, s[32:35], s37 offen offset:512 sc1
    s_waitcnt lgkmcnt(3)
    v_add_f32 v116, v116, v120
    v_mfma_f32_16x16x32_bf16 v[100:103], v[160:163], a[0:3], v[48:51]
    buffer_load_dwordx4 v[156:159], v56, s[32:35], s75 offen offset:1024 sc1
    v_mfma_f32_16x16x32_bf16 v[100:103], v[164:167], a[32:35], v[100:103]
    v_add_f32 v117, v117, v121
    v_add_f32 v118, v118, v122
    v_mfma_f32_16x16x32_bf16 v[100:103], v[168:171], a[64:67], v[100:103]
    v_add_f32 v119, v119, v123
    s_waitcnt lgkmcnt(2)
    v_add_f32 v124, v124, v80
    v_mfma_f32_16x16x32_bf16 v[100:103], v[172:175], a[96:99], v[100:103]
    v_add_f32 v125, v125, v81
    v_add_f32 v126, v126, v82
    v_mfma_f32_16x16x32_bf16 v[100:103], v[176:179], a[128:131], v[100:103]
    v_add_f32 v127, v127, v83
    v_add_f32 v240, v116, v124
    v_mfma_f32_16x16x32_bf16 v[100:103], v[180:183], a[160:163], v[100:103]
    v_add_f32 v241, v117, v125
    v_add_f32 v242, v118, v126
    v_mfma_f32_16x16x32_bf16 v[100:103], v[184:187], a[192:195], v[100:103]
    ds_write_b128 v43, v[92:95] offset:36864
    v_mfma_f32_16x16x32_bf16 v[100:103], v[188:191], a[224:227], v[100:103]
    s_waitcnt vmcnt(22)
    v_add_f32 v243, v119, v127
    v_mfma_f32_16x16x32_bf16 v[64:67], v[192:195], a[20:23], 0
    s_lshl_b32 s7, s68, 16
    s_add_u32 s7, s7, s4
    v_add_u32 v56, s7, v1
    buffer_load_dwordx4 v[160:163], v56, s[32:35], s72 offen offset:0 sc1
    v_mfma_f32_16x16x32_bf16 v[64:67], v[196:199], a[52:55], v[64:67]
    v_mfma_f32_16x16x32_bf16 v[64:67], v[200:203], a[84:87], v[64:67]
    v_mfma_f32_16x16x32_bf16 v[64:67], v[204:207], a[116:119], v[64:67]
    s_waitcnt vmcnt(16)
    v_mfma_f32_16x16x32_bf16 v[64:67], v[208:211], a[148:151], v[64:67]
    buffer_load_dwordx4 v11, s[24:27], s86 offen offset:2048 lds
    v_mfma_f32_16x16x32_bf16 v[64:67], v[212:215], a[180:183], v[64:67]
    v_mfma_f32_16x16x32_bf16 v[64:67], v[216:219], a[212:215], v[64:67]
    v_mfma_f32_16x16x32_bf16 v[64:67], v[220:223], a[244:247], v[64:67]
    v_mfma_f32_16x16x32_bf16 v[68:71], v[192:195], a[24:27], 0
    buffer_load_dwordx4 v[164:167], v56, s[32:35], s72 offen offset:1024 sc1
    v_mfma_f32_16x16x32_bf16 v[68:71], v[196:199], a[56:59], v[68:71]
    v_mfma_f32_16x16x32_bf16 v[68:71], v[200:203], a[88:91], v[68:71]
    v_mfma_f32_16x16x32_bf16 v[68:71], v[204:207], a[120:123], v[68:71]
    v_mfma_f32_16x16x32_bf16 v[68:71], v[208:211], a[152:155], v[68:71]
    s_waitcnt vmcnt(7)
    v_cmp_ne_u32 vcc, 1, v39
    v_mfma_f32_16x16x32_bf16 v[68:71], v[212:215], a[184:187], v[68:71]
    v_mfma_f32_16x16x32_bf16 v[68:71], v[216:219], a[216:219], v[68:71]
    ds_write_b128 v41, v[64:67] offset:0
    v_mfma_f32_16x16x32_bf16 v[68:71], v[220:223], a[248:251], v[68:71]
    s_cbranch_vccnz Lrt_30
Lrtd_31:
    v_mfma_f32_16x16x32_bf16 v[72:75], v[192:195], a[28:31], 0
    buffer_load_dwordx4 v[168:171], v56, s[32:35], s73 offen offset:0 sc1
    v_mfma_f32_16x16x32_bf16 v[72:75], v[196:199], a[60:63], v[72:75]
    buffer_load_dwordx2 v[224:225], v1, s[32:35], s91 offen sc1
    v_mfma_f32_16x16x32_bf16 v[72:75], v[200:203], a[92:95], v[72:75]
    v_mfma_f32_16x16x32_bf16 v[72:75], v[204:207], a[124:127], v[72:75]
    v_mfma_f32_16x16x32_bf16 v[72:75], v[208:211], a[156:159], v[72:75]
    s_and_b32 s60, s54, 1
    s_mul_i32 s61, s60, 14336
    v_mfma_f32_16x16x32_bf16 v[72:75], v[212:215], a[188:191], v[72:75]
    buffer_load_dwordx4 v[226:229], v1, s[32:35], s92 offen offset:0 sc1
    v_mfma_f32_16x16x32_bf16 v[72:75], v[216:219], a[220:223], v[72:75]
    ds_write_b128 v42, v[68:71] offset:0
    v_mfma_f32_16x16x32_bf16 v[72:75], v[220:223], a[252:255], v[72:75]
    s_add_u32 s8, s0, s61
    s_xor_b32 s9, s58, 1
    v_mfma_f32_16x16x32_bf16 v[76:79], v[192:195], a[16:19], 0
    buffer_load_dwordx4 v[172:175], v56, s[32:35], s73 offen offset:1024 sc1
    v_mfma_f32_16x16x32_bf16 v[76:79], v[196:199], a[48:51], v[76:79]
    buffer_load_dwordx4 v[230:233], v1, s[32:35], s92 offen offset:1024 sc1
    v_mfma_f32_16x16x32_bf16 v[76:79], v[200:203], a[80:83], v[76:79]
    s_mul_i32 s9, s9, 34816
    s_add_u32 s9, s9, s61
    v_mfma_f32_16x16x32_bf16 v[76:79], v[204:207], a[112:115], v[76:79]
    s_andn2_b32 s62, s39, 128
    s_lshl_b32 s60, s60, 4
    v_mfma_f32_16x16x32_bf16 v[76:79], v[208:211], a[144:147], v[76:79]
    buffer_load_dwordx4 v12, s[24:27], s86 offen offset:3072 lds
    v_mfma_f32_16x16x32_bf16 v[76:79], v[212:215], a[176:179], v[76:79]
    buffer_load_dwordx4 v[234:237], v1, s[32:35], s92 offen offset:2048 sc1
    v_mfma_f32_16x16x32_bf16 v[76:79], v[216:219], a[208:211], v[76:79]
    ds_write_b128 v43, v[72:75] offset:0
    v_mfma_f32_16x16x32_bf16 v[76:79], v[220:223], a[240:243], v[76:79]
    s_add_u32 m0, s90, 65536
    s_add_u32 s86, s89, 131072
    s_add_u32 s62, s62, s60
    v_mfma_f32_16x16x32_bf16 v[84:87], v[192:195], a[4:7], 0
    buffer_load_dwordx4 v[176:179], v56, s[32:35], s74 offen offset:0 sc1
    v_mfma_f32_16x16x32_bf16 v[84:87], v[196:199], a[36:39], v[84:87]
    buffer_load_dwordx2 v[52:53], v45, s[32:35], s36 offen offset:0 sc1
    v_mfma_f32_16x16x32_bf16 v[84:87], v[200:203], a[68:71], v[84:87]
    v_and_b32 v40, 3, v0
    v_lshl_add_u32 v40, v40, 2, s62
    v_mfma_f32_16x16x32_bf16 v[84:87], v[204:207], a[100:103], v[84:87]
    v_bfe_u32 v17, v0, 2, 1
    v_lshl_add_u32 v40, v17, 7, v40
    s_waitcnt lgkmcnt(0)
    s_barrier
    v_mfma_f32_16x16x32_bf16 v[84:87], v[208:211], a[132:135], v[84:87]
    ds_read_b128 v[104:107], v44 offset:0
    ds_read_b128 v[108:111], v44 offset:1024
    v_mfma_f32_16x16x32_bf16 v[84:87], v[212:215], a[164:167], v[84:87]
    ds_read_b128 v[112:115], v44 offset:2048
    ds_read_b128 v[116:119], v44 offset:36864
    v_mfma_f32_16x16x32_bf16 v[84:87], v[216:219], a[196:199], v[84:87]
    ds_read_b128 v[120:123], v44 offset:37888
    ds_read_b128 v[124:127], v44 offset:38912
    v_mfma_f32_16x16x32_bf16 v[84:87], v[220:223], a[228:231], v[84:87]
    v_lshrrev_b32 v17, 2, v0
    v_and_b32 v18, 3, v0
    v_mfma_f32_16x16x32_bf16 v[88:91], v[192:195], a[8:11], 0
    buffer_load_dwordx4 v[180:183], v56, s[32:35], s74 offen offset:1024 sc1
    v_mfma_f32_16x16x32_bf16 v[88:91], v[196:199], a[40:43], v[88:91]
    v_lshlrev_b32 v18, 3, v18
    v_lshl_add_u32 v18, v17, 7, v18
    v_mfma_f32_16x16x32_bf16 v[88:91], v[200:203], a[72:75], v[88:91]
    v_bfe_u32 v17, v17, 1, 2
    v_lshl_add_u32 v18, v17, 5, v18
    v_mfma_f32_16x16x32_bf16 v[88:91], v[204:207], a[104:107], v[88:91]
    v_add_u32 v13, 49152, v18
    v_xor_b32 v14, 32, v13
    v_mfma_f32_16x16x32_bf16 v[88:91], v[208:211], a[136:139], v[88:91]
    buffer_load_dwordx4 v9, s[24:27], s86 offen lds
    v_mfma_f32_16x16x32_bf16 v[88:91], v[212:215], a[168:171], v[88:91]
    v_xor_b32 v15, 64, v13
    v_xor_b32 v16, 96, v13
    v_mfma_f32_16x16x32_bf16 v[88:91], v[216:219], a[200:203], v[88:91]
    ds_write_b128 v41, v[84:87] offset:12288
    v_mfma_f32_16x16x32_bf16 v[88:91], v[220:223], a[232:235], v[88:91]
    s_lshl_b32 s61, s61, 2
    v_add_u32 v13, s61, v13
    v_mfma_f32_16x16x32_bf16 v[92:95], v[192:195], a[12:15], 0
    buffer_load_dwordx4 v[184:187], v56, s[32:35], s75 offen offset:0 sc1
    v_mfma_f32_16x16x32_bf16 v[92:95], v[196:199], a[44:47], v[92:95]
    v_add_u32 v14, s61, v14
    v_add_u32 v15, s61, v15
    v_mfma_f32_16x16x32_bf16 v[92:95], v[200:203], a[76:79], v[92:95]
    v_add_u32 v16, s61, v16
    s_waitcnt lgkmcnt(5)
    v_add_f32 v104, v104, v108
    v_mfma_f32_16x16x32_bf16 v[92:95], v[204:207], a[108:111], v[92:95]
    v_add_f32 v105, v105, v109
    v_add_f32 v106, v106, v110
    v_mfma_f32_16x16x32_bf16 v[92:95], v[208:211], a[140:143], v[92:95]
    v_add_f32 v107, v107, v111
    s_waitcnt lgkmcnt(4)
    v_add_f32 v112, v112, v76
    v_mfma_f32_16x16x32_bf16 v[92:95], v[212:215], a[172:175], v[92:95]
    v_add_f32 v113, v113, v77
    v_add_f32 v114, v114, v78
    v_mfma_f32_16x16x32_bf16 v[92:95], v[216:219], a[204:207], v[92:95]
    ds_write_b128 v42, v[88:91] offset:12288
    v_mfma_f32_16x16x32_bf16 v[92:95], v[220:223], a[236:239], v[92:95]
    v_add_f32 v115, v115, v79
    v_add_f32 v104, v104, v112
    v_mfma_f32_16x16x32_bf16 v[80:83], v[192:195], a[0:3], v[48:51]
    buffer_load_dwordx4 v[188:191], v56, s[32:35], s75 offen offset:1024 sc1
    v_mfma_f32_16x16x32_bf16 v[80:83], v[196:199], a[32:35], v[80:83]
    v_add_f32 v105, v105, v113
    v_add_f32 v106, v106, v114
    v_mfma_f32_16x16x32_bf16 v[80:83], v[200:203], a[64:67], v[80:83]
    v_add_f32 v107, v107, v115
    v_cvt_pk_bf16_f32 v62, v104, v105
    v_mfma_f32_16x16x32_bf16 v[80:83], v[204:207], a[96:99], v[80:83]
    v_cvt_pk_bf16_f32 v63, v106, v107
    buffer_store_dwordx2 v[62:63], v45, s[32:35], s37 offen offset:1024 sc1
    v_mfma_f32_16x16x32_bf16 v[80:83], v[208:211], a[128:131], v[80:83]
    buffer_load_dwordx4 v10, s[24:27], s86 offen offset:1024 lds
    v_mfma_f32_16x16x32_bf16 v[80:83], v[212:215], a[160:163], v[80:83]
    s_waitcnt lgkmcnt(3)
    v_add_f32 v116, v116, v120
    v_add_f32 v117, v117, v121
    v_mfma_f32_16x16x32_bf16 v[80:83], v[216:219], a[192:195], v[80:83]
    ds_write_b128 v43, v[92:95] offset:12288
    v_mfma_f32_16x16x32_bf16 v[80:83], v[220:223], a[224:227], v[80:83]
    v_add_f32 v118, v118, v122
    v_add_f32 v119, v119, v123
    v_mfma_f32_16x16x32_bf16 v[64:67], v[128:131], a[20:23], 0
    s_lshl_b32 s7, s69, 16
    s_add_u32 s7, s7, s4
    v_add_u32 v56, s7, v1
    buffer_load_dwordx4 v[192:195], v56, s[32:35], s72 offen offset:0 sc1
    v_mfma_f32_16x16x32_bf16 v[64:67], v[132:135], a[52:55], v[64:67]
    buffer_load_dwordx2 v[54:55], v45, s[32:35], s36 offen offset:512 sc1
    v_mfma_f32_16x16x32_bf16 v[64:67], v[136:139], a[84:87], v[64:67]
    s_waitcnt lgkmcnt(3)
    v_add_f32 v124, v124, v100
    v_add_f32 v125, v125, v101
    v_mfma_f32_16x16x32_bf16 v[64:67], v[140:143], a[116:119], v[64:67]
    s_waitcnt vmcnt(20)
    v_add_f32 v126, v126, v102
    v_add_f32 v127, v127, v103
    v_mfma_f32_16x16x32_bf16 v[64:67], v[144:147], a[148:151], v[64:67]
    v_add_f32 v244, v116, v124
    v_add_f32 v245, v117, v125
    v_mfma_f32_16x16x32_bf16 v[64:67], v[148:151], a[180:183], v[64:67]
    v_add_f32 v246, v118, v126
    v_add_f32 v247, v119, v127
    v_mfma_f32_16x16x32_bf16 v[64:67], v[152:155], a[212:215], v[64:67]
    v_mfma_f32_16x16x32_bf16 v[64:67], v[156:159], a[244:247], v[64:67]
    v_mfma_f32_16x16x32_bf16 v[68:71], v[128:131], a[24:27], 0
    buffer_load_dwordx4 v[196:199], v56, s[32:35], s72 offen offset:1024 sc1
    v_mfma_f32_16x16x32_bf16 v[68:71], v[132:135], a[56:59], v[68:71]
    v_mfma_f32_16x16x32_bf16 v[68:71], v[136:139], a[88:91], v[68:71]
    v_mfma_f32_16x16x32_bf16 v[68:71], v[140:143], a[120:123], v[68:71]
    v_mfma_f32_16x16x32_bf16 v[68:71], v[144:147], a[152:155], v[68:71]
    buffer_load_dwordx4 v11, s[24:27], s86 offen offset:2048 lds
    v_mfma_f32_16x16x32_bf16 v[68:71], v[148:151], a[184:187], v[68:71]
    v_mfma_f32_16x16x32_bf16 v[68:71], v[152:155], a[216:219], v[68:71]
    ds_write_b128 v41, v[64:67] offset:24576
    v_mfma_f32_16x16x32_bf16 v[68:71], v[156:159], a[248:251], v[68:71]
    v_mfma_f32_16x16x32_bf16 v[72:75], v[128:131], a[28:31], 0
    buffer_load_dwordx4 v[200:203], v56, s[32:35], s73 offen offset:0 sc1
    v_mfma_f32_16x16x32_bf16 v[72:75], v[132:135], a[60:63], v[72:75]
    s_waitcnt vmcnt(11)
    v_max_u32 v39, v52, v53
    v_cmp_eq_u32 vcc, -1, v39
    v_mfma_f32_16x16x32_bf16 v[72:75], v[136:139], a[92:95], v[72:75]
    v_lshlrev_b32 v46, 16, v224
    v_and_b32 v47, 0xffff0000, v224
    v_mfma_f32_16x16x32_bf16 v[72:75], v[140:143], a[124:127], v[72:75]
    v_lshlrev_b32 v238, 16, v225
    v_and_b32 v239, 0xffff0000, v225
    v_mfma_f32_16x16x32_bf16 v[72:75], v[144:147], a[156:159], v[72:75]
    s_cbranch_vccnz Lrt_33
Lrtd_34:
    v_lshlrev_b32 v32, 16, v52
    v_mfma_f32_16x16x32_bf16 v[72:75], v[148:151], a[188:191], v[72:75]
    v_and_b32 v33, 0xffff0000, v52
    v_lshlrev_b32 v35, 16, v53
    v_mfma_f32_16x16x32_bf16 v[72:75], v[152:155], a[220:223], v[72:75]
    ds_write_b128 v42, v[68:71] offset:24576
    v_mfma_f32_16x16x32_bf16 v[72:75], v[156:159], a[252:255], v[72:75]
    v_and_b32 v38, 0xffff0000, v53
    v_add_f32 v32, v32, v240
    v_mfma_f32_16x16x32_bf16 v[96:99], v[128:131], a[16:19], 0
    buffer_load_dwordx4 v[204:207], v56, s[32:35], s73 offen offset:1024 sc1
    v_mfma_f32_16x16x32_bf16 v[96:99], v[132:135], a[48:51], v[96:99]
    v_add_f32 v33, v33, v241
    v_add_f32 v35, v35, v242
    v_mfma_f32_16x16x32_bf16 v[96:99], v[136:139], a[80:83], v[96:99]
    v_add_f32 v38, v38, v243
    v_mul_f32 v32, v32, v46
    v_mfma_f32_16x16x32_bf16 v[96:99], v[140:143], a[112:115], v[96:99]
    v_mul_f32 v33, v33, v47
    v_mul_f32 v35, v35, v238
    v_mfma_f32_16x16x32_bf16 v[96:99], v[144:147], a[144:147], v[96:99]
    v_mul_f32 v38, v38, v239
    v_cvt_pk_bf16_f32 v58, v32, v33
    v_mfma_f32_16x16x32_bf16 v[96:99], v[148:151], a[176:179], v[96:99]
    v_cvt_pk_bf16_f32 v59, v35, v38
    buffer_store_dwordx2 v[58:59], v1, s[32:35], s91 offen nt
    v_mfma_f32_16x16x32_bf16 v[96:99], v[152:155], a[208:211], v[96:99]
    ds_write_b128 v43, v[72:75] offset:24576
    v_mfma_f32_16x16x32_bf16 v[96:99], v[156:159], a[240:243], v[96:99]
    v_mfma_f32_16x16x32_bf16 v[84:87], v[128:131], a[4:7], 0
    buffer_load_dwordx4 v[208:211], v56, s[32:35], s74 offen offset:0 sc1
    v_mfma_f32_16x16x32_bf16 v[84:87], v[132:135], a[36:39], v[84:87]
    v_mfma_f32_16x16x32_bf16 v[84:87], v[136:139], a[68:71], v[84:87]
    v_mfma_f32_16x16x32_bf16 v[84:87], v[140:143], a[100:103], v[84:87]
    s_waitcnt lgkmcnt(0)
    s_barrier
    v_mfma_f32_16x16x32_bf16 v[84:87], v[144:147], a[132:135], v[84:87]
    buffer_load_dwordx4 v12, s[24:27], s86 offen offset:3072 lds
    v_mfma_f32_16x16x32_bf16 v[84:87], v[148:151], a[164:167], v[84:87]
    ds_read_b128 v[104:107], v44 offset:24576
    ds_read_b128 v[108:111], v44 offset:25600
    v_mfma_f32_16x16x32_bf16 v[84:87], v[152:155], a[196:199], v[84:87]
    ds_read_b128 v[112:115], v44 offset:26624
    ds_read_b128 v[116:119], v44 offset:12288
    v_mfma_f32_16x16x32_bf16 v[84:87], v[156:159], a[228:231], v[84:87]
    s_add_u32 m0, s90, 53248
    s_add_u32 s86, s89, 32768
    ds_read_b128 v[120:123], v44 offset:13312
    v_mfma_f32_16x16x32_bf16 v[88:91], v[128:131], a[8:11], 0
    buffer_load_dwordx4 v[212:215], v56, s[32:35], s74 offen offset:1024 sc1
    v_mfma_f32_16x16x32_bf16 v[88:91], v[132:135], a[40:43], v[88:91]
    buffer_load_dwordx2 v[52:53], v45, s[32:35], s36 offen offset:1024 sc1
    v_mfma_f32_16x16x32_bf16 v[88:91], v[136:139], a[72:75], v[88:91]
    ds_read_b128 v[124:127], v44 offset:14336
    v_mfma_f32_16x16x32_bf16 v[88:91], v[140:143], a[104:107], v[88:91]
    v_mfma_f32_16x16x32_bf16 v[88:91], v[144:147], a[136:139], v[88:91]
    s_waitcnt lgkmcnt(4)
    v_add_f32 v104, v104, v108
    v_add_f32 v105, v105, v109
    v_mfma_f32_16x16x32_bf16 v[88:91], v[148:151], a[168:171], v[88:91]
    v_add_f32 v106, v106, v110
    v_add_f32 v107, v107, v111
    v_mfma_f32_16x16x32_bf16 v[88:91], v[152:155], a[200:203], v[88:91]
    ds_write_b128 v41, v[84:87] offset:36864
    v_mfma_f32_16x16x32_bf16 v[88:91], v[156:159], a[232:235], v[88:91]
    s_waitcnt lgkmcnt(4)
    v_add_f32 v112, v112, v96
    v_add_f32 v113, v113, v97
    v_mfma_f32_16x16x32_bf16 v[92:95], v[128:131], a[12:15], 0
    buffer_load_dwordx4 v[216:219], v56, s[32:35], s75 offen offset:0 sc1
    v_mfma_f32_16x16x32_bf16 v[92:95], v[132:135], a[44:47], v[92:95]
    v_add_f32 v114, v114, v98
    v_add_f32 v115, v115, v99
    v_mfma_f32_16x16x32_bf16 v[92:95], v[136:139], a[76:79], v[92:95]
Lstub8:
    s_cbranch_execz Lwarmb
    v_add_f32 v104, v104, v112
    v_add_f32 v105, v105, v113
    v_mfma_f32_16x16x32_bf16 v[92:95], v[140:143], a[108:111], v[92:95]
    v_add_f32 v106, v106, v114
    v_add_f32 v107, v107, v115
    v_mfma_f32_16x16x32_bf16 v[92:95], v[144:147], a[140:143], v[92:95]
    buffer_load_dwordx4 v9, s[24:27], s86 offen lds
    v_mfma_f32_16x16x32_bf16 v[92:95], v[148:151], a[172:175], v[92:95]
    v_cvt_pk_bf16_f32 v62, v104, v105
    v_cvt_pk_bf16_f32 v63, v106, v107
    v_mfma_f32_16x16x32_bf16 v[92:95], v[152:155], a[204:207], v[92:95]
    ds_write_b128 v42, v[88:91] offset:36864
    v_mfma_f32_16x16x32_bf16 v[92:95], v[156:159], a[236:239], v[92:95]
    buffer_store_dwordx2 v[62:63], v45, s[32:35], s37 offen offset:1536 sc1
    s_waitcnt lgkmcnt(3)
    v_add_f32 v116, v116, v120
    v_mfma_f32_16x16x32_bf16 v[100:103], v[128:131], a[0:3], v[48:51]
    buffer_load_dwordx4 v[220:223], v56, s[32:35], s75 offen offset:1024 sc1
    v_mfma_f32_16x16x32_bf16 v[100:103], v[132:135], a[32:35], v[100:103]
    v_add_f32 v117, v117, v121
    v_add_f32 v118, v118, v122
    v_mfma_f32_16x16x32_bf16 v[100:103], v[136:139], a[64:67], v[100:103]
    v_add_f32 v119, v119, v123
    s_waitcnt lgkmcnt(2)
    v_add_f32 v124, v124, v80
    v_mfma_f32_16x16x32_bf16 v[100:103], v[140:143], a[96:99], v[100:103]
    v_add_f32 v125, v125, v81
    v_add_f32 v126, v126, v82
    v_mfma_f32_16x16x32_bf16 v[100:103], v[144:147], a[128:131], v[100:103]
    v_add_f32 v127, v127, v83
    v_add_f32 v248, v116, v124
    v_mfma_f32_16x16x32_bf16 v[100:103], v[148:151], a[160:163], v[100:103]
    v_add_f32 v249, v117, v125
    v_add_f32 v250, v118, v126
    v_mfma_f32_16x16x32_bf16 v[100:103], v[152:155], a[192:195], v[100:103]
    ds_write_b128 v43, v[92:95] offset:36864
    v_mfma_f32_16x16x32_bf16 v[100:103], v[156:159], a[224:227], v[100:103]
    v_add_f32 v251, v119, v127
    v_mfma_f32_16x16x32_bf16 v[64:67], v[160:163], a[20:23], 0
    s_lshl_b32 s7, s70, 16
    s_add_u32 s7, s7, s4
    v_add_u32 v56, s7, v1
    buffer_load_dwordx4 v[128:131], v56, s[32:35], s72 offen offset:0 sc1
    v_mfma_f32_16x16x32_bf16 v[64:67], v[164:167], a[52:55], v[64:67]
    s_waitcnt vmcnt(14)
    v_max_u32 v39, v54, v55
    v_cmp_eq_u32 vcc, -1, v39
    v_mfma_f32_16x16x32_bf16 v[64:67], v[168:171], a[84:87], v[64:67]
    v_lshlrev_b32 v46, 16, v226
    v_and_b32 v47, 0xffff0000, v226
    v_mfma_f32_16x16x32_bf16 v[64:67], v[172:175], a[116:119], v[64:67]
    v_lshlrev_b32 v238, 16, v227
    v_and_b32 v239, 0xffff0000, v227
    v_mfma_f32_16x16x32_bf16 v[64:67], v[176:179], a[148:151], v[64:67]
    buffer_load_dwordx4 v[132:135], v56, s[32:35], s72 offen offset:1024 sc1
    v_mfma_f32_16x16x32_bf16 v[64:67], v[180:183], a[180:183], v[64:67]
    s_cbranch_vccnz Lrt_36
Lrtd_37:
    v_lshlrev_b32 v32, 16, v54
    v_mfma_f32_16x16x32_bf16 v[64:67], v[184:187], a[212:215], v[64:67]
    v_and_b32 v33, 0xffff0000, v54
    v_lshlrev_b32 v35, 16, v55
    v_mfma_f32_16x16x32_bf16 v[64:67], v[188:191], a[244:247], v[64:67]
    v_and_b32 v38, 0xffff0000, v55
    v_add_f32 v32, v32, v244
    v_mfma_f32_16x16x32_bf16 v[68:71], v[160:163], a[24:27], 0
    buffer_load_dwordx4 v10, s[24:27], s86 offen offset:1024 lds
    v_mfma_f32_16x16x32_bf16 v[68:71], v[164:167], a[56:59], v[68:71]
    v_add_f32 v33, v33, v245
    v_add_f32 v35, v35, v246
    v_mfma_f32_16x16x32_bf16 v[68:71], v[168:171], a[88:91], v[68:71]
    v_add_f32 v38, v38, v247
    v_mul_f32 v32, v32, v46
    v_mfma_f32_16x16x32_bf16 v[68:71], v[172:175], a[120:123], v[68:71]
    v_mul_f32 v33, v33, v47
    v_mul_f32 v35, v35, v238
    v_mfma_f32_16x16x32_bf16 v[68:71], v[176:179], a[152:155], v[68:71]
    buffer_load_dwordx4 v[136:139], v56, s[32:35], s73 offen offset:0 sc1
    v_mfma_f32_16x16x32_bf16 v[68:71], v[180:183], a[184:187], v[68:71]
    v_mul_f32 v38, v38, v239
    v_cvt_pk_bf16_f32 v58, v32, v33
    v_mfma_f32_16x16x32_bf16 v[68:71], v[184:187], a[216:219], v[68:71]
    ds_write_b128 v41, v[64:67] offset:0
    v_mfma_f32_16x16x32_bf16 v[68:71], v[188:191], a[248:251], v[68:71]
    v_cvt_pk_bf16_f32 v59, v35, v38
    v_mfma_f32_16x16x32_bf16 v[72:75], v[160:163], a[28:31], 0
    buffer_load_dwordx4 v[140:143], v56, s[32:35], s73 offen offset:1024 sc1
    v_mfma_f32_16x16x32_bf16 v[72:75], v[164:167], a[60:63], v[72:75]
    v_mfma_f32_16x16x32_bf16 v[72:75], v[168:171], a[92:95], v[72:75]
    v_mfma_f32_16x16x32_bf16 v[72:75], v[172:175], a[124:127], v[72:75]
    v_mfma_f32_16x16x32_bf16 v[72:75], v[176:179], a[156:159], v[72:75]
    v_mfma_f32_16x16x32_bf16 v[72:75], v[180:183], a[188:191], v[72:75]
    v_mfma_f32_16x16x32_bf16 v[72:75], v[184:187], a[220:223], v[72:75]
    ds_write_b128 v42, v[68:71] offset:0
    v_mfma_f32_16x16x32_bf16 v[72:75], v[188:191], a[252:255], v[72:75]
    v_mfma_f32_16x16x32_bf16 v[76:79], v[160:163], a[16:19], 0
    buffer_load_dwordx4 v[144:147], v56, s[32:35], s74 offen offset:0 sc1
    v_mfma_f32_16x16x32_bf16 v[76:79], v[164:167], a[48:51], v[76:79]
    s_waitcnt vmcnt(10)
    v_max_u32 v39, v52, v53
    v_cmp_eq_u32 vcc, -1, v39
    v_mfma_f32_16x16x32_bf16 v[76:79], v[168:171], a[80:83], v[76:79]
    v_lshlrev_b32 v46, 16, v228
    v_and_b32 v47, 0xffff0000, v228
    v_mfma_f32_16x16x32_bf16 v[76:79], v[172:175], a[112:115], v[76:79]
    v_lshlrev_b32 v238, 16, v229
    v_and_b32 v239, 0xffff0000, v229
    v_mfma_f32_16x16x32_bf16 v[76:79], v[176:179], a[144:147], v[76:79]
    buffer_load_dwordx4 v[148:151], v56, s[32:35], s74 offen offset:1024 sc1
    v_mfma_f32_16x16x32_bf16 v[76:79], v[180:183], a[176:179], v[76:79]
    s_cbranch_vccnz Lrt_39
Lrtd_40:
    v_lshlrev_b32 v32, 16, v52
    v_mfma_f32_16x16x32_bf16 v[76:79], v[184:187], a[208:211], v[76:79]
    ds_write_b128 v43, v[72:75] offset:0
    v_mfma_f32_16x16x32_bf16 v[76:79], v[188:191], a[240:243], v[76:79]
    v_and_b32 v33, 0xffff0000, v52
    v_lshlrev_b32 v35, 16, v53
    v_mfma_f32_16x16x32_bf16 v[84:87], v[160:163], a[4:7], 0
    v_and_b32 v38, 0xffff0000, v53
    v_add_f32 v32, v32, v248
    v_mfma_f32_16x16x32_bf16 v[84:87], v[164:167], a[36:39], v[84:87]
    v_add_f32 v33, v33, v249
    v_add_f32 v35, v35, v250
    v_mfma_f32_16x16x32_bf16 v[84:87], v[168:171], a[68:71], v[84:87]
    v_add_f32 v38, v38, v251
    v_mul_f32 v32, v32, v46
    v_mfma_f32_16x16x32_bf16 v[84:87], v[172:175], a[100:103], v[84:87]
    v_mul_f32 v33, v33, v47
    v_mul_f32 v35, v35, v238
    s_waitcnt lgkmcnt(0)
    s_barrier
    v_mfma_f32_16x16x32_bf16 v[84:87], v[176:179], a[132:135], v[84:87]
    buffer_load_dwordx4 v[152:155], v56, s[32:35], s75 offen offset:0 sc1
    v_mfma_f32_16x16x32_bf16 v[84:87], v[180:183], a[164:167], v[84:87]
    ds_read_b128 v[104:107], v44 offset:0
    ds_read_b128 v[108:111], v44 offset:1024
    v_mfma_f32_16x16x32_bf16 v[84:87], v[184:187], a[196:199], v[84:87]
    ds_read_b128 v[112:115], v44 offset:2048
    ds_read_b128 v[116:119], v44 offset:36864
    v_mfma_f32_16x16x32_bf16 v[84:87], v[188:191], a[228:231], v[84:87]
    ds_read_b128 v[120:123], v44 offset:37888
    ds_read_b128 v[124:127], v44 offset:38912
    v_mfma_f32_16x16x32_bf16 v[88:91], v[160:163], a[8:11], 0
    buffer_load_dwordx4 v[156:159], v56, s[32:35], s75 offen offset:1024 sc1
    v_mfma_f32_16x16x32_bf16 v[88:91], v[164:167], a[40:43], v[88:91]
    v_mul_f32 v38, v38, v239
    v_cvt_pk_bf16_f32 v60, v32, v33
    v_mfma_f32_16x16x32_bf16 v[88:91], v[168:171], a[72:75], v[88:91]
    v_cvt_pk_bf16_f32 v61, v35, v38
    buffer_store_dwordx4 v[58:61], v1, s[32:35], s92 offen offset:0 nt
    v_mfma_f32_16x16x32_bf16 v[88:91], v[172:175], a[104:107], v[88:91]
    v_mfma_f32_16x16x32_bf16 v[88:91], v[176:179], a[136:139], v[88:91]
    buffer_load_dwordx4 v11, s[24:27], s86 offen offset:2048 lds
    v_mfma_f32_16x16x32_bf16 v[88:91], v[180:183], a[168:171], v[88:91]
    buffer_load_dwordx2 v[54:55], v45, s[32:35], s36 offen offset:1536 sc1
    v_mfma_f32_16x16x32_bf16 v[88:91], v[184:187], a[200:203], v[88:91]
    ds_write_b128 v41, v[84:87] offset:12288
    v_mfma_f32_16x16x32_bf16 v[88:91], v[188:191], a[232:235], v[88:91]
    s_waitcnt lgkmcnt(5)
    v_add_f32 v104, v104, v108
    v_add_f32 v105, v105, v109
    v_mfma_f32_16x16x32_bf16 v[92:95], v[160:163], a[12:15], 0
    v_add_f32 v106, v106, v110
    v_add_f32 v107, v107, v111
    v_mfma_f32_16x16x32_bf16 v[92:95], v[164:167], a[44:47], v[92:95]
    s_waitcnt lgkmcnt(4)
    v_add_f32 v112, v112, v76
    v_add_f32 v113, v113, v77
    v_mfma_f32_16x16x32_bf16 v[92:95], v[168:171], a[76:79], v[92:95]
    v_add_f32 v114, v114, v78
    v_add_f32 v115, v115, v79
    v_mfma_f32_16x16x32_bf16 v[92:95], v[172:175], a[108:111], v[92:95]
    v_add_f32 v104, v104, v112
    v_add_f32 v105, v105, v113
    v_mfma_f32_16x16x32_bf16 v[92:95], v[176:179], a[140:143], v[92:95]
    buffer_load_dwordx4 v12, s[24:27], s86 offen offset:3072 lds
    v_mfma_f32_16x16x32_bf16 v[92:95], v[180:183], a[172:175], v[92:95]
    v_add_f32 v106, v106, v114
    v_add_f32 v107, v107, v115
    v_mfma_f32_16x16x32_bf16 v[92:95], v[184:187], a[204:207], v[92:95]
    ds_write_b128 v42, v[88:91] offset:12288
    v_mfma_f32_16x16x32_bf16 v[92:95], v[188:191], a[236:239], v[92:95]
    s_add_u32 m0, s90, 69632
    s_add_u32 s86, s89, 163840
    v_cvt_pk_bf16_f32 v62, v104, v105
    v_mfma_f32_16x16x32_bf16 v[80:83], v[160:163], a[0:3], v[48:51]
    v_cvt_pk_bf16_f32 v63, v106, v107
    buffer_store_dwordx2 v[62:63], v45, s[32:35], s37 offen offset:2048 sc1
    v_mfma_f32_16x16x32_bf16 v[80:83], v[164:167], a[32:35], v[80:83]
    s_waitcnt lgkmcnt(3)
    v_add_f32 v116, v116, v120
    v_add_f32 v117, v117, v121
    v_mfma_f32_16x16x32_bf16 v[80:83], v[168:171], a[64:67], v[80:83]
    v_add_f32 v118, v118, v122
    v_add_f32 v119, v119, v123
    v_mfma_f32_16x16x32_bf16 v[80:83], v[172:175], a[96:99], v[80:83]
    s_waitcnt lgkmcnt(2)
    v_add_f32 v124, v124, v100
    v_add_f32 v125, v125, v101
    v_mfma_f32_16x16x32_bf16 v[80:83], v[176:179], a[128:131], v[80:83]
    v_add_f32 v126, v126, v102
    v_add_f32 v127, v127, v103
    v_mfma_f32_16x16x32_bf16 v[80:83], v[180:183], a[160:163], v[80:83]
    v_add_f32 v240, v116, v124
    v_add_f32 v241, v117, v125
    v_mfma_f32_16x16x32_bf16 v[80:83], v[184:187], a[192:195], v[80:83]
    ds_write_b128 v43, v[92:95] offset:12288
    v_mfma_f32_16x16x32_bf16 v[80:83], v[188:191], a[224:227], v[80:83]
    v_add_f32 v242, v118, v126
    v_add_f32 v243, v119, v127
    v_mfma_f32_16x16x32_bf16 v[64:67], v[192:195], a[20:23], 0
    buffer_load_dwordx4 v9, s[24:27], s86 offen lds
    v_mfma_f32_16x16x32_bf16 v[64:67], v[196:199], a[52:55], v[64:67]
    v_mfma_f32_16x16x32_bf16 v[64:67], v[200:203], a[84:87], v[64:67]
    v_mfma_f32_16x16x32_bf16 v[64:67], v[204:207], a[116:119], v[64:67]
    s_waitcnt vmcnt(15)
    v_mfma_f32_16x16x32_bf16 v[64:67], v[208:211], a[148:151], v[64:67]
    v_mfma_f32_16x16x32_bf16 v[64:67], v[212:215], a[180:183], v[64:67]
    v_mfma_f32_16x16x32_bf16 v[64:67], v[216:219], a[212:215], v[64:67]
    v_mfma_f32_16x16x32_bf16 v[64:67], v[220:223], a[244:247], v[64:67]
    v_mfma_f32_16x16x32_bf16 v[68:71], v[192:195], a[24:27], 0
    buffer_load_dwordx4 v10, s[24:27], s86 offen offset:1024 lds
    v_mfma_f32_16x16x32_bf16 v[68:71], v[196:199], a[56:59], v[68:71]
    v_mfma_f32_16x16x32_bf16 v[68:71], v[200:203], a[88:91], v[68:71]
    v_mfma_f32_16x16x32_bf16 v[68:71], v[204:207], a[120:123], v[68:71]
    v_mfma_f32_16x16x32_bf16 v[68:71], v[208:211], a[152:155], v[68:71]
    v_mfma_f32_16x16x32_bf16 v[68:71], v[212:215], a[184:187], v[68:71]
    v_mfma_f32_16x16x32_bf16 v[68:71], v[216:219], a[216:219], v[68:71]
    ds_write_b128 v41, v[64:67] offset:24576
    v_mfma_f32_16x16x32_bf16 v[68:71], v[220:223], a[248:251], v[68:71]
    s_mov_b64 exec, 2
    s_waitcnt vmcnt(6)
    buffer_store_dword v0, off, s[32:35], s6 offset:0
    s_mov_b64 exec, -1
    v_mfma_f32_16x16x32_bf16 v[72:75], v[192:195], a[28:31], 0
    v_mfma_f32_16x16x32_bf16 v[72:75], v[196:199], a[60:63], v[72:75]
    v_mfma_f32_16x16x32_bf16 v[72:75], v[200:203], a[92:95], v[72:75]
    v_mfma_f32_16x16x32_bf16 v[72:75], v[204:207], a[124:127], v[72:75]
    v_mfma_f32_16x16x32_bf16 v[72:75], v[208:211], a[156:159], v[72:75]
    buffer_load_dwordx4 v11, s[24:27], s86 offen offset:2048 lds
    v_mfma_f32_16x16x32_bf16 v[72:75], v[212:215], a[188:191], v[72:75]
    v_mfma_f32_16x16x32_bf16 v[72:75], v[216:219], a[220:223], v[72:75]
    ds_write_b128 v42, v[68:71] offset:24576
    v_mfma_f32_16x16x32_bf16 v[72:75], v[220:223], a[252:255], v[72:75]
    v_mfma_f32_16x16x32_bf16 v[96:99], v[192:195], a[16:19], 0
    s_waitcnt vmcnt(6)
    v_max_u32 v39, v54, v55
    v_cmp_eq_u32 vcc, -1, v39
    v_mfma_f32_16x16x32_bf16 v[96:99], v[196:199], a[48:51], v[96:99]
    v_lshlrev_b32 v46, 16, v230
    v_and_b32 v47, 0xffff0000, v230
    v_mfma_f32_16x16x32_bf16 v[96:99], v[200:203], a[80:83], v[96:99]
    v_lshlrev_b32 v238, 16, v231
    v_and_b32 v239, 0xffff0000, v231
    v_mfma_f32_16x16x32_bf16 v[96:99], v[204:207], a[112:115], v[96:99]
    s_cbranch_vccnz Lrt_42
Lrtd_43:
    v_lshlrev_b32 v32, 16, v54
    v_mfma_f32_16x16x32_bf16 v[96:99], v[208:211], a[144:147], v[96:99]
    v_and_b32 v33, 0xffff0000, v54
    v_lshlrev_b32 v35, 16, v55
    v_mfma_f32_16x16x32_bf16 v[96:99], v[212:215], a[176:179], v[96:99]
    v_and_b32 v38, 0xffff0000, v55
    v_add_f32 v32, v32, v240
    v_mfma_f32_16x16x32_bf16 v[96:99], v[216:219], a[208:211], v[96:99]
    ds_write_b128 v43, v[72:75] offset:24576
    v_mfma_f32_16x16x32_bf16 v[96:99], v[220:223], a[240:243], v[96:99]
    v_add_f32 v33, v33, v241
    v_add_f32 v35, v35, v242
    v_mfma_f32_16x16x32_bf16 v[84:87], v[128:131], a[20:23], 0
    buffer_load_dwordx4 v12, s[24:27], s86 offen offset:3072 lds
    v_mfma_f32_16x16x32_bf16 v[84:87], v[132:135], a[52:55], v[84:87]
    v_add_f32 v38, v38, v243
    v_mul_f32 v32, v32, v46
    v_mfma_f32_16x16x32_bf16 v[84:87], v[136:139], a[84:87], v[84:87]
    v_mul_f32 v33, v33, v47
    v_mul_f32 v35, v35, v238
    v_mfma_f32_16x16x32_bf16 v[84:87], v[140:143], a[116:119], v[84:87]
    s_add_u32 m0, s90, 57344
    s_add_u32 s86, s89, 65536
    v_mul_f32 v38, v38, v239
    s_waitcnt lgkmcnt(0)
    s_barrier
    v_mfma_f32_16x16x32_bf16 v[84:87], v[144:147], a[148:151], v[84:87]
    ds_read_b128 v[104:107], v44 offset:24576
    ds_read_b128 v[108:111], v44 offset:25600
    v_mfma_f32_16x16x32_bf16 v[84:87], v[148:151], a[180:183], v[84:87]
    buffer_load_dwordx2 v[52:53], v45, s[32:35], s36 offen offset:2048 sc1
    v_mfma_f32_16x16x32_bf16 v[84:87], v[152:155], a[212:215], v[84:87]
    ds_read_b128 v[112:115], v44 offset:26624
    ds_read_b128 v[116:119], v44 offset:12288
    v_mfma_f32_16x16x32_bf16 v[84:87], v[156:159], a[244:247], v[84:87]
    ds_read_b128 v[120:123], v44 offset:13312
    ds_read_b128 v[124:127], v44 offset:14336
    v_mfma_f32_16x16x32_bf16 v[88:91], v[128:131], a[24:27], 0
    buffer_load_dwordx4 v9, s[24:27], s86 offen lds
    v_mfma_f32_16x16x32_bf16 v[88:91], v[132:135], a[56:59], v[88:91]
    v_cvt_pk_bf16_f32 v58, v32, v33
    v_cvt_pk_bf16_f32 v59, v35, v38
    v_mfma_f32_16x16x32_bf16 v[88:91], v[136:139], a[88:91], v[88:91]
    v_mfma_f32_16x16x32_bf16 v[88:91], v[140:143], a[120:123], v[88:91]
    v_mfma_f32_16x16x32_bf16 v[88:91], v[144:147], a[152:155], v[88:91]
    s_waitcnt lgkmcnt(4)
    v_add_f32 v104, v104, v108
    v_add_f32 v105, v105, v109
    v_mfma_f32_16x16x32_bf16 v[88:91], v[148:151], a[184:187], v[88:91]
    v_add_f32 v106, v106, v110
    v_add_f32 v107, v107, v111
    v_mfma_f32_16x16x32_bf16 v[88:91], v[152:155], a[216:219], v[88:91]
    ds_write_b128 v41, v[84:87] offset:36864
    v_mfma_f32_16x16x32_bf16 v[88:91], v[156:159], a[248:251], v[88:91]
    s_waitcnt lgkmcnt(4)
    v_add_f32 v112, v112, v96
    v_add_f32 v113, v113, v97
    v_mfma_f32_16x16x32_bf16 v[92:95], v[128:131], a[28:31], 0
    v_add_f32 v114, v114, v98
    v_add_f32 v115, v115, v99
    v_mfma_f32_16x16x32_bf16 v[92:95], v[132:135], a[60:63], v[92:95]
    v_add_f32 v104, v104, v112
    v_add_f32 v105, v105, v113
    v_mfma_f32_16x16x32_bf16 v[92:95], v[136:139], a[92:95], v[92:95]
    v_add_f32 v106, v106, v114
    v_add_f32 v107, v107, v115
    v_mfma_f32_16x16x32_bf16 v[92:95], v[140:143], a[124:127], v[92:95]
    v_cvt_pk_bf16_f32 v62, v104, v105
    v_cvt_pk_bf16_f32 v63, v106, v107
    v_mfma_f32_16x16x32_bf16 v[92:95], v[144:147], a[156:159], v[92:95]
    buffer_load_dwordx4 v10, s[24:27], s86 offen offset:1024 lds
    v_mfma_f32_16x16x32_bf16 v[92:95], v[148:151], a[188:191], v[92:95]
    buffer_store_dwordx2 v[62:63], v45, s[32:35], s37 offen offset:2560 sc1
    s_waitcnt lgkmcnt(2)
    v_add_f32 v116, v116, v120
    v_mfma_f32_16x16x32_bf16 v[92:95], v[152:155], a[220:223], v[92:95]
    ds_write_b128 v42, v[88:91] offset:36864
    v_mfma_f32_16x16x32_bf16 v[92:95], v[156:159], a[252:255], v[92:95]
    v_add_f32 v117, v117, v121
    v_add_f32 v118, v118, v122
    v_mfma_f32_16x16x32_bf16 v[100:103], v[128:131], a[16:19], 0
    v_add_f32 v119, v119, v123
    s_waitcnt lgkmcnt(2)
    v_add_f32 v124, v124, v80
    v_mfma_f32_16x16x32_bf16 v[100:103], v[132:135], a[48:51], v[100:103]
    v_add_f32 v125, v125, v81
    v_add_f32 v126, v126, v82
    v_mfma_f32_16x16x32_bf16 v[100:103], v[136:139], a[80:83], v[100:103]
    v_add_f32 v127, v127, v83
    v_add_f32 v244, v116, v124
    v_mfma_f32_16x16x32_bf16 v[100:103], v[140:143], a[112:115], v[100:103]
    v_add_f32 v245, v117, v125
    v_add_f32 v246, v118, v126
    v_mfma_f32_16x16x32_bf16 v[100:103], v[144:147], a[144:147], v[100:103]
    v_add_f32 v247, v119, v127
    v_mfma_f32_16x16x32_bf16 v[100:103], v[148:151], a[176:179], v[100:103]
    v_mfma_f32_16x16x32_bf16 v[100:103], v[152:155], a[208:211], v[100:103]
    ds_write_b128 v43, v[92:95] offset:36864
    v_mfma_f32_16x16x32_bf16 v[100:103], v[156:159], a[240:243], v[100:103]
    v_mfma_f32_16x16x32_bf16 v[64:67], v[192:195], a[4:7], 0
    buffer_load_dwordx4 v11, s[24:27], s86 offen offset:2048 lds
    v_mfma_f32_16x16x32_bf16 v[64:67], v[196:199], a[36:39], v[64:67]
    buffer_load_dword v57, v40, s[32:35], 0 offen offset:0 sc1
    v_mfma_f32_16x16x32_bf16 v[64:67], v[200:203], a[68:71], v[64:67]
    v_mfma_f32_16x16x32_bf16 v[64:67], v[204:207], a[100:103], v[64:67]
    s_waitcnt lgkmcnt(0)
    s_barrier
    v_mfma_f32_16x16x32_bf16 v[64:67], v[208:211], a[132:135], v[64:67]
    ds_read_b128 v[116:119], v44 offset:36864
    ds_read_b128 v[120:123], v44 offset:37888
    v_mfma_f32_16x16x32_bf16 v[64:67], v[212:215], a[164:167], v[64:67]
    ds_read_b128 v[124:127], v44 offset:38912
    v_mfma_f32_16x16x32_bf16 v[64:67], v[216:219], a[196:199], v[64:67]
    v_mfma_f32_16x16x32_bf16 v[64:67], v[220:223], a[228:231], v[64:67]
    v_mfma_f32_16x16x32_bf16 v[68:71], v[192:195], a[8:11], 0
    buffer_load_dwordx4 v12, s[24:27], s86 offen offset:3072 lds
    v_mfma_f32_16x16x32_bf16 v[68:71], v[196:199], a[40:43], v[68:71]
    v_mfma_f32_16x16x32_bf16 v[68:71], v[200:203], a[72:75], v[68:71]
    v_mfma_f32_16x16x32_bf16 v[68:71], v[204:207], a[104:107], v[68:71]
    s_add_u32 m0, s90, 73728
    s_add_u32 s86, s89, 196608
    v_mfma_f32_16x16x32_bf16 v[68:71], v[208:211], a[136:139], v[68:71]
    s_waitcnt lgkmcnt(1)
    v_add_f32 v116, v116, v120
    v_add_f32 v117, v117, v121
    v_mfma_f32_16x16x32_bf16 v[68:71], v[212:215], a[168:171], v[68:71]
    v_add_f32 v118, v118, v122
    v_add_f32 v119, v119, v123
    v_mfma_f32_16x16x32_bf16 v[68:71], v[216:219], a[200:203], v[68:71]
    ds_write_b128 v41, v[64:67] offset:0
    v_mfma_f32_16x16x32_bf16 v[68:71], v[220:223], a[232:235], v[68:71]
    s_waitcnt lgkmcnt(1)
    v_add_f32 v124, v124, v100
    v_add_f32 v125, v125, v101
    v_mfma_f32_16x16x32_bf16 v[72:75], v[192:195], a[12:15], 0
    v_add_f32 v126, v126, v102
    v_add_f32 v127, v127, v103
    v_mfma_f32_16x16x32_bf16 v[72:75], v[196:199], a[44:47], v[72:75]
    v_add_f32 v116, v116, v124
    v_add_f32 v117, v117, v125
    v_mfma_f32_16x16x32_bf16 v[72:75], v[200:203], a[76:79], v[72:75]
    v_add_f32 v118, v118, v126
    v_add_f32 v119, v119, v127
    v_mfma_f32_16x16x32_bf16 v[72:75], v[204:207], a[108:111], v[72:75]
    v_cvt_pk_bf16_f32 v62, v116, v117
    v_cvt_pk_bf16_f32 v63, v118, v119
    v_mfma_f32_16x16x32_bf16 v[72:75], v[208:211], a[140:143], v[72:75]
    buffer_load_dwordx4 v9, s[24:27], s86 offen lds
    v_mfma_f32_16x16x32_bf16 v[72:75], v[212:215], a[172:175], v[72:75]
    buffer_store_dwordx2 v[62:63], v45, s[32:35], s37 offen offset:3072 sc1
    s_waitcnt vmcnt(8)
    v_max_u32 v39, v52, v53
    v_mfma_f32_16x16x32_bf16 v[72:75], v[216:219], a[204:207], v[72:75]
    ds_write_b128 v42, v[68:71] offset:0
    v_mfma_f32_16x16x32_bf16 v[72:75], v[220:223], a[236:239], v[72:75]
    v_cmp_eq_u32 vcc, -1, v39
    v_lshlrev_b32 v46, 16, v232
    v_mfma_f32_16x16x32_bf16 v[76:79], v[192:195], a[0:3], v[48:51]
    v_and_b32 v47, 0xffff0000, v232
    v_lshlrev_b32 v238, 16, v233
    v_mfma_f32_16x16x32_bf16 v[76:79], v[196:199], a[32:35], v[76:79]
    v_and_b32 v239, 0xffff0000, v233
    s_cbranch_vccnz Lrt_45
Lrtd_46:
    v_mfma_f32_16x16x32_bf16 v[76:79], v[200:203], a[64:67], v[76:79]
    v_lshlrev_b32 v32, 16, v52
    v_and_b32 v33, 0xffff0000, v52
    v_mfma_f32_16x16x32_bf16 v[76:79], v[204:207], a[96:99], v[76:79]
    v_lshlrev_b32 v35, 16, v53
    v_and_b32 v38, 0xffff0000, v53
    v_mfma_f32_16x16x32_bf16 v[76:79], v[208:211], a[128:131], v[76:79]
    v_add_f32 v32, v32, v244
    v_add_f32 v33, v33, v245
    v_mfma_f32_16x16x32_bf16 v[76:79], v[212:215], a[160:163], v[76:79]
    v_add_f32 v35, v35, v246
    v_add_f32 v38, v38, v247
    v_mfma_f32_16x16x32_bf16 v[76:79], v[216:219], a[192:195], v[76:79]
    ds_write_b128 v43, v[72:75] offset:0
    v_mfma_f32_16x16x32_bf16 v[76:79], v[220:223], a[224:227], v[76:79]
    v_mul_f32 v32, v32, v46
    v_mul_f32 v33, v33, v47
    v_mfma_f32_16x16x32_bf16 v[84:87], v[128:131], a[4:7], 0
    buffer_load_dwordx4 v10, s[24:27], s86 offen offset:1024 lds
    v_mfma_f32_16x16x32_bf16 v[84:87], v[132:135], a[36:39], v[84:87]
    v_mul_f32 v35, v35, v238
    v_mul_f32 v38, v38, v239
    v_mfma_f32_16x16x32_bf16 v[84:87], v[136:139], a[68:71], v[84:87]
    v_cvt_pk_bf16_f32 v60, v32, v33
    v_cvt_pk_bf16_f32 v61, v35, v38
    v_mfma_f32_16x16x32_bf16 v[84:87], v[140:143], a[100:103], v[84:87]
    buffer_store_dwordx4 v[58:61], v1, s[32:35], s92 offen offset:1024 nt
    s_waitcnt vmcnt(5)
    v_cmp_ne_u32 vcc, 1, v57
    s_waitcnt lgkmcnt(0)
    s_barrier
    v_mfma_f32_16x16x32_bf16 v[84:87], v[144:147], a[132:135], v[84:87]
    ds_read_b128 v[104:107], v44 offset:0
    ds_read_b128 v[108:111], v44 offset:1024
    v_mfma_f32_16x16x32_bf16 v[84:87], v[148:151], a[164:167], v[84:87]
    buffer_load_dwordx2 v[54:55], v45, s[32:35], s36 offen offset:2560 sc1
    v_mfma_f32_16x16x32_bf16 v[84:87], v[152:155], a[196:199], v[84:87]
    ds_read_b128 v[112:115], v44 offset:2048
    s_nop 0
    v_mfma_f32_16x16x32_bf16 v[84:87], v[156:159], a[228:231], v[84:87]
    s_cbranch_vccnz Lrt_48
Lrtd_49:
    v_mfma_f32_16x16x32_bf16 v[88:91], v[128:131], a[8:11], 0
    buffer_load_dwordx4 v11, s[24:27], s86 offen offset:2048 lds
    v_mfma_f32_16x16x32_bf16 v[88:91], v[132:135], a[40:43], v[88:91]
    s_add_u32 s59, s8, 0
    buffer_load_dwordx4 v[160:163], v1, s[32:35], s59 offen sc1
    v_mfma_f32_16x16x32_bf16 v[88:91], v[136:139], a[72:75], v[88:91]
    v_mfma_f32_16x16x32_bf16 v[88:91], v[140:143], a[104:107], v[88:91]
    v_mfma_f32_16x16x32_bf16 v[88:91], v[144:147], a[136:139], v[88:91]
    s_waitcnt lgkmcnt(1)
    v_add_f32 v104, v104, v108
    v_add_f32 v105, v105, v109
    v_mfma_f32_16x16x32_bf16 v[88:91], v[148:151], a[168:171], v[88:91]
    s_add_u32 s59, s9, 0
    buffer_load_dwordx4 v[164:167], v1, s[32:35], s59 offen sc1
    v_mfma_f32_16x16x32_bf16 v[88:91], v[152:155], a[200:203], v[88:91]
    ds_write_b128 v41, v[84:87] offset:12288
    v_mfma_f32_16x16x32_bf16 v[88:91], v[156:159], a[232:235], v[88:91]
    v_add_f32 v106, v106, v110
    v_add_f32 v107, v107, v111
    v_mfma_f32_16x16x32_bf16 v[92:95], v[128:131], a[12:15], 0
    s_waitcnt lgkmcnt(1)
    v_add_f32 v112, v112, v76
    v_add_f32 v113, v113, v77
    v_mfma_f32_16x16x32_bf16 v[92:95], v[132:135], a[44:47], v[92:95]
    s_add_u32 s59, s8, 3072
    buffer_load_dwordx4 v[168:171], v1, s[32:35], s59 offen sc1
    v_mfma_f32_16x16x32_bf16 v[92:95], v[136:139], a[76:79], v[92:95]
    v_add_f32 v114, v114, v78
    v_add_f32 v115, v115, v79
    v_mfma_f32_16x16x32_bf16 v[92:95], v[140:143], a[108:111], v[92:95]
    v_add_f32 v248, v104, v112
    v_add_f32 v249, v105, v113
    v_mfma_f32_16x16x32_bf16 v[92:95], v[144:147], a[140:143], v[92:95]
    buffer_load_dwordx4 v12, s[24:27], s86 offen offset:3072 lds
    v_mfma_f32_16x16x32_bf16 v[92:95], v[148:151], a[172:175], v[92:95]
    s_add_u32 s59, s9, 3072
    buffer_load_dwordx4 v[172:175], v1, s[32:35], s59 offen sc1
    v_mfma_f32_16x16x32_bf16 v[92:95], v[152:155], a[204:207], v[92:95]
    ds_write_b128 v42, v[88:91] offset:12288
    v_mfma_f32_16x16x32_bf16 v[92:95], v[156:159], a[236:239], v[92:95]
    v_add_f32 v250, v106, v114
    v_add_f32 v251, v107, v115
    v_mfma_f32_16x16x32_bf16 v[80:83], v[128:131], a[0:3], v[48:51]
    v_mfma_f32_16x16x32_bf16 v[80:83], v[132:135], a[32:35], v[80:83]
    v_mfma_f32_16x16x32_bf16 v[80:83], v[136:139], a[64:67], v[80:83]
    v_mfma_f32_16x16x32_bf16 v[80:83], v[140:143], a[96:99], v[80:83]
    v_mfma_f32_16x16x32_bf16 v[80:83], v[144:147], a[128:131], v[80:83]
    v_mfma_f32_16x16x32_bf16 v[80:83], v[148:151], a[160:163], v[80:83]
    v_mfma_f32_16x16x32_bf16 v[80:83], v[152:155], a[192:195], v[80:83]
    ds_write_b128 v43, v[92:95] offset:12288
    v_mfma_f32_16x16x32_bf16 v[80:83], v[156:159], a[224:227], v[80:83]
    buffer_load_dwordx2 v[52:53], v45, s[32:35], s36 offen offset:3072 sc1
    s_mov_b64 exec, 2
    s_waitcnt vmcnt(8)
    buffer_store_dword v0, off, s[32:35], s6 offset:32
    s_mov_b64 exec, -1
    s_waitcnt lgkmcnt(0)
    s_barrier
    ds_read_b128 v[116:119], v44 offset:12288
    ds_read_b128 v[120:123], v44 offset:13312
    ds_read_b128 v[124:127], v44 offset:14336
    s_add_u32 s59, s8, 4096
    buffer_load_dwordx4 v[176:179], v1, s[32:35], s59 offen sc1
    s_add_u32 s59, s9, 4096
    buffer_load_dwordx4 v[180:183], v1, s[32:35], s59 offen sc1
    s_add_u32 s59, s8, 7168
    buffer_load_dwordx4 v[184:187], v1, s[32:35], s59 offen sc1
    s_add_u32 s59, s9, 7168
    buffer_load_dwordx4 v[188:191], v1, s[32:35], s59 offen sc1
    v_lshlrev_b32 v64, 16, v24
    v_and_b32 v65, 0xffff0000, v24
    v_lshlrev_b32 v66, 16, v25
    v_and_b32 v67, 0xffff0000, v25
    v_lshlrev_b32 v68, 16, v26
    v_and_b32 v69, 0xffff0000, v26
    v_lshlrev_b32 v70, 16, v27
    v_and_b32 v71, 0xffff0000, v27
    v_lshlrev_b32 v72, 16, v28
    v_and_b32 v73, 0xffff0000, v28
    v_lshlrev_b32 v74, 16, v29
    v_and_b32 v75, 0xffff0000, v29
    v_lshlrev_b32 v76, 16, v30
    v_and_b32 v77, 0xffff0000, v30
    v_lshlrev_b32 v78, 16, v31
    v_and_b32 v79, 0xffff0000, v31
    s_waitcnt lgkmcnt(1)
    v_pk_add_f32 v[116:117], v[116:117], v[120:121]
    s_waitcnt lgkmcnt(0)
    v_pk_add_f32 v[124:125], v[124:125], v[80:81]
    v_pk_add_f32 v[118:119], v[118:119], v[122:123]
    v_pk_add_f32 v[126:127], v[126:127], v[82:83]
    v_pk_add_f32 v[240:241], v[116:117], v[124:125]
    v_pk_add_f32 v[242:243], v[118:119], v[126:127]
    s_waitcnt vmcnt(12)
    v_max_u32 v39, v54, v55
    v_cmp_eq_u32 vcc, -1, v39
    v_lshlrev_b32 v46, 16, v234
    v_and_b32 v47, 0xffff0000, v234
    v_lshlrev_b32 v238, 16, v235
    v_and_b32 v239, 0xffff0000, v235
    s_cbranch_vccnz Lrt_51
Lrtd_52:
    v_lshlrev_b32 v32, 16, v54
    v_and_b32 v33, 0xffff0000, v54
    v_lshlrev_b32 v35, 16, v55
    v_and_b32 v38, 0xffff0000, v55
    v_add_f32 v32, v32, v248
    v_add_f32 v33, v33, v249
    v_add_f32 v35, v35, v250
    v_add_f32 v38, v38, v251
    v_mul_f32 v32, v32, v46
    v_mul_f32 v33, v33, v47
    v_mul_f32 v35, v35, v238
    v_mul_f32 v38, v38, v239
    v_cvt_pk_bf16_f32 v58, v32, v33
    v_cvt_pk_bf16_f32 v59, v35, v38
    ds_read_b64_tr_b16 v[104:105], v13 offset:0
    ds_read_b64_tr_b16 v[106:107], v13 offset:2048
    ds_read_b64_tr_b16 v[108:109], v14 offset:0
    ds_read_b64_tr_b16 v[110:111], v14 offset:2048
    ds_read_b64_tr_b16 v[112:113], v15 offset:0
    ds_read_b64_tr_b16 v[114:115], v15 offset:2048
    ds_read_b64_tr_b16 v[116:117], v16 offset:0
    ds_read_b64_tr_b16 v[118:119], v16 offset:2048
    ds_read_b64_tr_b16 v[120:121], v13 offset:12288
    ds_read_b64_tr_b16 v[122:123], v13 offset:14336
    s_waitcnt vmcnt(9) lgkmcnt(6)
    v_mfma_f32_16x16x32_bf16 v[64:67], v[104:107], v[160:163], v[64:67]
    s_add_u32 s59, s8, 10240
    ds_read_b64_tr_b16 v[124:125], v14 offset:12288
    ds_read_b64_tr_b16 v[126:127], v14 offset:14336
    v_mfma_f32_16x16x32_bf16 v[84:87], v[104:107], v[164:167], 0
    buffer_load_dwordx4 v[192:195], v1, s[32:35], s59 offen sc1
    buffer_load_dword v57, v40, s[32:35], 0 offen offset:32 sc1
    v_mfma_f32_16x16x32_bf16 v[68:71], v[108:111], v[160:163], v[68:71]
    s_add_u32 s59, s9, 10240
    ds_read_b64_tr_b16 v[104:105], v15 offset:12288
    ds_read_b64_tr_b16 v[106:107], v15 offset:14336
    v_mfma_f32_16x16x32_bf16 v[88:91], v[108:111], v[164:167], 0
    s_waitcnt lgkmcnt(6)
    v_mfma_f32_16x16x32_bf16 v[72:75], v[112:115], v[160:163], v[72:75]
    buffer_load_dwordx4 v[196:199], v1, s[32:35], s59 offen sc1
    v_mfma_f32_16x16x32_bf16 v[92:95], v[112:115], v[164:167], 0
    ds_read_b64_tr_b16 v[108:109], v16 offset:12288
    ds_read_b64_tr_b16 v[110:111], v16 offset:14336
    v_mfma_f32_16x16x32_bf16 v[76:79], v[116:119], v[160:163], v[76:79]
    s_add_u32 s59, s8, 11264
    ds_read_b64_tr_b16 v[112:113], v13 offset:16384
    ds_read_b64_tr_b16 v[114:115], v13 offset:18432
    v_mfma_f32_16x16x32_bf16 v[96:99], v[116:119], v[164:167], 0
    s_waitcnt vmcnt(9) lgkmcnt(6)
    s_waitcnt vmcnt(8)
    v_max_u32 v39, v52, v53
    v_cmp_eq_u32 vcc, -1, v39
    v_lshlrev_b32 v46, 16, v236
    v_and_b32 v47, 0xffff0000, v236
    v_lshlrev_b32 v238, 16, v237
    v_and_b32 v239, 0xffff0000, v237
    s_cbranch_vccnz Lrt_54
Lrtd_55:
    v_lshlrev_b32 v32, 16, v52
    v_and_b32 v33, 0xffff0000, v52
    v_lshlrev_b32 v35, 16, v53
    v_and_b32 v38, 0xffff0000, v53
    v_add_f32 v32, v32, v240
    v_add_f32 v33, v33, v241
    v_add_f32 v35, v35, v242
    v_add_f32 v38, v38, v243
    v_mul_f32 v32, v32, v46
    v_mul_f32 v33, v33, v47
    v_mul_f32 v35, v35, v238
    v_mul_f32 v38, v38, v239
    v_cvt_pk_bf16_f32 v60, v32, v33
Lstub9:
    s_cbranch_execz Lwarmb
    v_cvt_pk_bf16_f32 v61, v35, v38
    buffer_store_dwordx4 v[58:61], v1, s[32:35], s92 offen offset:2048 nt
    v_mfma_f32_16x16x32_bf16 v[64:67], v[120:123], v[168:171], v[64:67]
    buffer_load_dwordx4 v[200:203], v1, s[32:35], s59 offen sc1
    v_mfma_f32_16x16x32_bf16 v[84:87], v[120:123], v[172:175], v[84:87]
    s_mul_i32 s60, s54, 2304
    ds_read_b64_tr_b16 v[116:117], v14 offset:16384
    ds_read_b64_tr_b16 v[118:119], v14 offset:18432
    v_mfma_f32_16x16x32_bf16 v[68:71], v[124:127], v[168:171], v[68:71]
    s_add_u32 s59, s9, 11264
    ds_read_b64_tr_b16 v[120:121], v15 offset:16384
    ds_read_b64_tr_b16 v[122:123], v15 offset:18432
    v_mfma_f32_16x16x32_bf16 v[88:91], v[124:127], v[172:175], v[88:91]
    s_waitcnt lgkmcnt(6)
    v_mul_u32_u24 v20, 144, v3
    v_lshl_add_u32 v20, v4, 3, v20
    v_mfma_f32_16x16x32_bf16 v[72:75], v[104:107], v[168:171], v[72:75]
    buffer_load_dwordx4 v[204:207], v1, s[32:35], s59 offen sc1
    v_mfma_f32_16x16x32_bf16 v[92:95], v[104:107], v[172:175], v[92:95]
    ds_read_b64_tr_b16 v[124:125], v16 offset:16384
    ds_read_b64_tr_b16 v[126:127], v16 offset:18432
    s_barrier
    v_mfma_f32_16x16x32_bf16 v[76:79], v[108:111], v[168:171], v[76:79]
    ds_read_b64_tr_b16 v[104:105], v13 offset:28672
    ds_read_b64_tr_b16 v[106:107], v13 offset:30720
    v_mfma_f32_16x16x32_bf16 v[96:99], v[108:111], v[172:175], v[96:99]
    s_waitcnt vmcnt(8) lgkmcnt(6)
    v_add_u32 v20, s60, v20
    v_lshrrev_b32 v42, 3, v0
    v_mfma_f32_16x16x32_bf16 v[64:67], v[112:115], v[176:179], v[64:67]
    ds_read_b64_tr_b16 v[108:109], v14 offset:28672
    ds_read_b64_tr_b16 v[110:111], v14 offset:30720
    v_mfma_f32_16x16x32_bf16 v[84:87], v[112:115], v[180:183], v[84:87]
    v_and_b32 v43, 7, v0
    v_mul_u32_u24 v21, 144, v42
    s_waitcnt vmcnt(4)
    v_cmp_ne_u32 vcc, 1, v57
    v_mfma_f32_16x16x32_bf16 v[68:71], v[116:119], v[176:179], v[68:71]
    s_add_u32 s59, s8, 1024
    ds_read_b64_tr_b16 v[112:113], v15 offset:28672
    ds_read_b64_tr_b16 v[114:115], v15 offset:30720
    v_mfma_f32_16x16x32_bf16 v[88:91], v[116:119], v[180:183], v[88:91]
    s_waitcnt lgkmcnt(6)
    v_lshl_add_u32 v21, v43, 4, v21
    v_add_u32 v21, s60, v21
    s_cbranch_vccnz Lrt_57
Lrtd_58:
    v_mfma_f32_16x16x32_bf16 v[72:75], v[120:123], v[176:179], v[72:75]
    buffer_load_dwordx4 v[208:211], v1, s[32:35], s59 offen sc1
    v_mfma_f32_16x16x32_bf16 v[92:95], v[120:123], v[180:183], v[92:95]
    ds_read_b64_tr_b16 v[116:117], v16 offset:28672
    ds_read_b64_tr_b16 v[118:119], v16 offset:30720
    v_mfma_f32_16x16x32_bf16 v[76:79], v[124:127], v[176:179], v[76:79]
    s_add_u32 s59, s9, 1024
    ds_read_b64_tr_b16 v[120:121], v13 offset:40960
    ds_read_b64_tr_b16 v[122:123], v13 offset:43008
    v_mfma_f32_16x16x32_bf16 v[96:99], v[124:127], v[180:183], v[96:99]
    s_waitcnt lgkmcnt(6)
    v_lshrrev_b32 v44, 2, v42
    v_lshlrev_b32 v44, 3, v44
    v_mfma_f32_16x16x32_bf16 v[64:67], v[104:107], v[184:187], v[64:67]
    buffer_load_dwordx4 v[212:215], v1, s[32:35], s59 offen sc1
    v_mfma_f32_16x16x32_bf16 v[84:87], v[104:107], v[188:191], v[84:87]
    ds_read_b64_tr_b16 v[124:125], v14 offset:40960
    ds_read_b64_tr_b16 v[126:127], v14 offset:43008
    v_mfma_f32_16x16x32_bf16 v[68:71], v[108:111], v[184:187], v[68:71]
    s_add_u32 s59, s8, 5120
    ds_read_b64_tr_b16 v[104:105], v15 offset:40960
    ds_read_b64_tr_b16 v[106:107], v15 offset:43008
    v_mfma_f32_16x16x32_bf16 v[88:91], v[108:111], v[188:191], v[88:91]
    s_waitcnt lgkmcnt(6)
    v_and_or_b32 v44, v42, 3, v44
    v_lshlrev_b32 v44, 10, v44
    s_mov_b64 exec, 2
    s_waitcnt vmcnt(4)
    buffer_store_dword v0, off, s[32:35], s6 offset:64
    s_mov_b64 exec, -1
    v_mfma_f32_16x16x32_bf16 v[72:75], v[112:115], v[184:187], v[72:75]
    buffer_load_dwordx4 v[216:219], v1, s[32:35], s59 offen sc1
    v_mfma_f32_16x16x32_bf16 v[92:95], v[112:115], v[188:191], v[92:95]
    ds_read_b64_tr_b16 v[108:109], v16 offset:40960
    ds_read_b64_tr_b16 v[110:111], v16 offset:43008
    v_mfma_f32_16x16x32_bf16 v[76:79], v[116:119], v[184:187], v[76:79]
    s_add_u32 s59, s9, 5120
    ds_read_b64_tr_b16 v[112:113], v13 offset:45056
    ds_read_b64_tr_b16 v[114:115], v13 offset:47104
    v_mfma_f32_16x16x32_bf16 v[96:99], v[116:119], v[188:191], v[96:99]
    s_waitcnt lgkmcnt(6)
    v_lshl_add_u32 v44, v43, 4, v44
    s_lshr_b32 s61, s58, 1
    v_mfma_f32_16x16x32_bf16 v[64:67], v[120:123], v[192:195], v[64:67]
    buffer_load_dwordx4 v[220:223], v1, s[32:35], s59 offen sc1
    v_mfma_f32_16x16x32_bf16 v[84:87], v[120:123], v[196:199], v[84:87]
    s_lshl_b32 s61, s61, 15
    ds_read_b64_tr_b16 v[116:117], v14 offset:45056
    ds_read_b64_tr_b16 v[118:119], v14 offset:47104
    v_mfma_f32_16x16x32_bf16 v[68:71], v[124:127], v[192:195], v[68:71]
    s_add_u32 s59, s8, 8192
    ds_read_b64_tr_b16 v[120:121], v15 offset:45056
    ds_read_b64_tr_b16 v[122:123], v15 offset:47104
    v_mfma_f32_16x16x32_bf16 v[88:91], v[124:127], v[196:199], v[88:91]
    s_waitcnt lgkmcnt(6)
    s_and_b32 s62, s58, 1
    s_lshl_b32 s62, s62, 12
    v_mfma_f32_16x16x32_bf16 v[72:75], v[104:107], v[192:195], v[72:75]
    buffer_load_dwordx4 v[128:131], v1, s[32:35], s59 offen sc1
    v_mfma_f32_16x16x32_bf16 v[92:95], v[104:107], v[196:199], v[92:95]
    s_add_u32 s61, s61, s62
    ds_read_b64_tr_b16 v[124:125], v16 offset:45056
    ds_read_b64_tr_b16 v[126:127], v16 offset:47104
    v_mfma_f32_16x16x32_bf16 v[76:79], v[108:111], v[192:195], v[76:79]
    s_add_u32 s59, s9, 8192
    ds_read_b64_tr_b16 v[104:105], v13 offset:4096
    ds_read_b64_tr_b16 v[106:107], v13 offset:6144
    v_mfma_f32_16x16x32_bf16 v[96:99], v[108:111], v[196:199], v[96:99]
    s_waitcnt vmcnt(6) lgkmcnt(6)
    s_lshl_b32 s62, s53, 7
    s_add_u32 s61, s61, s62
    v_mfma_f32_16x16x32_bf16 v[64:67], v[112:115], v[200:203], v[64:67]
    buffer_load_dwordx4 v[132:135], v1, s[32:35], s59 offen sc1
    v_mfma_f32_16x16x32_bf16 v[84:87], v[112:115], v[204:207], v[84:87]
    s_add_u32 s62, s61, 16384
    ds_read_b64_tr_b16 v[108:109], v14 offset:4096
    ds_read_b64_tr_b16 v[110:111], v14 offset:6144
    v_mfma_f32_16x16x32_bf16 v[68:71], v[116:119], v[200:203], v[68:71]
    s_add_u32 s59, s8, 12288
    ds_read_b64_tr_b16 v[112:113], v15 offset:4096
    ds_read_b64_tr_b16 v[114:115], v15 offset:6144
    v_mfma_f32_16x16x32_bf16 v[88:91], v[116:119], v[204:207], v[88:91]
    s_waitcnt lgkmcnt(6)
    s_lshl_b32 s60, s54, 12
    s_add_u32 s60, s60, 24576
    buffer_load_dword v57, v40, s[32:35], 0 offen offset:64 sc1
    v_mfma_f32_16x16x32_bf16 v[72:75], v[120:123], v[200:203], v[72:75]
    buffer_load_dwordx4 v[136:139], v1, s[32:35], s59 offen sc1
    v_mfma_f32_16x16x32_bf16 v[92:95], v[120:123], v[204:207], v[92:95]
    ds_read_b64_tr_b16 v[116:117], v16 offset:4096
    ds_read_b64_tr_b16 v[118:119], v16 offset:6144
    v_mfma_f32_16x16x32_bf16 v[76:79], v[124:127], v[200:203], v[76:79]
    s_add_u32 s59, s9, 12288
    ds_read_b64_tr_b16 v[120:121], v13 offset:20480
    ds_read_b64_tr_b16 v[122:123], v13 offset:22528
    v_mfma_f32_16x16x32_bf16 v[96:99], v[124:127], v[204:207], v[96:99]
    s_waitcnt vmcnt(7) lgkmcnt(6)
    v_add_u32 v22, s60, v1
    v_xor_b32 v23, 4096, v22
    v_mfma_f32_16x16x32_bf16 v[64:67], v[104:107], v[208:211], v[64:67]
    buffer_load_dwordx4 v[140:143], v1, s[32:35], s59 offen sc1
    v_mfma_f32_16x16x32_bf16 v[84:87], v[104:107], v[212:215], v[84:87]
    ds_read_b64_tr_b16 v[124:125], v14 offset:20480
    ds_read_b64_tr_b16 v[126:127], v14 offset:22528
    v_mfma_f32_16x16x32_bf16 v[68:71], v[108:111], v[208:211], v[68:71]
    ds_read_b64_tr_b16 v[104:105], v15 offset:20480
    ds_read_b64_tr_b16 v[106:107], v15 offset:22528
    v_mfma_f32_16x16x32_bf16 v[88:91], v[108:111], v[212:215], v[88:91]
    s_waitcnt lgkmcnt(6)
    ds_read_b64_tr_b16 a[0:1], v13 offset:8192
    ds_read_b64_tr_b16 a[2:3], v13 offset:10240
    v_mfma_f32_16x16x32_bf16 v[72:75], v[112:115], v[208:211], v[72:75]
    ds_read_b64_tr_b16 v[108:109], v16 offset:20480
    ds_read_b64_tr_b16 v[110:111], v16 offset:22528
    v_mfma_f32_16x16x32_bf16 v[92:95], v[112:115], v[212:215], v[92:95]
    ds_read_b64_tr_b16 a[4:5], v14 offset:8192
    ds_read_b64_tr_b16 a[6:7], v14 offset:10240
    v_mfma_f32_16x16x32_bf16 v[76:79], v[116:119], v[208:211], v[76:79]
    ds_read_b64_tr_b16 v[112:113], v13 offset:32768
    ds_read_b64_tr_b16 v[114:115], v13 offset:34816
    v_mfma_f32_16x16x32_bf16 v[96:99], v[116:119], v[212:215], v[96:99]
    s_waitcnt vmcnt(5) lgkmcnt(10)
    ds_read_b64_tr_b16 a[8:9], v15 offset:8192
    ds_read_b64_tr_b16 a[10:11], v15 offset:10240
    v_mfma_f32_16x16x32_bf16 v[64:67], v[120:123], v[216:219], v[64:67]
    ds_read_b64_tr_b16 v[116:117], v14 offset:32768
    ds_read_b64_tr_b16 v[118:119], v14 offset:34816
    v_mfma_f32_16x16x32_bf16 v[84:87], v[120:123], v[220:223], v[84:87]
    ds_read_b64_tr_b16 a[12:13], v16 offset:8192
    ds_read_b64_tr_b16 a[14:15], v16 offset:10240
    v_mfma_f32_16x16x32_bf16 v[68:71], v[124:127], v[216:219], v[68:71]
    ds_read_b64_tr_b16 v[120:121], v15 offset:32768
    ds_read_b64_tr_b16 v[122:123], v15 offset:34816
    v_mfma_f32_16x16x32_bf16 v[88:91], v[124:127], v[220:223], v[88:91]
    s_waitcnt lgkmcnt(12)
    ds_read_b64_tr_b16 a[16:17], v13 offset:24576
    ds_read_b64_tr_b16 a[18:19], v13 offset:26624
    s_waitcnt vmcnt(2)
    v_cmp_ne_u32 vcc, 1, v57
    v_mfma_f32_16x16x32_bf16 v[72:75], v[104:107], v[216:219], v[72:75]
    ds_read_b64_tr_b16 v[124:125], v16 offset:32768
    ds_read_b64_tr_b16 v[126:127], v16 offset:34816
    v_mfma_f32_16x16x32_bf16 v[92:95], v[104:107], v[220:223], v[92:95]
    ds_read_b64_tr_b16 a[20:21], v14 offset:24576
    ds_read_b64_tr_b16 a[22:23], v14 offset:26624
    s_cbranch_vccnz Lrt_60
Lrtd_61:
    v_mfma_f32_16x16x32_bf16 v[76:79], v[108:111], v[216:219], v[76:79]
    s_add_u32 s59, s9, 2048
    ds_read_b64_tr_b16 v[104:105], v13 offset:49152
    ds_read_b64_tr_b16 v[106:107], v13 offset:51200
    v_mfma_f32_16x16x32_bf16 v[96:99], v[108:111], v[220:223], v[96:99]
    s_waitcnt lgkmcnt(12)
    ds_read_b64_tr_b16 a[24:25], v15 offset:24576
    ds_read_b64_tr_b16 a[26:27], v15 offset:26624
    v_mfma_f32_16x16x32_bf16 v[64:67], v[112:115], v[128:131], v[64:67]
    buffer_load_dwordx4 v[148:151], v1, s[32:35], s59 offen sc1
    v_mfma_f32_16x16x32_bf16 v[84:87], v[112:115], v[132:135], v[84:87]
    s_add_u32 s59, s9, 6144
    ds_read_b64_tr_b16 v[108:109], v14 offset:49152
    ds_read_b64_tr_b16 v[110:111], v14 offset:51200
    v_mfma_f32_16x16x32_bf16 v[68:71], v[116:119], v[128:131], v[68:71]
    buffer_load_dwordx4 v[156:159], v1, s[32:35], s59 offen sc1
    v_mfma_f32_16x16x32_bf16 v[88:91], v[116:119], v[132:135], v[88:91]
    s_waitcnt lgkmcnt(8)
    ds_read_b64_tr_b16 v[112:113], v15 offset:49152
    ds_read_b64_tr_b16 v[114:115], v15 offset:51200
    v_mfma_f32_16x16x32_bf16 v[72:75], v[120:123], v[128:131], v[72:75]
    s_add_u32 s59, s9, 9216
    ds_read_b64_tr_b16 v[116:117], v16 offset:49152
    ds_read_b64_tr_b16 v[118:119], v16 offset:51200
    v_mfma_f32_16x16x32_bf16 v[92:95], v[120:123], v[132:135], v[92:95]
    buffer_load_dwordx4 v[228:231], v1, s[32:35], s59 offen sc1
    v_mfma_f32_16x16x32_bf16 v[76:79], v[124:127], v[128:131], v[76:79]
    s_add_u32 s59, s9, 13312
    ds_read_b64_tr_b16 a[28:29], v16 offset:24576
    ds_read_b64_tr_b16 a[30:31], v16 offset:26624
    v_mfma_f32_16x16x32_bf16 v[96:99], v[124:127], v[132:135], v[96:99]
    s_waitcnt vmcnt(3) lgkmcnt(6)
    ds_read_b64_tr_b16 a[32:33], v13 offset:36864
    ds_read_b64_tr_b16 a[34:35], v13 offset:38912
    v_mfma_f32_16x16x32_bf16 v[64:67], v[104:107], v[136:139], v[64:67]
    buffer_load_dwordx4 v[236:239], v1, s[32:35], s59 offen sc1
    v_mfma_f32_16x16x32_bf16 v[84:87], v[104:107], v[140:143], v[84:87]
    s_add_u32 s59, s8, 2048
    ds_read_b64_tr_b16 a[36:37], v14 offset:36864
    ds_read_b64_tr_b16 a[38:39], v14 offset:38912
    v_mfma_f32_16x16x32_bf16 v[68:71], v[108:111], v[136:139], v[68:71]
    buffer_load_dwordx4 v[144:147], v1, s[32:35], s59 offen sc1
    v_mfma_f32_16x16x32_bf16 v[88:91], v[108:111], v[140:143], v[88:91]
    s_waitcnt lgkmcnt(6)
    ds_read_b64_tr_b16 a[40:41], v15 offset:36864
    ds_read_b64_tr_b16 a[42:43], v15 offset:38912
    v_mfma_f32_16x16x32_bf16 v[72:75], v[112:115], v[136:139], v[72:75]
    s_add_u32 s59, s8, 6144
    ds_read_b64_tr_b16 a[44:45], v16 offset:36864
    ds_read_b64_tr_b16 a[46:47], v16 offset:38912
    v_mfma_f32_16x16x32_bf16 v[92:95], v[112:115], v[140:143], v[92:95]
    buffer_load_dwordx4 v[152:155], v1, s[32:35], s59 offen sc1
    v_mfma_f32_16x16x32_bf16 v[76:79], v[116:119], v[136:139], v[76:79]
    s_add_u32 s59, s8, 9216
    ds_read_b64_tr_b16 a[48:49], v13 offset:53248
    ds_read_b64_tr_b16 a[50:51], v13 offset:55296
    v_mfma_f32_16x16x32_bf16 v[96:99], v[116:119], v[140:143], v[96:99]
    s_waitcnt vmcnt(5)
    ds_read_b64_tr_b16 a[52:53], v14 offset:53248
    ds_read_b64_tr_b16 a[54:55], v14 offset:55296
    ds_read_b64_tr_b16 a[56:57], v15 offset:53248
    ds_read_b64_tr_b16 a[58:59], v15 offset:55296
    ds_read_b64_tr_b16 a[60:61], v16 offset:53248
    ds_read_b64_tr_b16 a[62:63], v16 offset:55296
    v_mfma_f32_16x16x32_bf16 v[84:87], a[0:3], v[148:151], v[84:87]
    buffer_load_dwordx4 v[224:227], v1, s[32:35], s59 offen sc1
    v_mfma_f32_16x16x32_bf16 v[88:91], a[4:7], v[148:151], v[88:91]
    s_add_u32 s59, s8, 13312
    v_mfma_f32_16x16x32_bf16 v[92:95], a[8:11], v[148:151], v[92:95]
    buffer_load_dwordx4 v[232:235], v1, s[32:35], s59 offen sc1
    v_mfma_f32_16x16x32_bf16 v[96:99], a[12:15], v[148:151], v[96:99]
    s_waitcnt vmcnt(6)
    v_mfma_f32_16x16x32_bf16 v[84:87], a[16:19], v[156:159], v[84:87]
    v_mfma_f32_16x16x32_bf16 v[88:91], a[20:23], v[156:159], v[88:91]
    v_mfma_f32_16x16x32_bf16 v[92:95], a[24:27], v[156:159], v[92:95]
    s_waitcnt lgkmcnt(15)
    v_mfma_f32_16x16x32_bf16 v[96:99], a[28:31], v[156:159], v[96:99]
    s_waitcnt vmcnt(5)
    s_waitcnt lgkmcnt(14)
    v_mfma_f32_16x16x32_bf16 v[84:87], a[32:35], v[228:231], v[84:87]
    s_waitcnt lgkmcnt(12)
    v_mfma_f32_16x16x32_bf16 v[88:91], a[36:39], v[228:231], v[88:91]
    s_waitcnt lgkmcnt(10)
    v_mfma_f32_16x16x32_bf16 v[92:95], a[40:43], v[228:231], v[92:95]
    s_waitcnt lgkmcnt(8)
    v_mfma_f32_16x16x32_bf16 v[96:99], a[44:47], v[228:231], v[96:99]
    s_waitcnt vmcnt(4)
    s_waitcnt lgkmcnt(6)
    v_mfma_f32_16x16x32_bf16 v[84:87], a[48:51], v[236:239], v[84:87]
    s_waitcnt lgkmcnt(4)
    v_mfma_f32_16x16x32_bf16 v[88:91], a[52:55], v[236:239], v[88:91]
    s_waitcnt lgkmcnt(2)
    v_mfma_f32_16x16x32_bf16 v[92:95], a[56:59], v[236:239], v[92:95]
    s_waitcnt lgkmcnt(0)
    v_mfma_f32_16x16x32_bf16 v[96:99], a[60:63], v[236:239], v[96:99]
    s_waitcnt vmcnt(3)
    v_mfma_f32_16x16x32_bf16 v[64:67], a[0:3], v[144:147], v[64:67]
    v_mfma_f32_16x16x32_bf16 v[68:71], a[4:7], v[144:147], v[68:71]
    v_mfma_f32_16x16x32_bf16 v[72:75], a[8:11], v[144:147], v[72:75]
    ds_write_b128 v23, v[84:87] offset:0
    v_mfma_f32_16x16x32_bf16 v[76:79], a[12:15], v[144:147], v[76:79]
    s_waitcnt vmcnt(2)
    v_mfma_f32_16x16x32_bf16 v[64:67], a[16:19], v[152:155], v[64:67]
    ds_write_b128 v23, v[88:91] offset:1024
    v_mfma_f32_16x16x32_bf16 v[68:71], a[20:23], v[152:155], v[68:71]
    v_mfma_f32_16x16x32_bf16 v[72:75], a[24:27], v[152:155], v[72:75]
    ds_write_b128 v23, v[92:95] offset:2048
    v_mfma_f32_16x16x32_bf16 v[76:79], a[28:31], v[152:155], v[76:79]
    s_waitcnt vmcnt(1)
    v_mfma_f32_16x16x32_bf16 v[64:67], a[32:35], v[224:227], v[64:67]
    ds_write_b128 v23, v[96:99] offset:3072
    v_mfma_f32_16x16x32_bf16 v[68:71], a[36:39], v[224:227], v[68:71]
    v_mfma_f32_16x16x32_bf16 v[72:75], a[40:43], v[224:227], v[72:75]
    v_mfma_f32_16x16x32_bf16 v[76:79], a[44:47], v[224:227], v[76:79]
    s_waitcnt vmcnt(0)
    v_mfma_f32_16x16x32_bf16 v[64:67], a[48:51], v[232:235], v[64:67]
    s_waitcnt lgkmcnt(0)
    s_barrier
    ds_read_b128 v[104:107], v22 offset:0
    ds_read_b128 v[108:111], v22 offset:1024
    ds_read_b128 v[112:115], v22 offset:2048
    ds_read_b128 v[116:119], v22 offset:3072
    v_mfma_f32_16x16x32_bf16 v[68:71], a[52:55], v[232:235], v[68:71]
    v_mfma_f32_16x16x32_bf16 v[72:75], a[56:59], v[232:235], v[72:75]
    v_mfma_f32_16x16x32_bf16 v[76:79], a[60:63], v[232:235], v[76:79]
    s_waitcnt lgkmcnt(3)
    v_pk_add_f32 v[64:65], v[64:65], v[104:105]
    v_pk_add_f32 v[66:67], v[66:67], v[106:107]
    v_cvt_pk_bf16_f32 v84, v64, v65
    v_cvt_pk_bf16_f32 v85, v66, v67
    ds_write_b64 v20, v[84:85] offset:0
    s_waitcnt lgkmcnt(3)
    v_pk_add_f32 v[68:69], v[68:69], v[108:109]
    v_pk_add_f32 v[70:71], v[70:71], v[110:111]
    v_cvt_pk_bf16_f32 v86, v68, v69
    v_cvt_pk_bf16_f32 v87, v70, v71
    ds_write_b64 v20, v[86:87] offset:32
    s_waitcnt lgkmcnt(3)
    v_pk_add_f32 v[72:73], v[72:73], v[112:113]
    v_pk_add_f32 v[74:75], v[74:75], v[114:115]
    v_cvt_pk_bf16_f32 v88, v72, v73
    v_cvt_pk_bf16_f32 v89, v74, v75
    ds_write_b64 v20, v[88:89] offset:64
    s_waitcnt lgkmcnt(3)
    v_pk_add_f32 v[76:77], v[76:77], v[116:117]
    v_pk_add_f32 v[78:79], v[78:79], v[118:119]
    v_cvt_pk_bf16_f32 v90, v76, v77
    v_cvt_pk_bf16_f32 v91, v78, v79
    ds_write_b64 v20, v[90:91] offset:96
    ds_read_b128 v[92:95], v21 offset:0
    ds_read_b128 v[96:99], v21 offset:1152
    s_waitcnt lgkmcnt(1)
    buffer_store_dwordx4 v[92:95], v44, s[28:31], s61 offen nt
    s_waitcnt lgkmcnt(0)
    buffer_store_dwordx4 v[96:99], v44, s[28:31], s62 offen nt
    s_endpgm
Lrt_60:
    s_nop 1
    buffer_load_dword v57, v40, s[32:35], 0 offen offset:64 sc1
    s_sub_u32 s56, s56, 1
    s_cselect_b32 s56, 0, s56
    s_waitcnt vmcnt(0)
    s_cbranch_scc1 Lrte_62
    v_cmp_ne_u32 vcc, 1, v57
    s_cbranch_vccnz Lrt_60
Lrte_62:
    s_nop 1
    s_branch Lrtd_61
Lrt_57:
    s_nop 1
    buffer_load_dword v57, v40, s[32:35], 0 offen offset:32 sc1
    s_sub_u32 s56, s56, 1
    s_cselect_b32 s56, 0, s56
    s_waitcnt vmcnt(0)
    s_cbranch_scc1 Lrte_59
    v_cmp_ne_u32 vcc, 1, v57
    s_cbranch_vccnz Lrt_57
Lrte_59:
    s_nop 1
    s_branch Lrtd_58
Lrt_54:
    s_nop 1
    buffer_load_dwordx2 v[52:53], v45, s[32:35], s36 offen offset:3072 sc1
    s_sub_u32 s56, s56, 1
    s_cselect_b32 s56, 0, s56
    s_waitcnt vmcnt(0)
    s_cbranch_scc1 Lrte_56
    v_max_u32 v39, v52, v53
    v_cmp_eq_u32 vcc, -1, v39
    s_cbranch_vccnz Lrt_54
Lrte_56:
    s_nop 1
    s_branch Lrtd_55
Lrt_51:
    s_nop 1
    buffer_load_dwordx2 v[54:55], v45, s[32:35], s36 offen offset:2560 sc1
    s_sub_u32 s56, s56, 1
    s_cselect_b32 s56, 0, s56
    s_waitcnt vmcnt(0)
    s_cbranch_scc1 Lrte_53
    v_max_u32 v39, v54, v55
    v_cmp_eq_u32 vcc, -1, v39
    s_cbranch_vccnz Lrt_51
Lrte_53:
    s_nop 1
    s_branch Lrtd_52
Lrt_48:
    s_nop 1
    buffer_load_dword v57, v40, s[32:35], 0 offen offset:0 sc1
    s_sub_u32 s56, s56, 1
    s_cselect_b32 s56, 0, s56
    s_waitcnt vmcnt(0)
    s_cbranch_scc1 Lrte_50
    v_cmp_ne_u32 vcc, 1, v57
    s_cbranch_vccnz Lrt_48
Lrte_50:
    s_nop 1
    s_branch Lrtd_49
Lrt_45:
    s_nop 1
    buffer_load_dwordx2 v[52:53], v45, s[32:35], s36 offen offset:2048 sc1
    s_sub_u32 s56, s56, 1
    s_cselect_b32 s56, 0, s56
    s_waitcnt vmcnt(0)
    s_cbranch_scc1 Lrte_47
    v_max_u32 v39, v52, v53
    v_cmp_eq_u32 vcc, -1, v39
    s_cbranch_vccnz Lrt_45
Lrte_47:
    s_nop 1
    s_branch Lrtd_46
Lrt_42:
    s_nop 1
    buffer_load_dwordx2 v[54:55], v45, s[32:35], s36 offen offset:1536 sc1
    s_sub_u32 s56, s56, 1
    s_cselect_b32 s56, 0, s56
    s_waitcnt vmcnt(0)
    s_cbranch_scc1 Lrte_44
    v_max_u32 v39, v54, v55
    v_cmp_eq_u32 vcc, -1, v39
    s_cbranch_vccnz Lrt_42
Lrte_44:
    s_nop 1
    s_branch Lrtd_43
Lrt_39:
    s_nop 1
    buffer_load_dwordx2 v[52:53], v45, s[32:35], s36 offen offset:1024 sc1
    s_sub_u32 s56, s56, 1
    s_cselect_b32 s56, 0, s56
    s_waitcnt vmcnt(0)
    s_cbranch_scc1 Lrte_41
    v_max_u32 v39, v52, v53
    v_cmp_eq_u32 vcc, -1, v39
    s_cbranch_vccnz Lrt_39
Lrte_41:
    s_nop 1
    s_branch Lrtd_40
Lrt_36:
    s_nop 1
    buffer_load_dwordx2 v[54:55], v45, s[32:35], s36 offen offset:512 sc1
    s_sub_u32 s56, s56, 1
    s_cselect_b32 s56, 0, s56
    s_waitcnt vmcnt(0)
    s_cbranch_scc1 Lrte_38
    v_max_u32 v39, v54, v55
    v_cmp_eq_u32 vcc, -1, v39
    s_cbranch_vccnz Lrt_36
Lrte_38:
    s_nop 1
    s_branch Lrtd_37
Lrt_33:
    s_nop 1
    buffer_load_dwordx2 v[52:53], v45, s[32:35], s36 offen offset:0 sc1
    s_sub_u32 s56, s56, 1
    s_cselect_b32 s56, 0, s56
    s_waitcnt vmcnt(0)
    s_cbranch_scc1 Lrte_35
    v_max_u32 v39, v52, v53
    v_cmp_eq_u32 vcc, -1, v39
    s_cbranch_vccnz Lrt_33
Lrte_35:
    s_nop 1
    s_branch Lrtd_34
Lrt_30:
    s_nop 1
    buffer_load_dword v39, v40, s[32:35], 0 offen sc1
    s_sub_u32 s56, s56, 1
    s_cselect_b32 s56, 0, s56
    s_waitcnt vmcnt(0)
    s_cbranch_scc1 Lrte_32
    v_cmp_ne_u32 vcc, 1, v39
    s_cbranch_vccnz Lrt_30
Lrte_32:
    s_nop 1
    s_branch Lrtd_31
Lrt_27:
    s_nop 1
    s_sleep 3
    buffer_load_dword v39, v57, s[32:35], 0 offen sc1
    s_sub_u32 s56, s56, 1
    s_cselect_b32 s56, 0, s56
    s_waitcnt vmcnt(0)
    s_cbranch_scc1 Lrte_29
    v_cmp_ne_u32 vcc, s5, v39
    s_cbranch_vccnz Lrt_27
Lrte_29:
    s_nop 1
    s_branch Lrtd_28
Lrt_24:
    s_nop 1
    s_sleep 3
    buffer_load_dword v39, v57, s[32:35], 0 offen sc1
    s_sub_u32 s56, s56, 1
    s_cselect_b32 s56, 0, s56
    s_waitcnt vmcnt(0)
    s_cbranch_scc1 Lrte_26
    v_cmp_ne_u32 vcc, s5, v39
    s_cbranch_vccnz Lrt_24
Lrte_26:
    s_nop 1
    s_branch Lrtd_25
Lrt_21:
    s_nop 1
    buffer_load_dwordx4 v[128:131], v1, s[32:35], s44 offen offset:0 sc1
    buffer_load_dwordx4 v[132:135], v1, s[32:35], s44 offen offset:1024 sc1
    buffer_load_dwordx4 v[136:139], v1, s[32:35], s44 offen offset:2048 sc1
    buffer_load_dwordx4 v[140:143], v1, s[32:35], s44 offen offset:3072 sc1
    s_sub_u32 s56, s56, 1
    s_cselect_b32 s56, 0, s56
    s_waitcnt vmcnt(0)
    s_cbranch_scc1 Lrte_23
    v_max_u32 v39, v129, v131
    v_cndmask_b32_e64 v140, v140, 0, s[60:61]
    v_cndmask_b32_e64 v141, v141, 0, s[60:61]
    v_cndmask_b32_e64 v142, v142, 0, s[60:61]
    v_cndmask_b32_e64 v143, v143, 0, s[60:61]
    v_max3_u32 v39, v39, v133, v135
    v_max3_u32 v39, v39, v137, v139
    v_max3_u32 v39, v39, v141, v143
    v_cmp_eq_u32 vcc, -1, v39
    s_cbranch_vccnz Lrt_21
Lrte_23:
    s_nop 1
    s_branch Lrtd_22
Lrt_18:
    s_nop 1
    buffer_load_dword v39, v38, s[32:35], 0 offen offset:0 sc1
    s_sub_u32 s56, s56, 1
    s_cselect_b32 s56, 0, s56
    s_waitcnt vmcnt(0)
    s_cbranch_scc1 Lrte_20
    v_cmp_ne_u32 vcc, 1, v39
    s_cbranch_vccnz Lrt_18
Lrte_20:
    s_nop 1
    s_branch Lrtd_19
Lrt_13:
    s_nop 1
    buffer_load_dwordx4 v[84:87], v1, s[32:35], s6 offen sc1
    s_sub_u32 s56, s56, 1
    s_cselect_b32 s56, 0, s56
    s_waitcnt vmcnt(0)
    s_cbranch_scc1 Lrte_15
    v_max_u32 v39, v85, v87
    v_cmp_eq_u32 vcc, -1, v39
    s_cbranch_vccnz Lrt_13
Lrte_15:
    s_nop 1
    s_branch Lrtd_14
Lrt_10:
    s_nop 1
    buffer_load_dword v39, v38, s[32:35], 0 offen offset:0 sc1
    s_sub_u32 s56, s56, 1
    s_cselect_b32 s56, 0, s56
    s_waitcnt vmcnt(0)
    s_cbranch_scc1 Lrte_12
    v_cmp_ne_u32 vcc, 1, v39
    s_cbranch_vccnz Lrt_10
Lrte_12:
    s_nop 1
    s_branch Lrtd_11
Lrt_4:
    s_nop 1
    buffer_load_dword v177, v176, s[32:35], 0 offen offset:0 sc1
    s_sub_u32 s56, s56, 1
    s_cselect_b32 s56, 0, s56
    s_waitcnt vmcnt(0)
    s_cbranch_scc1 Lrte_6
    v_cmp_ne_u32 vcc, 1, v177
    s_cbranch_vccnz Lrt_4
Lrte_6:
    s_nop 1
    s_branch Lrtd_5
Lrt_1:
    s_nop 1
    s_sleep 8
    buffer_load_dwordx2 v[186:187], v184, s[44:47], 0 offen sc1
    s_sub_u32 s56, s56, 4
    s_cselect_b32 s56, 0, s56
    s_waitcnt vmcnt(0)
    s_cbranch_scc1 Lrte_3
    v_sad_u8 v185, v186, 0, 0
    v_sad_u8 v185, v187, 0, v185
    v_cmp_gt_u32 vcc, 32, v185
    s_cbranch_vccnz Lrt_1
Lrte_3:
    s_nop 1
    s_branch Lrtd_2
Lrt_7:
    s_nop 11
    buffer_load_dwordx4 v[188:191], v182, s[32:35], s62 offen offset:1024 sc1
    s_add_u32 s91, s62, 3456
    s_add_u32 s92, s62, 6912
    buffer_load_dwordx4 v[192:195], v1, s[32:35], s62 offen offset:0 sc1
    buffer_load_dwordx4 v[196:199], v1, s[32:35], s62 offen offset:1152 sc1
    buffer_load_dwordx4 v[200:203], v1, s[32:35], s62 offen offset:2304 sc1
    buffer_load_dwordx4 v[204:207], v1, s[32:35], s91 offen offset:0 sc1
    buffer_load_dwordx4 v[208:211], v1, s[32:35], s91 offen offset:1152 sc1
    buffer_load_dwordx4 v[212:215], v1, s[32:35], s91 offen offset:2304 sc1
    buffer_load_dwordx4 v[216:219], v1, s[32:35], s92 offen offset:0 sc1
    buffer_load_dwordx4 v[220:223], v1, s[32:35], s92 offen offset:1152 sc1
    s_sub_u32 s56, s56, 8
    s_cselect_b32 s56, 0, s56
    s_waitcnt vmcnt(0)
    s_cbranch_scc1 Lrte_9
    v_max_u32 v17, v188, v189
    v_max3_u32 v17, v17, v190, v191
    v_max3_u32 v17, v17, v192, v193
    v_max3_u32 v17, v17, v194, v195
    v_max3_u32 v17, v17, v196, v197
    v_max3_u32 v17, v17, v198, v199
    v_max3_u32 v17, v17, v200, v201
    v_max3_u32 v17, v17, v202, v203
    v_max3_u32 v17, v17, v204, v205
    v_max3_u32 v17, v17, v206, v207
    v_max3_u32 v17, v17, v208, v209
    v_max3_u32 v17, v17, v210, v211
    v_max3_u32 v17, v17, v212, v213
    v_max3_u32 v17, v17, v214, v215
    v_max3_u32 v17, v17, v216, v217
    v_max3_u32 v17, v17, v218, v219
    v_max3_u32 v17, v17, v220, v221
    v_max3_u32 v17, v17, v222, v223
    v_cmp_eq_u32 vcc, -1, v17
    s_cbranch_vccnz Lrt_7
Lrte_9:
    v_mfma_f32_16x16x32_bf16 v[80:83], v[188:191], v[96:99], 0
    v_mfma_f32_16x16x32_bf16 v[84:87], v[188:191], v[100:103], 0
    v_mfma_f32_16x16x32_bf16 v[88:91], v[188:191], v[104:107], 0
    v_mfma_f32_16x16x32_bf16 v[92:95], v[188:191], v[108:111], 0
    v_mfma_f32_16x16x32_bf16 v[164:167], v[160:163], v[192:195], 0
    v_mfma_f32_16x16x32_bf16 v[168:171], v[158:161], v[192:195], 0
    v_mfma_f32_16x16x32_bf16 v[164:167], v[160:163], v[196:199], v[164:167]
    v_mfma_f32_16x16x32_bf16 v[168:171], v[158:161], v[196:199], v[168:171]
    v_mfma_f32_16x16x32_bf16 v[164:167], v[160:163], v[200:203], v[164:167]
    v_add_f32 v80, v80, v81
    v_mfma_f32_16x16x32_bf16 v[168:171], v[158:161], v[200:203], v[168:171]
    v_add_f32 v82, v82, v83
    v_mfma_f32_16x16x32_bf16 v[164:167], v[160:163], v[204:207], v[164:167]
    v_add_f32 v84, v84, v85
    v_mfma_f32_16x16x32_bf16 v[168:171], v[158:161], v[204:207], v[168:171]
    v_add_f32 v86, v86, v87
    v_mfma_f32_16x16x32_bf16 v[164:167], v[160:163], v[208:211], v[164:167]
    v_add_f32 v88, v88, v89
    v_mfma_f32_16x16x32_bf16 v[168:171], v[158:161], v[208:211], v[168:171]
    v_add_f32 v90, v90, v91
    v_mfma_f32_16x16x32_bf16 v[164:167], v[160:163], v[212:215], v[164:167]
    v_add_f32 v92, v92, v93
    v_mfma_f32_16x16x32_bf16 v[168:171], v[158:161], v[212:215], v[168:171]
    v_add_f32 v94, v94, v95
    v_mfma_f32_16x16x32_bf16 v[164:167], v[160:163], v[216:219], v[164:167]
    v_add_f32 v80, v80, v82
    v_mfma_f32_16x16x32_bf16 v[168:171], v[158:161], v[216:219], v[168:171]
    v_add_f32 v84, v84, v86
    v_mfma_f32_16x16x32_bf16 v[164:167], v[160:163], v[220:223], v[164:167]
    v_add_f32 v88, v88, v90
    v_mfma_f32_16x16x32_bf16 v[168:171], v[158:161], v[220:223], v[168:171]
    v_add_f32 v92, v92, v94
    s_nop 11
    s_branch Lrtd_8
Lidle_16:
    s_waitcnt vmcnt(0) lgkmcnt(0)
    s_and_b32 s93, s58, 15
    s_mul_i32 s93, s93, 28672
    s_add_u32 s93, s93, 0
    s_add_u32 s86, s93, 14336
    v_min_u32 v36, 13, v3
    v_mul_u32_u24 v37, 28, v4
    v_add_lshl_u32 v36, v36, v37, 7
    buffer_load_dword v19, v36, s[16:19], s93 offen sc1
    buffer_load_dword v19, v36, s[16:19], s86 offen sc1
    s_xor_b32 s93, s87, 0
    s_add_u32 m0, s88, 32768
    s_add_u32 s86, s93, s77
    buffer_load_dwordx4 v5, s[20:23], s86 offen lds
    buffer_load_dwordx4 v6, s[20:23], s86 offen offset:1024 lds
    buffer_load_dwordx4 v7, s[20:23], s86 offen offset:2048 lds
    buffer_load_dwordx4 v8, s[20:23], s86 offen offset:3072 lds
    s_xor_b32 s93, s87, 131072
    s_add_u32 m0, s88, 36864
    s_add_u32 s86, s93, s77
    buffer_load_dwordx4 v5, s[20:23], s86 offen lds
    buffer_load_dwordx4 v6, s[20:23], s86 offen offset:1024 lds
    buffer_load_dwordx4 v7, s[20:23], s86 offen offset:2048 lds
    buffer_load_dwordx4 v8, s[20:23], s86 offen offset:3072 lds
    ds_read_b128 a[0:3], v20 offset:0
    ds_read_b128 a[4:7], v22 offset:0
    ds_read_b128 a[32:35], v21 offset:0
    ds_read_b128 a[36:39], v23 offset:0
    s_waitcnt lgkmcnt(0)
    s_xor_b32 s93, s87, 1048576
    s_add_u32 m0, s88, 0
    s_add_u32 s86, s93, s77
    buffer_load_dwordx4 v5, s[20:23], s86 offen lds
    buffer_load_dwordx4 v6, s[20:23], s86 offen offset:1024 lds
    buffer_load_dwordx4 v7, s[20:23], s86 offen offset:2048 lds
    buffer_load_dwordx4 v8, s[20:23], s86 offen offset:3072 lds
    ds_read_b128 a[8:11], v20 offset:4096
    ds_read_b128 a[12:15], v22 offset:4096
    ds_read_b128 a[40:43], v21 offset:4096
    ds_read_b128 a[44:47], v23 offset:4096
    s_waitcnt lgkmcnt(0)
    s_xor_b32 s93, s87, 1179648
    s_add_u32 m0, s88, 4096
    s_add_u32 s86, s93, s77
    buffer_load_dwordx4 v5, s[20:23], s86 offen lds
    buffer_load_dwordx4 v6, s[20:23], s86 offen offset:1024 lds
    buffer_load_dwordx4 v7, s[20:23], s86 offen offset:2048 lds
    buffer_load_dwordx4 v8, s[20:23], s86 offen offset:3072 lds
    s_waitcnt vmcnt(12)
    ds_read_b128 a[64:67], v20 offset:32768
    ds_read_b128 a[68:71], v22 offset:32768
    ds_read_b128 a[96:99], v21 offset:32768
    ds_read_b128 a[100:103], v23 offset:32768
    s_waitcnt lgkmcnt(0)
    s_xor_b32 s93, s87, 0
    s_add_u32 m0, s88, 32768
    s_add_u32 s86, s93, s78
    buffer_load_dwordx4 v5, s[20:23], s86 offen lds
    buffer_load_dwordx4 v6, s[20:23], s86 offen offset:1024 lds
    buffer_load_dwordx4 v7, s[20:23], s86 offen offset:2048 lds
    buffer_load_dwordx4 v8, s[20:23], s86 offen offset:3072 lds
    s_waitcnt vmcnt(12)
    ds_read_b128 a[72:75], v20 offset:36864
    ds_read_b128 a[76:79], v22 offset:36864
    ds_read_b128 a[104:107], v21 offset:36864
    ds_read_b128 a[108:111], v23 offset:36864
    s_waitcnt lgkmcnt(0)
    s_xor_b32 s93, s87, 131072
    s_add_u32 m0, s88, 36864
    s_add_u32 s86, s93, s78
    buffer_load_dwordx4 v5, s[20:23], s86 offen lds
    buffer_load_dwordx4 v6, s[20:23], s86 offen offset:1024 lds
    buffer_load_dwordx4 v7, s[20:23], s86 offen offset:2048 lds
    buffer_load_dwordx4 v8, s[20:23], s86 offen offset:3072 lds
    s_waitcnt vmcnt(12)
    ds_read_b128 a[80:83], v20 offset:0
    ds_read_b128 a[84:87], v22 offset:0
    ds_read_b128 a[112:115], v21 offset:0
    ds_read_b128 a[116:119], v23 offset:0
    s_waitcnt lgkmcnt(0)
    s_xor_b32 s93, s87, 1048576
    s_add_u32 m0, s88, 0
    s_add_u32 s86, s93, s78
    buffer_load_dwordx4 v5, s[20:23], s86 offen lds
    buffer_load_dwordx4 v6, s[20:23], s86 offen offset:1024 lds
    buffer_load_dwordx4 v7, s[20:23], s86 offen offset:2048 lds
    buffer_load_dwordx4 v8, s[20:23], s86 offen offset:3072 lds
    s_waitcnt vmcnt(12)
    ds_read_b128 a[88:91], v20 offset:4096
    ds_read_b128 a[92:95], v22 offset:4096
    ds_read_b128 a[120:123], v21 offset:4096
    ds_read_b128 a[124:127], v23 offset:4096
    s_waitcnt lgkmcnt(0)
    s_xor_b32 s93, s87, 1179648
    s_add_u32 m0, s88, 4096
    s_add_u32 s86, s93, s78
    buffer_load_dwordx4 v5, s[20:23], s86 offen lds
    buffer_load_dwordx4 v6, s[20:23], s86 offen offset:1024 lds
    buffer_load_dwordx4 v7, s[20:23], s86 offen offset:2048 lds
    buffer_load_dwordx4 v8, s[20:23], s86 offen offset:3072 lds
    s_waitcnt vmcnt(12)
    ds_read_b128 a[128:131], v20 offset:32768
    ds_read_b128 a[132:135], v22 offset:32768
    ds_read_b128 a[160:163], v21 offset:32768
    ds_read_b128 a[164:167], v23 offset:32768
    s_waitcnt lgkmcnt(0)
    s_xor_b32 s93, s87, 1048576
    s_add_u32 m0, s88, 32768
    s_add_u32 s86, s93, s76
    buffer_load_dwordx4 v5, s[20:23], s86 offen lds
    buffer_load_dwordx4 v6, s[20:23], s86 offen offset:1024 lds
    buffer_load_dwordx4 v7, s[20:23], s86 offen offset:2048 lds
    buffer_load_dwordx4 v8, s[20:23], s86 offen offset:3072 lds
    s_waitcnt vmcnt(12)
    ds_read_b128 a[136:139], v20 offset:36864
    ds_read_b128 a[140:143], v22 offset:36864
    ds_read_b128 a[168:171], v21 offset:36864
    ds_read_b128 a[172:175], v23 offset:36864
    s_waitcnt lgkmcnt(0)
    s_xor_b32 s93, s87, 1179648
    s_add_u32 m0, s88, 36864
    s_add_u32 s86, s93, s76
    buffer_load_dwordx4 v5, s[20:23], s86 offen lds
    buffer_load_dwordx4 v6, s[20:23], s86 offen offset:1024 lds
    buffer_load_dwordx4 v7, s[20:23], s86 offen offset:2048 lds
    buffer_load_dwordx4 v8, s[20:23], s86 offen offset:3072 lds
    s_waitcnt vmcnt(12)
    ds_read_b128 a[144:147], v20 offset:0
    ds_read_b128 a[148:151], v22 offset:0
    ds_read_b128 a[176:179], v21 offset:0
    ds_read_b128 a[180:183], v23 offset:0
    s_waitcnt vmcnt(8)
    ds_read_b128 a[152:155], v20 offset:4096
    ds_read_b128 a[156:159], v22 offset:4096
    ds_read_b128 a[184:187], v21 offset:4096
    ds_read_b128 a[188:191], v23 offset:4096
    s_waitcnt vmcnt(4)
    ds_read_b128 a[16:19], v20 offset:32768
    ds_read_b128 a[20:23], v22 offset:32768
    ds_read_b128 a[48:51], v21 offset:32768
    ds_read_b128 a[52:55], v23 offset:32768
    s_waitcnt vmcnt(0)
    ds_read_b128 a[24:27], v20 offset:36864
    ds_read_b128 a[28:31], v22 offset:36864
    ds_read_b128 a[56:59], v21 offset:36864
    ds_read_b128 a[60:63], v23 offset:36864
    s_mul_i32 s59, s53, 7
    v_min_u32 v46, 6, v0
    v_add_u32 v46, s59, v46
    v_lshrrev_b32 v46, 2, v46
    s_andn2_b32 s63, 1, s48
    s_lshl_b32 s59, s63, 7
    s_add_u32 s59, s59, 10780672
    s_lshl_b32 s62, s54, 28
    s_add_u32 s59, s59, s62
    v_lshl_add_u32 v57, v46, 8, s59
    s_min_u32 s5, s54, 1
    s_xor_b32 s5, s5, 1
    s_mul_i32 s5, s5, 7
    s_bfe_u32 s59, s58, 196609
    s_lshl_b32 s59, s59, 7
    s_add_u32 s59, s59, s3
    s_add_u32 s59, s59, 51200
    v_lshl_add_u32 v40, v46, 2, s59
    s_lshl_b32 s4, s63, 13
    s_lshl_b32 s59, s54, 14
    s_add_u32 s4, s4, s59
    s_add_u32 s4, s4, 6291456
    s_lshl_b32 s59, s64, 16
    s_add_u32 s59, s59, s4
    v_add_u32 v56, s59, v1
    s_xor_b32 s59, s54, 1
    s_mul_i32 s59, s59, 3072
    s_add_u32 s59, s59, 0
    v_add_u32 v41, s59, v1
    s_xor_b32 s59, s54, 2
    s_mul_i32 s59, s59, 3072
    s_add_u32 s59, s59, 1024
    v_add_u32 v42, s59, v1
    s_xor_b32 s59, s54, 3
    s_mul_i32 s59, s59, 3072
    s_add_u32 s59, s59, 2048
    v_add_u32 v43, s59, v1
    s_mul_i32 s59, s54, 3072
    v_add_u32 v44, s59, v1
    v_lshlrev_b32 v45, 3, v0
    v_lshlrev_b32 v48, 16, v34
    v_lshlrev_b32 v49, 16, v34
    v_lshlrev_b32 v50, 16, v34
    v_lshlrev_b32 v51, 16, v34
    s_lshr_b32 s91, s64, 1
    s_lshl_b32 s91, s91, 10
    s_and_b32 s59, s64, 1
    s_lshl_b32 s59, s59, 3
    s_add_u32 s91, s91, s59
    s_add_u32 s91, s91, s0
    s_lshl_b32 s92, s65, 9
    s_add_u32 s92, s92, s0
    s_lshl_b32 s36, s94, 12
    s_xor_b32 s37, s36, 524288
    s_add_u32 s36, s36, 11534336
    s_add_u32 s37, s37, 11534336
    s_bfe_u32 s38, s57, 196608
    s_lshl_b32 s38, s38, 7
    s_add_u32 s38, s38, s3
    s_add_u32 s38, s38, 51200
    s_lshl_b32 s59, s51, 2
    s_add_u32 s38, s38, s59
    s_bfe_u32 s39, s58, 262144
    s_lshl_b32 s39, s39, 7
    s_add_u32 s39, s39, s3
    s_add_u32 s39, s39, 52224
    s_lshl_b32 s6, s53, 2
    s_add_u32 s6, s6, s39
    buffer_load_dword v39, v57, s[32:35], 0 offen sc1
    s_waitcnt vmcnt(0)
    v_cmp_ne_u32 vcc, s5, v39
    s_cbranch_vccnz Lrt_27
Lrtd_28:
    s_waitcnt lgkmcnt(0)
    s_barrier
    buffer_load_dwordx4 v[128:131], v56, s[32:35], s72 offen offset:0 sc1
    buffer_load_dwordx4 v[132:135], v56, s[32:35], s72 offen offset:1024 sc1
    buffer_load_dwordx4 v[136:139], v56, s[32:35], s73 offen offset:0 sc1
    buffer_load_dwordx4 v[140:143], v56, s[32:35], s73 offen offset:1024 sc1
    buffer_load_dwordx4 v[144:147], v56, s[32:35], s74 offen offset:0 sc1
    buffer_load_dwordx4 v[148:151], v56, s[32:35], s74 offen offset:1024 sc1
    buffer_load_dwordx4 v[152:155], v56, s[32:35], s75 offen offset:0 sc1
    buffer_load_dwordx4 v[156:159], v56, s[32:35], s75 offen offset:1024 sc1
    s_lshl_b32 s7, s65, 16
    s_add_u32 s7, s7, s4
    v_add_u32 v56, s7, v1
    buffer_load_dwordx4 v[160:163], v56, s[32:35], s72 offen offset:0 sc1
    buffer_load_dwordx4 v[164:167], v56, s[32:35], s72 offen offset:1024 sc1
    buffer_load_dwordx4 v[168:171], v56, s[32:35], s73 offen offset:0 sc1
    buffer_load_dwordx4 v[172:175], v56, s[32:35], s73 offen offset:1024 sc1
    buffer_load_dwordx4 v[176:179], v56, s[32:35], s74 offen offset:0 sc1
    buffer_load_dword v19, off, s[32:35], s3 sc1
    buffer_load_dword v19, off, s[32:35], s3 sc1
    buffer_load_dword v19, off, s[32:35], s3 sc1
    buffer_load_dword v19, off, s[32:35], s3 sc1
    s_nop 7
    s_branch Lp3_17
L_slow:
    buffer_store_dwordx4 v[80:83], v1, s[32:35], s62 offen sc1
    buffer_store_dwordx4 v[84:87], v1, s[32:35], s62 offen offset:1024 sc1
    s_mov_b32 exec_lo, 0x00030003
    s_mov_b32 exec_hi, 0x00030003
    buffer_store_dwordx4 v[88:91], v18, s[32:35], s62 offen offset:2048 sc1
    s_mov_b64 exec, -1
    s_and_b32 s59, s94, 127
    s_min_u32 s59, s59, 111
    s_mul_i32 s93, s59, 4
    v_min_u32 v36, 3, v0
    v_add_lshl_u32 v36, v36, s93, 7
    buffer_load_dword v19, v36, s[32:35], s3 offen sc1
    s_waitcnt lgkmcnt(0)
    s_barrier
    ds_read_b64_tr_b16 v[96:97], v13 offset:0
    ds_read_b64_tr_b16 v[98:99], v13 offset:512
    ds_read_b64_tr_b16 v[100:101], v13 offset:4096
    ds_read_b64_tr_b16 v[102:103], v13 offset:4608
    ds_read_b64_tr_b16 v[104:105], v13 offset:8192
    ds_read_b64_tr_b16 v[106:107], v13 offset:8704
    s_waitcnt lgkmcnt(4)
    v_mfma_f32_16x16x32_bf16 v[64:67], v[96:99], v[192:195], 0
    s_bfe_u32 s91, s71, 327680
    ds_read_b64_tr_b16 v[108:109], v13 offset:12288
    ds_read_b64_tr_b16 v[110:111], v13 offset:12800
    v_mfma_f32_16x16x32_bf16 v[68:71], v[96:99], a[0:3], 0
    s_lshl_b32 s91, s91, 4
    s_add_u32 s91, s91, s3
    s_add_u32 s91, s91, 49152
    v_mfma_f32_16x16x32_bf16 v[72:75], v[96:99], a[64:67], 0
    v_and_b32 v176, 3, v0
    v_lshl_add_u32 v176, v176, 2, s91
    v_mfma_f32_16x16x32_bf16 v[76:79], v[96:99], a[128:131], 0
    s_and_b32 s60, s52, 3
    s_lshl_b32 s61, s60, 2
    s_add_u32 s91, s91, s61
    v_mfma_f32_16x16x32_bf16 v[40:43], v[96:99], v[24:27], 0
    s_waitcnt lgkmcnt(4)
    v_lshrrev_b32 v36, 5, v0
    v_bfe_u32 v37, v0, 3, 2
    v_mfma_f32_16x16x32_bf16 v[64:67], v[100:103], v[196:199], v[64:67]
    ds_read_b64_tr_b16 v[96:97], v13 offset:16384
    ds_read_b64_tr_b16 v[98:99], v13 offset:16896
    v_mfma_f32_16x16x32_bf16 v[68:71], v[100:103], a[4:7], v[68:71]
    v_lshl_add_u32 v36, v36, 3, v37
    v_mul_u32_u24 v36, 4096, v36
    v_mfma_f32_16x16x32_bf16 v[72:75], v[100:103], a[68:71], v[72:75]
    v_xor_b32 v37, v4, v0
    v_and_b32 v37, 7, v37
    v_mfma_f32_16x16x32_bf16 v[76:79], v[100:103], a[132:135], v[76:79]
    v_lshl_add_u32 v5, v37, 4, v36
    v_xor_b32 v37, 64, v5
    v_mfma_f32_16x16x32_bf16 v[40:43], v[100:103], v[24:27], v[40:43]
    s_waitcnt lgkmcnt(4)
    v_add_u32 v6, 64512, v37
    v_add_u32 v7, 14336, v5
    v_add_u32 v8, 78848, v37
    v_lshrrev_b32 v36, 1, v3
    v_xor_b32 v36, v36, v4
    v_lshlrev_b32 v36, 4, v36
    v_lshl_add_u32 v36, v3, 7, v36
    s_lshl_b32 s88, s54, 13
    s_and_b32 s93, s54, 1
    s_lshl_b32 s93, s93, 11
    s_add_u32 s93, s93, s88
    v_add_u32 v20, s93, v36
    v_xor_b32 v21, 64, v20
    v_xor_b32 v22, 2048, v20
    v_xor_b32 v23, 2048, v21
    s_lshr_b32 s87, s58, 1
    s_lshl_b32 s87, s87, 17
    s_andn2_b32 s93, 1, s48
    s_lshl_b32 s93, s93, 9
    s_add_u32 s87, s87, s93
    s_lshl_b32 s93, s54, 10
    s_add_u32 s87, s87, s93
    s_mov_b64 exec, 2
    s_waitcnt vmcnt(1)
    buffer_store_dword v0, off, s[32:35], s91 offset:0 sc1
    s_mov_b64 exec, -1
    v_mfma_f32_16x16x32_bf16 v[64:67], v[104:107], v[200:203], v[64:67]
    v_lshrrev_b32 v36, 3, v0
    v_lshlrev_b32 v37, 1, v4
    v_xor_b32 v37, v37, v0
    v_and_b32 v37, 7, v37
    v_mul_u32_u24 v36, 1024, v36
    v_lshl_add_u32 v9, v37, 4, v36
    v_add_u32 v10, 7168, v9
    v_add_u32 v11, 14336, v9
    v_add_u32 v12, 21504, v9
    s_lshl_b32 s89, s53, 7
    s_mul_i32 s93, s54, 32768
    s_add_u32 s89, s89, s93
    s_add_u32 m0, s90, 98304
    s_add_u32 s86, s89, 0
    v_mfma_f32_16x16x32_bf16 v[68:71], v[104:107], a[8:11], v[68:71]
    buffer_load_dwordx4 v9, s[12:15], s86 offen lds
    v_mfma_f32_16x16x32_bf16 v[72:75], v[104:107], a[72:75], v[72:75]
    s_mul_i32 s61, s48, 557056
    ds_read_b64_tr_b16 v[100:101], v13 offset:20480
    ds_read_b64_tr_b16 v[102:103], v13 offset:20992
    v_mfma_f32_16x16x32_bf16 v[76:79], v[104:107], a[136:139], v[76:79]
    s_add_u32 s61, s61, s63
    s_lshl_b32 s59, s60, 8
    v_lshl_add_u32 v178, v3, 4, s59
    v_mfma_f32_16x16x32_bf16 v[40:43], v[104:107], v[24:27], v[40:43]
    s_waitcnt lgkmcnt(4)
    v_lshl_add_u32 v179, v4, 3, v178
    v_lshl_add_u32 v178, v4, 10, v178
    v_mfma_f32_16x16x32_bf16 v[64:67], v[108:111], v[204:207], v[64:67]
    buffer_load_dwordx4 v10, s[12:15], s86 offen offset:1024 lds
    v_mfma_f32_16x16x32_bf16 v[68:71], v[108:111], a[12:15], v[68:71]
    s_lshl_b32 s59, s60, 4
    ds_read_b64_tr_b16 v[104:105], v13 offset:24576
    ds_read_b64_tr_b16 v[106:107], v13 offset:25088
    v_mfma_f32_16x16x32_bf16 v[72:75], v[108:111], a[76:79], v[72:75]
    s_add_u32 s59, s59, 1024
    v_lshl_add_u32 v180, v3, 3, s59
    v_cmp_lt_u32 vcc, 31, v0
    v_mfma_f32_16x16x32_bf16 v[76:79], v[108:111], a[140:143], v[76:79]
    buffer_load_dwordx4 v11, s[12:15], s86 offen offset:2048 lds
    v_mfma_f32_16x16x32_bf16 v[40:43], v[108:111], v[24:27], v[40:43]
    s_waitcnt lgkmcnt(4)
    v_lshlrev_b32 v181, 1, v180
    s_mul_i32 s62, s71, 9216
    v_mfma_f32_16x16x32_bf16 v[64:67], v[96:99], v[208:211], v[64:67]
    ds_read_b64_tr_b16 v[108:109], v13 offset:28672
    ds_read_b64_tr_b16 v[110:111], v13 offset:29184
    v_mfma_f32_16x16x32_bf16 v[68:71], v[96:99], a[16:19], v[68:71]
    v_cndmask_b32 v179, v179, v180, vcc
    v_cndmask_b32 v178, v178, v181, vcc
    v_mfma_f32_16x16x32_bf16 v[72:75], v[96:99], a[80:83], v[72:75]
    buffer_load_dwordx4 v12, s[12:15], s86 offen offset:3072 lds
    v_mfma_f32_16x16x32_bf16 v[76:79], v[96:99], a[144:147], v[76:79]
    s_add_u32 s62, s62, 10485760
    s_mul_i32 s59, s48, 1152
    s_add_u32 s92, s59, s62
    v_mfma_f32_16x16x32_bf16 v[40:43], v[96:99], v[24:27], v[40:43]
    s_waitcnt lgkmcnt(4)
    s_lshr_b32 s4, s71, 1
    s_lshl_b32 s4, s4, 10
    v_mfma_f32_16x16x32_bf16 v[64:67], v[100:103], v[212:215], v[64:67]
    s_add_u32 m0, s90, 114688
    s_add_u32 s86, s89, 131072
    ds_read_b64_tr_b16 v[96:97], v13 offset:32768
    v_mfma_f32_16x16x32_bf16 v[68:71], v[100:103], a[20:23], v[68:71]
    buffer_load_dwordx4 v9, s[12:15], s86 offen lds
    v_mfma_f32_16x16x32_bf16 v[72:75], v[100:103], a[84:87], v[72:75]
    s_and_b32 s5, s71, 1
    ds_read_b64_tr_b16 v[98:99], v13 offset:33280
    s_lshl_b32 s5, s5, 3
    v_mfma_f32_16x16x32_bf16 v[76:79], v[100:103], a[148:151], v[76:79]
    s_add_u32 s4, s4, s5
    s_mul_i32 s5, s52, 139264
    s_add_u32 s4, s4, s5
    v_mfma_f32_16x16x32_bf16 v[40:43], v[100:103], v[24:27], v[40:43]
    s_waitcnt lgkmcnt(4)
    s_add_u32 s36, s54, 0
    s_and_b32 s36, s36, 3
    buffer_load_dword v177, v176, s[32:35], 0 offen sc1
    v_mfma_f32_16x16x32_bf16 v[64:67], v[104:107], v[216:219], v[64:67]
    s_mul_i32 s36, s36, 34816
    ds_read_b64_tr_b16 v[100:101], v13 offset:36864
    ds_read_b64_tr_b16 v[102:103], v13 offset:37376
    v_mfma_f32_16x16x32_bf16 v[68:71], v[104:107], a[24:27], v[68:71]
    buffer_load_dwordx4 v10, s[12:15], s86 offen offset:1024 lds
    v_mfma_f32_16x16x32_bf16 v[72:75], v[104:107], a[88:91], v[72:75]
    s_add_u32 s36, s36, s4
    s_add_u32 s37, s54, 1
    s_and_b32 s37, s37, 3
    v_mfma_f32_16x16x32_bf16 v[76:79], v[104:107], a[152:155], v[76:79]
    s_mul_i32 s37, s37, 34816
    s_add_u32 s37, s37, s4
    s_add_u32 s38, s54, 2
    v_mfma_f32_16x16x32_bf16 v[40:43], v[104:107], v[24:27], v[40:43]
    s_waitcnt lgkmcnt(4)
    s_and_b32 s38, s38, 3
    s_mul_i32 s38, s38, 34816
    v_mfma_f32_16x16x32_bf16 v[64:67], v[108:111], v[220:223], v[64:67]
    buffer_load_dwordx4 v11, s[12:15], s86 offen offset:2048 lds
    v_mfma_f32_16x16x32_bf16 v[68:71], v[108:111], a[28:31], v[68:71]
    s_add_u32 s38, s38, s4
    ds_read_b64_tr_b16 v[104:105], v13 offset:40960
    ds_read_b64_tr_b16 v[106:107], v13 offset:41472
    v_mfma_f32_16x16x32_bf16 v[72:75], v[108:111], a[92:95], v[72:75]
    s_add_u32 s39, s54, 3
    s_and_b32 s39, s39, 3
    s_mul_i32 s39, s39, 34816
    v_mfma_f32_16x16x32_bf16 v[76:79], v[108:111], a[156:159], v[76:79]
    s_add_u32 s39, s39, s4
    s_bfe_u32 s4, s52, 131072
    s_lshl_b32 s4, s4, 7
    v_mfma_f32_16x16x32_bf16 v[40:43], v[108:111], v[24:27], v[40:43]
    s_waitcnt lgkmcnt(4)
    s_add_u32 s4, s4, s3
    s_add_u32 s4, s4, 49664
    v_mfma_f32_16x16x32_bf16 v[64:67], v[96:99], v[224:227], v[64:67]
    buffer_load_dwordx4 v12, s[12:15], s86 offen offset:3072 lds
    v_mfma_f32_16x16x32_bf16 v[68:71], v[96:99], a[32:35], v[68:71]
    s_lshl_b32 s5, s71, 2
    ds_read_b64_tr_b16 v[108:109], v13 offset:45056
    ds_read_b64_tr_b16 v[110:111], v13 offset:45568
    v_mfma_f32_16x16x32_bf16 v[72:75], v[96:99], a[96:99], v[72:75]
    s_add_u32 m0, s90, 131072
    s_add_u32 s86, s89, 262144
    s_add_u32 s5, s5, s4
    v_mfma_f32_16x16x32_bf16 v[76:79], v[96:99], a[160:163], v[76:79]
    buffer_load_dwordx4 v9, s[12:15], s86 offen lds
    v_mfma_f32_16x16x32_bf16 v[40:43], v[96:99], v[24:27], v[40:43]
    s_waitcnt lgkmcnt(4)
    s_bfe_u32 s6, s58, 262144
    s_lshl_b32 s6, s6, 10
    v_mfma_f32_16x16x32_bf16 v[64:67], v[100:103], v[228:231], v[64:67]
    s_add_u32 s6, s6, s3
    ds_read_b64_tr_b16 v[96:97], v13 offset:49152
    ds_read_b64_tr_b16 v[98:99], v13 offset:49664
    v_mfma_f32_16x16x32_bf16 v[68:71], v[100:103], a[36:39], v[68:71]
    s_add_u32 s6, s6, 32768
    s_lshr_b32 s7, s53, 1
    s_lshl_b32 s7, s7, 8
    v_mfma_f32_16x16x32_bf16 v[72:75], v[100:103], a[100:103], v[72:75]
    s_add_u32 s7, s7, s6
    s_and_b32 s8, s53, 1
    s_lshl_b32 s8, s8, 3
    v_mfma_f32_16x16x32_bf16 v[76:79], v[100:103], a[164:167], v[76:79]
    buffer_load_dwordx4 v10, s[12:15], s86 offen offset:1024 lds
    v_mfma_f32_16x16x32_bf16 v[40:43], v[100:103], v[24:27], v[40:43]
    s_waitcnt lgkmcnt(4)
    s_add_u32 s7, s7, s8
    s_lshl_b32 s8, s53, 11
    s_add_u32 s8, s8, s0
    s_bfe_u32 s10, s58, 196609
    s_lshl_b32 s10, s10, 7
    s_add_u32 s10, s10, s3
    s_add_u32 s10, s10, 50176
    s_and_b32 s9, s58, 1
    s_lshl_b32 s9, s9, 3
    s_add_u32 s9, s9, s53
    s_lshl_b32 s9, s9, 2
    s_add_u32 s10, s10, s9
    s_bfe_u32 s9, s57, 196608
    s_lshl_b32 s9, s9, 7
    s_add_u32 s9, s9, s3
    s_add_u32 s9, s9, 50176
    v_and_b32 v182, 7, v3
    v_mul_u32_u24 v182, 1152, v182
    v_lshl_add_u32 v182, v4, 4, v182
    v_mov_b32 v158, 0
    v_mov_b32 v159, 0
    v_mov_b32 v162, 0
    v_mov_b32 v163, 0
    v_mov_b32 v160, v60
    v_mov_b32 v161, v61
    s_waitcnt vmcnt(5)
    v_cmp_ne_u32 vcc, 1, v177
    s_cbranch_vccnz Lrt_63
Lrtd_64:
    s_mov_b32 exec_hi, 3
    buffer_load_dwordx4 v[128:131], v178, s[32:35], s61 offen sc1
    s_add_u32 s61, s61, 139264
    buffer_load_dwordx4 v[132:135], v178, s[32:35], s61 offen sc1
    s_add_u32 s61, s61, 139264
    buffer_load_dwordx4 v[136:139], v178, s[32:35], s61 offen sc1
    s_add_u32 s61, s61, 139264
    buffer_load_dwordx4 v[140:143], v178, s[32:35], s61 offen sc1
    s_mov_b64 exec, -1
    v_mfma_f32_16x16x32_bf16 v[64:67], v[104:107], v[232:235], v[64:67]
    ds_read_b64_tr_b16 v[100:101], v13 offset:53248
    ds_read_b64_tr_b16 v[102:103], v13 offset:53760
    v_mfma_f32_16x16x32_bf16 v[68:71], v[104:107], a[40:43], v[68:71]
    v_mfma_f32_16x16x32_bf16 v[72:75], v[104:107], a[104:107], v[72:75]
    buffer_load_dwordx4 v11, s[12:15], s86 offen offset:2048 lds
    v_mfma_f32_16x16x32_bf16 v[76:79], v[104:107], a[168:171], v[76:79]
    v_mfma_f32_16x16x32_bf16 v[40:43], v[104:107], v[24:27], v[40:43]
    s_waitcnt lgkmcnt(4)
    v_mfma_f32_16x16x32_bf16 v[64:67], v[108:111], v[236:239], v[64:67]
    ds_read_b64_tr_b16 v[104:105], v13 offset:57344
    ds_read_b64_tr_b16 v[106:107], v13 offset:57856
    v_mfma_f32_16x16x32_bf16 v[68:71], v[108:111], a[44:47], v[68:71]
    buffer_load_dwordx4 v12, s[12:15], s86 offen offset:3072 lds
    v_mfma_f32_16x16x32_bf16 v[72:75], v[108:111], a[108:111], v[72:75]
    v_mfma_f32_16x16x32_bf16 v[76:79], v[108:111], a[172:175], v[76:79]
    v_mfma_f32_16x16x32_bf16 v[40:43], v[108:111], v[24:27], v[40:43]
    s_waitcnt lgkmcnt(4)
    v_mfma_f32_16x16x32_bf16 v[64:67], v[96:99], v[240:243], v[64:67]
    s_add_u32 m0, s90, 147456
    s_add_u32 s86, s89, 393216
    ds_read_b64_tr_b16 v[108:109], v13 offset:61440
    v_mfma_f32_16x16x32_bf16 v[68:71], v[96:99], a[48:51], v[68:71]
    buffer_load_dwordx4 v9, s[12:15], s86 offen lds
    v_mfma_f32_16x16x32_bf16 v[72:75], v[96:99], a[112:115], v[72:75]
    ds_read_b64_tr_b16 v[110:111], v13 offset:61952
    v_mfma_f32_16x16x32_bf16 v[76:79], v[96:99], a[176:179], v[76:79]
    v_mfma_f32_16x16x32_bf16 v[40:43], v[96:99], v[24:27], v[40:43]
    s_waitcnt lgkmcnt(4)
    v_mfma_f32_16x16x32_bf16 v[64:67], v[100:103], v[244:247], v[64:67]
    buffer_load_dwordx4 v10, s[12:15], s86 offen offset:1024 lds
    v_mfma_f32_16x16x32_bf16 v[68:71], v[100:103], a[52:55], v[68:71]
    v_mfma_f32_16x16x32_bf16 v[72:75], v[100:103], a[116:119], v[72:75]
    v_mfma_f32_16x16x32_bf16 v[76:79], v[100:103], a[180:183], v[76:79]
    v_mfma_f32_16x16x32_bf16 v[40:43], v[100:103], v[24:27], v[40:43]
    s_waitcnt lgkmcnt(2)
    v_mfma_f32_16x16x32_bf16 v[64:67], v[104:107], v[248:251], v[64:67]
    buffer_load_dwordx4 v11, s[12:15], s86 offen offset:2048 lds
    v_mfma_f32_16x16x32_bf16 v[68:71], v[104:107], a[56:59], v[68:71]
    v_mfma_f32_16x16x32_bf16 v[72:75], v[104:107], a[120:123], v[72:75]
    v_mfma_f32_16x16x32_bf16 v[76:79], v[104:107], a[184:187], v[76:79]
    buffer_load_dwordx4 v12, s[12:15], s86 offen offset:3072 lds
    v_mfma_f32_16x16x32_bf16 v[40:43], v[104:107], v[24:27], v[40:43]
    s_waitcnt lgkmcnt(0)
    v_mfma_f32_16x16x32_bf16 v[64:67], v[108:111], v[252:255], v[64:67]
    v_mov_b32 v28, -1
    v_mov_b32 v29, -1
    v_mfma_f32_16x16x32_bf16 v[68:71], v[108:111], a[60:63], v[68:71]
    v_mov_b32 v30, -1
    v_mov_b32 v31, -1
    v_mfma_f32_16x16x32_bf16 v[72:75], v[108:111], a[124:127], v[72:75]
    s_lshl_b32 s11, s94, 12
    s_add_u32 s11, s11, 11534336
    v_mfma_f32_16x16x32_bf16 v[76:79], v[108:111], a[188:191], v[76:79]
    v_mfma_f32_16x16x32_bf16 v[40:43], v[108:111], v[24:27], v[40:43]
    s_waitcnt vmcnt(8)
    v_pk_add_f32 v[128:129], v[128:129], v[132:133]
    s_waitcnt vmcnt(6)
    v_pk_add_f32 v[136:137], v[136:137], v[140:141]
    v_pk_add_f32 v[130:131], v[130:131], v[134:135]
    v_pk_add_f32 v[138:139], v[138:139], v[142:143]
    v_pk_add_f32 v[128:129], v[128:129], v[136:137]
    v_pk_add_f32 v[130:131], v[130:131], v[138:139]
    v_cvt_pk_bf16_f32 v144, v128, v129
    v_cvt_pk_bf16_f32 v145, v130, v131
    s_mov_b32 exec_hi, 3
    buffer_store_dwordx2 v[144:145], v179, s[32:35], s92 offen sc1
    s_mov_b64 exec, -1
    buffer_store_dwordx4 v[28:31], v1, s[32:35], s11 offen offset:0 sc1
    buffer_store_dwordx4 v[28:31], v1, s[32:35], s11 offen offset:1024 sc1
    buffer_store_dwordx4 v[28:31], v1, s[32:35], s11 offen offset:2048 sc1
    buffer_store_dwordx4 v[28:31], v1, s[32:35], s11 offen offset:3072 sc1
    s_waitcnt vmcnt(5)
    s_barrier
    v_pk_fma_f32 v[64:65], v[40:41], v[52:53], v[64:65] op_sel_hi:[1,0,1]
    v_pk_fma_f32 v[66:67], v[42:43], v[52:53], v[66:67] op_sel_hi:[1,0,1]
    v_pk_fma_f32 v[68:69], v[40:41], v[54:55], v[68:69] op_sel_hi:[1,0,1]
    v_pk_fma_f32 v[70:71], v[42:43], v[54:55], v[70:71] op_sel_hi:[1,0,1]
    v_pk_fma_f32 v[72:73], v[40:41], v[56:57], v[72:73] op_sel_hi:[1,0,1]
    v_pk_fma_f32 v[74:75], v[42:43], v[56:57], v[74:75] op_sel_hi:[1,0,1]
    v_pk_fma_f32 v[76:77], v[40:41], v[58:59], v[76:77] op_sel_hi:[1,0,1]
    v_pk_fma_f32 v[78:79], v[42:43], v[58:59], v[78:79] op_sel_hi:[1,0,1]
    v_pk_mul_f32 v[64:65], v[64:65], v[52:53] op_sel:[0,1] op_sel_hi:[1,1]
    v_pk_mul_f32 v[66:67], v[66:67], v[52:53] op_sel:[0,1] op_sel_hi:[1,1]
    v_pk_mul_f32 v[68:69], v[68:69], v[54:55] op_sel:[0,1] op_sel_hi:[1,1]
    v_pk_mul_f32 v[70:71], v[70:71], v[54:55] op_sel:[0,1] op_sel_hi:[1,1]
    v_pk_mul_f32 v[72:73], v[72:73], v[56:57] op_sel:[0,1] op_sel_hi:[1,1]
    v_lshrrev_b32 v36, 3, v0
    v_lshlrev_b32 v37, 1, v4
    v_xor_b32 v37, v37, v0
    v_and_b32 v37, 7, v37
    v_mul_u32_u24 v36, 3584, v36
    v_lshl_add_u32 v9, v37, 4, v36
    v_add_u32 v10, 27648, v9
    v_add_u32 v11, 55296, v9
    v_add_u32 v12, 82944, v9
    s_lshl_b32 s89, s51, 7
    s_add_u32 s89, s89, 1792
    s_cmp_ge_u32 s51, 14
    s_cselect_b32 s89, 0x10000000, s89
    s_mul_i32 s93, s54, 114688
    s_add_u32 s89, s89, s93
    s_add_u32 m0, s90, 32768
    s_add_u32 s86, s89, 0
    v_pk_mul_f32 v[74:75], v[74:75], v[56:57] op_sel:[0,1] op_sel_hi:[1,1]
    v_pk_mul_f32 v[76:77], v[76:77], v[58:59] op_sel:[0,1] op_sel_hi:[1,1]
    v_pk_mul_f32 v[78:79], v[78:79], v[58:59] op_sel:[0,1] op_sel_hi:[1,1]
    v_cvt_pk_bf16_f32 v112, v64, v65
    buffer_load_dwordx4 v9, s[16:19], s86 offen lds
    v_cvt_pk_bf16_f32 v113, v66, v67
    v_cvt_pk_bf16_f32 v114, v68, v69
    v_cvt_pk_bf16_f32 v115, v70, v71
    v_cvt_pk_bf16_f32 v116, v72, v73
    v_cvt_pk_bf16_f32 v117, v74, v75
    v_cvt_pk_bf16_f32 v118, v76, v77
    v_cvt_pk_bf16_f32 v119, v78, v79
    v_mfma_f32_16x16x16_bf16 v[64:67], v[62:63], v[112:113], 0
    v_mfma_f32_16x16x16_bf16 v[68:71], v[62:63], v[114:115], 0
    v_mfma_f32_16x16x16_bf16 v[72:75], v[62:63], v[116:117], 0
    v_mfma_f32_16x16x16_bf16 v[76:79], v[62:63], v[118:119], 0
    s_nop 4
    v_max3_f32 v120, v64, v65, v66
    v_max3_f32 v121, -v64, -v65, -v66
    buffer_load_dwordx4 v10, s[16:19], s86 offen offset:1024 lds
    v_max3_f32 v122, v68, v69, v70
    v_max3_f32 v123, -v68, -v69, -v70
    v_max3_f32 v124, v72, v73, v74
    v_max3_f32 v125, -v72, -v73, -v74
    v_max3_f32 v126, v76, v77, v78
    v_max3_f32 v127, -v76, -v77, -v78
    v_max_f32 v120, v120, v67
    v_max_f32_e64 v121, v121, -v67
    v_max_f32 v122, v122, v71
    v_max_f32_e64 v123, v123, -v71
    v_max_f32 v124, v124, v75
    v_max_f32_e64 v125, v125, -v75
    v_max_f32 v126, v126, v79
    v_max_f32_e64 v127, v127, -v79
    v_permlane32_swap_b32 v120, v121
    v_permlane32_swap_b32 v122, v123
    buffer_load_dwordx4 v11, s[16:19], s86 offen offset:2048 lds
    v_permlane32_swap_b32 v124, v125
    v_permlane32_swap_b32 v126, v127
    v_max_f32 v120, v120, v121
    v_max_f32 v122, v122, v123
    v_max_f32 v124, v124, v125
    v_max_f32 v126, v126, v127
    v_permlane16_swap_b32 v120, v122
    s_nop 0
    v_permlane16_swap_b32 v124, v126
    v_max_f32 v120, v120, v122
    v_max_f32 v124, v124, v126
    v_mul_f32 v120, s80, v120
    v_mul_f32 v124, s80, v124
    buffer_load_dwordx4 v12, s[16:19], s86 offen offset:3072 lds
    v_mov_b32 v122, v120
    v_mov_b32 v126, v124
    s_nop 0
    v_permlane16_swap_b32 v120, v122
    v_permlane16_swap_b32 v124, v126
    v_mov_b32 v121, v120
    v_mov_b32 v123, v122
    v_mov_b32 v125, v124
    v_mov_b32 v127, v126
    v_permlane32_swap_b32 v120, v121
    v_permlane32_swap_b32 v122, v123
    s_xor_b32 s93, s87, 0
    s_add_u32 m0, s88, 0
    s_add_u32 s86, s93, s79
    v_permlane32_swap_b32 v124, v125
    v_permlane32_swap_b32 v126, v127
    buffer_load_dwordx4 v5, s[20:23], s86 offen lds
    v_pk_fma_f32 v[80:81], v[64:65], s[80:81], v[120:121] op_sel_hi:[1,1,0] neg_lo:[0,0,1] neg_hi:[0,0,1]
    v_pk_fma_f32 v[82:83], v[66:67], s[80:81], v[120:121] op_sel_hi:[1,1,0] neg_lo:[0,0,1] neg_hi:[0,0,1]
    v_pk_fma_f32 v[64:65], v[64:65], s[80:81], v[120:121] op_sel:[0,0,1] op_sel_hi:[1,1,1] neg_lo:[1,0,1] neg_hi:[1,0,1]
    v_pk_fma_f32 v[66:67], v[66:67], s[80:81], v[120:121] op_sel:[0,0,1] op_sel_hi:[1,1,1] neg_lo:[1,0,1] neg_hi:[1,0,1]
    v_pk_fma_f32 v[84:85], v[68:69], s[80:81], v[122:123] op_sel_hi:[1,1,0] neg_lo:[0,0,1] neg_hi:[0,0,1]
    v_pk_fma_f32 v[86:87], v[70:71], s[80:81], v[122:123] op_sel_hi:[1,1,0] neg_lo:[0,0,1] neg_hi:[0,0,1]
    v_pk_fma_f32 v[68:69], v[68:69], s[80:81], v[122:123] op_sel:[0,0,1] op_sel_hi:[1,1,1] neg_lo:[1,0,1] neg_hi:[1,0,1]
    v_pk_fma_f32 v[70:71], v[70:71], s[80:81], v[122:123] op_sel:[0,0,1] op_sel_hi:[1,1,1] neg_lo:[1,0,1] neg_hi:[1,0,1]
    v_pk_fma_f32 v[88:89], v[72:73], s[80:81], v[124:125] op_sel_hi:[1,1,0] neg_lo:[0,0,1] neg_hi:[0,0,1]
    v_pk_fma_f32 v[90:91], v[74:75], s[80:81], v[124:125] op_sel_hi:[1,1,0] neg_lo:[0,0,1] neg_hi:[0,0,1]
    v_pk_fma_f32 v[72:73], v[72:73], s[80:81], v[124:125] op_sel:[0,0,1] op_sel_hi:[1,1,1] neg_lo:[1,0,1] neg_hi:[1,0,1]
    v_pk_fma_f32 v[74:75], v[74:75], s[80:81], v[124:125] op_sel:[0,0,1] op_sel_hi:[1,1,1] neg_lo:[1,0,1] neg_hi:[1,0,1]
    v_pk_fma_f32 v[92:93], v[76:77], s[80:81], v[126:127] op_sel_hi:[1,1,0] neg_lo:[0,0,1] neg_hi:[0,0,1]
    v_pk_fma_f32 v[94:95], v[78:79], s[80:81], v[126:127] op_sel_hi:[1,1,0] neg_lo:[0,0,1] neg_hi:[0,0,1]
    v_pk_fma_f32 v[76:77], v[76:77], s[80:81], v[126:127] op_sel:[0,0,1] op_sel_hi:[1,1,1] neg_lo:[1,0,1] neg_hi:[1,0,1]
    v_pk_fma_f32 v[78:79], v[78:79], s[80:81], v[126:127] op_sel:[0,0,1] op_sel_hi:[1,1,1] neg_lo:[1,0,1] neg_hi:[1,0,1]
    buffer_load_dwordx4 v6, s[20:23], s86 offen offset:1024 lds
    v_exp_f32 v80, v80
    v_exp_f32 v64, v64
    v_exp_f32 v81, v81
    v_exp_f32 v65, v65
    v_exp_f32 v82, v82
    v_exp_f32 v66, v66
    v_exp_f32 v83, v83
    v_exp_f32 v67, v67
    v_exp_f32 v84, v84
    buffer_load_dwordx4 v7, s[20:23], s86 offen offset:2048 lds
    v_exp_f32 v68, v68
    v_exp_f32 v85, v85
    v_exp_f32 v69, v69
    v_exp_f32 v86, v86
    v_exp_f32 v70, v70
    v_exp_f32 v87, v87
    v_exp_f32 v71, v71
    v_exp_f32 v88, v88
    buffer_load_dwordx4 v8, s[20:23], s86 offen offset:3072 lds
    v_exp_f32 v72, v72
    v_exp_f32 v89, v89
    v_exp_f32 v73, v73
    v_exp_f32 v90, v90
    v_exp_f32 v74, v74
    v_exp_f32 v91, v91
    v_exp_f32 v75, v75
    v_exp_f32 v92, v92
    v_exp_f32 v76, v76
    v_exp_f32 v93, v93
    v_exp_f32 v77, v77
    v_exp_f32 v94, v94
    v_exp_f32 v78, v78
    v_exp_f32 v95, v95
    v_exp_f32 v79, v79
    v_pk_add_f32 v[224:225], v[80:81], v[82:83]
    v_pk_add_f32 v[226:227], v[64:65], v[66:67]
    v_pk_add_f32 v[228:229], v[84:85], v[86:87]
    v_pk_add_f32 v[230:231], v[68:69], v[70:71]
    v_pk_add_f32 v[232:233], v[88:89], v[90:91]
    v_pk_add_f32 v[234:235], v[72:73], v[74:75]
    v_pk_add_f32 v[236:237], v[92:93], v[94:95]
    v_pk_add_f32 v[238:239], v[76:77], v[78:79]
    buffer_load_dwordx4 v[188:191], v182, s[32:35], s62 offen offset:1024 sc1
    s_add_u32 s91, s62, 3456
    s_add_u32 s92, s62, 6912
    v_add_f32 v120, v224, v225
    v_add_f32 v121, v226, v227
    v_add_f32 v122, v228, v229
    v_add_f32 v123, v230, v231
    v_add_f32 v124, v232, v233
    v_add_f32 v125, v234, v235
    v_add_f32 v126, v236, v237
    v_add_f32 v127, v238, v239
    buffer_load_dwordx4 v[192:195], v1, s[32:35], s62 offen offset:0 sc1
    v_permlane32_swap_b32 v120, v121
    v_permlane32_swap_b32 v122, v123
    v_permlane32_swap_b32 v124, v125
    v_permlane32_swap_b32 v126, v127
    buffer_load_dwordx4 v[196:199], v1, s[32:35], s62 offen offset:1152 sc1
    v_add_f32 v120, v120, v121
    v_add_f32 v122, v122, v123
    v_add_f32 v124, v124, v125
    v_add_f32 v126, v126, v127
    v_permlane16_swap_b32 v120, v122
    s_nop 0
    v_permlane16_swap_b32 v124, v126
    buffer_load_dwordx4 v[200:203], v1, s[32:35], s62 offen offset:2304 sc1
    v_add_f32 v120, v120, v122
    v_add_f32 v124, v124, v126
    v_rcp_f32 v120, v120
    v_rcp_f32 v124, v124
    v_mov_b32 v122, v120
    v_mov_b32 v126, v124
    buffer_load_dwordx4 v[204:207], v1, s[32:35], s91 offen offset:0 sc1
    v_permlane16_swap_b32 v120, v122
    v_permlane16_swap_b32 v124, v126
    v_mov_b32 v121, v120
    v_mov_b32 v123, v122
    v_mov_b32 v125, v124
    v_mov_b32 v127, v126
    buffer_load_dwordx4 v[208:211], v1, s[32:35], s91 offen offset:1152 sc1
    v_permlane32_swap_b32 v120, v121
    v_permlane32_swap_b32 v122, v123
    v_permlane32_swap_b32 v124, v125
    v_permlane32_swap_b32 v126, v127
    buffer_load_dwordx4 v[212:215], v1, s[32:35], s91 offen offset:2304 sc1
    v_pk_mul_f32 v[80:81], v[80:81], v[120:121] op_sel_hi:[1,0]
    v_pk_mul_f32 v[64:65], v[64:65], v[120:121] op_sel:[0,1] op_sel_hi:[1,1]
    v_pk_mul_f32 v[82:83], v[82:83], v[120:121] op_sel_hi:[1,0]
    v_pk_mul_f32 v[66:67], v[66:67], v[120:121] op_sel:[0,1] op_sel_hi:[1,1]
    v_pk_mul_f32 v[84:85], v[84:85], v[122:123] op_sel_hi:[1,0]
    v_pk_mul_f32 v[68:69], v[68:69], v[122:123] op_sel:[0,1] op_sel_hi:[1,1]
    v_pk_mul_f32 v[86:87], v[86:87], v[122:123] op_sel_hi:[1,0]
    v_pk_mul_f32 v[70:71], v[70:71], v[122:123] op_sel:[0,1] op_sel_hi:[1,1]
    buffer_load_dwordx4 v[216:219], v1, s[32:35], s92 offen offset:0 sc1
    v_pk_mul_f32 v[88:89], v[88:89], v[124:125] op_sel_hi:[1,0]
    v_pk_mul_f32 v[72:73], v[72:73], v[124:125] op_sel:[0,1] op_sel_hi:[1,1]
    v_pk_mul_f32 v[90:91], v[90:91], v[124:125] op_sel_hi:[1,0]
    v_pk_mul_f32 v[74:75], v[74:75], v[124:125] op_sel:[0,1] op_sel_hi:[1,1]
    v_pk_mul_f32 v[92:93], v[92:93], v[126:127] op_sel_hi:[1,0]
    v_pk_mul_f32 v[76:77], v[76:77], v[126:127] op_sel:[0,1] op_sel_hi:[1,1]
    v_pk_mul_f32 v[94:95], v[94:95], v[126:127] op_sel_hi:[1,0]
    v_pk_mul_f32 v[78:79], v[78:79], v[126:127] op_sel:[0,1] op_sel_hi:[1,1]
    buffer_load_dwordx4 v[220:223], v1, s[32:35], s92 offen offset:1152 sc1
    v_cvt_pk_bf16_f32 v96, v80, v81
    v_cvt_pk_bf16_f32 v98, v64, v65
    v_cvt_pk_bf16_f32 v97, v82, v83
    v_cvt_pk_bf16_f32 v99, v66, v67
    v_cvt_pk_bf16_f32 v100, v84, v85
    v_cvt_pk_bf16_f32 v102, v68, v69
    v_cvt_pk_bf16_f32 v101, v86, v87
    v_cvt_pk_bf16_f32 v103, v70, v71
    v_cvt_pk_bf16_f32 v104, v88, v89
    v_cvt_pk_bf16_f32 v106, v72, v73
    v_cvt_pk_bf16_f32 v105, v90, v91
    v_cvt_pk_bf16_f32 v107, v74, v75
    v_cvt_pk_bf16_f32 v108, v92, v93
    v_cvt_pk_bf16_f32 v110, v76, v77
    v_cvt_pk_bf16_f32 v109, v94, v95
    v_cvt_pk_bf16_f32 v111, v78, v79
    s_add_u32 m0, s90, 49152
    s_add_u32 s86, s89, 458752
    buffer_load_dwordx4 v9, s[16:19], s86 offen lds
    buffer_load_dwordx4 v10, s[16:19], s86 offen offset:1024 lds
    buffer_load_dwordx4 v11, s[16:19], s86 offen offset:2048 lds
    buffer_load_dwordx4 v12, s[16:19], s86 offen offset:3072 lds
    s_add_u32 m0, s90, 65536
    s_add_u32 s86, s89, 917504
    buffer_load_dwordx4 v9, s[16:19], s86 offen lds
    buffer_load_dwordx4 v10, s[16:19], s86 offen offset:1024 lds
    buffer_load_dwordx4 v11, s[16:19], s86 offen offset:2048 lds
    buffer_load_dwordx4 v12, s[16:19], s86 offen offset:3072 lds
    s_waitcnt vmcnt(16)
    v_mfma_f32_16x16x32_bf16 v[80:83], v[188:191], v[96:99], 0
    v_max_u32 v17, v188, v189
    v_mfma_f32_16x16x32_bf16 v[84:87], v[188:191], v[100:103], 0
    v_max3_u32 v17, v17, v190, v191
    v_mfma_f32_16x16x32_bf16 v[88:91], v[188:191], v[104:107], 0
    v_mfma_f32_16x16x32_bf16 v[92:95], v[188:191], v[108:111], 0
    s_waitcnt vmcnt(15)
    v_mfma_f32_16x16x32_bf16 v[164:167], v[160:163], v[192:195], 0
    v_max3_u32 v17, v17, v192, v193
    v_mfma_f32_16x16x32_bf16 v[168:171], v[158:161], v[192:195], 0
    v_max3_u32 v17, v17, v194, v195
    s_waitcnt vmcnt(14)
    v_mfma_f32_16x16x32_bf16 v[164:167], v[160:163], v[196:199], v[164:167]
    v_max3_u32 v17, v17, v196, v197
    v_mfma_f32_16x16x32_bf16 v[168:171], v[158:161], v[196:199], v[168:171]
    v_max3_u32 v17, v17, v198, v199
    s_waitcnt vmcnt(13)
    v_mfma_f32_16x16x32_bf16 v[164:167], v[160:163], v[200:203], v[164:167]
    v_max3_u32 v17, v17, v200, v201
    v_add_f32 v80, v80, v81
    v_mfma_f32_16x16x32_bf16 v[168:171], v[158:161], v[200:203], v[168:171]
    v_max3_u32 v17, v17, v202, v203
    v_add_f32 v82, v82, v83
    s_waitcnt vmcnt(12)
    v_mfma_f32_16x16x32_bf16 v[164:167], v[160:163], v[204:207], v[164:167]
    v_max3_u32 v17, v17, v204, v205
    v_add_f32 v84, v84, v85
    v_mfma_f32_16x16x32_bf16 v[168:171], v[158:161], v[204:207], v[168:171]
    v_max3_u32 v17, v17, v206, v207
    v_add_f32 v86, v86, v87
    s_waitcnt vmcnt(11)
    v_mfma_f32_16x16x32_bf16 v[164:167], v[160:163], v[208:211], v[164:167]
    v_max3_u32 v17, v17, v208, v209
    v_add_f32 v88, v88, v89
    v_mfma_f32_16x16x32_bf16 v[168:171], v[158:161], v[208:211], v[168:171]
    v_max3_u32 v17, v17, v210, v211
    v_add_f32 v90, v90, v91
    s_waitcnt vmcnt(10)
    v_mfma_f32_16x16x32_bf16 v[164:167], v[160:163], v[212:215], v[164:167]
    v_max3_u32 v17, v17, v212, v213
    v_add_f32 v92, v92, v93
    v_mfma_f32_16x16x32_bf16 v[168:171], v[158:161], v[212:215], v[168:171]
    v_max3_u32 v17, v17, v214, v215
    v_add_f32 v94, v94, v95
    s_waitcnt vmcnt(9)
    v_mfma_f32_16x16x32_bf16 v[164:167], v[160:163], v[216:219], v[164:167]
    v_max3_u32 v17, v17, v216, v217
    v_add_f32 v80, v80, v82
    v_mfma_f32_16x16x32_bf16 v[168:171], v[158:161], v[216:219], v[168:171]
    v_max3_u32 v17, v17, v218, v219
    v_add_f32 v84, v84, v86
    s_waitcnt vmcnt(8)
    v_mfma_f32_16x16x32_bf16 v[164:167], v[160:163], v[220:223], v[164:167]
    v_max3_u32 v17, v17, v220, v221
    v_add_f32 v88, v88, v90
    v_mfma_f32_16x16x32_bf16 v[168:171], v[158:161], v[220:223], v[168:171]
    v_max3_u32 v17, v17, v222, v223
    v_add_f32 v92, v92, v94
    v_cmp_eq_u32 vcc, -1, v17
    s_cbranch_vccnz Lrt_66
Lrtd_67:
    v_mov_b32 v81, v80
    v_mov_b32 v85, v84
    v_mov_b32 v89, v88
    v_mov_b32 v93, v92
    v_permlane16_swap_b32 v80, v81
    v_permlane16_swap_b32 v84, v85
    v_cvt_pk_bf16_f32 v172, v164, v165
    v_cvt_pk_bf16_f32 v173, v166, v167
    v_cvt_pk_bf16_f32 v174, v168, v169
    v_cvt_pk_bf16_f32 v175, v170, v171
    v_permlane16_swap_b32 v88, v89
    v_permlane16_swap_b32 v92, v93
    v_mfma_f32_16x16x32_bf16 v[64:67], v[172:175], v[96:99], 0
    v_add_f32 v80, v80, v81
    v_add_f32 v80, 0x358637bd, v80
    v_mfma_f32_16x16x32_bf16 v[68:71], v[172:175], v[100:103], 0
    v_add_f32 v84, v84, v85
    v_add_f32 v84, 0x358637bd, v84
    v_mfma_f32_16x16x32_bf16 v[72:75], v[172:175], v[104:107], 0
    v_add_f32 v88, v88, v89
    v_add_f32 v88, 0x358637bd, v88
    v_mfma_f32_16x16x32_bf16 v[76:79], v[172:175], v[108:111], 0
    v_add_f32 v92, v92, v93
    v_add_f32 v92, 0x358637bd, v92
    v_rcp_f32 v80, v80
    v_rcp_f32 v84, v84
    v_rcp_f32 v88, v88
    v_rcp_f32 v92, v92
    v_pk_mul_f32 v[64:65], v[64:65], v[80:81] op_sel_hi:[1,0]
    v_pk_mul_f32 v[66:67], v[66:67], v[80:81] op_sel_hi:[1,0]
    v_cvt_pk_bf16_f32 v112, v64, v65
    v_cvt_pk_bf16_f32 v113, v66, v67
    buffer_store_dwordx2 v[112:113], v1, s[32:35], s36 offen sc1
    v_pk_mul_f32 v[68:69], v[68:69], v[84:85] op_sel_hi:[1,0]
    v_pk_mul_f32 v[70:71], v[70:71], v[84:85] op_sel_hi:[1,0]
    v_cvt_pk_bf16_f32 v114, v68, v69
    v_cvt_pk_bf16_f32 v115, v70, v71
    buffer_store_dwordx2 v[114:115], v1, s[32:35], s37 offen sc1
    v_pk_mul_f32 v[72:73], v[72:73], v[88:89] op_sel_hi:[1,0]
    v_pk_mul_f32 v[74:75], v[74:75], v[88:89] op_sel_hi:[1,0]
    v_cvt_pk_bf16_f32 v116, v72, v73
    v_cvt_pk_bf16_f32 v117, v74, v75
    buffer_store_dwordx2 v[116:117], v1, s[32:35], s38 offen sc1
    v_pk_mul_f32 v[76:77], v[76:77], v[92:93] op_sel_hi:[1,0]
    v_pk_mul_f32 v[78:79], v[78:79], v[92:93] op_sel_hi:[1,0]
    v_cvt_pk_bf16_f32 v118, v76, v77
    v_cvt_pk_bf16_f32 v119, v78, v79
    buffer_store_dwordx2 v[118:119], v1, s[32:35], s39 offen sc1
    v_lshrrev_b32 v17, 2, v0
    v_and_b32 v18, 3, v0
    v_lshlrev_b32 v18, 3, v18
    v_lshl_add_u32 v18, v17, 7, v18
    v_bfe_u32 v17, v17, 1, 2
    v_lshl_add_u32 v18, v17, 5, v18
    v_add_u32 v13, 98304, v18
    v_xor_b32 v14, 32, v13
    v_xor_b32 v15, 64, v13
    v_xor_b32 v16, 96, v13
    v_and_b32 v38, 31, v0
    v_lshl_add_u32 v38, v38, 2, s4
    v_mov_b32 v24, v48
    v_mov_b32 v25, v49
    v_mov_b32 v26, v50
    v_mov_b32 v27, v51
    v_lshlrev_b32 v40, 16, v32
    v_and_b32 v41, 0xffff0000, v32
    v_lshlrev_b32 v42, 16, v33
    v_and_b32 v43, 0xffff0000, v33
    v_lshlrev_b32 v44, 16, v34
    v_and_b32 v45, 0xffff0000, v34
    v_lshlrev_b32 v46, 16, v35
    v_and_b32 v47, 0xffff0000, v35
    v_lshlrev_b32 v48, 16, v24
    v_and_b32 v49, 0xffff0000, v24
    v_lshlrev_b32 v50, 16, v25
    v_and_b32 v51, 0xffff0000, v25
    v_lshlrev_b32 v52, 16, v26
    v_and_b32 v53, 0xffff0000, v26
    v_lshlrev_b32 v54, 16, v27
    v_and_b32 v55, 0xffff0000, v27
    s_mov_b64 exec, 2
    s_waitcnt vmcnt(0)
    buffer_store_dword v0, off, s[32:35], s5 offset:0 sc1
    s_mov_b64 exec, -1
    s_xor_b32 s93, s87, 131072
    s_add_u32 m0, s88, 4096
    s_add_u32 s86, s93, s79
    buffer_load_dwordx4 v5, s[20:23], s86 offen lds
    buffer_load_dwordx4 v6, s[20:23], s86 offen offset:1024 lds
    buffer_load_dwordx4 v7, s[20:23], s86 offen offset:2048 lds
    buffer_load_dwordx4 v8, s[20:23], s86 offen offset:3072 lds
    v_lshrrev_b32 v37, 2, v3
    v_lshlrev_b32 v37, 3, v37
    v_and_or_b32 v37, v3, 3, v37
    s_lshr_b32 s62, s58, 1
    s_lshl_b32 s62, s62, 5
    s_and_b32 s63, s58, 1
    s_lshl_b32 s63, s63, 2
    s_add_u32 s62, s62, s63
    v_add_u32 v36, s62, v37
    v_lshlrev_b32 v36, 1, v36
    buffer_load_ushort v34, v36, s[40:43], 0 offen
    ds_read_b128 a[192:195], v20 offset:0
    ds_read_b128 a[196:199], v22 offset:0
    ds_read_b128 a[224:227], v21 offset:0
    ds_read_b128 a[228:231], v23 offset:0
    s_waitcnt lgkmcnt(0)
    s_xor_b32 s93, s87, 1048576
    s_add_u32 m0, s88, 0
    s_add_u32 s86, s93, s79
    buffer_load_dwordx4 v5, s[20:23], s86 offen lds
    buffer_load_dwordx4 v6, s[20:23], s86 offen offset:1024 lds
    buffer_load_dwordx4 v7, s[20:23], s86 offen offset:2048 lds
    buffer_load_dwordx4 v8, s[20:23], s86 offen offset:3072 lds
    ds_read_b64_tr_b16 v[128:129], v13 offset:0
    ds_read_b64_tr_b16 v[130:131], v13 offset:2048
    ds_read_b64_tr_b16 v[132:133], v14 offset:0
    ds_read_b64_tr_b16 v[134:135], v14 offset:2048
    ds_read_b64_tr_b16 v[136:137], v13 offset:4096
    ds_read_b64_tr_b16 v[138:139], v13 offset:6144
    ds_read_b64_tr_b16 v[140:141], v14 offset:4096
    ds_read_b64_tr_b16 v[142:143], v14 offset:6144
    s_mov_b32 s59, s0
    buffer_load_dword v39, v38, s[32:35], 0 offen sc1
    s_waitcnt vmcnt(6)
    ds_read_b128 a[200:203], v20 offset:4096
    ds_read_b128 a[204:207], v22 offset:4096
    ds_read_b128 a[232:235], v21 offset:4096
    ds_read_b128 a[236:239], v23 offset:4096
    s_waitcnt lgkmcnt(0)
    s_xor_b32 s93, s87, 1179648
    s_add_u32 m0, s88, 4096
    s_add_u32 s86, s93, s79
    buffer_load_dwordx4 v5, s[20:23], s86 offen lds
    buffer_load_dwordx4 v6, s[20:23], s86 offen offset:1024 lds
    buffer_load_dwordx4 v7, s[20:23], s86 offen offset:2048 lds
    buffer_load_dwordx4 v8, s[20:23], s86 offen offset:3072 lds
    ds_read_b64_tr_b16 v[144:145], v13 offset:8192
    ds_read_b64_tr_b16 v[146:147], v13 offset:10240
    ds_read_b64_tr_b16 v[148:149], v14 offset:8192
    ds_read_b64_tr_b16 v[150:151], v14 offset:10240
    ds_read_b64_tr_b16 v[152:153], v13 offset:12288
    ds_read_b64_tr_b16 v[154:155], v13 offset:14336
    ds_read_b64_tr_b16 v[156:157], v14 offset:12288
    ds_read_b64_tr_b16 v[158:159], v14 offset:14336
    ds_read_b64_tr_b16 v[160:161], v13 offset:16384
    ds_read_b64_tr_b16 v[162:163], v13 offset:18432
    ds_read_b64_tr_b16 v[164:165], v14 offset:16384
    ds_read_b64_tr_b16 v[166:167], v14 offset:18432
    ds_read_b64_tr_b16 v[168:169], v13 offset:20480
    ds_read_b64_tr_b16 v[170:171], v13 offset:22528
    ds_read_b64_tr_b16 v[172:173], v14 offset:20480
    ds_read_b64_tr_b16 v[174:175], v14 offset:22528
    ds_read_b64_tr_b16 v[176:177], v13 offset:24576
    ds_read_b64_tr_b16 v[178:179], v13 offset:26624
    ds_read_b64_tr_b16 v[180:181], v14 offset:24576
    ds_read_b64_tr_b16 v[182:183], v14 offset:26624
    ds_read_b64_tr_b16 v[184:185], v13 offset:28672
    ds_read_b64_tr_b16 v[186:187], v13 offset:30720
    ds_read_b64_tr_b16 v[188:189], v14 offset:28672
    ds_read_b64_tr_b16 v[190:191], v14 offset:30720
    s_waitcnt vmcnt(4)
    v_cmp_ne_u32 vcc, 1, v39
    s_cbranch_vccnz Lrt_69
Lrtd_70:
    buffer_load_dwordx4 v[80:83], v1, s[32:35], s59 offen offset:0 sc1
    buffer_load_dwordx4 v[84:87], v1, s[32:35], s59 offen offset:1024 sc1
    buffer_load_dwordx4 v[88:91], v1, s[32:35], s59 offen offset:2048 sc1
    buffer_load_dwordx4 v[92:95], v1, s[32:35], s59 offen offset:3072 sc1
    s_add_u32 s59, s59, 4096
    buffer_load_dwordx4 v[96:99], v1, s[32:35], s59 offen offset:0 sc1
    buffer_load_dwordx4 v[100:103], v1, s[32:35], s59 offen offset:1024 sc1
    buffer_load_dwordx4 v[104:107], v1, s[32:35], s59 offen offset:2048 sc1
    buffer_load_dwordx4 v[108:111], v1, s[32:35], s59 offen offset:3072 sc1
    ds_read_b64_tr_b16 v[192:193], v13 offset:32768
    ds_read_b64_tr_b16 v[194:195], v13 offset:34816
    ds_read_b64_tr_b16 v[196:197], v14 offset:32768
    ds_read_b64_tr_b16 v[198:199], v14 offset:34816
    ds_read_b64_tr_b16 v[200:201], v13 offset:36864
    ds_read_b64_tr_b16 v[202:203], v13 offset:38912
    ds_read_b64_tr_b16 v[204:205], v14 offset:36864
    ds_read_b64_tr_b16 v[206:207], v14 offset:38912
    ds_read_b64_tr_b16 v[208:209], v13 offset:40960
    ds_read_b64_tr_b16 v[210:211], v13 offset:43008
    ds_read_b64_tr_b16 v[212:213], v14 offset:40960
    ds_read_b64_tr_b16 v[214:215], v14 offset:43008
    ds_read_b64_tr_b16 v[216:217], v13 offset:45056
    ds_read_b64_tr_b16 v[218:219], v13 offset:47104
    ds_read_b64_tr_b16 v[220:221], v14 offset:45056
    ds_read_b64_tr_b16 v[222:223], v14 offset:47104
    ds_read_b64_tr_b16 v[224:225], v13 offset:49152
    ds_read_b64_tr_b16 v[226:227], v13 offset:51200
    ds_read_b64_tr_b16 v[228:229], v14 offset:49152
    ds_read_b64_tr_b16 v[230:231], v14 offset:51200
    ds_read_b64_tr_b16 v[232:233], v13 offset:53248
    ds_read_b64_tr_b16 v[234:235], v13 offset:55296
    ds_read_b64_tr_b16 v[236:237], v14 offset:53248
    ds_read_b64_tr_b16 v[238:239], v14 offset:55296
    ds_read_b64_tr_b16 v[240:241], v13 offset:57344
    ds_read_b64_tr_b16 v[242:243], v13 offset:59392
    ds_read_b64_tr_b16 v[244:245], v14 offset:57344
    ds_read_b64_tr_b16 v[246:247], v14 offset:59392
    ds_read_b64_tr_b16 v[248:249], v13 offset:61440
    ds_read_b64_tr_b16 v[250:251], v13 offset:63488
    ds_read_b64_tr_b16 v[252:253], v14 offset:61440
    ds_read_b64_tr_b16 v[254:255], v14 offset:63488
    ds_read_b64_tr_b16 v[56:57], v15 offset:0
    ds_read_b64_tr_b16 v[58:59], v15 offset:2048
    ds_read_b64_tr_b16 v[60:61], v16 offset:0
    ds_read_b64_tr_b16 v[62:63], v16 offset:2048
    ds_read_b64_tr_b16 v[64:65], v15 offset:4096
    ds_read_b64_tr_b16 v[66:67], v15 offset:6144
    ds_read_b64_tr_b16 v[68:69], v16 offset:4096
    ds_read_b64_tr_b16 v[70:71], v16 offset:6144
    ds_read_b64_tr_b16 v[72:73], v15 offset:8192
    ds_read_b64_tr_b16 v[74:75], v15 offset:10240
    s_waitcnt vmcnt(7) lgkmcnt(6)
    v_mfma_f32_16x16x32_bf16 v[48:51], v[56:59], v[80:83], v[48:51]
    s_add_u32 s59, s59, 4096
    ds_read_b64_tr_b16 v[76:77], v16 offset:8192
    ds_read_b64_tr_b16 v[78:79], v16 offset:10240
    v_mfma_f32_16x16x32_bf16 v[52:55], v[60:63], v[80:83], v[52:55]
    buffer_load_dwordx4 v[112:115], v1, s[32:35], s59 offen offset:0 sc1
    v_mfma_f32_16x16x32_bf16 v[40:43], v[128:131], v[80:83], v[40:43]
    ds_read_b64_tr_b16 v[56:57], v15 offset:12288
    ds_read_b64_tr_b16 v[58:59], v15 offset:14336
    v_mfma_f32_16x16x32_bf16 v[44:47], v[132:135], v[80:83], v[44:47]
    s_waitcnt vmcnt(7) lgkmcnt(6)
    v_mfma_f32_16x16x32_bf16 v[48:51], v[64:67], v[84:87], v[48:51]
    buffer_load_dwordx4 v[116:119], v1, s[32:35], s59 offen offset:1024 sc1
    v_mfma_f32_16x16x32_bf16 v[52:55], v[68:71], v[84:87], v[52:55]
    ds_read_b64_tr_b16 v[60:61], v16 offset:12288
    ds_read_b64_tr_b16 v[62:63], v16 offset:14336
    v_mfma_f32_16x16x32_bf16 v[40:43], v[136:139], v[84:87], v[40:43]
    ds_read_b64_tr_b16 v[64:65], v15 offset:16384
    ds_read_b64_tr_b16 v[66:67], v15 offset:18432
    v_mfma_f32_16x16x32_bf16 v[44:47], v[140:143], v[84:87], v[44:47]
    s_waitcnt vmcnt(7) lgkmcnt(6)
    v_mfma_f32_16x16x32_bf16 v[48:51], v[72:75], v[88:91], v[48:51]
    buffer_load_dwordx4 v[120:123], v1, s[32:35], s59 offen offset:2048 sc1
    v_mfma_f32_16x16x32_bf16 v[52:55], v[76:79], v[88:91], v[52:55]
    ds_read_b64_tr_b16 v[68:69], v16 offset:16384
    ds_read_b64_tr_b16 v[70:71], v16 offset:18432
    v_mfma_f32_16x16x32_bf16 v[40:43], v[144:147], v[88:91], v[40:43]
    ds_read_b64_tr_b16 v[72:73], v15 offset:20480
    ds_read_b64_tr_b16 v[74:75], v15 offset:22528
    v_mfma_f32_16x16x32_bf16 v[44:47], v[148:151], v[88:91], v[44:47]
    s_waitcnt vmcnt(7) lgkmcnt(6)
    v_mfma_f32_16x16x32_bf16 v[48:51], v[56:59], v[92:95], v[48:51]
    buffer_load_dwordx4 v[124:127], v1, s[32:35], s59 offen offset:3072 sc1
    v_mfma_f32_16x16x32_bf16 v[52:55], v[60:63], v[92:95], v[52:55]
    ds_read_b64_tr_b16 v[76:77], v16 offset:20480
    ds_read_b64_tr_b16 v[78:79], v16 offset:22528
    v_mfma_f32_16x16x32_bf16 v[40:43], v[152:155], v[92:95], v[40:43]
    ds_read_b64_tr_b16 v[56:57], v15 offset:24576
    ds_read_b64_tr_b16 v[58:59], v15 offset:26624
    v_mfma_f32_16x16x32_bf16 v[44:47], v[156:159], v[92:95], v[44:47]
    s_waitcnt vmcnt(7) lgkmcnt(6)
    v_mfma_f32_16x16x32_bf16 v[48:51], v[64:67], v[96:99], v[48:51]
    s_add_u32 s59, s59, 4096
    ds_read_b64_tr_b16 v[60:61], v16 offset:24576
    ds_read_b64_tr_b16 v[62:63], v16 offset:26624
    v_mfma_f32_16x16x32_bf16 v[52:55], v[68:71], v[96:99], v[52:55]
    buffer_load_dwordx4 v[80:83], v1, s[32:35], s59 offen offset:0 sc1
    v_mfma_f32_16x16x32_bf16 v[40:43], v[160:163], v[96:99], v[40:43]
    ds_read_b64_tr_b16 v[64:65], v15 offset:28672
    ds_read_b64_tr_b16 v[66:67], v15 offset:30720
    v_mfma_f32_16x16x32_bf16 v[44:47], v[164:167], v[96:99], v[44:47]
    s_waitcnt vmcnt(7) lgkmcnt(6)
    v_mfma_f32_16x16x32_bf16 v[48:51], v[72:75], v[100:103], v[48:51]
    buffer_load_dwordx4 v[84:87], v1, s[32:35], s59 offen offset:1024 sc1
    v_mfma_f32_16x16x32_bf16 v[52:55], v[76:79], v[100:103], v[52:55]
    ds_read_b64_tr_b16 v[68:69], v16 offset:28672
    ds_read_b64_tr_b16 v[70:71], v16 offset:30720
    v_mfma_f32_16x16x32_bf16 v[40:43], v[168:171], v[100:103], v[40:43]
    ds_read_b64_tr_b16 v[72:73], v15 offset:32768
    ds_read_b64_tr_b16 v[74:75], v15 offset:34816
    v_mfma_f32_16x16x32_bf16 v[44:47], v[172:175], v[100:103], v[44:47]
    s_waitcnt vmcnt(7) lgkmcnt(6)
    v_mfma_f32_16x16x32_bf16 v[48:51], v[56:59], v[104:107], v[48:51]
    buffer_load_dwordx4 v[88:91], v1, s[32:35], s59 offen offset:2048 sc1
    v_mfma_f32_16x16x32_bf16 v[52:55], v[60:63], v[104:107], v[52:55]
    ds_read_b64_tr_b16 v[76:77], v16 offset:32768
    ds_read_b64_tr_b16 v[78:79], v16 offset:34816
    v_mfma_f32_16x16x32_bf16 v[40:43], v[176:179], v[104:107], v[40:43]
    ds_read_b64_tr_b16 v[56:57], v15 offset:36864
    ds_read_b64_tr_b16 v[58:59], v15 offset:38912
    v_mfma_f32_16x16x32_bf16 v[44:47], v[180:183], v[104:107], v[44:47]
    s_waitcnt vmcnt(7) lgkmcnt(6)
    v_mfma_f32_16x16x32_bf16 v[48:51], v[64:67], v[108:111], v[48:51]
    buffer_load_dwordx4 v[92:95], v1, s[32:35], s59 offen offset:3072 sc1
    v_mfma_f32_16x16x32_bf16 v[52:55], v[68:71], v[108:111], v[52:55]
    ds_read_b64_tr_b16 v[60:61], v16 offset:36864
    ds_read_b64_tr_b16 v[62:63], v16 offset:38912
    v_mfma_f32_16x16x32_bf16 v[40:43], v[184:187], v[108:111], v[40:43]
    ds_read_b64_tr_b16 v[64:65], v15 offset:40960
    ds_read_b64_tr_b16 v[66:67], v15 offset:43008
    v_mfma_f32_16x16x32_bf16 v[44:47], v[188:191], v[108:111], v[44:47]
    s_waitcnt vmcnt(7) lgkmcnt(6)
    v_mfma_f32_16x16x32_bf16 v[48:51], v[72:75], v[112:115], v[48:51]
    ds_read_b64_tr_b16 v[68:69], v16 offset:40960
    ds_read_b64_tr_b16 v[70:71], v16 offset:43008
    v_mfma_f32_16x16x32_bf16 v[52:55], v[76:79], v[112:115], v[52:55]
    ds_read_b64_tr_b16 v[72:73], v15 offset:45056
    ds_read_b64_tr_b16 v[74:75], v15 offset:47104
    v_mfma_f32_16x16x32_bf16 v[40:43], v[192:195], v[112:115], v[40:43]
    v_mfma_f32_16x16x32_bf16 v[44:47], v[196:199], v[112:115], v[44:47]
    s_waitcnt vmcnt(6) lgkmcnt(6)
    v_mfma_f32_16x16x32_bf16 v[48:51], v[56:59], v[116:119], v[48:51]
    ds_read_b64_tr_b16 v[76:77], v16 offset:45056
    ds_read_b64_tr_b16 v[78:79], v16 offset:47104
    v_mfma_f32_16x16x32_bf16 v[52:55], v[60:63], v[116:119], v[52:55]
    s_add_u32 m0, s90, 81920
    s_add_u32 s86, s89, 1376256
    ds_read_b64_tr_b16 v[56:57], v15 offset:49152
    v_mfma_f32_16x16x32_bf16 v[40:43], v[200:203], v[116:119], v[40:43]
    buffer_load_dwordx4 v9, s[16:19], s86 offen lds
    v_mfma_f32_16x16x32_bf16 v[44:47], v[204:207], v[116:119], v[44:47]
    s_waitcnt vmcnt(6) lgkmcnt(5)
    ds_read_b64_tr_b16 v[58:59], v15 offset:51200
    v_mfma_f32_16x16x32_bf16 v[48:51], v[64:67], v[120:123], v[48:51]
    ds_read_b64_tr_b16 v[60:61], v16 offset:49152
    ds_read_b64_tr_b16 v[62:63], v16 offset:51200
    v_mfma_f32_16x16x32_bf16 v[52:55], v[68:71], v[120:123], v[52:55]
    ds_read_b64_tr_b16 v[64:65], v15 offset:53248
    ds_read_b64_tr_b16 v[66:67], v15 offset:55296
    v_mfma_f32_16x16x32_bf16 v[40:43], v[208:211], v[120:123], v[40:43]
    buffer_load_dwordx4 v10, s[16:19], s86 offen offset:1024 lds
    v_mfma_f32_16x16x32_bf16 v[44:47], v[212:215], v[120:123], v[44:47]
    s_waitcnt vmcnt(6) lgkmcnt(6)
    v_mfma_f32_16x16x32_bf16 v[48:51], v[72:75], v[124:127], v[48:51]
    ds_read_b64_tr_b16 v[68:69], v16 offset:53248
    ds_read_b64_tr_b16 v[70:71], v16 offset:55296
    v_mfma_f32_16x16x32_bf16 v[52:55], v[76:79], v[124:127], v[52:55]
    ds_read_b64_tr_b16 v[72:73], v15 offset:57344
    ds_read_b64_tr_b16 v[74:75], v15 offset:59392
    v_mfma_f32_16x16x32_bf16 v[40:43], v[216:219], v[124:127], v[40:43]
    buffer_load_dwordx4 v11, s[16:19], s86 offen offset:2048 lds
    v_mfma_f32_16x16x32_bf16 v[44:47], v[220:223], v[124:127], v[44:47]
    s_waitcnt vmcnt(6) lgkmcnt(6)
    v_mfma_f32_16x16x32_bf16 v[48:51], v[56:59], v[80:83], v[48:51]
    ds_read_b64_tr_b16 v[76:77], v16 offset:57344
    ds_read_b64_tr_b16 v[78:79], v16 offset:59392
    v_mfma_f32_16x16x32_bf16 v[52:55], v[60:63], v[80:83], v[52:55]
    ds_read_b64_tr_b16 v[56:57], v15 offset:61440
    ds_read_b64_tr_b16 v[58:59], v15 offset:63488
    v_mfma_f32_16x16x32_bf16 v[40:43], v[224:227], v[80:83], v[40:43]
    buffer_load_dwordx4 v12, s[16:19], s86 offen offset:3072 lds
    v_mfma_f32_16x16x32_bf16 v[44:47], v[228:231], v[80:83], v[44:47]
    s_waitcnt vmcnt(6) lgkmcnt(6)
    v_mfma_f32_16x16x32_bf16 v[48:51], v[64:67], v[84:87], v[48:51]
    ds_read_b64_tr_b16 v[60:61], v16 offset:61440
    ds_read_b64_tr_b16 v[62:63], v16 offset:63488
    v_mfma_f32_16x16x32_bf16 v[52:55], v[68:71], v[84:87], v[52:55]
    v_mfma_f32_16x16x32_bf16 v[40:43], v[232:235], v[84:87], v[40:43]
    v_mfma_f32_16x16x32_bf16 v[44:47], v[236:239], v[84:87], v[44:47]
    s_waitcnt vmcnt(5) lgkmcnt(4)
    v_mfma_f32_16x16x32_bf16 v[48:51], v[72:75], v[88:91], v[48:51]
    v_mfma_f32_16x16x32_bf16 v[52:55], v[76:79], v[88:91], v[52:55]
    v_mfma_f32_16x16x32_bf16 v[40:43], v[240:243], v[88:91], v[40:43]
    v_mfma_f32_16x16x32_bf16 v[44:47], v[244:247], v[88:91], v[44:47]
    s_waitcnt vmcnt(4) lgkmcnt(0)
    v_mfma_f32_16x16x32_bf16 v[48:51], v[56:59], v[92:95], v[48:51]
    v_mfma_f32_16x16x32_bf16 v[52:55], v[60:63], v[92:95], v[52:55]
    v_mfma_f32_16x16x32_bf16 v[40:43], v[248:251], v[92:95], v[40:43]
    v_mfma_f32_16x16x32_bf16 v[44:47], v[252:255], v[92:95], v[44:47]
    v_lshlrev_b32 v38, 4, v3
    s_nop 5
    v_pk_add_f32 v[80:81], v[40:41], v[42:43]
    v_pk_mul_f32 v[82:83], v[40:41], v[40:41]
    v_pk_add_f32 v[84:85], v[44:45], v[46:47]
    v_pk_mul_f32 v[86:87], v[44:45], v[44:45]
    v_pk_fma_f32 v[82:83], v[42:43], v[42:43], v[82:83]
    v_pk_fma_f32 v[86:87], v[46:47], v[46:47], v[86:87]
    v_pk_add_f32 v[80:81], v[80:81], v[48:49]
    v_pk_fma_f32 v[82:83], v[48:49], v[48:49], v[82:83]
    v_pk_add_f32 v[84:85], v[84:85], v[50:51]
    v_pk_fma_f32 v[86:87], v[50:51], v[50:51], v[86:87]
    v_pk_add_f32 v[80:81], v[80:81], v[52:53]
    v_pk_fma_f32 v[82:83], v[52:53], v[52:53], v[82:83]
    v_pk_add_f32 v[84:85], v[84:85], v[54:55]
    v_pk_fma_f32 v[86:87], v[54:55], v[54:55], v[86:87]
    v_pk_add_f32 v[80:81], v[80:81], v[84:85]
    v_pk_add_f32 v[82:83], v[82:83], v[86:87]
    v_add_f32 v80, v80, v81
    v_add_f32 v81, v82, v83
    s_nop 1
    v_permlane32_swap_b32 v80, v81
    v_add_f32 v80, v80, v81
    v_mov_b32 v82, v80
    s_nop 1
    v_permlane16_swap_b32 v80, v82
    v_add_f32 v80, v80, v82
    v_mov_b32 v81, v80
    s_nop 1
    v_permlane32_swap_b32 v80, v81
    s_mov_b64 exec, 0xffff
    v_max_f32 v81, 0, v81
    buffer_store_dwordx2 v[80:81], v38, s[32:35], s7 offen sc1
    s_mov_b64 exec, -1
    v_cvt_pk_bf16_f32 v24, v40, v41
    v_cvt_pk_bf16_f32 v25, v42, v43
    v_cvt_pk_bf16_f32 v26, v44, v45
    v_cvt_pk_bf16_f32 v27, v46, v47
    v_cvt_pk_bf16_f32 v28, v48, v49
    v_cvt_pk_bf16_f32 v29, v50, v51
    v_cvt_pk_bf16_f32 v30, v52, v53
    v_cvt_pk_bf16_f32 v31, v54, v55
    v_mov_b32 v32, 0xc0135761
    v_mov_b32 v33, 0xc0135761
    v_subrev_u32 v13, 65536, v13
    v_subrev_u32 v14, 65536, v14
    v_subrev_u32 v15, 65536, v15
    v_subrev_u32 v16, 65536, v16
    v_lshl_add_u32 v38, v3, 2, s9
    buffer_load_dwordx4 v[84:87], v1, s[32:35], s6 offen sc1
    ds_read_b128 a[208:211], v20 offset:0
    ds_read_b128 a[212:215], v22 offset:0
    ds_read_b128 a[240:243], v21 offset:0
    ds_read_b128 a[244:247], v23 offset:0
    s_waitcnt lgkmcnt(0)
    s_xor_b32 s93, s87, 0
    s_add_u32 m0, s88, 0
    s_add_u32 s86, s93, s76
    buffer_load_dwordx4 v5, s[20:23], s86 offen lds
    buffer_load_dwordx4 v6, s[20:23], s86 offen offset:1024 lds
    buffer_load_dwordx4 v7, s[20:23], s86 offen offset:2048 lds
    buffer_load_dwordx4 v8, s[20:23], s86 offen offset:3072 lds
    s_bfe_u32 s44, s57, 196608
    s_lshl_b32 s44, s44, 12
    s_add_u32 s44, s44, s3
    s_bfe_u32 s45, s51, 131073
    s_lshl_b32 s45, s45, 10
    s_add_u32 s45, s45, s44
    s_lshr_b32 s59, s51, 3
    s_lshl_b32 s59, s59, 4
    s_add_u32 s45, s45, s59
    s_and_b32 s59, s51, 1
    s_lshl_b32 s59, s59, 3
    s_add_u32 s45, s45, s59
    s_lshl_b32 s46, s51, 8
    s_add_u32 s46, s46, s57
    s_lshl_b32 s46, s46, 10
    s_add_u32 s46, s46, 6291456
    s_and_b32 s60, s48, 1
    s_lshl_b32 s47, s51, 1
    s_add_u32 s47, s47, s60
    s_lshl_b32 s47, s47, 7
    s_add_u32 s47, s47, 10780672
    s_lshl_b32 s60, s54, 28
    s_add_u32 s47, s47, s60
    s_waitcnt vmcnt(4)
    v_max_u32 v39, v85, v87
    v_cmp_eq_u32 vcc, -1, v39
    s_cbranch_vccnz Lrt_72
Lrtd_73:
    v_pk_add_f32 v[80:81], v[84:85], v[86:87]
    s_nop 1
    v_permlane32_swap_b32 v80, v81
    v_add_f32 v80, v80, v81
    v_mov_b32 v82, v80
    s_nop 1
    v_permlane16_swap_b32 v80, v82
    v_add_f32 v80, v80, v82
    v_mov_b32 v81, v80
    s_nop 1
    v_permlane32_swap_b32 v80, v81
    v_mul_f32 v80, 0xbb000000, v80
    v_mul_f32 v81, 0x3b000000, v81
    v_fma_f32 v81, -v80, v80, v81
    v_max_f32 v81, 0, v81
    v_add_f32 v81, 0x3727c5ac, v81
    v_rsq_f32 v81, v81
    s_nop 0
    v_mul_f32 v80, v80, v81
    v_pk_fma_f32 v[40:41], v[40:41], v[80:81], v[80:81] op_sel:[0,1,0] op_sel_hi:[1,1,0]
    v_pk_fma_f32 v[42:43], v[42:43], v[80:81], v[80:81] op_sel:[0,1,0] op_sel_hi:[1,1,0]
    v_pk_fma_f32 v[44:45], v[44:45], v[80:81], v[80:81] op_sel:[0,1,0] op_sel_hi:[1,1,0]
    v_pk_fma_f32 v[46:47], v[46:47], v[80:81], v[80:81] op_sel:[0,1,0] op_sel_hi:[1,1,0]
    v_cvt_pk_bf16_f32 v84, v40, v41
    v_cvt_pk_bf16_f32 v85, v42, v43
    v_cvt_pk_bf16_f32 v86, v44, v45
    v_cvt_pk_bf16_f32 v87, v46, v47
    buffer_store_dwordx4 v[84:87], v1, s[32:35], s8 offen offset:0 sc1
    v_pk_fma_f32 v[48:49], v[48:49], v[80:81], v[80:81] op_sel:[0,1,0] op_sel_hi:[1,1,0]
    v_pk_fma_f32 v[50:51], v[50:51], v[80:81], v[80:81] op_sel:[0,1,0] op_sel_hi:[1,1,0]
    v_pk_fma_f32 v[52:53], v[52:53], v[80:81], v[80:81] op_sel:[0,1,0] op_sel_hi:[1,1,0]
    v_pk_fma_f32 v[54:55], v[54:55], v[80:81], v[80:81] op_sel:[0,1,0] op_sel_hi:[1,1,0]
    v_cvt_pk_bf16_f32 v88, v48, v49
    v_cvt_pk_bf16_f32 v89, v50, v51
    v_cvt_pk_bf16_f32 v90, v52, v53
    v_cvt_pk_bf16_f32 v91, v54, v55
    buffer_store_dwordx4 v[88:91], v1, s[32:35], s8 offen offset:1024 sc1
    ds_read_b128 a[216:219], v20 offset:4096
    ds_read_b128 a[220:223], v22 offset:4096
    ds_read_b128 a[248:251], v21 offset:4096
    ds_read_b128 a[252:255], v23 offset:4096
    s_waitcnt lgkmcnt(0)
    s_xor_b32 s93, s87, 131072
    s_add_u32 m0, s88, 4096
    s_add_u32 s86, s93, s76
    buffer_load_dwordx4 v5, s[20:23], s86 offen lds
    buffer_load_dwordx4 v6, s[20:23], s86 offen offset:1024 lds
    buffer_load_dwordx4 v7, s[20:23], s86 offen offset:2048 lds
    buffer_load_dwordx4 v8, s[20:23], s86 offen offset:3072 lds
    s_mov_b64 exec, 2
    s_waitcnt vmcnt(4)
    buffer_store_dword v0, off, s[32:35], s10 offset:0 sc1
    s_mov_b64 exec, -1
    s_barrier
    s_cmp_ge_u32 s51, 14
    s_cbranch_scc1 Lidle_75
    ds_read_b128 a[0:3], v20 offset:0
    ds_read_b128 a[4:7], v22 offset:0
    ds_read_b128 a[32:35], v21 offset:0
    ds_read_b128 a[36:39], v23 offset:0
    s_waitcnt lgkmcnt(0)
    s_xor_b32 s93, s87, 1048576
    s_add_u32 m0, s88, 0
    s_add_u32 s86, s93, s76
    buffer_load_dwordx4 v5, s[20:23], s86 offen lds
    buffer_load_dwordx4 v6, s[20:23], s86 offen offset:1024 lds
    buffer_load_dwordx4 v7, s[20:23], s86 offen offset:2048 lds
    buffer_load_dwordx4 v8, s[20:23], s86 offen offset:3072 lds
    s_mov_b32 s59, s1
    s_add_u32 s60, s1, 34816
    buffer_load_dword v39, v38, s[32:35], 0 offen sc1
    s_waitcnt vmcnt(6)
    ds_read_b128 a[8:11], v20 offset:4096
    ds_read_b128 a[12:15], v22 offset:4096
    ds_read_b128 a[40:43], v21 offset:4096
    ds_read_b128 a[44:47], v23 offset:4096
    s_waitcnt lgkmcnt(0)
    s_xor_b32 s93, s87, 1179648
    s_add_u32 m0, s88, 4096
    s_add_u32 s86, s93, s76
    buffer_load_dwordx4 v5, s[20:23], s86 offen lds
    buffer_load_dwordx4 v6, s[20:23], s86 offen offset:1024 lds
    buffer_load_dwordx4 v7, s[20:23], s86 offen offset:2048 lds
    buffer_load_dwordx4 v8, s[20:23], s86 offen offset:3072 lds
    s_waitcnt vmcnt(4)
    v_cmp_ne_u32 vcc, 1, v39
    s_cbranch_vccnz Lrt_77
Lrtd_78:
    buffer_load_dwordx4 v[128:131], v1, s[32:35], s59 offen offset:0 sc1
    buffer_load_dwordx4 v[132:135], v1, s[32:35], s60 offen offset:0 sc1
    buffer_load_dwordx4 v[136:139], v1, s[32:35], s59 offen offset:1024 sc1
    buffer_load_dwordx4 v[140:143], v1, s[32:35], s60 offen offset:1024 sc1
    buffer_load_dwordx4 v[144:147], v1, s[32:35], s59 offen offset:2048 sc1
    buffer_load_dwordx4 v[148:151], v1, s[32:35], s60 offen offset:2048 sc1
    buffer_load_dwordx4 v[152:155], v1, s[32:35], s59 offen offset:3072 sc1
    buffer_load_dwordx4 v[156:159], v1, s[32:35], s60 offen offset:3072 sc1
    ds_read_b64_tr_b16 v[104:105], v13 offset:0
    ds_read_b64_tr_b16 v[106:107], v13 offset:2048
    ds_read_b64_tr_b16 v[108:109], v14 offset:0
    ds_read_b64_tr_b16 v[110:111], v14 offset:2048
    ds_read_b64_tr_b16 v[112:113], v15 offset:0
    ds_read_b64_tr_b16 v[114:115], v15 offset:2048
    ds_read_b64_tr_b16 v[116:117], v16 offset:0
    ds_read_b64_tr_b16 v[118:119], v16 offset:2048
    ds_read_b64_tr_b16 v[120:121], v13 offset:4096
    ds_read_b64_tr_b16 v[122:123], v13 offset:6144
    s_waitcnt vmcnt(6) lgkmcnt(6)
    v_mfma_f32_16x16x32_bf16 v[40:43], v[128:131], v[104:107], 0
    s_add_u32 s59, s59, 4096
    ds_read_b64_tr_b16 v[124:125], v14 offset:4096
    ds_read_b64_tr_b16 v[126:127], v14 offset:6144
    v_mfma_f32_16x16x32_bf16 v[44:47], v[132:135], v[104:107], 0
    buffer_load_dwordx4 v[160:163], v1, s[32:35], s59 offen offset:0 sc1
    v_mfma_f32_16x16x32_bf16 v[48:51], v[128:131], v[108:111], 0
    s_add_u32 s60, s60, 4096
    ds_read_b64_tr_b16 v[104:105], v15 offset:4096
    ds_read_b64_tr_b16 v[106:107], v15 offset:6144
    v_mfma_f32_16x16x32_bf16 v[52:55], v[132:135], v[108:111], 0
    s_waitcnt lgkmcnt(6)
    v_mfma_f32_16x16x32_bf16 v[56:59], v[128:131], v[112:115], 0
    buffer_load_dwordx4 v[164:167], v1, s[32:35], s60 offen offset:0 sc1
    v_mfma_f32_16x16x32_bf16 v[60:63], v[132:135], v[112:115], 0
    ds_read_b64_tr_b16 v[108:109], v16 offset:4096
    ds_read_b64_tr_b16 v[110:111], v16 offset:6144
    v_mfma_f32_16x16x32_bf16 v[64:67], v[128:131], v[116:119], 0
    ds_read_b64_tr_b16 v[112:113], v13 offset:8192
    ds_read_b64_tr_b16 v[114:115], v13 offset:10240
    v_mfma_f32_16x16x32_bf16 v[68:71], v[132:135], v[116:119], 0
    s_waitcnt vmcnt(6) lgkmcnt(6)
    v_mfma_f32_16x16x32_bf16 v[40:43], v[136:139], v[120:123], v[40:43]
    buffer_load_dwordx4 v[168:171], v1, s[32:35], s59 offen offset:1024 sc1
    v_mfma_f32_16x16x32_bf16 v[44:47], v[140:143], v[120:123], v[44:47]
    ds_read_b64_tr_b16 v[116:117], v14 offset:8192
    ds_read_b64_tr_b16 v[118:119], v14 offset:10240
    v_mfma_f32_16x16x32_bf16 v[48:51], v[136:139], v[124:127], v[48:51]
    ds_read_b64_tr_b16 v[120:121], v15 offset:8192
    ds_read_b64_tr_b16 v[122:123], v15 offset:10240
    v_mfma_f32_16x16x32_bf16 v[52:55], v[140:143], v[124:127], v[52:55]
    s_waitcnt lgkmcnt(6)
    v_mfma_f32_16x16x32_bf16 v[56:59], v[136:139], v[104:107], v[56:59]
    buffer_load_dwordx4 v[172:175], v1, s[32:35], s60 offen offset:1024 sc1
    v_mfma_f32_16x16x32_bf16 v[60:63], v[140:143], v[104:107], v[60:63]
    ds_read_b64_tr_b16 v[124:125], v16 offset:8192
    ds_read_b64_tr_b16 v[126:127], v16 offset:10240
    v_mfma_f32_16x16x32_bf16 v[64:67], v[136:139], v[108:111], v[64:67]
    ds_read_b64_tr_b16 v[104:105], v13 offset:12288
    ds_read_b64_tr_b16 v[106:107], v13 offset:14336
    v_mfma_f32_16x16x32_bf16 v[68:71], v[140:143], v[108:111], v[68:71]
    s_waitcnt vmcnt(6) lgkmcnt(6)
    v_mfma_f32_16x16x32_bf16 v[40:43], v[144:147], v[112:115], v[40:43]
    buffer_load_dwordx4 v[176:179], v1, s[32:35], s59 offen offset:2048 sc1
    v_mfma_f32_16x16x32_bf16 v[44:47], v[148:151], v[112:115], v[44:47]
    ds_read_b64_tr_b16 v[108:109], v14 offset:12288
    ds_read_b64_tr_b16 v[110:111], v14 offset:14336
    v_mfma_f32_16x16x32_bf16 v[48:51], v[144:147], v[116:119], v[48:51]
    ds_read_b64_tr_b16 v[112:113], v15 offset:12288
    ds_read_b64_tr_b16 v[114:115], v15 offset:14336
    v_mfma_f32_16x16x32_bf16 v[52:55], v[148:151], v[116:119], v[52:55]
    s_waitcnt lgkmcnt(6)
    v_mfma_f32_16x16x32_bf16 v[56:59], v[144:147], v[120:123], v[56:59]
    buffer_load_dwordx4 v[180:183], v1, s[32:35], s60 offen offset:2048 sc1
    v_mfma_f32_16x16x32_bf16 v[60:63], v[148:151], v[120:123], v[60:63]
    ds_read_b64_tr_b16 v[116:117], v16 offset:12288
    ds_read_b64_tr_b16 v[118:119], v16 offset:14336
    v_mfma_f32_16x16x32_bf16 v[64:67], v[144:147], v[124:127], v[64:67]
    ds_read_b64_tr_b16 v[120:121], v13 offset:16384
    ds_read_b64_tr_b16 v[122:123], v13 offset:18432
    v_mfma_f32_16x16x32_bf16 v[68:71], v[148:151], v[124:127], v[68:71]
    s_waitcnt vmcnt(6) lgkmcnt(6)
    v_mfma_f32_16x16x32_bf16 v[40:43], v[152:155], v[104:107], v[40:43]
    buffer_load_dwordx4 v[184:187], v1, s[32:35], s59 offen offset:3072 sc1
    v_mfma_f32_16x16x32_bf16 v[44:47], v[156:159], v[104:107], v[44:47]
    ds_read_b64_tr_b16 v[124:125], v14 offset:16384
    ds_read_b64_tr_b16 v[126:127], v14 offset:18432
    v_mfma_f32_16x16x32_bf16 v[48:51], v[152:155], v[108:111], v[48:51]
    ds_read_b64_tr_b16 v[104:105], v15 offset:16384
    ds_read_b64_tr_b16 v[106:107], v15 offset:18432
    v_mfma_f32_16x16x32_bf16 v[52:55], v[156:159], v[108:111], v[52:55]
    s_waitcnt lgkmcnt(6)
    v_mfma_f32_16x16x32_bf16 v[56:59], v[152:155], v[112:115], v[56:59]
    buffer_load_dwordx4 v[188:191], v1, s[32:35], s60 offen offset:3072 sc1
    v_mfma_f32_16x16x32_bf16 v[60:63], v[156:159], v[112:115], v[60:63]
    ds_read_b64_tr_b16 v[108:109], v16 offset:16384
    ds_read_b64_tr_b16 v[110:111], v16 offset:18432
    v_mfma_f32_16x16x32_bf16 v[64:67], v[152:155], v[116:119], v[64:67]
    s_add_u32 s59, s59, 4096
    ds_read_b64_tr_b16 v[112:113], v13 offset:20480
    ds_read_b64_tr_b16 v[114:115], v13 offset:22528
    v_mfma_f32_16x16x32_bf16 v[68:71], v[156:159], v[116:119], v[68:71]
    s_waitcnt vmcnt(6) lgkmcnt(6)
    v_mfma_f32_16x16x32_bf16 v[40:43], v[160:163], v[120:123], v[40:43]
    buffer_load_dwordx4 v[192:195], v1, s[32:35], s59 offen offset:0 sc1
    v_mfma_f32_16x16x32_bf16 v[44:47], v[164:167], v[120:123], v[44:47]
    ds_read_b64_tr_b16 v[116:117], v14 offset:20480
    ds_read_b64_tr_b16 v[118:119], v14 offset:22528
    v_mfma_f32_16x16x32_bf16 v[48:51], v[160:163], v[124:127], v[48:51]
    s_add_u32 s60, s60, 4096
    ds_read_b64_tr_b16 v[120:121], v15 offset:20480
    ds_read_b64_tr_b16 v[122:123], v15 offset:22528
    v_mfma_f32_16x16x32_bf16 v[52:55], v[164:167], v[124:127], v[52:55]
    s_waitcnt lgkmcnt(6)
    v_mfma_f32_16x16x32_bf16 v[56:59], v[160:163], v[104:107], v[56:59]
    buffer_load_dwordx4 v[196:199], v1, s[32:35], s60 offen offset:0 sc1
    v_mfma_f32_16x16x32_bf16 v[60:63], v[164:167], v[104:107], v[60:63]
    ds_read_b64_tr_b16 v[124:125], v16 offset:20480
    ds_read_b64_tr_b16 v[126:127], v16 offset:22528
    v_mfma_f32_16x16x32_bf16 v[64:67], v[160:163], v[108:111], v[64:67]
    ds_read_b64_tr_b16 v[104:105], v13 offset:24576
    ds_read_b64_tr_b16 v[106:107], v13 offset:26624
    v_mfma_f32_16x16x32_bf16 v[68:71], v[164:167], v[108:111], v[68:71]
    s_waitcnt vmcnt(6) lgkmcnt(6)
    v_mfma_f32_16x16x32_bf16 v[40:43], v[168:171], v[112:115], v[40:43]
    buffer_load_dwordx4 v[200:203], v1, s[32:35], s59 offen offset:1024 sc1
    v_mfma_f32_16x16x32_bf16 v[44:47], v[172:175], v[112:115], v[44:47]
    ds_read_b64_tr_b16 v[108:109], v14 offset:24576
    ds_read_b64_tr_b16 v[110:111], v14 offset:26624
    v_mfma_f32_16x16x32_bf16 v[48:51], v[168:171], v[116:119], v[48:51]
    ds_read_b64_tr_b16 v[112:113], v15 offset:24576
    ds_read_b64_tr_b16 v[114:115], v15 offset:26624
    v_mfma_f32_16x16x32_bf16 v[52:55], v[172:175], v[116:119], v[52:55]
    s_waitcnt lgkmcnt(6)
    v_mfma_f32_16x16x32_bf16 v[56:59], v[168:171], v[120:123], v[56:59]
    buffer_load_dwordx4 v[204:207], v1, s[32:35], s60 offen offset:1024 sc1
    v_mfma_f32_16x16x32_bf16 v[60:63], v[172:175], v[120:123], v[60:63]
    ds_read_b64_tr_b16 v[116:117], v16 offset:24576
    ds_read_b64_tr_b16 v[118:119], v16 offset:26624
    v_mfma_f32_16x16x32_bf16 v[64:67], v[168:171], v[124:127], v[64:67]
    ds_read_b64_tr_b16 v[120:121], v13 offset:28672
    ds_read_b64_tr_b16 v[122:123], v13 offset:30720
    v_mfma_f32_16x16x32_bf16 v[68:71], v[172:175], v[124:127], v[68:71]
    s_waitcnt vmcnt(6) lgkmcnt(6)
    v_mfma_f32_16x16x32_bf16 v[40:43], v[176:179], v[104:107], v[40:43]
    buffer_load_dwordx4 v[208:211], v1, s[32:35], s59 offen offset:2048 sc1
    v_mfma_f32_16x16x32_bf16 v[44:47], v[180:183], v[104:107], v[44:47]
    ds_read_b64_tr_b16 v[124:125], v14 offset:28672
    ds_read_b64_tr_b16 v[126:127], v14 offset:30720
    v_mfma_f32_16x16x32_bf16 v[48:51], v[176:179], v[108:111], v[48:51]
    ds_read_b64_tr_b16 v[104:105], v15 offset:28672
    ds_read_b64_tr_b16 v[106:107], v15 offset:30720
    v_mfma_f32_16x16x32_bf16 v[52:55], v[180:183], v[108:111], v[52:55]
    s_waitcnt lgkmcnt(6)
    v_mfma_f32_16x16x32_bf16 v[56:59], v[176:179], v[112:115], v[56:59]
    buffer_load_dwordx4 v[212:215], v1, s[32:35], s60 offen offset:2048 sc1
    v_mfma_f32_16x16x32_bf16 v[60:63], v[180:183], v[112:115], v[60:63]
    ds_read_b64_tr_b16 v[108:109], v16 offset:28672
    ds_read_b64_tr_b16 v[110:111], v16 offset:30720
    v_mfma_f32_16x16x32_bf16 v[64:67], v[176:179], v[116:119], v[64:67]
    ds_read_b64_tr_b16 v[112:113], v13 offset:32768
    ds_read_b64_tr_b16 v[114:115], v13 offset:34816
    v_mfma_f32_16x16x32_bf16 v[68:71], v[180:183], v[116:119], v[68:71]
    s_waitcnt vmcnt(6) lgkmcnt(6)
    v_mfma_f32_16x16x32_bf16 v[40:43], v[184:187], v[120:123], v[40:43]
    buffer_load_dwordx4 v[216:219], v1, s[32:35], s59 offen offset:3072 sc1
    v_mfma_f32_16x16x32_bf16 v[44:47], v[188:191], v[120:123], v[44:47]
    ds_read_b64_tr_b16 v[116:117], v14 offset:32768
    ds_read_b64_tr_b16 v[118:119], v14 offset:34816
    v_mfma_f32_16x16x32_bf16 v[48:51], v[184:187], v[124:127], v[48:51]
    ds_read_b64_tr_b16 v[120:121], v15 offset:32768
    ds_read_b64_tr_b16 v[122:123], v15 offset:34816
    v_mfma_f32_16x16x32_bf16 v[52:55], v[188:191], v[124:127], v[52:55]
    s_waitcnt lgkmcnt(6)
    v_mfma_f32_16x16x32_bf16 v[56:59], v[184:187], v[104:107], v[56:59]
    buffer_load_dwordx4 v[220:223], v1, s[32:35], s60 offen offset:3072 sc1
    v_mfma_f32_16x16x32_bf16 v[60:63], v[188:191], v[104:107], v[60:63]
    ds_read_b64_tr_b16 v[124:125], v16 offset:32768
    ds_read_b64_tr_b16 v[126:127], v16 offset:34816
    v_mfma_f32_16x16x32_bf16 v[64:67], v[184:187], v[108:111], v[64:67]
    s_add_u32 s59, s59, 4096
    ds_read_b64_tr_b16 v[104:105], v13 offset:36864
    ds_read_b64_tr_b16 v[106:107], v13 offset:38912
    v_mfma_f32_16x16x32_bf16 v[68:71], v[188:191], v[108:111], v[68:71]
    s_waitcnt vmcnt(6) lgkmcnt(6)
    v_mfma_f32_16x16x32_bf16 v[40:43], v[192:195], v[112:115], v[40:43]
    buffer_load_dwordx4 v[224:227], v1, s[32:35], s59 offen offset:0 sc1
    v_mfma_f32_16x16x32_bf16 v[44:47], v[196:199], v[112:115], v[44:47]
    ds_read_b64_tr_b16 v[108:109], v14 offset:36864
    ds_read_b64_tr_b16 v[110:111], v14 offset:38912
    v_mfma_f32_16x16x32_bf16 v[48:51], v[192:195], v[116:119], v[48:51]
    s_add_u32 s60, s60, 4096
    ds_read_b64_tr_b16 v[112:113], v15 offset:36864
    ds_read_b64_tr_b16 v[114:115], v15 offset:38912
    v_mfma_f32_16x16x32_bf16 v[52:55], v[196:199], v[116:119], v[52:55]
    s_waitcnt lgkmcnt(6)
    v_mfma_f32_16x16x32_bf16 v[56:59], v[192:195], v[120:123], v[56:59]
    buffer_load_dwordx4 v[228:231], v1, s[32:35], s60 offen offset:0 sc1
    v_mfma_f32_16x16x32_bf16 v[60:63], v[196:199], v[120:123], v[60:63]
    ds_read_b64_tr_b16 v[116:117], v16 offset:36864
    ds_read_b64_tr_b16 v[118:119], v16 offset:38912
    v_mfma_f32_16x16x32_bf16 v[64:67], v[192:195], v[124:127], v[64:67]
    ds_read_b64_tr_b16 v[120:121], v13 offset:40960
    ds_read_b64_tr_b16 v[122:123], v13 offset:43008
    v_mfma_f32_16x16x32_bf16 v[68:71], v[196:199], v[124:127], v[68:71]
    s_waitcnt vmcnt(6) lgkmcnt(6)
    v_mfma_f32_16x16x32_bf16 v[40:43], v[200:203], v[104:107], v[40:43]
    buffer_load_dwordx4 v[232:235], v1, s[32:35], s59 offen offset:1024 sc1
    v_mfma_f32_16x16x32_bf16 v[44:47], v[204:207], v[104:107], v[44:47]
    ds_read_b64_tr_b16 v[124:125], v14 offset:40960
    ds_read_b64_tr_b16 v[126:127], v14 offset:43008
    v_mfma_f32_16x16x32_bf16 v[48:51], v[200:203], v[108:111], v[48:51]
    ds_read_b64_tr_b16 v[104:105], v15 offset:40960
    ds_read_b64_tr_b16 v[106:107], v15 offset:43008
    v_mfma_f32_16x16x32_bf16 v[52:55], v[204:207], v[108:111], v[52:55]
    s_waitcnt lgkmcnt(6)
    v_mfma_f32_16x16x32_bf16 v[56:59], v[200:203], v[112:115], v[56:59]
    buffer_load_dwordx4 v[236:239], v1, s[32:35], s60 offen offset:1024 sc1
    v_mfma_f32_16x16x32_bf16 v[60:63], v[204:207], v[112:115], v[60:63]
    ds_read_b64_tr_b16 v[108:109], v16 offset:40960
    ds_read_b64_tr_b16 v[110:111], v16 offset:43008
    v_mfma_f32_16x16x32_bf16 v[64:67], v[200:203], v[116:119], v[64:67]
    ds_read_b64_tr_b16 v[112:113], v13 offset:45056
    ds_read_b64_tr_b16 v[114:115], v13 offset:47104
    v_mfma_f32_16x16x32_bf16 v[68:71], v[204:207], v[116:119], v[68:71]
    s_waitcnt vmcnt(6) lgkmcnt(6)
    v_mfma_f32_16x16x32_bf16 v[40:43], v[208:211], v[120:123], v[40:43]
    buffer_load_dwordx4 v[240:243], v1, s[32:35], s59 offen offset:2048 sc1
    v_mfma_f32_16x16x32_bf16 v[44:47], v[212:215], v[120:123], v[44:47]
    ds_read_b64_tr_b16 v[116:117], v14 offset:45056
    ds_read_b64_tr_b16 v[118:119], v14 offset:47104
    v_mfma_f32_16x16x32_bf16 v[48:51], v[208:211], v[124:127], v[48:51]
    ds_read_b64_tr_b16 v[120:121], v15 offset:45056
    ds_read_b64_tr_b16 v[122:123], v15 offset:47104
    v_mfma_f32_16x16x32_bf16 v[52:55], v[212:215], v[124:127], v[52:55]
    s_waitcnt lgkmcnt(6)
    v_mfma_f32_16x16x32_bf16 v[56:59], v[208:211], v[104:107], v[56:59]
    buffer_load_dwordx4 v[244:247], v1, s[32:35], s60 offen offset:2048 sc1
    v_mfma_f32_16x16x32_bf16 v[60:63], v[212:215], v[104:107], v[60:63]
    ds_read_b64_tr_b16 v[124:125], v16 offset:45056
    ds_read_b64_tr_b16 v[126:127], v16 offset:47104
    v_mfma_f32_16x16x32_bf16 v[64:67], v[208:211], v[108:111], v[64:67]
    ds_read_b64_tr_b16 v[104:105], v13 offset:49152
    ds_read_b64_tr_b16 v[106:107], v13 offset:51200
    v_mfma_f32_16x16x32_bf16 v[68:71], v[212:215], v[108:111], v[68:71]
    s_waitcnt vmcnt(6) lgkmcnt(6)
    v_mfma_f32_16x16x32_bf16 v[40:43], v[216:219], v[112:115], v[40:43]
    buffer_load_dwordx4 v[248:251], v1, s[32:35], s59 offen offset:3072 sc1
    v_mfma_f32_16x16x32_bf16 v[44:47], v[220:223], v[112:115], v[44:47]
    ds_read_b64_tr_b16 v[108:109], v14 offset:49152
    ds_read_b64_tr_b16 v[110:111], v14 offset:51200
    v_mfma_f32_16x16x32_bf16 v[48:51], v[216:219], v[116:119], v[48:51]
    ds_read_b64_tr_b16 v[112:113], v15 offset:49152
    ds_read_b64_tr_b16 v[114:115], v15 offset:51200
    v_mfma_f32_16x16x32_bf16 v[52:55], v[220:223], v[116:119], v[52:55]
    s_waitcnt lgkmcnt(6)
    v_mfma_f32_16x16x32_bf16 v[56:59], v[216:219], v[120:123], v[56:59]
    buffer_load_dwordx4 v[252:255], v1, s[32:35], s60 offen offset:3072 sc1
    v_mfma_f32_16x16x32_bf16 v[60:63], v[220:223], v[120:123], v[60:63]
    ds_read_b64_tr_b16 v[116:117], v16 offset:49152
    ds_read_b64_tr_b16 v[118:119], v16 offset:51200
    v_mfma_f32_16x16x32_bf16 v[64:67], v[216:219], v[124:127], v[64:67]
    ds_read_b64_tr_b16 v[120:121], v13 offset:53248
    ds_read_b64_tr_b16 v[122:123], v13 offset:55296
    v_mfma_f32_16x16x32_bf16 v[68:71], v[220:223], v[124:127], v[68:71]
    s_waitcnt vmcnt(6) lgkmcnt(6)
    v_mfma_f32_16x16x32_bf16 v[40:43], v[224:227], v[104:107], v[40:43]
    ds_read_b64_tr_b16 v[124:125], v14 offset:53248
    ds_read_b64_tr_b16 v[126:127], v14 offset:55296
    v_mfma_f32_16x16x32_bf16 v[44:47], v[228:231], v[104:107], v[44:47]
    v_mfma_f32_16x16x32_bf16 v[48:51], v[224:227], v[108:111], v[48:51]
    ds_read_b64_tr_b16 v[104:105], v15 offset:53248
    ds_read_b64_tr_b16 v[106:107], v15 offset:55296
    v_mfma_f32_16x16x32_bf16 v[52:55], v[228:231], v[108:111], v[52:55]
    s_waitcnt lgkmcnt(6)
    v_mfma_f32_16x16x32_bf16 v[56:59], v[224:227], v[112:115], v[56:59]
    ds_read_b64_tr_b16 v[108:109], v16 offset:53248
    ds_read_b64_tr_b16 v[110:111], v16 offset:55296
    v_mfma_f32_16x16x32_bf16 v[60:63], v[228:231], v[112:115], v[60:63]
    v_and_b32 v17, 1, v0
    v_cmp_eq_u32 s[60:61], 1, v17
    v_mfma_f32_16x16x32_bf16 v[64:67], v[224:227], v[116:119], v[64:67]
    ds_read_b64_tr_b16 v[112:113], v13 offset:57344
    ds_read_b64_tr_b16 v[114:115], v13 offset:59392
    v_mfma_f32_16x16x32_bf16 v[68:71], v[228:231], v[116:119], v[68:71]
    s_waitcnt vmcnt(4) lgkmcnt(6)
    v_lshrrev_b32 v38, 2, v0
    v_lshl_or_b32 v38, v38, 1, v17
    v_mfma_f32_16x16x32_bf16 v[40:43], v[232:235], v[120:123], v[40:43]
    s_lshl_b32 s89, s51, 7
    s_mul_i32 s93, s54, 114688
    s_add_u32 s89, s89, s93
    s_add_u32 m0, s90, 98304
    s_add_u32 s86, s89, 0
    v_mfma_f32_16x16x32_bf16 v[44:47], v[236:239], v[120:123], v[44:47]
    buffer_load_dwordx4 v9, s[16:19], s86 offen lds
    v_mfma_f32_16x16x32_bf16 v[48:51], v[232:235], v[124:127], v[48:51]
    ds_read_b64_tr_b16 v[116:117], v14 offset:57344
    ds_read_b64_tr_b16 v[118:119], v14 offset:59392
    v_mfma_f32_16x16x32_bf16 v[52:55], v[236:239], v[124:127], v[52:55]
    s_waitcnt lgkmcnt(4)
    ds_read_b64_tr_b16 v[120:121], v15 offset:57344
    ds_read_b64_tr_b16 v[122:123], v15 offset:59392
    v_mfma_f32_16x16x32_bf16 v[56:59], v[232:235], v[104:107], v[56:59]
    buffer_load_dwordx4 v10, s[16:19], s86 offen offset:1024 lds
    v_mfma_f32_16x16x32_bf16 v[60:63], v[236:239], v[104:107], v[60:63]
    ds_read_b64_tr_b16 v[124:125], v16 offset:57344
    ds_read_b64_tr_b16 v[126:127], v16 offset:59392
    v_mfma_f32_16x16x32_bf16 v[64:67], v[232:235], v[108:111], v[64:67]
    ds_read_b64_tr_b16 v[104:105], v13 offset:61440
    ds_read_b64_tr_b16 v[106:107], v13 offset:63488
    v_mfma_f32_16x16x32_bf16 v[68:71], v[236:239], v[108:111], v[68:71]
    s_waitcnt vmcnt(4) lgkmcnt(6)
    v_lshlrev_b32 v38, 5, v38
    s_lshl_b32 s62, s54, 8
    v_mfma_f32_16x16x32_bf16 v[40:43], v[240:243], v[112:115], v[40:43]
    buffer_load_dwordx4 v11, s[16:19], s86 offen offset:2048 lds
    v_mfma_f32_16x16x32_bf16 v[44:47], v[244:247], v[112:115], v[44:47]
    s_add_u32 s62, s62, 81920
    ds_read_b64_tr_b16 v[108:109], v14 offset:61440
    ds_read_b64_tr_b16 v[110:111], v14 offset:63488
    v_mfma_f32_16x16x32_bf16 v[48:51], v[240:243], v[116:119], v[48:51]
    ds_read_b64_tr_b16 v[112:113], v15 offset:61440
    ds_read_b64_tr_b16 v[114:115], v15 offset:63488
    v_mfma_f32_16x16x32_bf16 v[52:55], v[244:247], v[116:119], v[52:55]
    s_waitcnt lgkmcnt(6)
    v_lshlrev_b32 v17, 7, v17
    v_lshrrev_b32 v35, 1, v0
    v_mfma_f32_16x16x32_bf16 v[56:59], v[240:243], v[120:123], v[56:59]
    buffer_load_dwordx4 v12, s[16:19], s86 offen offset:3072 lds
    v_mfma_f32_16x16x32_bf16 v[60:63], v[244:247], v[120:123], v[60:63]
    ds_read_b64_tr_b16 v[116:117], v16 offset:61440
    ds_read_b64_tr_b16 v[118:119], v16 offset:63488
    v_mfma_f32_16x16x32_bf16 v[64:67], v[240:243], v[124:127], v[64:67]
    v_lshl_add_u32 v17, v35, 2, v17
    v_add_u32 v17, s62, v17
    v_mfma_f32_16x16x32_bf16 v[68:71], v[244:247], v[124:127], v[68:71]
    s_waitcnt vmcnt(4) lgkmcnt(4)
    v_lshl_add_u32 v35, v4, 5, s62
    v_mfma_f32_16x16x32_bf16 v[40:43], v[248:251], v[104:107], v[40:43]
    s_add_u32 m0, s90, 114688
    s_add_u32 s86, s89, 458752
    v_mfma_f32_16x16x32_bf16 v[44:47], v[252:255], v[104:107], v[44:47]
    buffer_load_dwordx4 v9, s[16:19], s86 offen lds
    v_mfma_f32_16x16x32_bf16 v[48:51], v[248:251], v[108:111], v[48:51]
    v_mfma_f32_16x16x32_bf16 v[52:55], v[252:255], v[108:111], v[52:55]
    s_waitcnt lgkmcnt(0)
    v_mfma_f32_16x16x32_bf16 v[56:59], v[248:251], v[112:115], v[56:59]
    v_mfma_f32_16x16x32_bf16 v[60:63], v[252:255], v[112:115], v[60:63]
    buffer_load_dwordx4 v10, s[16:19], s86 offen offset:1024 lds
    v_mfma_f32_16x16x32_bf16 v[64:67], v[248:251], v[116:119], v[64:67]
    v_mfma_f32_16x16x32_bf16 v[68:71], v[252:255], v[116:119], v[68:71]
    v_pk_mul_f32 v[104:105], v[40:41], v[40:41]
    v_pk_mul_f32 v[106:107], v[42:43], v[42:43]
    v_pk_mul_f32 v[108:109], v[44:45], v[44:45]
    v_pk_mul_f32 v[110:111], v[46:47], v[46:47]
    v_pk_mul_f32 v[112:113], v[48:49], v[48:49]
    v_pk_mul_f32 v[114:115], v[50:51], v[50:51]
    v_pk_mul_f32 v[116:117], v[52:53], v[52:53]
    buffer_load_dwordx4 v11, s[16:19], s86 offen offset:2048 lds
    v_pk_mul_f32 v[118:119], v[54:55], v[54:55]
    v_pk_fma_f32 v[104:105], v[104:105], s[82:83], v[32:33]
    v_pk_fma_f32 v[106:107], v[106:107], s[82:83], v[32:33]
    v_pk_fma_f32 v[108:109], v[108:109], s[82:83], v[32:33]
    v_pk_fma_f32 v[110:111], v[110:111], s[82:83], v[32:33]
    v_pk_fma_f32 v[112:113], v[112:113], s[82:83], v[32:33]
    v_pk_fma_f32 v[114:115], v[114:115], s[82:83], v[32:33]
    v_pk_fma_f32 v[116:117], v[116:117], s[82:83], v[32:33]
    v_pk_fma_f32 v[118:119], v[118:119], s[82:83], v[32:33]
    v_pk_mul_f32 v[104:105], v[104:105], v[40:41]
    v_pk_mul_f32 v[106:107], v[106:107], v[42:43]
    v_pk_mul_f32 v[108:109], v[108:109], v[44:45]
    v_pk_mul_f32 v[110:111], v[110:111], v[46:47]
    v_pk_mul_f32 v[112:113], v[112:113], v[48:49]
    v_pk_mul_f32 v[114:115], v[114:115], v[50:51]
    v_pk_mul_f32 v[116:117], v[116:117], v[52:53]
    v_pk_mul_f32 v[118:119], v[118:119], v[54:55]
    buffer_load_dwordx4 v12, s[16:19], s86 offen offset:3072 lds
    v_exp_f32 v104, v104
    v_exp_f32 v105, v105
    v_exp_f32 v106, v106
    v_exp_f32 v107, v107
    v_exp_f32 v108, v108
    v_exp_f32 v109, v109
    v_exp_f32 v110, v110
    s_add_u32 m0, s90, 131072
    s_add_u32 s86, s89, 917504
    v_exp_f32 v111, v111
    v_exp_f32 v112, v112
    buffer_load_dwordx4 v9, s[16:19], s86 offen lds
    v_exp_f32 v113, v113
    v_exp_f32 v114, v114
    v_exp_f32 v115, v115
    v_exp_f32 v116, v116
    v_exp_f32 v117, v117
    v_exp_f32 v118, v118
    v_exp_f32 v119, v119
    v_pk_add_f32 v[104:105], v[104:105], s[84:85]
    v_pk_add_f32 v[106:107], v[106:107], s[84:85]
    buffer_load_dwordx4 v10, s[16:19], s86 offen offset:1024 lds
    v_pk_add_f32 v[108:109], v[108:109], s[84:85]
    v_pk_add_f32 v[110:111], v[110:111], s[84:85]
    v_pk_add_f32 v[112:113], v[112:113], s[84:85]
    v_pk_add_f32 v[114:115], v[114:115], s[84:85]
    v_pk_add_f32 v[116:117], v[116:117], s[84:85]
    v_pk_add_f32 v[118:119], v[118:119], s[84:85]
    v_rcp_f32 v104, v104
    v_rcp_f32 v105, v105
    v_rcp_f32 v106, v106
    v_rcp_f32 v107, v107
    v_rcp_f32 v108, v108
    v_rcp_f32 v109, v109
    buffer_load_dwordx4 v11, s[16:19], s86 offen offset:2048 lds
    v_rcp_f32 v110, v110
    v_rcp_f32 v111, v111
    v_rcp_f32 v112, v112
    v_rcp_f32 v113, v113
    v_rcp_f32 v114, v114
    v_rcp_f32 v115, v115
    v_rcp_f32 v116, v116
    v_rcp_f32 v117, v117
    buffer_load_dwordx4 v12, s[16:19], s86 offen offset:3072 lds
    v_rcp_f32 v118, v118
    v_rcp_f32 v119, v119
    v_pk_mul_f32 v[40:41], v[40:41], v[104:105]
    v_pk_mul_f32 v[42:43], v[42:43], v[106:107]
    v_pk_mul_f32 v[44:45], v[44:45], v[108:109]
    v_pk_mul_f32 v[46:47], v[46:47], v[110:111]
    v_pk_mul_f32 v[48:49], v[48:49], v[112:113]
    v_pk_mul_f32 v[50:51], v[50:51], v[114:115]
    v_pk_mul_f32 v[52:53], v[52:53], v[116:117]
    v_pk_mul_f32 v[54:55], v[54:55], v[118:119]
    v_pk_mul_f32 v[104:105], v[56:57], v[56:57]
    v_pk_mul_f32 v[106:107], v[58:59], v[58:59]
    v_pk_mul_f32 v[108:109], v[60:61], v[60:61]
    v_pk_mul_f32 v[110:111], v[62:63], v[62:63]
    v_pk_mul_f32 v[112:113], v[64:65], v[64:65]
    v_pk_mul_f32 v[114:115], v[66:67], v[66:67]
    v_pk_mul_f32 v[116:117], v[68:69], v[68:69]
    v_pk_mul_f32 v[118:119], v[70:71], v[70:71]
    v_pk_fma_f32 v[104:105], v[104:105], s[82:83], v[32:33]
    v_pk_fma_f32 v[106:107], v[106:107], s[82:83], v[32:33]
    v_pk_fma_f32 v[108:109], v[108:109], s[82:83], v[32:33]
    v_pk_fma_f32 v[110:111], v[110:111], s[82:83], v[32:33]
    v_pk_fma_f32 v[112:113], v[112:113], s[82:83], v[32:33]
    v_pk_fma_f32 v[114:115], v[114:115], s[82:83], v[32:33]
    v_pk_fma_f32 v[116:117], v[116:117], s[82:83], v[32:33]
    v_pk_fma_f32 v[118:119], v[118:119], s[82:83], v[32:33]
    v_pk_mul_f32 v[104:105], v[104:105], v[56:57]
    v_pk_mul_f32 v[106:107], v[106:107], v[58:59]
    v_pk_mul_f32 v[108:109], v[108:109], v[60:61]
    v_pk_mul_f32 v[110:111], v[110:111], v[62:63]
    v_pk_mul_f32 v[112:113], v[112:113], v[64:65]
    v_pk_mul_f32 v[114:115], v[114:115], v[66:67]
    v_pk_mul_f32 v[116:117], v[116:117], v[68:69]
    v_pk_mul_f32 v[118:119], v[118:119], v[70:71]
    v_exp_f32 v104, v104
    v_exp_f32 v105, v105
    v_exp_f32 v106, v106
    v_exp_f32 v107, v107
    v_exp_f32 v108, v108
    v_exp_f32 v109, v109
    v_exp_f32 v110, v110
    v_exp_f32 v111, v111
    v_exp_f32 v112, v112
    v_exp_f32 v113, v113
    v_exp_f32 v114, v114
    v_exp_f32 v115, v115
    v_exp_f32 v116, v116
    v_exp_f32 v117, v117
    v_exp_f32 v118, v118
    v_exp_f32 v119, v119
    v_pk_add_f32 v[104:105], v[104:105], s[84:85]
    v_pk_add_f32 v[106:107], v[106:107], s[84:85]
    v_pk_add_f32 v[108:109], v[108:109], s[84:85]
    v_pk_add_f32 v[110:111], v[110:111], s[84:85]
    v_pk_add_f32 v[112:113], v[112:113], s[84:85]
    v_pk_add_f32 v[114:115], v[114:115], s[84:85]
    v_pk_add_f32 v[116:117], v[116:117], s[84:85]
    v_pk_add_f32 v[118:119], v[118:119], s[84:85]
    v_rcp_f32 v104, v104
    v_rcp_f32 v105, v105
    v_rcp_f32 v106, v106
    v_rcp_f32 v107, v107
    v_rcp_f32 v108, v108
    v_rcp_f32 v109, v109
    v_rcp_f32 v110, v110
    v_rcp_f32 v111, v111
    v_rcp_f32 v112, v112
    v_rcp_f32 v113, v113
    v_rcp_f32 v114, v114
    v_rcp_f32 v115, v115
    v_rcp_f32 v116, v116
    v_rcp_f32 v117, v117
    v_rcp_f32 v118, v118
    v_rcp_f32 v119, v119
    v_pk_mul_f32 v[56:57], v[56:57], v[104:105]
    v_pk_mul_f32 v[58:59], v[58:59], v[106:107]
    v_pk_mul_f32 v[60:61], v[60:61], v[108:109]
    v_pk_mul_f32 v[62:63], v[62:63], v[110:111]
    v_pk_mul_f32 v[64:65], v[64:65], v[112:113]
    v_pk_mul_f32 v[66:67], v[66:67], v[114:115]
    v_pk_mul_f32 v[68:69], v[68:69], v[116:117]
    v_pk_mul_f32 v[70:71], v[70:71], v[118:119]
    v_pk_add_f32 v[104:105], v[40:41], v[48:49]
    v_pk_mul_f32 v[112:113], v[40:41], v[40:41]
    v_pk_add_f32 v[106:107], v[42:43], v[50:51]
    v_pk_mul_f32 v[114:115], v[42:43], v[42:43]
    v_pk_add_f32 v[108:109], v[44:45], v[52:53]
    v_pk_mul_f32 v[116:117], v[44:45], v[44:45]
    v_pk_add_f32 v[110:111], v[46:47], v[54:55]
    v_pk_mul_f32 v[118:119], v[46:47], v[46:47]
    v_pk_fma_f32 v[112:113], v[48:49], v[48:49], v[112:113]
    v_pk_fma_f32 v[114:115], v[50:51], v[50:51], v[114:115]
    v_pk_fma_f32 v[116:117], v[52:53], v[52:53], v[116:117]
    v_pk_fma_f32 v[118:119], v[54:55], v[54:55], v[118:119]
    v_pk_add_f32 v[104:105], v[104:105], v[56:57]
    v_pk_fma_f32 v[112:113], v[56:57], v[56:57], v[112:113]
    v_pk_add_f32 v[106:107], v[106:107], v[58:59]
    v_pk_fma_f32 v[114:115], v[58:59], v[58:59], v[114:115]
    v_pk_add_f32 v[108:109], v[108:109], v[60:61]
    v_pk_fma_f32 v[116:117], v[60:61], v[60:61], v[116:117]
    v_pk_add_f32 v[110:111], v[110:111], v[62:63]
    v_pk_fma_f32 v[118:119], v[62:63], v[62:63], v[118:119]
    v_pk_add_f32 v[104:105], v[104:105], v[64:65]
    v_pk_fma_f32 v[112:113], v[64:65], v[64:65], v[112:113]
    v_pk_add_f32 v[106:107], v[106:107], v[66:67]
    v_pk_fma_f32 v[114:115], v[66:67], v[66:67], v[114:115]
    v_pk_add_f32 v[108:109], v[108:109], v[68:69]
    v_pk_fma_f32 v[116:117], v[68:69], v[68:69], v[116:117]
    v_pk_add_f32 v[110:111], v[110:111], v[70:71]
    v_pk_fma_f32 v[118:119], v[70:71], v[70:71], v[118:119]
    v_add_f32_dpp v104, v104, v104 row_ror:8 row_mask:0xf bank_mask:0x3
    v_add_f32_dpp v105, v105, v105 row_ror:8 row_mask:0xf bank_mask:0x3
    v_add_f32_dpp v106, v106, v106 row_ror:8 row_mask:0xf bank_mask:0x3
    v_add_f32_dpp v107, v107, v107 row_ror:8 row_mask:0xf bank_mask:0x3
    v_add_f32_dpp v104, v108, v108 row_ror:8 row_mask:0xf bank_mask:0xc
    v_add_f32_dpp v105, v109, v109 row_ror:8 row_mask:0xf bank_mask:0xc
    v_add_f32_dpp v106, v110, v110 row_ror:8 row_mask:0xf bank_mask:0xc
    v_add_f32_dpp v107, v111, v111 row_ror:8 row_mask:0xf bank_mask:0xc
    v_add_f32_dpp v112, v112, v112 row_ror:8 row_mask:0xf bank_mask:0x3
    v_add_f32_dpp v113, v113, v113 row_ror:8 row_mask:0xf bank_mask:0x3
    v_add_f32_dpp v114, v114, v114 row_ror:8 row_mask:0xf bank_mask:0x3
    v_add_f32_dpp v115, v115, v115 row_ror:8 row_mask:0xf bank_mask:0x3
    v_add_f32_dpp v112, v116, v116 row_ror:8 row_mask:0xf bank_mask:0xc
    v_add_f32_dpp v113, v117, v117 row_ror:8 row_mask:0xf bank_mask:0xc
    v_add_f32_dpp v114, v118, v118 row_ror:8 row_mask:0xf bank_mask:0xc
    v_add_f32_dpp v115, v119, v119 row_ror:8 row_mask:0xf bank_mask:0xc
    v_add_f32_dpp v104, v104, v104 row_half_mirror row_mask:0xf bank_mask:0x5
    v_add_f32_dpp v105, v105, v105 row_half_mirror row_mask:0xf bank_mask:0x5
    v_add_f32_dpp v112, v112, v112 row_half_mirror row_mask:0xf bank_mask:0x5
    v_add_f32_dpp v113, v113, v113 row_half_mirror row_mask:0xf bank_mask:0x5
    v_add_f32_dpp v104, v106, v106 row_half_mirror row_mask:0xf bank_mask:0xa
    v_add_f32_dpp v105, v107, v107 row_half_mirror row_mask:0xf bank_mask:0xa
    v_add_f32_dpp v112, v114, v114 row_half_mirror row_mask:0xf bank_mask:0xa
    v_add_f32_dpp v113, v115, v115 row_half_mirror row_mask:0xf bank_mask:0xa
    v_add_f32_dpp v104, v104, v104 quad_perm:[1,0,3,2] row_mask:0xf bank_mask:0xf
    v_add_f32_dpp v105, v105, v105 quad_perm:[1,0,3,2] row_mask:0xf bank_mask:0xf
    v_add_f32_dpp v112, v112, v112 quad_perm:[1,0,3,2] row_mask:0xf bank_mask:0xf
    v_add_f32_dpp v113, v113, v113 quad_perm:[1,0,3,2] row_mask:0xf bank_mask:0xf
    v_add_f32_dpp v104, v104, v104 quad_perm:[2,3,0,1] row_mask:0xf bank_mask:0xf
    v_add_f32_dpp v105, v105, v105 quad_perm:[2,3,0,1] row_mask:0xf bank_mask:0xf
    v_add_f32_dpp v112, v112, v112 quad_perm:[2,3,0,1] row_mask:0xf bank_mask:0xf
    v_add_f32_dpp v113, v113, v113 quad_perm:[2,3,0,1] row_mask:0xf bank_mask:0xf
    v_cndmask_b32 v112, v112, v113, s[60:61]
    v_cndmask_b32 v104, v104, v105, s[60:61]
    s_mov_b32 exec_lo, 0x33333333
    s_mov_b32 exec_hi, 0x33333333
    v_max_f32 v105, 0, v112
    buffer_store_dwordx2 v[104:105], v38, s[32:35], s45 offen sc1
    s_mov_b64 exec, -1
    v_add_u32 v13, 65536, v13
    v_add_u32 v14, 65536, v14
    v_add_u32 v15, 65536, v15
    v_add_u32 v16, 65536, v16
    s_waitcnt vmcnt(1)
    s_waitcnt lgkmcnt(0)
    s_barrier
    ds_read_b64_tr_b16 v[104:105], v13 offset:0
    ds_read_b64_tr_b16 v[106:107], v13 offset:2048
    ds_read_b64_tr_b16 v[108:109], v14 offset:0
    ds_read_b64_tr_b16 v[110:111], v14 offset:2048
    ds_read_b64_tr_b16 v[112:113], v15 offset:0
    ds_read_b64_tr_b16 v[114:115], v15 offset:2048
    ds_read_b64_tr_b16 v[116:117], v16 offset:0
    ds_read_b64_tr_b16 v[118:119], v16 offset:2048
    ds_read_b64_tr_b16 v[120:121], v13 offset:4096
    ds_read_b64_tr_b16 v[122:123], v13 offset:6144
    s_waitcnt lgkmcnt(6)
    v_mfma_f32_16x16x32_bf16 v[72:75], v[104:107], v[128:131], 0
    ds_read_b64_tr_b16 v[124:125], v14 offset:4096
    ds_read_b64_tr_b16 v[126:127], v14 offset:6144
    v_mfma_f32_16x16x32_bf16 v[76:79], v[104:107], v[132:135], 0
    v_mfma_f32_16x16x32_bf16 v[80:83], v[108:111], v[128:131], 0
    ds_read_b64_tr_b16 v[104:105], v15 offset:4096
    ds_read_b64_tr_b16 v[106:107], v15 offset:6144
    v_mfma_f32_16x16x32_bf16 v[84:87], v[108:111], v[132:135], 0
    s_waitcnt lgkmcnt(6)
    v_mfma_f32_16x16x32_bf16 v[88:91], v[112:115], v[128:131], 0
    s_xor_b32 s93, s87, 0
    s_add_u32 m0, s88, 32768
    s_add_u32 s86, s93, s77
    v_mfma_f32_16x16x32_bf16 v[92:95], v[112:115], v[132:135], 0
    buffer_load_dwordx4 v5, s[20:23], s86 offen lds
    v_mfma_f32_16x16x32_bf16 v[96:99], v[116:119], v[128:131], 0
    ds_read_b64_tr_b16 v[108:109], v16 offset:4096
    ds_read_b64_tr_b16 v[110:111], v16 offset:6144
    v_mfma_f32_16x16x32_bf16 v[100:103], v[116:119], v[132:135], 0
    s_waitcnt lgkmcnt(4)
    ds_read_b64_tr_b16 v[112:113], v13 offset:8192
    ds_read_b64_tr_b16 v[114:115], v13 offset:10240
    v_mfma_f32_16x16x32_bf16 v[72:75], v[120:123], v[136:139], v[72:75]
    buffer_load_dwordx4 v6, s[20:23], s86 offen offset:1024 lds
    v_mfma_f32_16x16x32_bf16 v[76:79], v[120:123], v[140:143], v[76:79]
    ds_read_b64_tr_b16 v[116:117], v14 offset:8192
    ds_read_b64_tr_b16 v[118:119], v14 offset:10240
    v_mfma_f32_16x16x32_bf16 v[80:83], v[124:127], v[136:139], v[80:83]
    ds_read_b64_tr_b16 v[120:121], v15 offset:8192
    ds_read_b64_tr_b16 v[122:123], v15 offset:10240
    v_mfma_f32_16x16x32_bf16 v[84:87], v[124:127], v[140:143], v[84:87]
    s_waitcnt lgkmcnt(6)
    v_mfma_f32_16x16x32_bf16 v[88:91], v[104:107], v[136:139], v[88:91]
    buffer_load_dwordx4 v7, s[20:23], s86 offen offset:2048 lds
    v_mfma_f32_16x16x32_bf16 v[92:95], v[104:107], v[140:143], v[92:95]
    ds_read_b64_tr_b16 v[124:125], v16 offset:8192
    ds_read_b64_tr_b16 v[126:127], v16 offset:10240
    v_mfma_f32_16x16x32_bf16 v[96:99], v[108:111], v[136:139], v[96:99]
    ds_read_b64_tr_b16 v[104:105], v13 offset:12288
    ds_read_b64_tr_b16 v[106:107], v13 offset:14336
    v_mfma_f32_16x16x32_bf16 v[100:103], v[108:111], v[140:143], v[100:103]
    s_waitcnt lgkmcnt(6)
    buffer_load_dwordx4 v[128:131], v1, s[32:35], s44 offen offset:0 sc1
    buffer_load_dwordx4 v[132:135], v1, s[32:35], s44 offen offset:1024 sc1
    buffer_load_dwordx4 v[136:139], v1, s[32:35], s44 offen offset:2048 sc1
    buffer_load_dwordx4 v[140:143], v1, s[32:35], s44 offen offset:3072 sc1
    v_mfma_f32_16x16x32_bf16 v[72:75], v[112:115], v[144:147], v[72:75]
    buffer_load_dwordx4 v8, s[20:23], s86 offen offset:3072 lds
    v_mfma_f32_16x16x32_bf16 v[76:79], v[112:115], v[148:151], v[76:79]
    ds_read_b64_tr_b16 v[108:109], v14 offset:12288
    ds_read_b64_tr_b16 v[110:111], v14 offset:14336
    v_mfma_f32_16x16x32_bf16 v[80:83], v[116:119], v[144:147], v[80:83]
    ds_read_b64_tr_b16 v[112:113], v15 offset:12288
    ds_read_b64_tr_b16 v[114:115], v15 offset:14336
    v_mfma_f32_16x16x32_bf16 v[84:87], v[116:119], v[148:151], v[84:87]
    s_waitcnt lgkmcnt(6)
    v_mfma_f32_16x16x32_bf16 v[88:91], v[120:123], v[144:147], v[88:91]
    s_add_u32 m0, s90, 147456
    s_add_u32 s86, s89, 1376256
    ds_read_b64_tr_b16 v[116:117], v16 offset:12288
    v_mfma_f32_16x16x32_bf16 v[92:95], v[120:123], v[148:151], v[92:95]
    buffer_load_dwordx4 v9, s[16:19], s86 offen lds
    v_mfma_f32_16x16x32_bf16 v[96:99], v[124:127], v[144:147], v[96:99]
    ds_read_b64_tr_b16 v[118:119], v16 offset:14336
    ds_read_b64_tr_b16 v[120:121], v13 offset:16384
    v_mfma_f32_16x16x32_bf16 v[100:103], v[124:127], v[148:151], v[100:103]
    s_waitcnt lgkmcnt(5)
    ds_read_b64_tr_b16 v[122:123], v13 offset:18432
    v_mfma_f32_16x16x32_bf16 v[72:75], v[104:107], v[152:155], v[72:75]
    ds_read_b64_tr_b16 v[124:125], v14 offset:16384
    ds_read_b64_tr_b16 v[126:127], v14 offset:18432
    v_mfma_f32_16x16x32_bf16 v[76:79], v[104:107], v[156:159], v[76:79]
    buffer_load_dwordx4 v10, s[16:19], s86 offen offset:1024 lds
    v_mfma_f32_16x16x32_bf16 v[80:83], v[108:111], v[152:155], v[80:83]
    ds_read_b64_tr_b16 v[104:105], v15 offset:16384
    ds_read_b64_tr_b16 v[106:107], v15 offset:18432
    v_mfma_f32_16x16x32_bf16 v[84:87], v[108:111], v[156:159], v[84:87]
    s_waitcnt lgkmcnt(6)
    v_mfma_f32_16x16x32_bf16 v[88:91], v[112:115], v[152:155], v[88:91]
    ds_read_b64_tr_b16 v[108:109], v16 offset:16384
    ds_read_b64_tr_b16 v[110:111], v16 offset:18432
    v_mfma_f32_16x16x32_bf16 v[92:95], v[112:115], v[156:159], v[92:95]
    buffer_load_dwordx4 v11, s[16:19], s86 offen offset:2048 lds
    v_mfma_f32_16x16x32_bf16 v[96:99], v[116:119], v[152:155], v[96:99]
    ds_read_b64_tr_b16 v[112:113], v13 offset:20480
    ds_read_b64_tr_b16 v[114:115], v13 offset:22528
    v_mfma_f32_16x16x32_bf16 v[100:103], v[116:119], v[156:159], v[100:103]
    s_waitcnt lgkmcnt(6)
    s_waitcnt vmcnt(7)
    v_max_u32 v39, v129, v131
    s_waitcnt vmcnt(4)
    v_cndmask_b32_e64 v140, v140, 0, s[60:61]
    v_cndmask_b32_e64 v141, v141, 0, s[60:61]
    v_cndmask_b32_e64 v142, v142, 0, s[60:61]
    v_cndmask_b32_e64 v143, v143, 0, s[60:61]
    v_max3_u32 v39, v39, v133, v135
    v_max3_u32 v39, v39, v137, v139
    v_max3_u32 v39, v39, v141, v143
    v_cmp_eq_u32 vcc, -1, v39
    s_cbranch_vccnz Lrt_80
Lrtd_81:
    v_mfma_f32_16x16x32_bf16 v[72:75], v[120:123], v[160:163], v[72:75]
    ds_read_b64_tr_b16 v[116:117], v14 offset:20480
    ds_read_b64_tr_b16 v[118:119], v14 offset:22528
    v_add_f32 v128, v128, v136
    v_mfma_f32_16x16x32_bf16 v[76:79], v[120:123], v[164:167], v[76:79]
    buffer_load_dwordx4 v12, s[16:19], s86 offen offset:3072 lds
    v_mfma_f32_16x16x32_bf16 v[80:83], v[124:127], v[160:163], v[80:83]
    ds_read_b64_tr_b16 v[120:121], v15 offset:20480
    ds_read_b64_tr_b16 v[122:123], v15 offset:22528
    v_add_f32 v129, v129, v137
    v_mfma_f32_16x16x32_bf16 v[84:87], v[124:127], v[164:167], v[84:87]
    s_waitcnt lgkmcnt(6)
    v_add_f32 v130, v130, v138
    v_add_f32 v131, v131, v139
    v_add_f32 v132, v132, v140
    v_mfma_f32_16x16x32_bf16 v[88:91], v[104:107], v[160:163], v[88:91]
    ds_read_b64_tr_b16 v[124:125], v16 offset:20480
    ds_read_b64_tr_b16 v[126:127], v16 offset:22528
    v_add_f32 v133, v133, v141
    v_mfma_f32_16x16x32_bf16 v[92:95], v[104:107], v[164:167], v[92:95]
    s_xor_b32 s93, s87, 131072
    s_add_u32 m0, s88, 36864
    s_add_u32 s86, s93, s77
    v_add_f32 v134, v134, v142
    v_mfma_f32_16x16x32_bf16 v[96:99], v[108:111], v[160:163], v[96:99]
    buffer_load_dwordx4 v5, s[20:23], s86 offen lds
    v_mfma_f32_16x16x32_bf16 v[100:103], v[108:111], v[164:167], v[100:103]
    s_waitcnt lgkmcnt(4)
    ds_read_b64_tr_b16 v[104:105], v13 offset:24576
    ds_read_b64_tr_b16 v[106:107], v13 offset:26624
    v_add_f32 v135, v135, v143
    v_mfma_f32_16x16x32_bf16 v[72:75], v[112:115], v[168:171], v[72:75]
    ds_read_b64_tr_b16 v[108:109], v14 offset:24576
    ds_read_b64_tr_b16 v[110:111], v14 offset:26624
    v_add_f32 v128, v128, v132
    v_mfma_f32_16x16x32_bf16 v[76:79], v[112:115], v[172:175], v[76:79]
    v_add_f32 v129, v129, v133
    v_add_f32 v130, v130, v134
    v_add_f32 v131, v131, v135
    v_mfma_f32_16x16x32_bf16 v[80:83], v[116:119], v[168:171], v[80:83]
    buffer_load_dwordx4 v6, s[20:23], s86 offen offset:1024 lds
    v_mfma_f32_16x16x32_bf16 v[84:87], v[116:119], v[172:175], v[84:87]
    s_waitcnt lgkmcnt(4)
    ds_read_b64_tr_b16 v[112:113], v15 offset:24576
    ds_read_b64_tr_b16 v[114:115], v15 offset:26624
    v_add_f32 v128, v128, v130
    v_mfma_f32_16x16x32_bf16 v[88:91], v[120:123], v[168:171], v[88:91]
    ds_read_b64_tr_b16 v[116:117], v16 offset:24576
    ds_read_b64_tr_b16 v[118:119], v16 offset:26624
    v_add_f32 v129, v129, v131
    v_mfma_f32_16x16x32_bf16 v[92:95], v[120:123], v[172:175], v[92:95]
    v_add_f32_dpp v128, v128, v128 quad_perm:[1,0,3,2] row_mask:0xf bank_mask:0xf
    v_add_f32_dpp v129, v129, v129 quad_perm:[1,0,3,2] row_mask:0xf bank_mask:0xf
    v_mul_f32 v128, 0xba924925, v128
    v_mfma_f32_16x16x32_bf16 v[96:99], v[124:127], v[168:171], v[96:99]
    buffer_load_dwordx4 v7, s[20:23], s86 offen offset:2048 lds
    v_mfma_f32_16x16x32_bf16 v[100:103], v[124:127], v[172:175], v[100:103]
    s_waitcnt lgkmcnt(4)
    ds_read_b64_tr_b16 v[120:121], v13 offset:28672
    ds_read_b64_tr_b16 v[122:123], v13 offset:30720
    v_mul_f32 v129, 0x3a924925, v129
    v_fma_f32 v129, -v128, v128, v129
    v_max_f32 v129, 0, v129
    v_add_f32 v129, 0x3727c5ac, v129
    v_rsq_f32 v129, v129
    s_nop 0
    v_mul_f32 v128, v128, v129
    v_cndmask_b32 v128, v128, v129, s[60:61]
    ds_write_b32 v17, v128
    ds_read_b128 v[132:135], v35 offset:0
    ds_read_b128 v[140:143], v35 offset:128
    ds_read_b128 v[136:139], v35 offset:16
    ds_read_b128 v[144:147], v35 offset:144
    s_waitcnt lgkmcnt(2)
    v_pk_fma_f32 v[40:41], v[40:41], v[140:141], v[132:133]
    v_pk_fma_f32 v[42:43], v[42:43], v[142:143], v[134:135]
    s_waitcnt lgkmcnt(0)
    v_pk_fma_f32 v[44:45], v[44:45], v[144:145], v[136:137]
    v_pk_fma_f32 v[46:47], v[46:47], v[146:147], v[138:139]
    v_cvt_pk_bf16_f32 v148, v40, v41
    v_cvt_pk_bf16_f32 v149, v42, v43
    v_cvt_pk_bf16_f32 v150, v44, v45
    v_cvt_pk_bf16_f32 v151, v46, v47
    buffer_store_dwordx4 v[148:151], v1, s[32:35], s46 offen sc1
    s_add_u32 s46, s46, 65536
    v_pk_fma_f32 v[48:49], v[48:49], v[140:141], v[132:133]
    v_pk_fma_f32 v[50:51], v[50:51], v[142:143], v[134:135]
    v_pk_fma_f32 v[52:53], v[52:53], v[144:145], v[136:137]
    v_pk_fma_f32 v[54:55], v[54:55], v[146:147], v[138:139]
    v_cvt_pk_bf16_f32 v152, v48, v49
    v_cvt_pk_bf16_f32 v153, v50, v51
    v_cvt_pk_bf16_f32 v154, v52, v53
    v_cvt_pk_bf16_f32 v155, v54, v55
    buffer_store_dwordx4 v[152:155], v1, s[32:35], s46 offen sc1
    s_add_u32 s46, s46, 65536
    v_pk_fma_f32 v[56:57], v[56:57], v[140:141], v[132:133]
    v_pk_fma_f32 v[58:59], v[58:59], v[142:143], v[134:135]
    v_pk_fma_f32 v[60:61], v[60:61], v[144:145], v[136:137]
    v_pk_fma_f32 v[62:63], v[62:63], v[146:147], v[138:139]
    v_cvt_pk_bf16_f32 v156, v56, v57
    v_cvt_pk_bf16_f32 v157, v58, v59
    v_cvt_pk_bf16_f32 v158, v60, v61
    v_cvt_pk_bf16_f32 v159, v62, v63
    buffer_store_dwordx4 v[156:159], v1, s[32:35], s46 offen sc1
    s_add_u32 s46, s46, 65536
    v_pk_fma_f32 v[64:65], v[64:65], v[140:141], v[132:133]
    v_pk_fma_f32 v[66:67], v[66:67], v[142:143], v[134:135]
    v_pk_fma_f32 v[68:69], v[68:69], v[144:145], v[136:137]
    v_pk_fma_f32 v[70:71], v[70:71], v[146:147], v[138:139]
    v_cvt_pk_bf16_f32 v160, v64, v65
    v_cvt_pk_bf16_f32 v161, v66, v67
    v_cvt_pk_bf16_f32 v162, v68, v69
    v_cvt_pk_bf16_f32 v163, v70, v71
    buffer_store_dwordx4 v[160:163], v1, s[32:35], s46 offen sc1
    v_mfma_f32_16x16x32_bf16 v[72:75], v[104:107], v[176:179], v[72:75]
    s_mul_i32 s59, s53, 7
    ds_read_b64_tr_b16 v[124:125], v14 offset:28672
    ds_read_b64_tr_b16 v[126:127], v14 offset:30720
    v_mfma_f32_16x16x32_bf16 v[76:79], v[104:107], v[180:183], v[76:79]
    v_min_u32 v46, 6, v0
    v_add_u32 v46, s59, v46
    v_mfma_f32_16x16x32_bf16 v[80:83], v[108:111], v[176:179], v[80:83]
    buffer_load_dwordx4 v8, s[20:23], s86 offen offset:3072 lds
    v_mfma_f32_16x16x32_bf16 v[84:87], v[108:111], v[180:183], v[84:87]
    ds_read_b64_tr_b16 v[104:105], v15 offset:28672
    ds_read_b64_tr_b16 v[106:107], v15 offset:30720
    v_mfma_f32_16x16x32_bf16 v[88:91], v[112:115], v[176:179], v[88:91]
    ds_read_b128 a[16:19], v20 offset:0
    ds_read_b64_tr_b16 v[108:109], v16 offset:28672
    v_mfma_f32_16x16x32_bf16 v[92:95], v[112:115], v[180:183], v[92:95]
    ds_read_b128 a[20:23], v22 offset:0
    ds_read_b64_tr_b16 v[110:111], v16 offset:30720
    v_mfma_f32_16x16x32_bf16 v[96:99], v[116:119], v[176:179], v[96:99]
    ds_read_b128 a[48:51], v21 offset:0
    ds_read_b64_tr_b16 v[112:113], v13 offset:32768
    v_mfma_f32_16x16x32_bf16 v[100:103], v[116:119], v[180:183], v[100:103]
    s_waitcnt lgkmcnt(8)
    ds_read_b64_tr_b16 v[114:115], v13 offset:34816
    v_lshrrev_b32 v46, 2, v46
    v_mfma_f32_16x16x32_bf16 v[72:75], v[120:123], v[184:187], v[72:75]
    ds_read_b128 a[52:55], v23 offset:0
    ds_read_b64_tr_b16 v[116:117], v14 offset:32768
    v_mfma_f32_16x16x32_bf16 v[76:79], v[120:123], v[188:191], v[76:79]
    s_andn2_b32 s63, 1, s48
    ds_read_b64_tr_b16 v[118:119], v14 offset:34816
    s_lshl_b32 s59, s63, 7
    v_mfma_f32_16x16x32_bf16 v[80:83], v[124:127], v[184:187], v[80:83]
    s_waitcnt lgkmcnt(2)
    s_xor_b32 s93, s87, 1048576
    s_add_u32 m0, s88, 0
    s_add_u32 s86, s93, s77
    v_mfma_f32_16x16x32_bf16 v[84:87], v[124:127], v[188:191], v[84:87]
    ds_read_b64_tr_b16 v[120:121], v15 offset:32768
    ds_read_b64_tr_b16 v[122:123], v15 offset:34816
    v_mfma_f32_16x16x32_bf16 v[88:91], v[104:107], v[184:187], v[88:91]
    buffer_load_dwordx4 v5, s[20:23], s86 offen lds
    v_mfma_f32_16x16x32_bf16 v[92:95], v[104:107], v[188:191], v[92:95]
    s_add_u32 s59, s59, 10780672
    ds_read_b64_tr_b16 v[124:125], v16 offset:32768
    ds_read_b64_tr_b16 v[126:127], v16 offset:34816
    v_mfma_f32_16x16x32_bf16 v[96:99], v[108:111], v[184:187], v[96:99]
    s_lshl_b32 s62, s54, 28
    ds_read_b64_tr_b16 v[104:105], v13 offset:36864
    ds_read_b64_tr_b16 v[106:107], v13 offset:38912
    v_mfma_f32_16x16x32_bf16 v[100:103], v[108:111], v[188:191], v[100:103]
    s_waitcnt lgkmcnt(6)
    s_add_u32 s59, s59, s62
    v_lshl_add_u32 v57, v46, 8, s59
    v_mfma_f32_16x16x32_bf16 v[72:75], v[112:115], v[192:195], v[72:75]
    buffer_load_dwordx4 v6, s[20:23], s86 offen offset:1024 lds
    v_mfma_f32_16x16x32_bf16 v[76:79], v[112:115], v[196:199], v[76:79]
    s_min_u32 s5, s54, 1
    ds_read_b64_tr_b16 v[108:109], v14 offset:36864
    ds_read_b64_tr_b16 v[110:111], v14 offset:38912
    v_mfma_f32_16x16x32_bf16 v[80:83], v[116:119], v[192:195], v[80:83]
    s_xor_b32 s5, s5, 1
    ds_read_b64_tr_b16 v[112:113], v15 offset:36864
    ds_read_b64_tr_b16 v[114:115], v15 offset:38912
    v_mfma_f32_16x16x32_bf16 v[84:87], v[116:119], v[196:199], v[84:87]
    s_waitcnt lgkmcnt(6)
    s_mul_i32 s5, s5, 7
    s_bfe_u32 s59, s58, 196609
    v_mfma_f32_16x16x32_bf16 v[88:91], v[120:123], v[192:195], v[88:91]
    buffer_load_dwordx4 v7, s[20:23], s86 offen offset:2048 lds
    v_mfma_f32_16x16x32_bf16 v[92:95], v[120:123], v[196:199], v[92:95]
    s_lshl_b32 s59, s59, 7
    ds_read_b64_tr_b16 v[116:117], v16 offset:36864
    ds_read_b64_tr_b16 v[118:119], v16 offset:38912
    v_mfma_f32_16x16x32_bf16 v[96:99], v[124:127], v[192:195], v[96:99]
    s_add_u32 s59, s59, s3
    ds_read_b64_tr_b16 v[120:121], v13 offset:40960
    ds_read_b64_tr_b16 v[122:123], v13 offset:43008
    v_mfma_f32_16x16x32_bf16 v[100:103], v[124:127], v[196:199], v[100:103]
    s_waitcnt lgkmcnt(6)
    s_add_u32 s59, s59, 51200
    v_lshl_add_u32 v40, v46, 2, s59
    v_mfma_f32_16x16x32_bf16 v[72:75], v[104:107], v[200:203], v[72:75]
    buffer_load_dwordx4 v8, s[20:23], s86 offen offset:3072 lds
    v_mfma_f32_16x16x32_bf16 v[76:79], v[104:107], v[204:207], v[76:79]
    ds_read_b128 a[24:27], v20 offset:4096
    ds_read_b64_tr_b16 v[124:125], v14 offset:40960
    v_mfma_f32_16x16x32_bf16 v[80:83], v[108:111], v[200:203], v[80:83]
    ds_read_b128 a[28:31], v22 offset:4096
    ds_read_b64_tr_b16 v[126:127], v14 offset:43008
    v_mfma_f32_16x16x32_bf16 v[84:87], v[108:111], v[204:207], v[84:87]
    s_waitcnt lgkmcnt(6)
    ds_read_b64_tr_b16 v[104:105], v15 offset:40960
    ds_read_b64_tr_b16 v[106:107], v15 offset:43008
    v_mfma_f32_16x16x32_bf16 v[88:91], v[112:115], v[200:203], v[88:91]
    ds_read_b128 a[56:59], v21 offset:4096
    ds_read_b64_tr_b16 v[108:109], v16 offset:40960
    v_mfma_f32_16x16x32_bf16 v[92:95], v[112:115], v[204:207], v[92:95]
    ds_read_b128 a[60:63], v23 offset:4096
    ds_read_b64_tr_b16 v[110:111], v16 offset:43008
    v_mfma_f32_16x16x32_bf16 v[96:99], v[116:119], v[200:203], v[96:99]
    s_lshl_b32 s4, s63, 13
    ds_read_b64_tr_b16 v[112:113], v13 offset:45056
    ds_read_b64_tr_b16 v[114:115], v13 offset:47104
    v_mfma_f32_16x16x32_bf16 v[100:103], v[116:119], v[204:207], v[100:103]
    s_waitcnt lgkmcnt(8)
    s_lshl_b32 s59, s54, 14
    s_add_u32 s4, s4, s59
    v_mfma_f32_16x16x32_bf16 v[72:75], v[120:123], v[208:211], v[72:75]
    s_waitcnt lgkmcnt(3)
    s_xor_b32 s93, s87, 1179648
    s_add_u32 m0, s88, 4096
    s_add_u32 s86, s93, s77
    v_mfma_f32_16x16x32_bf16 v[76:79], v[120:123], v[212:215], v[76:79]
    buffer_load_dwordx4 v5, s[20:23], s86 offen lds
    v_mfma_f32_16x16x32_bf16 v[80:83], v[124:127], v[208:211], v[80:83]
    s_add_u32 s4, s4, 6291456
    ds_read_b64_tr_b16 v[116:117], v14 offset:45056
    ds_read_b64_tr_b16 v[118:119], v14 offset:47104
    v_mfma_f32_16x16x32_bf16 v[84:87], v[124:127], v[212:215], v[84:87]
    s_waitcnt lgkmcnt(4)
    ds_read_b64_tr_b16 v[120:121], v15 offset:45056
    ds_read_b64_tr_b16 v[122:123], v15 offset:47104
    v_mfma_f32_16x16x32_bf16 v[88:91], v[104:107], v[208:211], v[88:91]
    buffer_load_dwordx4 v6, s[20:23], s86 offen offset:1024 lds
    v_mfma_f32_16x16x32_bf16 v[92:95], v[104:107], v[212:215], v[92:95]
    s_lshl_b32 s59, s64, 16
    ds_read_b64_tr_b16 v[124:125], v16 offset:45056
    ds_read_b64_tr_b16 v[126:127], v16 offset:47104
    s_waitcnt vmcnt(14)
    s_barrier
    v_mfma_f32_16x16x32_bf16 v[96:99], v[108:111], v[208:211], v[96:99]
    s_add_u32 s59, s59, s4
    ds_read_b64_tr_b16 v[104:105], v13 offset:49152
    ds_read_b64_tr_b16 v[106:107], v13 offset:51200
    v_mfma_f32_16x16x32_bf16 v[100:103], v[108:111], v[212:215], v[100:103]
    s_waitcnt lgkmcnt(6)
    v_add_u32 v56, s59, v1
    s_xor_b32 s59, s54, 1
    v_mfma_f32_16x16x32_bf16 v[72:75], v[112:115], v[216:219], v[72:75]
    s_mul_i32 s59, s59, 3072
    ds_read_b64_tr_b16 v[108:109], v14 offset:49152
    ds_read_b64_tr_b16 v[110:111], v14 offset:51200
    v_mfma_f32_16x16x32_bf16 v[76:79], v[112:115], v[220:223], v[76:79]
    s_add_u32 s59, s59, 0
    v_add_u32 v41, s59, v1
    s_xor_b32 s59, s54, 2
    v_mfma_f32_16x16x32_bf16 v[80:83], v[116:119], v[216:219], v[80:83]
    buffer_load_dwordx4 v7, s[20:23], s86 offen offset:2048 lds
    v_mfma_f32_16x16x32_bf16 v[84:87], v[116:119], v[220:223], v[84:87]
    s_waitcnt lgkmcnt(4)
    ds_read_b64_tr_b16 v[112:113], v15 offset:49152
    ds_read_b64_tr_b16 v[114:115], v15 offset:51200
    v_mfma_f32_16x16x32_bf16 v[88:91], v[120:123], v[216:219], v[88:91]
    s_mul_i32 s59, s59, 3072
    ds_read_b64_tr_b16 v[116:117], v16 offset:49152
    ds_read_b64_tr_b16 v[118:119], v16 offset:51200
    v_mfma_f32_16x16x32_bf16 v[92:95], v[120:123], v[220:223], v[92:95]
    s_add_u32 s59, s59, 1024
    v_add_u32 v42, s59, v1
    s_xor_b32 s59, s54, 3
    v_mfma_f32_16x16x32_bf16 v[96:99], v[124:127], v[216:219], v[96:99]
    buffer_load_dwordx4 v8, s[20:23], s86 offen offset:3072 lds
    v_mfma_f32_16x16x32_bf16 v[100:103], v[124:127], v[220:223], v[100:103]
    s_waitcnt lgkmcnt(4)
    ds_read_b64_tr_b16 v[120:121], v13 offset:53248
    ds_read_b64_tr_b16 v[122:123], v13 offset:55296
    s_waitcnt vmcnt(9)
    s_barrier
    s_mov_b64 exec, 2
    buffer_atomic_add v0, off, s[32:35], s47
    s_mov_b64 exec, -1
    v_mfma_f32_16x16x32_bf16 v[72:75], v[104:107], v[224:227], v[72:75]
    ds_read_b128 a[64:67], v20 offset:32768
    ds_read_b64_tr_b16 v[124:125], v14 offset:53248
    v_mfma_f32_16x16x32_bf16 v[76:79], v[104:107], v[228:231], v[76:79]
    ds_read_b128 a[68:71], v22 offset:32768
    ds_read_b64_tr_b16 v[126:127], v14 offset:55296
    v_mfma_f32_16x16x32_bf16 v[80:83], v[108:111], v[224:227], v[80:83]
    ds_read_b128 a[96:99], v21 offset:32768
    ds_read_b64_tr_b16 v[104:105], v15 offset:53248
    v_mfma_f32_16x16x32_bf16 v[84:87], v[108:111], v[228:231], v[84:87]
    s_waitcnt lgkmcnt(8)
    ds_read_b64_tr_b16 v[106:107], v15 offset:55296
    s_mul_i32 s59, s59, 3072
    v_mfma_f32_16x16x32_bf16 v[88:91], v[112:115], v[224:227], v[88:91]
    ds_read_b128 a[100:103], v23 offset:32768
    ds_read_b64_tr_b16 v[108:109], v16 offset:53248
    v_mfma_f32_16x16x32_bf16 v[92:95], v[112:115], v[228:231], v[92:95]
    s_add_u32 s59, s59, 2048
    ds_read_b64_tr_b16 v[110:111], v16 offset:55296
    v_add_u32 v43, s59, v1
    v_mfma_f32_16x16x32_bf16 v[96:99], v[116:119], v[224:227], v[96:99]
    s_waitcnt lgkmcnt(2)
    s_xor_b32 s93, s87, 0
    s_add_u32 m0, s88, 32768
    s_add_u32 s86, s93, s78
    v_mfma_f32_16x16x32_bf16 v[100:103], v[116:119], v[228:231], v[100:103]
    ds_read_b64_tr_b16 v[112:113], v13 offset:57344
    ds_read_b64_tr_b16 v[114:115], v13 offset:59392
    v_mfma_f32_16x16x32_bf16 v[72:75], v[120:123], v[232:235], v[72:75]
    buffer_load_dwordx4 v5, s[20:23], s86 offen lds
    v_mfma_f32_16x16x32_bf16 v[76:79], v[120:123], v[236:239], v[76:79]
    s_mul_i32 s59, s54, 3072
    ds_read_b64_tr_b16 v[116:117], v14 offset:57344
    ds_read_b64_tr_b16 v[118:119], v14 offset:59392
    v_mfma_f32_16x16x32_bf16 v[80:83], v[124:127], v[232:235], v[80:83]
    ds_read_b64_tr_b16 v[120:121], v15 offset:57344
    ds_read_b64_tr_b16 v[122:123], v15 offset:59392
    v_mfma_f32_16x16x32_bf16 v[84:87], v[124:127], v[236:239], v[84:87]
    s_waitcnt lgkmcnt(6)
    v_add_u32 v44, s59, v1
    v_lshlrev_b32 v45, 3, v0
    v_mfma_f32_16x16x32_bf16 v[88:91], v[104:107], v[232:235], v[88:91]
    buffer_load_dwordx4 v6, s[20:23], s86 offen offset:1024 lds
    v_mfma_f32_16x16x32_bf16 v[92:95], v[104:107], v[236:239], v[92:95]
    ds_read_b64_tr_b16 v[124:125], v16 offset:57344
    ds_read_b64_tr_b16 v[126:127], v16 offset:59392
    v_mfma_f32_16x16x32_bf16 v[96:99], v[108:111], v[232:235], v[96:99]
    ds_read_b64_tr_b16 v[104:105], v13 offset:61440
    ds_read_b64_tr_b16 v[106:107], v13 offset:63488
    v_mfma_f32_16x16x32_bf16 v[100:103], v[108:111], v[236:239], v[100:103]
    s_waitcnt lgkmcnt(6)
    v_lshlrev_b32 v48, 16, v34
    v_lshlrev_b32 v49, 16, v34
    v_mfma_f32_16x16x32_bf16 v[72:75], v[112:115], v[240:243], v[72:75]
    buffer_load_dwordx4 v7, s[20:23], s86 offen offset:2048 lds
    v_mfma_f32_16x16x32_bf16 v[76:79], v[112:115], v[244:247], v[76:79]
    ds_read_b64_tr_b16 v[108:109], v14 offset:61440
    ds_read_b64_tr_b16 v[110:111], v14 offset:63488
    v_mfma_f32_16x16x32_bf16 v[80:83], v[116:119], v[240:243], v[80:83]
    ds_read_b64_tr_b16 v[112:113], v15 offset:61440
    ds_read_b64_tr_b16 v[114:115], v15 offset:63488
    v_mfma_f32_16x16x32_bf16 v[84:87], v[116:119], v[244:247], v[84:87]
    s_waitcnt lgkmcnt(6)
    v_lshlrev_b32 v50, 16, v34
    v_lshlrev_b32 v51, 16, v34
    v_mfma_f32_16x16x32_bf16 v[88:91], v[120:123], v[240:243], v[88:91]
    buffer_load_dwordx4 v8, s[20:23], s86 offen offset:3072 lds
    v_mfma_f32_16x16x32_bf16 v[92:95], v[120:123], v[244:247], v[92:95]
    s_waitcnt vmcnt(13)
    ds_read_b128 a[72:75], v20 offset:36864
    ds_read_b64_tr_b16 v[116:117], v16 offset:61440
    v_mfma_f32_16x16x32_bf16 v[96:99], v[124:127], v[240:243], v[96:99]
    ds_read_b128 a[76:79], v22 offset:36864
    ds_read_b64_tr_b16 v[118:119], v16 offset:63488
    v_mfma_f32_16x16x32_bf16 v[100:103], v[124:127], v[244:247], v[100:103]
    s_waitcnt lgkmcnt(6)
    s_lshr_b32 s91, s64, 1
    s_lshl_b32 s91, s91, 10
    v_mfma_f32_16x16x32_bf16 v[72:75], v[104:107], v[248:251], v[72:75]
    ds_read_b128 a[104:107], v21 offset:36864
    s_and_b32 s59, s64, 1
    v_mfma_f32_16x16x32_bf16 v[76:79], v[104:107], v[252:255], v[76:79]
    ds_read_b128 a[108:111], v23 offset:36864
    s_lshl_b32 s59, s59, 3
    v_mfma_f32_16x16x32_bf16 v[80:83], v[108:111], v[248:251], v[80:83]
    s_add_u32 s91, s91, s59
    s_add_u32 s91, s91, s0
    s_lshl_b32 s92, s65, 9
    v_mfma_f32_16x16x32_bf16 v[84:87], v[108:111], v[252:255], v[84:87]
    s_waitcnt lgkmcnt(2)
    s_add_u32 s92, s92, s0
    s_lshl_b32 s36, s94, 12
    v_mfma_f32_16x16x32_bf16 v[88:91], v[112:115], v[248:251], v[88:91]
    s_waitcnt lgkmcnt(0)
    s_xor_b32 s93, s87, 131072
    s_add_u32 m0, s88, 36864
    s_add_u32 s86, s93, s78
    v_mfma_f32_16x16x32_bf16 v[92:95], v[112:115], v[252:255], v[92:95]
    buffer_load_dwordx4 v5, s[20:23], s86 offen lds
    v_mfma_f32_16x16x32_bf16 v[96:99], v[116:119], v[248:251], v[96:99]
    s_xor_b32 s37, s36, 524288
    s_add_u32 s36, s36, 11534336
    s_add_u32 s37, s37, 11534336
    v_mfma_f32_16x16x32_bf16 v[100:103], v[116:119], v[252:255], v[100:103]
    s_bfe_u32 s38, s57, 196608
    s_lshl_b32 s38, s38, 7
    s_add_u32 s38, s38, s3
    s_add_u32 s38, s38, 51200
    s_lshl_b32 s59, s51, 2
    s_add_u32 s38, s38, s59
    s_bfe_u32 s39, s58, 262144
    s_lshl_b32 s39, s39, 7
    s_add_u32 s39, s39, s3
    s_add_u32 s39, s39, 52224
    s_lshl_b32 s6, s53, 2
    s_add_u32 s6, s6, s39
    v_pk_mul_f32 v[104:105], v[72:73], v[72:73]
    v_pk_mul_f32 v[106:107], v[74:75], v[74:75]
    buffer_load_dwordx4 v6, s[20:23], s86 offen offset:1024 lds
    v_pk_mul_f32 v[108:109], v[76:77], v[76:77]
    v_pk_mul_f32 v[110:111], v[78:79], v[78:79]
    v_pk_mul_f32 v[112:113], v[80:81], v[80:81]
    v_pk_mul_f32 v[114:115], v[82:83], v[82:83]
    v_pk_mul_f32 v[116:117], v[84:85], v[84:85]
    v_pk_mul_f32 v[118:119], v[86:87], v[86:87]
    v_pk_fma_f32 v[104:105], v[104:105], s[82:83], v[32:33]
    v_pk_fma_f32 v[106:107], v[106:107], s[82:83], v[32:33]
    v_pk_fma_f32 v[108:109], v[108:109], s[82:83], v[32:33]
    v_pk_fma_f32 v[110:111], v[110:111], s[82:83], v[32:33]
    v_pk_fma_f32 v[112:113], v[112:113], s[82:83], v[32:33]
    v_pk_fma_f32 v[114:115], v[114:115], s[82:83], v[32:33]
    v_pk_fma_f32 v[116:117], v[116:117], s[82:83], v[32:33]
    v_pk_fma_f32 v[118:119], v[118:119], s[82:83], v[32:33]
    v_pk_mul_f32 v[104:105], v[104:105], v[72:73]
    v_pk_mul_f32 v[106:107], v[106:107], v[74:75]
    v_pk_mul_f32 v[108:109], v[108:109], v[76:77]
    buffer_load_dwordx4 v7, s[20:23], s86 offen offset:2048 lds
    v_pk_mul_f32 v[110:111], v[110:111], v[78:79]
    v_pk_mul_f32 v[112:113], v[112:113], v[80:81]
    v_pk_mul_f32 v[114:115], v[114:115], v[82:83]
    v_pk_mul_f32 v[116:117], v[116:117], v[84:85]
    v_pk_mul_f32 v[118:119], v[118:119], v[86:87]
    v_exp_f32 v104, v104
    v_exp_f32 v105, v105
    v_exp_f32 v106, v106
    v_exp_f32 v107, v107
    v_exp_f32 v108, v108
    v_exp_f32 v109, v109
    buffer_load_dwordx4 v8, s[20:23], s86 offen offset:3072 lds
    v_exp_f32 v110, v110
    v_exp_f32 v111, v111
    s_waitcnt vmcnt(13)
    ds_read_b128 a[80:83], v20 offset:0
    v_exp_f32 v112, v112
    v_exp_f32 v113, v113
    ds_read_b128 a[84:87], v22 offset:0
    v_exp_f32 v114, v114
    v_exp_f32 v115, v115
    ds_read_b128 a[112:115], v21 offset:0
    v_exp_f32 v116, v116
    v_exp_f32 v117, v117
    ds_read_b128 a[116:119], v23 offset:0
    v_exp_f32 v118, v118
    v_exp_f32 v119, v119
    v_pk_add_f32 v[104:105], v[104:105], s[84:85]
    v_pk_add_f32 v[106:107], v[106:107], s[84:85]
    v_pk_add_f32 v[108:109], v[108:109], s[84:85]
    v_pk_add_f32 v[110:111], v[110:111], s[84:85]
    v_pk_add_f32 v[112:113], v[112:113], s[84:85]
    v_pk_add_f32 v[114:115], v[114:115], s[84:85]
    v_pk_add_f32 v[116:117], v[116:117], s[84:85]
    v_pk_add_f32 v[118:119], v[118:119], s[84:85]
    v_rcp_f32 v104, v104
    s_waitcnt lgkmcnt(0)
    s_xor_b32 s93, s87, 1048576
    s_add_u32 m0, s88, 0
    s_add_u32 s86, s93, s78
    v_rcp_f32 v105, v105
    v_rcp_f32 v106, v106
    buffer_load_dwordx4 v5, s[20:23], s86 offen lds
    v_rcp_f32 v107, v107
    v_rcp_f32 v108, v108
    v_rcp_f32 v109, v109
    v_rcp_f32 v110, v110
    v_rcp_f32 v111, v111
    v_rcp_f32 v112, v112
    v_rcp_f32 v113, v113
    v_rcp_f32 v114, v114
    buffer_load_dwordx4 v6, s[20:23], s86 offen offset:1024 lds
    v_rcp_f32 v115, v115
    v_rcp_f32 v116, v116
    v_rcp_f32 v117, v117
    v_rcp_f32 v118, v118
    v_rcp_f32 v119, v119
    v_pk_mul_f32 v[72:73], v[72:73], v[104:105]
    v_pk_mul_f32 v[74:75], v[74:75], v[106:107]
    v_pk_mul_f32 v[76:77], v[76:77], v[108:109]
    v_pk_mul_f32 v[78:79], v[78:79], v[110:111]
    v_pk_mul_f32 v[80:81], v[80:81], v[112:113]
    v_pk_mul_f32 v[82:83], v[82:83], v[114:115]
    v_pk_mul_f32 v[84:85], v[84:85], v[116:117]
    buffer_load_dwordx4 v7, s[20:23], s86 offen offset:2048 lds
    v_pk_mul_f32 v[86:87], v[86:87], v[118:119]
    buffer_load_dwordx4 v8, s[20:23], s86 offen offset:3072 lds
    s_waitcnt vmcnt(13)
    ds_read_b128 a[88:91], v20 offset:4096
    ds_read_b128 a[92:95], v22 offset:4096
    ds_read_b128 a[120:123], v21 offset:4096
    ds_read_b128 a[124:127], v23 offset:4096
    s_waitcnt lgkmcnt(0)
    s_xor_b32 s93, s87, 1179648
    s_add_u32 m0, s88, 4096
    s_add_u32 s86, s93, s78
    buffer_load_dwordx4 v5, s[20:23], s86 offen lds
    buffer_load_dwordx4 v6, s[20:23], s86 offen offset:1024 lds
    buffer_load_dwordx4 v7, s[20:23], s86 offen offset:2048 lds
    buffer_load_dwordx4 v8, s[20:23], s86 offen offset:3072 lds
    buffer_load_dword v39, v57, s[32:35], 0 offen sc1
    s_waitcnt vmcnt(13)
    ds_read_b128 a[128:131], v20 offset:32768
    ds_read_b128 a[132:135], v22 offset:32768
    ds_read_b128 a[160:163], v21 offset:32768
    ds_read_b128 a[164:167], v23 offset:32768
    s_waitcnt vmcnt(9)
    ds_read_b128 a[136:139], v20 offset:36864
    ds_read_b128 a[140:143], v22 offset:36864
    ds_read_b128 a[168:171], v21 offset:36864
    ds_read_b128 a[172:175], v23 offset:36864
    s_waitcnt vmcnt(5)
    ds_read_b128 a[144:147], v20 offset:0
    ds_read_b128 a[148:151], v22 offset:0
    ds_read_b128 a[176:179], v21 offset:0
    ds_read_b128 a[180:183], v23 offset:0
    s_waitcnt vmcnt(1)
    ds_read_b128 a[152:155], v20 offset:4096
    ds_read_b128 a[156:159], v22 offset:4096
    ds_read_b128 a[184:187], v21 offset:4096
    ds_read_b128 a[188:191], v23 offset:4096
    s_waitcnt vmcnt(0)
    v_cmp_ne_u32 vcc, s5, v39
    s_cbranch_vccnz Lrt_83
Lrtd_84:
    s_waitcnt lgkmcnt(0)
    s_barrier
    buffer_load_dwordx4 v[128:131], v56, s[32:35], s72 offen offset:0 sc1
    buffer_load_dwordx4 v[132:135], v56, s[32:35], s72 offen offset:1024 sc1
    buffer_load_dwordx4 v[136:139], v56, s[32:35], s73 offen offset:0 sc1
    buffer_load_dwordx4 v[140:143], v56, s[32:35], s73 offen offset:1024 sc1
    buffer_load_dwordx4 v[144:147], v56, s[32:35], s74 offen offset:0 sc1
    buffer_load_dwordx4 v[148:151], v56, s[32:35], s74 offen offset:1024 sc1
    buffer_load_dwordx4 v[152:155], v56, s[32:35], s75 offen offset:0 sc1
    buffer_load_dwordx4 v[156:159], v56, s[32:35], s75 offen offset:1024 sc1
    v_pk_mul_f32 v[104:105], v[88:89], v[88:89]
    v_pk_mul_f32 v[106:107], v[90:91], v[90:91]
    v_pk_mul_f32 v[108:109], v[92:93], v[92:93]
    v_pk_mul_f32 v[110:111], v[94:95], v[94:95]
    v_pk_mul_f32 v[112:113], v[96:97], v[96:97]
    v_pk_mul_f32 v[114:115], v[98:99], v[98:99]
    v_pk_mul_f32 v[116:117], v[100:101], v[100:101]
    v_pk_mul_f32 v[118:119], v[102:103], v[102:103]
    v_pk_fma_f32 v[104:105], v[104:105], s[82:83], v[32:33]
    v_pk_fma_f32 v[106:107], v[106:107], s[82:83], v[32:33]
    v_pk_fma_f32 v[108:109], v[108:109], s[82:83], v[32:33]
    v_pk_fma_f32 v[110:111], v[110:111], s[82:83], v[32:33]
    v_pk_fma_f32 v[112:113], v[112:113], s[82:83], v[32:33]
    v_pk_fma_f32 v[114:115], v[114:115], s[82:83], v[32:33]
    v_pk_fma_f32 v[116:117], v[116:117], s[82:83], v[32:33]
    v_pk_fma_f32 v[118:119], v[118:119], s[82:83], v[32:33]
    v_pk_mul_f32 v[104:105], v[104:105], v[88:89]
    v_pk_mul_f32 v[106:107], v[106:107], v[90:91]
    v_pk_mul_f32 v[108:109], v[108:109], v[92:93]
    v_pk_mul_f32 v[110:111], v[110:111], v[94:95]
    v_pk_mul_f32 v[112:113], v[112:113], v[96:97]
    v_pk_mul_f32 v[114:115], v[114:115], v[98:99]
    v_pk_mul_f32 v[116:117], v[116:117], v[100:101]
    v_pk_mul_f32 v[118:119], v[118:119], v[102:103]
    s_lshl_b32 s7, s65, 16
    s_add_u32 s7, s7, s4
    v_add_u32 v56, s7, v1
    buffer_load_dwordx4 v[160:163], v56, s[32:35], s72 offen offset:0 sc1
    v_exp_f32 v104, v104
    v_exp_f32 v105, v105
    v_exp_f32 v106, v106
    v_exp_f32 v107, v107
    v_exp_f32 v108, v108
    v_exp_f32 v109, v109
    v_exp_f32 v110, v110
    v_exp_f32 v111, v111
    v_exp_f32 v112, v112
    v_exp_f32 v113, v113
    v_exp_f32 v114, v114
    v_exp_f32 v115, v115
    buffer_load_dwordx4 v[164:167], v56, s[32:35], s72 offen offset:1024 sc1
    v_exp_f32 v116, v116
    v_exp_f32 v117, v117
    v_exp_f32 v118, v118
    v_exp_f32 v119, v119
    v_pk_add_f32 v[104:105], v[104:105], s[84:85]
    v_pk_add_f32 v[106:107], v[106:107], s[84:85]
    v_pk_add_f32 v[108:109], v[108:109], s[84:85]
    v_pk_add_f32 v[110:111], v[110:111], s[84:85]
    v_pk_add_f32 v[112:113], v[112:113], s[84:85]
    v_pk_add_f32 v[114:115], v[114:115], s[84:85]
    v_pk_add_f32 v[116:117], v[116:117], s[84:85]
    v_pk_add_f32 v[118:119], v[118:119], s[84:85]
    v_rcp_f32 v104, v104
    v_rcp_f32 v105, v105
    v_rcp_f32 v106, v106
    v_rcp_f32 v107, v107
    buffer_load_dwordx4 v[168:171], v56, s[32:35], s73 offen offset:0 sc1
    v_rcp_f32 v108, v108
    v_rcp_f32 v109, v109
    v_rcp_f32 v110, v110
    v_rcp_f32 v111, v111
    v_rcp_f32 v112, v112
    v_rcp_f32 v113, v113
    v_rcp_f32 v114, v114
    v_rcp_f32 v115, v115
    v_rcp_f32 v116, v116
    v_rcp_f32 v117, v117
    v_rcp_f32 v118, v118
    v_rcp_f32 v119, v119
    buffer_load_dwordx4 v[172:175], v56, s[32:35], s73 offen offset:1024 sc1
    v_pk_mul_f32 v[88:89], v[88:89], v[104:105]
    v_pk_mul_f32 v[90:91], v[90:91], v[106:107]
    v_pk_mul_f32 v[92:93], v[92:93], v[108:109]
    v_pk_mul_f32 v[94:95], v[94:95], v[110:111]
    v_pk_mul_f32 v[96:97], v[96:97], v[112:113]
    v_pk_mul_f32 v[98:99], v[98:99], v[114:115]
    v_pk_mul_f32 v[100:101], v[100:101], v[116:117]
    v_pk_mul_f32 v[102:103], v[102:103], v[118:119]
    buffer_load_dwordx4 v[176:179], v56, s[32:35], s74 offen offset:0 sc1
    s_lshl_b32 s59, s51, 11
    s_add_u32 s59, s59, s1
    s_add_u32 s60, s59, 34816
    v_cvt_pk_bf16_f32 v240, v72, v73
    v_cvt_pk_bf16_f32 v241, v74, v75
    v_cvt_pk_bf16_f32 v242, v80, v81
    v_cvt_pk_bf16_f32 v243, v82, v83
    buffer_store_dwordx4 v[240:243], v1, s[32:35], s59 offen offset:0 sc1
    v_cvt_pk_bf16_f32 v244, v88, v89
    v_cvt_pk_bf16_f32 v245, v90, v91
    v_cvt_pk_bf16_f32 v246, v96, v97
    v_cvt_pk_bf16_f32 v247, v98, v99
    buffer_store_dwordx4 v[244:247], v1, s[32:35], s59 offen offset:1024 sc1
    v_cvt_pk_bf16_f32 v248, v76, v77
    v_cvt_pk_bf16_f32 v249, v78, v79
    v_cvt_pk_bf16_f32 v250, v84, v85
    v_cvt_pk_bf16_f32 v251, v86, v87
    buffer_store_dwordx4 v[248:251], v1, s[32:35], s60 offen offset:0 sc1
    v_cvt_pk_bf16_f32 v252, v92, v93
    v_cvt_pk_bf16_f32 v253, v94, v95
    v_cvt_pk_bf16_f32 v254, v100, v101
    v_cvt_pk_bf16_f32 v255, v102, v103
    buffer_store_dwordx4 v[252:255], v1, s[32:35], s60 offen offset:1024 sc1
Lp3_76:
    s_waitcnt vmcnt(16)
    v_mfma_f32_16x16x32_bf16 v[64:67], v[128:131], a[20:23], 0
    buffer_load_dwordx4 v[180:183], v56, s[32:35], s74 offen offset:1024 sc1
    s_waitcnt vmcnt(16)
    v_mfma_f32_16x16x32_bf16 v[64:67], v[132:135], a[52:55], v[64:67]
    s_waitcnt vmcnt(15)
    v_mfma_f32_16x16x32_bf16 v[64:67], v[136:139], a[84:87], v[64:67]
    s_waitcnt vmcnt(14)
    v_mfma_f32_16x16x32_bf16 v[64:67], v[140:143], a[116:119], v[64:67]
    v_lshrrev_b32 v36, 3, v0
    v_lshlrev_b32 v37, 1, v4
    v_xor_b32 v37, v37, v0
    v_and_b32 v37, 7, v37
    v_mul_u32_u24 v36, 1024, v36
    v_lshl_add_u32 v9, v37, 4, v36
    v_add_u32 v10, 7168, v9
    v_add_u32 v11, 14336, v9
    v_add_u32 v12, 21504, v9
    s_lshl_b32 s89, s53, 7
    s_mul_i32 s93, s54, 229376
    s_add_u32 s89, s89, s93
    s_mul_i32 s90, s54, 28672
    s_add_u32 m0, s90, 49152
    s_add_u32 s86, s89, 0
    s_waitcnt vmcnt(13)
    v_mfma_f32_16x16x32_bf16 v[64:67], v[144:147], a[148:151], v[64:67]
    buffer_load_dwordx4 v[184:187], v56, s[32:35], s75 offen offset:0 sc1
    s_waitcnt vmcnt(13)
    v_mfma_f32_16x16x32_bf16 v[64:67], v[148:151], a[180:183], v[64:67]
    s_waitcnt vmcnt(12)
    v_mfma_f32_16x16x32_bf16 v[64:67], v[152:155], a[212:215], v[64:67]
    s_waitcnt vmcnt(11)
    v_mfma_f32_16x16x32_bf16 v[64:67], v[156:159], a[244:247], v[64:67]
    v_mfma_f32_16x16x32_bf16 v[68:71], v[128:131], a[24:27], 0
    buffer_load_dwordx4 v[188:191], v56, s[32:35], s75 offen offset:1024 sc1
    v_mfma_f32_16x16x32_bf16 v[68:71], v[132:135], a[56:59], v[68:71]
    v_mfma_f32_16x16x32_bf16 v[68:71], v[136:139], a[88:91], v[68:71]
    v_mfma_f32_16x16x32_bf16 v[68:71], v[140:143], a[120:123], v[68:71]
    v_mfma_f32_16x16x32_bf16 v[68:71], v[144:147], a[152:155], v[68:71]
    s_lshl_b32 s7, s66, 16
    s_add_u32 s7, s7, s4
    v_add_u32 v56, s7, v1
    buffer_load_dwordx4 v[192:195], v56, s[32:35], s72 offen offset:0 sc1
    v_mfma_f32_16x16x32_bf16 v[68:71], v[148:151], a[184:187], v[68:71]
    v_mfma_f32_16x16x32_bf16 v[68:71], v[152:155], a[216:219], v[68:71]
    ds_write_b128 v41, v[64:67] offset:0
    v_mfma_f32_16x16x32_bf16 v[68:71], v[156:159], a[248:251], v[68:71]
    v_mfma_f32_16x16x32_bf16 v[72:75], v[128:131], a[28:31], 0
    buffer_load_dwordx4 v[196:199], v56, s[32:35], s72 offen offset:1024 sc1
    v_mfma_f32_16x16x32_bf16 v[72:75], v[132:135], a[60:63], v[72:75]
    v_mfma_f32_16x16x32_bf16 v[72:75], v[136:139], a[92:95], v[72:75]
    v_mfma_f32_16x16x32_bf16 v[72:75], v[140:143], a[124:127], v[72:75]
    v_mfma_f32_16x16x32_bf16 v[72:75], v[144:147], a[156:159], v[72:75]
    buffer_load_dwordx4 v[200:203], v56, s[32:35], s73 offen offset:0 sc1
    v_mfma_f32_16x16x32_bf16 v[72:75], v[148:151], a[188:191], v[72:75]
    v_mfma_f32_16x16x32_bf16 v[72:75], v[152:155], a[220:223], v[72:75]
    ds_write_b128 v42, v[68:71] offset:0
    v_mfma_f32_16x16x32_bf16 v[72:75], v[156:159], a[252:255], v[72:75]
    v_mfma_f32_16x16x32_bf16 v[76:79], v[128:131], a[16:19], 0
    buffer_load_dwordx4 v[204:207], v56, s[32:35], s73 offen offset:1024 sc1
    v_mfma_f32_16x16x32_bf16 v[76:79], v[132:135], a[48:51], v[76:79]
    v_mfma_f32_16x16x32_bf16 v[76:79], v[136:139], a[80:83], v[76:79]
    v_mfma_f32_16x16x32_bf16 v[76:79], v[140:143], a[112:115], v[76:79]
    v_mfma_f32_16x16x32_bf16 v[76:79], v[144:147], a[144:147], v[76:79]
    buffer_load_dwordx4 v9, s[24:27], s86 offen lds
    v_mfma_f32_16x16x32_bf16 v[76:79], v[148:151], a[176:179], v[76:79]
    v_mfma_f32_16x16x32_bf16 v[76:79], v[152:155], a[208:211], v[76:79]
    ds_write_b128 v43, v[72:75] offset:0
    v_mfma_f32_16x16x32_bf16 v[76:79], v[156:159], a[240:243], v[76:79]
    v_mfma_f32_16x16x32_bf16 v[84:87], v[128:131], a[4:7], 0
    buffer_load_dwordx4 v[208:211], v56, s[32:35], s74 offen offset:0 sc1
    v_mfma_f32_16x16x32_bf16 v[84:87], v[132:135], a[36:39], v[84:87]
    v_mfma_f32_16x16x32_bf16 v[84:87], v[136:139], a[68:71], v[84:87]
    v_mfma_f32_16x16x32_bf16 v[84:87], v[140:143], a[100:103], v[84:87]
    s_waitcnt lgkmcnt(0)
    s_barrier
    v_mfma_f32_16x16x32_bf16 v[84:87], v[144:147], a[132:135], v[84:87]
    ds_read_b128 v[104:107], v44 offset:0
    ds_read_b128 v[108:111], v44 offset:1024
    v_mfma_f32_16x16x32_bf16 v[84:87], v[148:151], a[164:167], v[84:87]
    ds_read_b128 v[112:115], v44 offset:2048
    v_mfma_f32_16x16x32_bf16 v[84:87], v[152:155], a[196:199], v[84:87]
    v_mfma_f32_16x16x32_bf16 v[84:87], v[156:159], a[228:231], v[84:87]
    v_mfma_f32_16x16x32_bf16 v[88:91], v[128:131], a[8:11], 0
    buffer_load_dwordx4 v[212:215], v56, s[32:35], s74 offen offset:1024 sc1
    v_mfma_f32_16x16x32_bf16 v[88:91], v[132:135], a[40:43], v[88:91]
    v_mfma_f32_16x16x32_bf16 v[88:91], v[136:139], a[72:75], v[88:91]
    v_mfma_f32_16x16x32_bf16 v[88:91], v[140:143], a[104:107], v[88:91]
    v_mfma_f32_16x16x32_bf16 v[88:91], v[144:147], a[136:139], v[88:91]
    buffer_load_dwordx4 v10, s[24:27], s86 offen offset:1024 lds
    v_mfma_f32_16x16x32_bf16 v[88:91], v[148:151], a[168:171], v[88:91]
    s_waitcnt lgkmcnt(1)
    v_add_f32 v104, v104, v108
    v_add_f32 v105, v105, v109
    v_mfma_f32_16x16x32_bf16 v[88:91], v[152:155], a[200:203], v[88:91]
    ds_write_b128 v41, v[84:87] offset:12288
    v_mfma_f32_16x16x32_bf16 v[88:91], v[156:159], a[232:235], v[88:91]
    v_add_f32 v106, v106, v110
    v_add_f32 v107, v107, v111
    v_mfma_f32_16x16x32_bf16 v[92:95], v[128:131], a[12:15], 0
    buffer_load_dwordx4 v[216:219], v56, s[32:35], s75 offen offset:0 sc1
    v_mfma_f32_16x16x32_bf16 v[92:95], v[132:135], a[44:47], v[92:95]
    s_waitcnt lgkmcnt(1)
    v_add_f32 v112, v112, v76
    v_add_f32 v113, v113, v77
    v_mfma_f32_16x16x32_bf16 v[92:95], v[136:139], a[76:79], v[92:95]
    v_add_f32 v114, v114, v78
    v_add_f32 v115, v115, v79
    v_mfma_f32_16x16x32_bf16 v[92:95], v[140:143], a[108:111], v[92:95]
    v_add_f32 v104, v104, v112
    v_add_f32 v105, v105, v113
    v_mfma_f32_16x16x32_bf16 v[92:95], v[144:147], a[140:143], v[92:95]
    v_add_f32 v106, v106, v114
    v_add_f32 v107, v107, v115
    v_mfma_f32_16x16x32_bf16 v[92:95], v[148:151], a[172:175], v[92:95]
    v_cvt_pk_bf16_f32 v62, v104, v105
    v_cvt_pk_bf16_f32 v63, v106, v107
    v_mfma_f32_16x16x32_bf16 v[92:95], v[152:155], a[204:207], v[92:95]
    ds_write_b128 v42, v[88:91] offset:12288
    v_mfma_f32_16x16x32_bf16 v[92:95], v[156:159], a[236:239], v[92:95]
    buffer_store_dwordx2 v[62:63], v45, s[32:35], s37 offen offset:0 sc1
    v_mfma_f32_16x16x32_bf16 v[80:83], v[128:131], a[0:3], v[48:51]
    buffer_load_dwordx4 v[220:223], v56, s[32:35], s75 offen offset:1024 sc1
    v_mfma_f32_16x16x32_bf16 v[80:83], v[132:135], a[32:35], v[80:83]
    v_mfma_f32_16x16x32_bf16 v[80:83], v[136:139], a[64:67], v[80:83]
    v_mfma_f32_16x16x32_bf16 v[80:83], v[140:143], a[96:99], v[80:83]
    v_mfma_f32_16x16x32_bf16 v[80:83], v[144:147], a[128:131], v[80:83]
    buffer_load_dwordx4 v11, s[24:27], s86 offen offset:2048 lds
    v_mfma_f32_16x16x32_bf16 v[80:83], v[148:151], a[160:163], v[80:83]
    v_mfma_f32_16x16x32_bf16 v[80:83], v[152:155], a[192:195], v[80:83]
    ds_write_b128 v43, v[92:95] offset:12288
    v_mfma_f32_16x16x32_bf16 v[80:83], v[156:159], a[224:227], v[80:83]
    s_waitcnt vmcnt(20)
    v_mfma_f32_16x16x32_bf16 v[64:67], v[160:163], a[20:23], 0
    s_lshl_b32 s7, s67, 16
    s_add_u32 s7, s7, s4
    v_add_u32 v56, s7, v1
    buffer_load_dwordx4 v[128:131], v56, s[32:35], s72 offen offset:0 sc1
    v_mfma_f32_16x16x32_bf16 v[64:67], v[164:167], a[52:55], v[64:67]
    v_mfma_f32_16x16x32_bf16 v[64:67], v[168:171], a[84:87], v[64:67]
    v_mfma_f32_16x16x32_bf16 v[64:67], v[172:175], a[116:119], v[64:67]
    s_waitcnt vmcnt(13)
    s_mov_b64 exec, 2
    buffer_store_dword v0, off, s[32:35], s38 offset:0 sc1
    s_mov_b64 exec, -1
    v_mfma_f32_16x16x32_bf16 v[64:67], v[176:179], a[148:151], v[64:67]
    v_mfma_f32_16x16x32_bf16 v[64:67], v[180:183], a[180:183], v[64:67]
    v_mfma_f32_16x16x32_bf16 v[64:67], v[184:187], a[212:215], v[64:67]
    v_mfma_f32_16x16x32_bf16 v[64:67], v[188:191], a[244:247], v[64:67]
    v_mfma_f32_16x16x32_bf16 v[68:71], v[160:163], a[24:27], 0
    buffer_load_dwordx4 v[132:135], v56, s[32:35], s72 offen offset:1024 sc1
    v_mfma_f32_16x16x32_bf16 v[68:71], v[164:167], a[56:59], v[68:71]
    v_mfma_f32_16x16x32_bf16 v[68:71], v[168:171], a[88:91], v[68:71]
    v_mfma_f32_16x16x32_bf16 v[68:71], v[172:175], a[120:123], v[68:71]
    v_mfma_f32_16x16x32_bf16 v[68:71], v[176:179], a[152:155], v[68:71]
    buffer_load_dwordx4 v12, s[24:27], s86 offen offset:3072 lds
    v_mfma_f32_16x16x32_bf16 v[68:71], v[180:183], a[184:187], v[68:71]
    v_mfma_f32_16x16x32_bf16 v[68:71], v[184:187], a[216:219], v[68:71]
    ds_write_b128 v41, v[64:67] offset:24576
    v_mfma_f32_16x16x32_bf16 v[68:71], v[188:191], a[248:251], v[68:71]
    s_add_u32 m0, s90, 61440
    s_add_u32 s86, s89, 98304
    v_mfma_f32_16x16x32_bf16 v[72:75], v[160:163], a[28:31], 0
    buffer_load_dwordx4 v[136:139], v56, s[32:35], s73 offen offset:0 sc1
    v_mfma_f32_16x16x32_bf16 v[72:75], v[164:167], a[60:63], v[72:75]
    v_mfma_f32_16x16x32_bf16 v[72:75], v[168:171], a[92:95], v[72:75]
    v_mfma_f32_16x16x32_bf16 v[72:75], v[172:175], a[124:127], v[72:75]
    v_mfma_f32_16x16x32_bf16 v[72:75], v[176:179], a[156:159], v[72:75]
    v_mfma_f32_16x16x32_bf16 v[72:75], v[180:183], a[188:191], v[72:75]
    v_mfma_f32_16x16x32_bf16 v[72:75], v[184:187], a[220:223], v[72:75]
    ds_write_b128 v42, v[68:71] offset:24576
    v_mfma_f32_16x16x32_bf16 v[72:75], v[188:191], a[252:255], v[72:75]
    v_mfma_f32_16x16x32_bf16 v[96:99], v[160:163], a[16:19], 0
    buffer_load_dwordx4 v[140:143], v56, s[32:35], s73 offen offset:1024 sc1
    v_mfma_f32_16x16x32_bf16 v[96:99], v[164:167], a[48:51], v[96:99]
    v_mfma_f32_16x16x32_bf16 v[96:99], v[168:171], a[80:83], v[96:99]
    v_mfma_f32_16x16x32_bf16 v[96:99], v[172:175], a[112:115], v[96:99]
    v_mfma_f32_16x16x32_bf16 v[96:99], v[176:179], a[144:147], v[96:99]
    v_mfma_f32_16x16x32_bf16 v[96:99], v[180:183], a[176:179], v[96:99]
    v_mfma_f32_16x16x32_bf16 v[96:99], v[184:187], a[208:211], v[96:99]
    ds_write_b128 v43, v[72:75] offset:24576
    v_mfma_f32_16x16x32_bf16 v[96:99], v[188:191], a[240:243], v[96:99]
    v_mfma_f32_16x16x32_bf16 v[84:87], v[160:163], a[4:7], 0
    buffer_load_dwordx4 v[144:147], v56, s[32:35], s74 offen offset:0 sc1
    v_mfma_f32_16x16x32_bf16 v[84:87], v[164:167], a[36:39], v[84:87]
    v_mfma_f32_16x16x32_bf16 v[84:87], v[168:171], a[68:71], v[84:87]
    v_mfma_f32_16x16x32_bf16 v[84:87], v[172:175], a[100:103], v[84:87]
    s_waitcnt lgkmcnt(0)
    s_barrier
    v_mfma_f32_16x16x32_bf16 v[84:87], v[176:179], a[132:135], v[84:87]
    buffer_load_dwordx4 v9, s[24:27], s86 offen lds
    v_mfma_f32_16x16x32_bf16 v[84:87], v[180:183], a[164:167], v[84:87]
    ds_read_b128 v[104:107], v44 offset:24576
    ds_read_b128 v[108:111], v44 offset:25600
    v_mfma_f32_16x16x32_bf16 v[84:87], v[184:187], a[196:199], v[84:87]
    ds_read_b128 v[112:115], v44 offset:26624
    ds_read_b128 v[116:119], v44 offset:12288
    v_mfma_f32_16x16x32_bf16 v[84:87], v[188:191], a[228:231], v[84:87]
    ds_read_b128 v[120:123], v44 offset:13312
    ds_read_b128 v[124:127], v44 offset:14336
    v_mfma_f32_16x16x32_bf16 v[88:91], v[160:163], a[8:11], 0
    buffer_load_dwordx4 v[148:151], v56, s[32:35], s74 offen offset:1024 sc1
    v_mfma_f32_16x16x32_bf16 v[88:91], v[164:167], a[40:43], v[88:91]
    buffer_load_dword v39, v40, s[32:35], 0 offen sc1
    v_mfma_f32_16x16x32_bf16 v[88:91], v[168:171], a[72:75], v[88:91]
    v_mfma_f32_16x16x32_bf16 v[88:91], v[172:175], a[104:107], v[88:91]
    v_mfma_f32_16x16x32_bf16 v[88:91], v[176:179], a[136:139], v[88:91]
    s_waitcnt lgkmcnt(4)
    v_add_f32 v104, v104, v108
    v_add_f32 v105, v105, v109
    v_mfma_f32_16x16x32_bf16 v[88:91], v[180:183], a[168:171], v[88:91]
    v_add_f32 v106, v106, v110
    v_add_f32 v107, v107, v111
    v_mfma_f32_16x16x32_bf16 v[88:91], v[184:187], a[200:203], v[88:91]
    ds_write_b128 v41, v[84:87] offset:36864
    v_mfma_f32_16x16x32_bf16 v[88:91], v[188:191], a[232:235], v[88:91]
    s_waitcnt lgkmcnt(4)
    v_add_f32 v112, v112, v96
    v_add_f32 v113, v113, v97
    v_mfma_f32_16x16x32_bf16 v[92:95], v[160:163], a[12:15], 0
    buffer_load_dwordx4 v[152:155], v56, s[32:35], s75 offen offset:0 sc1
    v_mfma_f32_16x16x32_bf16 v[92:95], v[164:167], a[44:47], v[92:95]
    v_add_f32 v114, v114, v98
    v_add_f32 v115, v115, v99
    v_mfma_f32_16x16x32_bf16 v[92:95], v[168:171], a[76:79], v[92:95]
    v_add_f32 v104, v104, v112
    v_add_f32 v105, v105, v113
    v_mfma_f32_16x16x32_bf16 v[92:95], v[172:175], a[108:111], v[92:95]
    v_add_f32 v106, v106, v114
    v_add_f32 v107, v107, v115
    v_mfma_f32_16x16x32_bf16 v[92:95], v[176:179], a[140:143], v[92:95]
    buffer_load_dwordx4 v10, s[24:27], s86 offen offset:1024 lds
    v_mfma_f32_16x16x32_bf16 v[92:95], v[180:183], a[172:175], v[92:95]
    v_cvt_pk_bf16_f32 v62, v104, v105
    v_cvt_pk_bf16_f32 v63, v106, v107
    v_mfma_f32_16x16x32_bf16 v[92:95], v[184:187], a[204:207], v[92:95]
    ds_write_b128 v42, v[88:91] offset:36864
    v_mfma_f32_16x16x32_bf16 v[92:95], v[188:191], a[236:239], v[92:95]
    buffer_store_dwordx2 v[62:63], v45, s[32:35], s37 offen offset:512 sc1
    s_waitcnt lgkmcnt(3)
    v_add_f32 v116, v116, v120
    v_mfma_f32_16x16x32_bf16 v[100:103], v[160:163], a[0:3], v[48:51]
    buffer_load_dwordx4 v[156:159], v56, s[32:35], s75 offen offset:1024 sc1
    v_mfma_f32_16x16x32_bf16 v[100:103], v[164:167], a[32:35], v[100:103]
    v_add_f32 v117, v117, v121
    v_add_f32 v118, v118, v122
    v_mfma_f32_16x16x32_bf16 v[100:103], v[168:171], a[64:67], v[100:103]
    v_add_f32 v119, v119, v123
    s_waitcnt lgkmcnt(2)
    v_add_f32 v124, v124, v80
    v_mfma_f32_16x16x32_bf16 v[100:103], v[172:175], a[96:99], v[100:103]
    v_add_f32 v125, v125, v81
    v_add_f32 v126, v126, v82
    v_mfma_f32_16x16x32_bf16 v[100:103], v[176:179], a[128:131], v[100:103]
    v_add_f32 v127, v127, v83
    v_add_f32 v240, v116, v124
    v_mfma_f32_16x16x32_bf16 v[100:103], v[180:183], a[160:163], v[100:103]
    v_add_f32 v241, v117, v125
    v_add_f32 v242, v118, v126
    v_mfma_f32_16x16x32_bf16 v[100:103], v[184:187], a[192:195], v[100:103]
    ds_write_b128 v43, v[92:95] offset:36864
    v_mfma_f32_16x16x32_bf16 v[100:103], v[188:191], a[224:227], v[100:103]
    s_waitcnt vmcnt(22)
    v_add_f32 v243, v119, v127
    v_mfma_f32_16x16x32_bf16 v[64:67], v[192:195], a[20:23], 0
    s_lshl_b32 s7, s68, 16
    s_add_u32 s7, s7, s4
    v_add_u32 v56, s7, v1
    buffer_load_dwordx4 v[160:163], v56, s[32:35], s72 offen offset:0 sc1
    v_mfma_f32_16x16x32_bf16 v[64:67], v[196:199], a[52:55], v[64:67]
    v_mfma_f32_16x16x32_bf16 v[64:67], v[200:203], a[84:87], v[64:67]
    v_mfma_f32_16x16x32_bf16 v[64:67], v[204:207], a[116:119], v[64:67]
    s_waitcnt vmcnt(16)
    v_mfma_f32_16x16x32_bf16 v[64:67], v[208:211], a[148:151], v[64:67]
    buffer_load_dwordx4 v11, s[24:27], s86 offen offset:2048 lds
    v_mfma_f32_16x16x32_bf16 v[64:67], v[212:215], a[180:183], v[64:67]
    v_mfma_f32_16x16x32_bf16 v[64:67], v[216:219], a[212:215], v[64:67]
    v_mfma_f32_16x16x32_bf16 v[64:67], v[220:223], a[244:247], v[64:67]
    v_mfma_f32_16x16x32_bf16 v[68:71], v[192:195], a[24:27], 0
    buffer_load_dwordx4 v[164:167], v56, s[32:35], s72 offen offset:1024 sc1
    v_mfma_f32_16x16x32_bf16 v[68:71], v[196:199], a[56:59], v[68:71]
    v_mfma_f32_16x16x32_bf16 v[68:71], v[200:203], a[88:91], v[68:71]
    v_mfma_f32_16x16x32_bf16 v[68:71], v[204:207], a[120:123], v[68:71]
    v_mfma_f32_16x16x32_bf16 v[68:71], v[208:211], a[152:155], v[68:71]
    s_waitcnt vmcnt(7)
    v_cmp_ne_u32 vcc, 1, v39
    v_mfma_f32_16x16x32_bf16 v[68:71], v[212:215], a[184:187], v[68:71]
    v_mfma_f32_16x16x32_bf16 v[68:71], v[216:219], a[216:219], v[68:71]
    ds_write_b128 v41, v[64:67] offset:0
    v_mfma_f32_16x16x32_bf16 v[68:71], v[220:223], a[248:251], v[68:71]
    s_cbranch_vccnz Lrt_89
Lrtd_90:
    v_mfma_f32_16x16x32_bf16 v[72:75], v[192:195], a[28:31], 0
    buffer_load_dwordx4 v[168:171], v56, s[32:35], s73 offen offset:0 sc1
    v_mfma_f32_16x16x32_bf16 v[72:75], v[196:199], a[60:63], v[72:75]
    buffer_load_dwordx2 v[224:225], v1, s[32:35], s91 offen sc1
    v_mfma_f32_16x16x32_bf16 v[72:75], v[200:203], a[92:95], v[72:75]
    v_mfma_f32_16x16x32_bf16 v[72:75], v[204:207], a[124:127], v[72:75]
    v_mfma_f32_16x16x32_bf16 v[72:75], v[208:211], a[156:159], v[72:75]
    s_and_b32 s60, s54, 1
    s_mul_i32 s61, s60, 14336
    v_mfma_f32_16x16x32_bf16 v[72:75], v[212:215], a[188:191], v[72:75]
    buffer_load_dwordx4 v[226:229], v1, s[32:35], s92 offen offset:0 sc1
    v_mfma_f32_16x16x32_bf16 v[72:75], v[216:219], a[220:223], v[72:75]
    ds_write_b128 v42, v[68:71] offset:0
    v_mfma_f32_16x16x32_bf16 v[72:75], v[220:223], a[252:255], v[72:75]
    s_add_u32 s8, s0, s61
    s_xor_b32 s9, s58, 1
    v_mfma_f32_16x16x32_bf16 v[76:79], v[192:195], a[16:19], 0
    buffer_load_dwordx4 v[172:175], v56, s[32:35], s73 offen offset:1024 sc1
    v_mfma_f32_16x16x32_bf16 v[76:79], v[196:199], a[48:51], v[76:79]
    buffer_load_dwordx4 v[230:233], v1, s[32:35], s92 offen offset:1024 sc1
    v_mfma_f32_16x16x32_bf16 v[76:79], v[200:203], a[80:83], v[76:79]
    s_mul_i32 s9, s9, 34816
    s_add_u32 s9, s9, s61
    v_mfma_f32_16x16x32_bf16 v[76:79], v[204:207], a[112:115], v[76:79]
    s_andn2_b32 s62, s39, 128
    s_lshl_b32 s60, s60, 4
    v_mfma_f32_16x16x32_bf16 v[76:79], v[208:211], a[144:147], v[76:79]
    buffer_load_dwordx4 v12, s[24:27], s86 offen offset:3072 lds
    v_mfma_f32_16x16x32_bf16 v[76:79], v[212:215], a[176:179], v[76:79]
    buffer_load_dwordx4 v[234:237], v1, s[32:35], s92 offen offset:2048 sc1
    v_mfma_f32_16x16x32_bf16 v[76:79], v[216:219], a[208:211], v[76:79]
    ds_write_b128 v43, v[72:75] offset:0
    v_mfma_f32_16x16x32_bf16 v[76:79], v[220:223], a[240:243], v[76:79]
    s_add_u32 m0, s90, 65536
    s_add_u32 s86, s89, 131072
    s_add_u32 s62, s62, s60
    v_mfma_f32_16x16x32_bf16 v[84:87], v[192:195], a[4:7], 0
    buffer_load_dwordx4 v[176:179], v56, s[32:35], s74 offen offset:0 sc1
    v_mfma_f32_16x16x32_bf16 v[84:87], v[196:199], a[36:39], v[84:87]
    buffer_load_dwordx2 v[52:53], v45, s[32:35], s36 offen offset:0 sc1
    v_mfma_f32_16x16x32_bf16 v[84:87], v[200:203], a[68:71], v[84:87]
    v_and_b32 v40, 3, v0
    v_lshl_add_u32 v40, v40, 2, s62
    v_mfma_f32_16x16x32_bf16 v[84:87], v[204:207], a[100:103], v[84:87]
    v_bfe_u32 v17, v0, 2, 1
    v_lshl_add_u32 v40, v17, 7, v40
    s_waitcnt lgkmcnt(0)
    s_barrier
    v_mfma_f32_16x16x32_bf16 v[84:87], v[208:211], a[132:135], v[84:87]
    ds_read_b128 v[104:107], v44 offset:0
    ds_read_b128 v[108:111], v44 offset:1024
    v_mfma_f32_16x16x32_bf16 v[84:87], v[212:215], a[164:167], v[84:87]
    ds_read_b128 v[112:115], v44 offset:2048
    ds_read_b128 v[116:119], v44 offset:36864
    v_mfma_f32_16x16x32_bf16 v[84:87], v[216:219], a[196:199], v[84:87]
    ds_read_b128 v[120:123], v44 offset:37888
    ds_read_b128 v[124:127], v44 offset:38912
    v_mfma_f32_16x16x32_bf16 v[84:87], v[220:223], a[228:231], v[84:87]
    v_lshrrev_b32 v17, 2, v0
    v_and_b32 v18, 3, v0
    v_mfma_f32_16x16x32_bf16 v[88:91], v[192:195], a[8:11], 0
    buffer_load_dwordx4 v[180:183], v56, s[32:35], s74 offen offset:1024 sc1
    v_mfma_f32_16x16x32_bf16 v[88:91], v[196:199], a[40:43], v[88:91]
    v_lshlrev_b32 v18, 3, v18
    v_lshl_add_u32 v18, v17, 7, v18
    v_mfma_f32_16x16x32_bf16 v[88:91], v[200:203], a[72:75], v[88:91]
    v_bfe_u32 v17, v17, 1, 2
    v_lshl_add_u32 v18, v17, 5, v18
    v_mfma_f32_16x16x32_bf16 v[88:91], v[204:207], a[104:107], v[88:91]
    v_add_u32 v13, 49152, v18
    v_xor_b32 v14, 32, v13
    v_mfma_f32_16x16x32_bf16 v[88:91], v[208:211], a[136:139], v[88:91]
    buffer_load_dwordx4 v9, s[24:27], s86 offen lds
    v_mfma_f32_16x16x32_bf16 v[88:91], v[212:215], a[168:171], v[88:91]
    v_xor_b32 v15, 64, v13
    v_xor_b32 v16, 96, v13
    v_mfma_f32_16x16x32_bf16 v[88:91], v[216:219], a[200:203], v[88:91]
    ds_write_b128 v41, v[84:87] offset:12288
    v_mfma_f32_16x16x32_bf16 v[88:91], v[220:223], a[232:235], v[88:91]
    s_lshl_b32 s61, s61, 2
    v_add_u32 v13, s61, v13
    v_mfma_f32_16x16x32_bf16 v[92:95], v[192:195], a[12:15], 0
    buffer_load_dwordx4 v[184:187], v56, s[32:35], s75 offen offset:0 sc1
    v_mfma_f32_16x16x32_bf16 v[92:95], v[196:199], a[44:47], v[92:95]
    v_add_u32 v14, s61, v14
    v_add_u32 v15, s61, v15
    v_mfma_f32_16x16x32_bf16 v[92:95], v[200:203], a[76:79], v[92:95]
    v_add_u32 v16, s61, v16
    s_waitcnt lgkmcnt(5)
    v_add_f32 v104, v104, v108
    v_mfma_f32_16x16x32_bf16 v[92:95], v[204:207], a[108:111], v[92:95]
    v_add_f32 v105, v105, v109
    v_add_f32 v106, v106, v110
    v_mfma_f32_16x16x32_bf16 v[92:95], v[208:211], a[140:143], v[92:95]
    v_add_f32 v107, v107, v111
    s_waitcnt lgkmcnt(4)
    v_add_f32 v112, v112, v76
    v_mfma_f32_16x16x32_bf16 v[92:95], v[212:215], a[172:175], v[92:95]
    v_add_f32 v113, v113, v77
    v_add_f32 v114, v114, v78
    v_mfma_f32_16x16x32_bf16 v[92:95], v[216:219], a[204:207], v[92:95]
    ds_write_b128 v42, v[88:91] offset:12288
    v_mfma_f32_16x16x32_bf16 v[92:95], v[220:223], a[236:239], v[92:95]
    v_add_f32 v115, v115, v79
    v_add_f32 v104, v104, v112
    v_mfma_f32_16x16x32_bf16 v[80:83], v[192:195], a[0:3], v[48:51]
    buffer_load_dwordx4 v[188:191], v56, s[32:35], s75 offen offset:1024 sc1
    v_mfma_f32_16x16x32_bf16 v[80:83], v[196:199], a[32:35], v[80:83]
    v_add_f32 v105, v105, v113
    v_add_f32 v106, v106, v114
    v_mfma_f32_16x16x32_bf16 v[80:83], v[200:203], a[64:67], v[80:83]
    v_add_f32 v107, v107, v115
    v_cvt_pk_bf16_f32 v62, v104, v105
    v_mfma_f32_16x16x32_bf16 v[80:83], v[204:207], a[96:99], v[80:83]
    v_cvt_pk_bf16_f32 v63, v106, v107
    buffer_store_dwordx2 v[62:63], v45, s[32:35], s37 offen offset:1024 sc1
    v_mfma_f32_16x16x32_bf16 v[80:83], v[208:211], a[128:131], v[80:83]
    buffer_load_dwordx4 v10, s[24:27], s86 offen offset:1024 lds
    v_mfma_f32_16x16x32_bf16 v[80:83], v[212:215], a[160:163], v[80:83]
    s_waitcnt lgkmcnt(3)
    v_add_f32 v116, v116, v120
    v_add_f32 v117, v117, v121
    v_mfma_f32_16x16x32_bf16 v[80:83], v[216:219], a[192:195], v[80:83]
    ds_write_b128 v43, v[92:95] offset:12288
    v_mfma_f32_16x16x32_bf16 v[80:83], v[220:223], a[224:227], v[80:83]
    v_add_f32 v118, v118, v122
    v_add_f32 v119, v119, v123
    v_mfma_f32_16x16x32_bf16 v[64:67], v[128:131], a[20:23], 0
    s_lshl_b32 s7, s69, 16
    s_add_u32 s7, s7, s4
    v_add_u32 v56, s7, v1
    buffer_load_dwordx4 v[192:195], v56, s[32:35], s72 offen offset:0 sc1
    v_mfma_f32_16x16x32_bf16 v[64:67], v[132:135], a[52:55], v[64:67]
    buffer_load_dwordx2 v[54:55], v45, s[32:35], s36 offen offset:512 sc1
    v_mfma_f32_16x16x32_bf16 v[64:67], v[136:139], a[84:87], v[64:67]
    s_waitcnt lgkmcnt(3)
    v_add_f32 v124, v124, v100
    v_add_f32 v125, v125, v101
    v_mfma_f32_16x16x32_bf16 v[64:67], v[140:143], a[116:119], v[64:67]
    s_waitcnt vmcnt(20)
    v_add_f32 v126, v126, v102
    v_add_f32 v127, v127, v103
    v_mfma_f32_16x16x32_bf16 v[64:67], v[144:147], a[148:151], v[64:67]
    v_add_f32 v244, v116, v124
    v_add_f32 v245, v117, v125
    v_mfma_f32_16x16x32_bf16 v[64:67], v[148:151], a[180:183], v[64:67]
    v_add_f32 v246, v118, v126
    v_add_f32 v247, v119, v127
    v_mfma_f32_16x16x32_bf16 v[64:67], v[152:155], a[212:215], v[64:67]
    v_mfma_f32_16x16x32_bf16 v[64:67], v[156:159], a[244:247], v[64:67]
    v_mfma_f32_16x16x32_bf16 v[68:71], v[128:131], a[24:27], 0
    buffer_load_dwordx4 v[196:199], v56, s[32:35], s72 offen offset:1024 sc1
    v_mfma_f32_16x16x32_bf16 v[68:71], v[132:135], a[56:59], v[68:71]
    v_mfma_f32_16x16x32_bf16 v[68:71], v[136:139], a[88:91], v[68:71]
    v_mfma_f32_16x16x32_bf16 v[68:71], v[140:143], a[120:123], v[68:71]
    v_mfma_f32_16x16x32_bf16 v[68:71], v[144:147], a[152:155], v[68:71]
    buffer_load_dwordx4 v11, s[24:27], s86 offen offset:2048 lds
    v_mfma_f32_16x16x32_bf16 v[68:71], v[148:151], a[184:187], v[68:71]
    v_mfma_f32_16x16x32_bf16 v[68:71], v[152:155], a[216:219], v[68:71]
    ds_write_b128 v41, v[64:67] offset:24576
    v_mfma_f32_16x16x32_bf16 v[68:71], v[156:159], a[248:251], v[68:71]
    v_mfma_f32_16x16x32_bf16 v[72:75], v[128:131], a[28:31], 0
    buffer_load_dwordx4 v[200:203], v56, s[32:35], s73 offen offset:0 sc1
    v_mfma_f32_16x16x32_bf16 v[72:75], v[132:135], a[60:63], v[72:75]
    s_waitcnt vmcnt(11)
    v_max_u32 v39, v52, v53
    v_cmp_eq_u32 vcc, -1, v39
    v_mfma_f32_16x16x32_bf16 v[72:75], v[136:139], a[92:95], v[72:75]
    v_lshlrev_b32 v46, 16, v224
    v_and_b32 v47, 0xffff0000, v224
    v_mfma_f32_16x16x32_bf16 v[72:75], v[140:143], a[124:127], v[72:75]
    v_lshlrev_b32 v238, 16, v225
    v_and_b32 v239, 0xffff0000, v225
    v_mfma_f32_16x16x32_bf16 v[72:75], v[144:147], a[156:159], v[72:75]
    s_cbranch_vccnz Lrt_92
Lrtd_93:
    v_lshlrev_b32 v32, 16, v52
    v_mfma_f32_16x16x32_bf16 v[72:75], v[148:151], a[188:191], v[72:75]
    v_and_b32 v33, 0xffff0000, v52
    v_lshlrev_b32 v35, 16, v53
    v_mfma_f32_16x16x32_bf16 v[72:75], v[152:155], a[220:223], v[72:75]
    ds_write_b128 v42, v[68:71] offset:24576
    v_mfma_f32_16x16x32_bf16 v[72:75], v[156:159], a[252:255], v[72:75]
    v_and_b32 v38, 0xffff0000, v53
    v_add_f32 v32, v32, v240
    v_mfma_f32_16x16x32_bf16 v[96:99], v[128:131], a[16:19], 0
    buffer_load_dwordx4 v[204:207], v56, s[32:35], s73 offen offset:1024 sc1
    v_mfma_f32_16x16x32_bf16 v[96:99], v[132:135], a[48:51], v[96:99]
    v_add_f32 v33, v33, v241
    v_add_f32 v35, v35, v242
    v_mfma_f32_16x16x32_bf16 v[96:99], v[136:139], a[80:83], v[96:99]
    v_add_f32 v38, v38, v243
    v_mul_f32 v32, v32, v46
    v_mfma_f32_16x16x32_bf16 v[96:99], v[140:143], a[112:115], v[96:99]
    v_mul_f32 v33, v33, v47
    v_mul_f32 v35, v35, v238
    v_mfma_f32_16x16x32_bf16 v[96:99], v[144:147], a[144:147], v[96:99]
    v_mul_f32 v38, v38, v239
    v_cvt_pk_bf16_f32 v58, v32, v33
    v_mfma_f32_16x16x32_bf16 v[96:99], v[148:151], a[176:179], v[96:99]
    v_cvt_pk_bf16_f32 v59, v35, v38
    buffer_store_dwordx2 v[58:59], v1, s[32:35], s91 offen sc1
    v_mfma_f32_16x16x32_bf16 v[96:99], v[152:155], a[208:211], v[96:99]
    ds_write_b128 v43, v[72:75] offset:24576
    v_mfma_f32_16x16x32_bf16 v[96:99], v[156:159], a[240:243], v[96:99]
    v_mfma_f32_16x16x32_bf16 v[84:87], v[128:131], a[4:7], 0
    buffer_load_dwordx4 v[208:211], v56, s[32:35], s74 offen offset:0 sc1
    v_mfma_f32_16x16x32_bf16 v[84:87], v[132:135], a[36:39], v[84:87]
    v_mfma_f32_16x16x32_bf16 v[84:87], v[136:139], a[68:71], v[84:87]
    v_mfma_f32_16x16x32_bf16 v[84:87], v[140:143], a[100:103], v[84:87]
    s_waitcnt lgkmcnt(0)
    s_barrier
    v_mfma_f32_16x16x32_bf16 v[84:87], v[144:147], a[132:135], v[84:87]
    buffer_load_dwordx4 v12, s[24:27], s86 offen offset:3072 lds
    v_mfma_f32_16x16x32_bf16 v[84:87], v[148:151], a[164:167], v[84:87]
    ds_read_b128 v[104:107], v44 offset:24576
    ds_read_b128 v[108:111], v44 offset:25600
    v_mfma_f32_16x16x32_bf16 v[84:87], v[152:155], a[196:199], v[84:87]
    ds_read_b128 v[112:115], v44 offset:26624
    ds_read_b128 v[116:119], v44 offset:12288
    v_mfma_f32_16x16x32_bf16 v[84:87], v[156:159], a[228:231], v[84:87]
    s_add_u32 m0, s90, 53248
    s_add_u32 s86, s89, 32768
    ds_read_b128 v[120:123], v44 offset:13312
    v_mfma_f32_16x16x32_bf16 v[88:91], v[128:131], a[8:11], 0
    buffer_load_dwordx4 v[212:215], v56, s[32:35], s74 offen offset:1024 sc1
    v_mfma_f32_16x16x32_bf16 v[88:91], v[132:135], a[40:43], v[88:91]
    buffer_load_dwordx2 v[52:53], v45, s[32:35], s36 offen offset:1024 sc1
    v_mfma_f32_16x16x32_bf16 v[88:91], v[136:139], a[72:75], v[88:91]
    ds_read_b128 v[124:127], v44 offset:14336
    v_mfma_f32_16x16x32_bf16 v[88:91], v[140:143], a[104:107], v[88:91]
    v_mfma_f32_16x16x32_bf16 v[88:91], v[144:147], a[136:139], v[88:91]
    s_waitcnt lgkmcnt(4)
    v_add_f32 v104, v104, v108
    v_add_f32 v105, v105, v109
    v_mfma_f32_16x16x32_bf16 v[88:91], v[148:151], a[168:171], v[88:91]
    v_add_f32 v106, v106, v110
    v_add_f32 v107, v107, v111
    v_mfma_f32_16x16x32_bf16 v[88:91], v[152:155], a[200:203], v[88:91]
    ds_write_b128 v41, v[84:87] offset:36864
    v_mfma_f32_16x16x32_bf16 v[88:91], v[156:159], a[232:235], v[88:91]
    s_waitcnt lgkmcnt(4)
    v_add_f32 v112, v112, v96
    v_add_f32 v113, v113, v97
    v_mfma_f32_16x16x32_bf16 v[92:95], v[128:131], a[12:15], 0
    buffer_load_dwordx4 v[216:219], v56, s[32:35], s75 offen offset:0 sc1
    v_mfma_f32_16x16x32_bf16 v[92:95], v[132:135], a[44:47], v[92:95]
    v_add_f32 v114, v114, v98
    v_add_f32 v115, v115, v99
    v_mfma_f32_16x16x32_bf16 v[92:95], v[136:139], a[76:79], v[92:95]
    v_add_f32 v104, v104, v112
    v_add_f32 v105, v105, v113
    v_mfma_f32_16x16x32_bf16 v[92:95], v[140:143], a[108:111], v[92:95]
    v_add_f32 v106, v106, v114
    v_add_f32 v107, v107, v115
    v_mfma_f32_16x16x32_bf16 v[92:95], v[144:147], a[140:143], v[92:95]
    buffer_load_dwordx4 v9, s[24:27], s86 offen lds
    v_mfma_f32_16x16x32_bf16 v[92:95], v[148:151], a[172:175], v[92:95]
    v_cvt_pk_bf16_f32 v62, v104, v105
    v_cvt_pk_bf16_f32 v63, v106, v107
    v_mfma_f32_16x16x32_bf16 v[92:95], v[152:155], a[204:207], v[92:95]
    ds_write_b128 v42, v[88:91] offset:36864
    v_mfma_f32_16x16x32_bf16 v[92:95], v[156:159], a[236:239], v[92:95]
    buffer_store_dwordx2 v[62:63], v45, s[32:35], s37 offen offset:1536 sc1
    s_waitcnt lgkmcnt(3)
    v_add_f32 v116, v116, v120
    v_mfma_f32_16x16x32_bf16 v[100:103], v[128:131], a[0:3], v[48:51]
    buffer_load_dwordx4 v[220:223], v56, s[32:35], s75 offen offset:1024 sc1
    v_mfma_f32_16x16x32_bf16 v[100:103], v[132:135], a[32:35], v[100:103]
    v_add_f32 v117, v117, v121
    v_add_f32 v118, v118, v122
    v_mfma_f32_16x16x32_bf16 v[100:103], v[136:139], a[64:67], v[100:103]
    v_add_f32 v119, v119, v123
    s_waitcnt lgkmcnt(2)
    v_add_f32 v124, v124, v80
    v_mfma_f32_16x16x32_bf16 v[100:103], v[140:143], a[96:99], v[100:103]
    v_add_f32 v125, v125, v81
    v_add_f32 v126, v126, v82
    v_mfma_f32_16x16x32_bf16 v[100:103], v[144:147], a[128:131], v[100:103]
    v_add_f32 v127, v127, v83
    v_add_f32 v248, v116, v124
    v_mfma_f32_16x16x32_bf16 v[100:103], v[148:151], a[160:163], v[100:103]
    v_add_f32 v249, v117, v125
    v_add_f32 v250, v118, v126
    v_mfma_f32_16x16x32_bf16 v[100:103], v[152:155], a[192:195], v[100:103]
    ds_write_b128 v43, v[92:95] offset:36864
    v_mfma_f32_16x16x32_bf16 v[100:103], v[156:159], a[224:227], v[100:103]
    v_add_f32 v251, v119, v127
    v_mfma_f32_16x16x32_bf16 v[64:67], v[160:163], a[20:23], 0
    s_lshl_b32 s7, s70, 16
    s_add_u32 s7, s7, s4
    v_add_u32 v56, s7, v1
    buffer_load_dwordx4 v[128:131], v56, s[32:35], s72 offen offset:0 sc1
    v_mfma_f32_16x16x32_bf16 v[64:67], v[164:167], a[52:55], v[64:67]
    s_waitcnt vmcnt(14)
    v_max_u32 v39, v54, v55
    v_cmp_eq_u32 vcc, -1, v39
    v_mfma_f32_16x16x32_bf16 v[64:67], v[168:171], a[84:87], v[64:67]
    v_lshlrev_b32 v46, 16, v226
    v_and_b32 v47, 0xffff0000, v226
    v_mfma_f32_16x16x32_bf16 v[64:67], v[172:175], a[116:119], v[64:67]
    v_lshlrev_b32 v238, 16, v227
    v_and_b32 v239, 0xffff0000, v227
    v_mfma_f32_16x16x32_bf16 v[64:67], v[176:179], a[148:151], v[64:67]
    buffer_load_dwordx4 v[132:135], v56, s[32:35], s72 offen offset:1024 sc1
    v_mfma_f32_16x16x32_bf16 v[64:67], v[180:183], a[180:183], v[64:67]
    s_cbranch_vccnz Lrt_95
Lrtd_96:
    v_lshlrev_b32 v32, 16, v54
    v_mfma_f32_16x16x32_bf16 v[64:67], v[184:187], a[212:215], v[64:67]
    v_and_b32 v33, 0xffff0000, v54
    v_lshlrev_b32 v35, 16, v55
    v_mfma_f32_16x16x32_bf16 v[64:67], v[188:191], a[244:247], v[64:67]
    v_and_b32 v38, 0xffff0000, v55
    v_add_f32 v32, v32, v244
    v_mfma_f32_16x16x32_bf16 v[68:71], v[160:163], a[24:27], 0
    buffer_load_dwordx4 v10, s[24:27], s86 offen offset:1024 lds
    v_mfma_f32_16x16x32_bf16 v[68:71], v[164:167], a[56:59], v[68:71]
    v_add_f32 v33, v33, v245
    v_add_f32 v35, v35, v246
    v_mfma_f32_16x16x32_bf16 v[68:71], v[168:171], a[88:91], v[68:71]
    v_add_f32 v38, v38, v247
    v_mul_f32 v32, v32, v46
    v_mfma_f32_16x16x32_bf16 v[68:71], v[172:175], a[120:123], v[68:71]
    v_mul_f32 v33, v33, v47
    v_mul_f32 v35, v35, v238
    v_mfma_f32_16x16x32_bf16 v[68:71], v[176:179], a[152:155], v[68:71]
    buffer_load_dwordx4 v[136:139], v56, s[32:35], s73 offen offset:0 sc1
    v_mfma_f32_16x16x32_bf16 v[68:71], v[180:183], a[184:187], v[68:71]
    v_mul_f32 v38, v38, v239
    v_cvt_pk_bf16_f32 v58, v32, v33
    v_mfma_f32_16x16x32_bf16 v[68:71], v[184:187], a[216:219], v[68:71]
    ds_write_b128 v41, v[64:67] offset:0
    v_mfma_f32_16x16x32_bf16 v[68:71], v[188:191], a[248:251], v[68:71]
    v_cvt_pk_bf16_f32 v59, v35, v38
    v_mfma_f32_16x16x32_bf16 v[72:75], v[160:163], a[28:31], 0
    buffer_load_dwordx4 v[140:143], v56, s[32:35], s73 offen offset:1024 sc1
    v_mfma_f32_16x16x32_bf16 v[72:75], v[164:167], a[60:63], v[72:75]
    v_mfma_f32_16x16x32_bf16 v[72:75], v[168:171], a[92:95], v[72:75]
    v_mfma_f32_16x16x32_bf16 v[72:75], v[172:175], a[124:127], v[72:75]
    v_mfma_f32_16x16x32_bf16 v[72:75], v[176:179], a[156:159], v[72:75]
    v_mfma_f32_16x16x32_bf16 v[72:75], v[180:183], a[188:191], v[72:75]
    v_mfma_f32_16x16x32_bf16 v[72:75], v[184:187], a[220:223], v[72:75]
    ds_write_b128 v42, v[68:71] offset:0
    v_mfma_f32_16x16x32_bf16 v[72:75], v[188:191], a[252:255], v[72:75]
    v_mfma_f32_16x16x32_bf16 v[76:79], v[160:163], a[16:19], 0
    buffer_load_dwordx4 v[144:147], v56, s[32:35], s74 offen offset:0 sc1
    v_mfma_f32_16x16x32_bf16 v[76:79], v[164:167], a[48:51], v[76:79]
    s_waitcnt vmcnt(10)
    v_max_u32 v39, v52, v53
    v_cmp_eq_u32 vcc, -1, v39
    v_mfma_f32_16x16x32_bf16 v[76:79], v[168:171], a[80:83], v[76:79]
    v_lshlrev_b32 v46, 16, v228
    v_and_b32 v47, 0xffff0000, v228
    v_mfma_f32_16x16x32_bf16 v[76:79], v[172:175], a[112:115], v[76:79]
    v_lshlrev_b32 v238, 16, v229
    v_and_b32 v239, 0xffff0000, v229
    v_mfma_f32_16x16x32_bf16 v[76:79], v[176:179], a[144:147], v[76:79]
    buffer_load_dwordx4 v[148:151], v56, s[32:35], s74 offen offset:1024 sc1
    v_mfma_f32_16x16x32_bf16 v[76:79], v[180:183], a[176:179], v[76:79]
    s_cbranch_vccnz Lrt_98
Lrtd_99:
    v_lshlrev_b32 v32, 16, v52
    v_mfma_f32_16x16x32_bf16 v[76:79], v[184:187], a[208:211], v[76:79]
    ds_write_b128 v43, v[72:75] offset:0
    v_mfma_f32_16x16x32_bf16 v[76:79], v[188:191], a[240:243], v[76:79]
    v_and_b32 v33, 0xffff0000, v52
    v_lshlrev_b32 v35, 16, v53
    v_mfma_f32_16x16x32_bf16 v[84:87], v[160:163], a[4:7], 0
    v_and_b32 v38, 0xffff0000, v53
    v_add_f32 v32, v32, v248
    v_mfma_f32_16x16x32_bf16 v[84:87], v[164:167], a[36:39], v[84:87]
    v_add_f32 v33, v33, v249
    v_add_f32 v35, v35, v250
    v_mfma_f32_16x16x32_bf16 v[84:87], v[168:171], a[68:71], v[84:87]
    v_add_f32 v38, v38, v251
    v_mul_f32 v32, v32, v46
    v_mfma_f32_16x16x32_bf16 v[84:87], v[172:175], a[100:103], v[84:87]
    v_mul_f32 v33, v33, v47
    v_mul_f32 v35, v35, v238
    s_waitcnt lgkmcnt(0)
    s_barrier
    v_mfma_f32_16x16x32_bf16 v[84:87], v[176:179], a[132:135], v[84:87]
    buffer_load_dwordx4 v[152:155], v56, s[32:35], s75 offen offset:0 sc1
    v_mfma_f32_16x16x32_bf16 v[84:87], v[180:183], a[164:167], v[84:87]
    ds_read_b128 v[104:107], v44 offset:0
    ds_read_b128 v[108:111], v44 offset:1024
    v_mfma_f32_16x16x32_bf16 v[84:87], v[184:187], a[196:199], v[84:87]
    ds_read_b128 v[112:115], v44 offset:2048
    ds_read_b128 v[116:119], v44 offset:36864
    v_mfma_f32_16x16x32_bf16 v[84:87], v[188:191], a[228:231], v[84:87]
    ds_read_b128 v[120:123], v44 offset:37888
    ds_read_b128 v[124:127], v44 offset:38912
    v_mfma_f32_16x16x32_bf16 v[88:91], v[160:163], a[8:11], 0
    buffer_load_dwordx4 v[156:159], v56, s[32:35], s75 offen offset:1024 sc1
    v_mfma_f32_16x16x32_bf16 v[88:91], v[164:167], a[40:43], v[88:91]
    v_mul_f32 v38, v38, v239
    v_cvt_pk_bf16_f32 v60, v32, v33
    v_mfma_f32_16x16x32_bf16 v[88:91], v[168:171], a[72:75], v[88:91]
    v_cvt_pk_bf16_f32 v61, v35, v38
    buffer_store_dwordx4 v[58:61], v1, s[32:35], s92 offen offset:0 sc1
    v_mfma_f32_16x16x32_bf16 v[88:91], v[172:175], a[104:107], v[88:91]
    v_mfma_f32_16x16x32_bf16 v[88:91], v[176:179], a[136:139], v[88:91]
    buffer_load_dwordx4 v11, s[24:27], s86 offen offset:2048 lds
    v_mfma_f32_16x16x32_bf16 v[88:91], v[180:183], a[168:171], v[88:91]
    buffer_load_dwordx2 v[54:55], v45, s[32:35], s36 offen offset:1536 sc1
    v_mfma_f32_16x16x32_bf16 v[88:91], v[184:187], a[200:203], v[88:91]
    ds_write_b128 v41, v[84:87] offset:12288
    v_mfma_f32_16x16x32_bf16 v[88:91], v[188:191], a[232:235], v[88:91]
    s_waitcnt lgkmcnt(5)
    v_add_f32 v104, v104, v108
    v_add_f32 v105, v105, v109
    v_mfma_f32_16x16x32_bf16 v[92:95], v[160:163], a[12:15], 0
    v_add_f32 v106, v106, v110
    v_add_f32 v107, v107, v111
    v_mfma_f32_16x16x32_bf16 v[92:95], v[164:167], a[44:47], v[92:95]
    s_waitcnt lgkmcnt(4)
    v_add_f32 v112, v112, v76
    v_add_f32 v113, v113, v77
    v_mfma_f32_16x16x32_bf16 v[92:95], v[168:171], a[76:79], v[92:95]
    v_add_f32 v114, v114, v78
    v_add_f32 v115, v115, v79
    v_mfma_f32_16x16x32_bf16 v[92:95], v[172:175], a[108:111], v[92:95]
    v_add_f32 v104, v104, v112
    v_add_f32 v105, v105, v113
    v_mfma_f32_16x16x32_bf16 v[92:95], v[176:179], a[140:143], v[92:95]
    buffer_load_dwordx4 v12, s[24:27], s86 offen offset:3072 lds
    v_mfma_f32_16x16x32_bf16 v[92:95], v[180:183], a[172:175], v[92:95]
    v_add_f32 v106, v106, v114
    v_add_f32 v107, v107, v115
    v_mfma_f32_16x16x32_bf16 v[92:95], v[184:187], a[204:207], v[92:95]
    ds_write_b128 v42, v[88:91] offset:12288
    v_mfma_f32_16x16x32_bf16 v[92:95], v[188:191], a[236:239], v[92:95]
    s_add_u32 m0, s90, 69632
    s_add_u32 s86, s89, 163840
    v_cvt_pk_bf16_f32 v62, v104, v105
    v_mfma_f32_16x16x32_bf16 v[80:83], v[160:163], a[0:3], v[48:51]
    v_cvt_pk_bf16_f32 v63, v106, v107
    buffer_store_dwordx2 v[62:63], v45, s[32:35], s37 offen offset:2048 sc1
    v_mfma_f32_16x16x32_bf16 v[80:83], v[164:167], a[32:35], v[80:83]
    s_waitcnt lgkmcnt(3)
    v_add_f32 v116, v116, v120
    v_add_f32 v117, v117, v121
    v_mfma_f32_16x16x32_bf16 v[80:83], v[168:171], a[64:67], v[80:83]
    v_add_f32 v118, v118, v122
    v_add_f32 v119, v119, v123
    v_mfma_f32_16x16x32_bf16 v[80:83], v[172:175], a[96:99], v[80:83]
    s_waitcnt lgkmcnt(2)
    v_add_f32 v124, v124, v100
    v_add_f32 v125, v125, v101
    v_mfma_f32_16x16x32_bf16 v[80:83], v[176:179], a[128:131], v[80:83]
    v_add_f32 v126, v126, v102
    v_add_f32 v127, v127, v103
    v_mfma_f32_16x16x32_bf16 v[80:83], v[180:183], a[160:163], v[80:83]
    v_add_f32 v240, v116, v124
    v_add_f32 v241, v117, v125
    v_mfma_f32_16x16x32_bf16 v[80:83], v[184:187], a[192:195], v[80:83]
    ds_write_b128 v43, v[92:95] offset:12288
    v_mfma_f32_16x16x32_bf16 v[80:83], v[188:191], a[224:227], v[80:83]
    v_add_f32 v242, v118, v126
    v_add_f32 v243, v119, v127
    v_mfma_f32_16x16x32_bf16 v[64:67], v[192:195], a[20:23], 0
    buffer_load_dwordx4 v9, s[24:27], s86 offen lds
    v_mfma_f32_16x16x32_bf16 v[64:67], v[196:199], a[52:55], v[64:67]
    v_mfma_f32_16x16x32_bf16 v[64:67], v[200:203], a[84:87], v[64:67]
    v_mfma_f32_16x16x32_bf16 v[64:67], v[204:207], a[116:119], v[64:67]
    s_waitcnt vmcnt(15)
    v_mfma_f32_16x16x32_bf16 v[64:67], v[208:211], a[148:151], v[64:67]
    v_mfma_f32_16x16x32_bf16 v[64:67], v[212:215], a[180:183], v[64:67]
    v_mfma_f32_16x16x32_bf16 v[64:67], v[216:219], a[212:215], v[64:67]
    v_mfma_f32_16x16x32_bf16 v[64:67], v[220:223], a[244:247], v[64:67]
    v_mfma_f32_16x16x32_bf16 v[68:71], v[192:195], a[24:27], 0
    buffer_load_dwordx4 v10, s[24:27], s86 offen offset:1024 lds
    v_mfma_f32_16x16x32_bf16 v[68:71], v[196:199], a[56:59], v[68:71]
    v_mfma_f32_16x16x32_bf16 v[68:71], v[200:203], a[88:91], v[68:71]
    v_mfma_f32_16x16x32_bf16 v[68:71], v[204:207], a[120:123], v[68:71]
    v_mfma_f32_16x16x32_bf16 v[68:71], v[208:211], a[152:155], v[68:71]
    v_mfma_f32_16x16x32_bf16 v[68:71], v[212:215], a[184:187], v[68:71]
    v_mfma_f32_16x16x32_bf16 v[68:71], v[216:219], a[216:219], v[68:71]
    ds_write_b128 v41, v[64:67] offset:24576
    v_mfma_f32_16x16x32_bf16 v[68:71], v[220:223], a[248:251], v[68:71]
    s_mov_b64 exec, 2
    s_waitcnt vmcnt(6)
    buffer_store_dword v0, off, s[32:35], s6 offset:0 sc1
    s_mov_b64 exec, -1
    v_mfma_f32_16x16x32_bf16 v[72:75], v[192:195], a[28:31], 0
    v_mfma_f32_16x16x32_bf16 v[72:75], v[196:199], a[60:63], v[72:75]
    v_mfma_f32_16x16x32_bf16 v[72:75], v[200:203], a[92:95], v[72:75]
    v_mfma_f32_16x16x32_bf16 v[72:75], v[204:207], a[124:127], v[72:75]
    v_mfma_f32_16x16x32_bf16 v[72:75], v[208:211], a[156:159], v[72:75]
    buffer_load_dwordx4 v11, s[24:27], s86 offen offset:2048 lds
    v_mfma_f32_16x16x32_bf16 v[72:75], v[212:215], a[188:191], v[72:75]
    v_mfma_f32_16x16x32_bf16 v[72:75], v[216:219], a[220:223], v[72:75]
    ds_write_b128 v42, v[68:71] offset:24576
    v_mfma_f32_16x16x32_bf16 v[72:75], v[220:223], a[252:255], v[72:75]
    v_mfma_f32_16x16x32_bf16 v[96:99], v[192:195], a[16:19], 0
    s_waitcnt vmcnt(6)
    v_max_u32 v39, v54, v55
    v_cmp_eq_u32 vcc, -1, v39
    v_mfma_f32_16x16x32_bf16 v[96:99], v[196:199], a[48:51], v[96:99]
    v_lshlrev_b32 v46, 16, v230
    v_and_b32 v47, 0xffff0000, v230
    v_mfma_f32_16x16x32_bf16 v[96:99], v[200:203], a[80:83], v[96:99]
    v_lshlrev_b32 v238, 16, v231
    v_and_b32 v239, 0xffff0000, v231
    v_mfma_f32_16x16x32_bf16 v[96:99], v[204:207], a[112:115], v[96:99]
    s_cbranch_vccnz Lrt_101
Lrtd_102:
    v_lshlrev_b32 v32, 16, v54
    v_mfma_f32_16x16x32_bf16 v[96:99], v[208:211], a[144:147], v[96:99]
    v_and_b32 v33, 0xffff0000, v54
    v_lshlrev_b32 v35, 16, v55
    v_mfma_f32_16x16x32_bf16 v[96:99], v[212:215], a[176:179], v[96:99]
    v_and_b32 v38, 0xffff0000, v55
    v_add_f32 v32, v32, v240
    v_mfma_f32_16x16x32_bf16 v[96:99], v[216:219], a[208:211], v[96:99]
    ds_write_b128 v43, v[72:75] offset:24576
    v_mfma_f32_16x16x32_bf16 v[96:99], v[220:223], a[240:243], v[96:99]
    v_add_f32 v33, v33, v241
    v_add_f32 v35, v35, v242
    v_mfma_f32_16x16x32_bf16 v[84:87], v[128:131], a[20:23], 0
    buffer_load_dwordx4 v12, s[24:27], s86 offen offset:3072 lds
    v_mfma_f32_16x16x32_bf16 v[84:87], v[132:135], a[52:55], v[84:87]
    v_add_f32 v38, v38, v243
    v_mul_f32 v32, v32, v46
    v_mfma_f32_16x16x32_bf16 v[84:87], v[136:139], a[84:87], v[84:87]
    v_mul_f32 v33, v33, v47
    v_mul_f32 v35, v35, v238
    v_mfma_f32_16x16x32_bf16 v[84:87], v[140:143], a[116:119], v[84:87]
    s_add_u32 m0, s90, 57344
    s_add_u32 s86, s89, 65536
    v_mul_f32 v38, v38, v239
    s_waitcnt lgkmcnt(0)
    s_barrier
    v_mfma_f32_16x16x32_bf16 v[84:87], v[144:147], a[148:151], v[84:87]
    ds_read_b128 v[104:107], v44 offset:24576
    ds_read_b128 v[108:111], v44 offset:25600
    v_mfma_f32_16x16x32_bf16 v[84:87], v[148:151], a[180:183], v[84:87]
    buffer_load_dwordx2 v[52:53], v45, s[32:35], s36 offen offset:2048 sc1
    v_mfma_f32_16x16x32_bf16 v[84:87], v[152:155], a[212:215], v[84:87]
    ds_read_b128 v[112:115], v44 offset:26624
    ds_read_b128 v[116:119], v44 offset:12288
    v_mfma_f32_16x16x32_bf16 v[84:87], v[156:159], a[244:247], v[84:87]
    ds_read_b128 v[120:123], v44 offset:13312
    ds_read_b128 v[124:127], v44 offset:14336
    v_mfma_f32_16x16x32_bf16 v[88:91], v[128:131], a[24:27], 0
    buffer_load_dwordx4 v9, s[24:27], s86 offen lds
    v_mfma_f32_16x16x32_bf16 v[88:91], v[132:135], a[56:59], v[88:91]
    v_cvt_pk_bf16_f32 v58, v32, v33
    v_cvt_pk_bf16_f32 v59, v35, v38
    v_mfma_f32_16x16x32_bf16 v[88:91], v[136:139], a[88:91], v[88:91]
    v_mfma_f32_16x16x32_bf16 v[88:91], v[140:143], a[120:123], v[88:91]
    v_mfma_f32_16x16x32_bf16 v[88:91], v[144:147], a[152:155], v[88:91]
    s_waitcnt lgkmcnt(4)
    v_add_f32 v104, v104, v108
    v_add_f32 v105, v105, v109
    v_mfma_f32_16x16x32_bf16 v[88:91], v[148:151], a[184:187], v[88:91]
    v_add_f32 v106, v106, v110
    v_add_f32 v107, v107, v111
    v_mfma_f32_16x16x32_bf16 v[88:91], v[152:155], a[216:219], v[88:91]
    ds_write_b128 v41, v[84:87] offset:36864
    v_mfma_f32_16x16x32_bf16 v[88:91], v[156:159], a[248:251], v[88:91]
    s_waitcnt lgkmcnt(4)
    v_add_f32 v112, v112, v96
    v_add_f32 v113, v113, v97
    v_mfma_f32_16x16x32_bf16 v[92:95], v[128:131], a[28:31], 0
    v_add_f32 v114, v114, v98
    v_add_f32 v115, v115, v99
    v_mfma_f32_16x16x32_bf16 v[92:95], v[132:135], a[60:63], v[92:95]
    v_add_f32 v104, v104, v112
    v_add_f32 v105, v105, v113
    v_mfma_f32_16x16x32_bf16 v[92:95], v[136:139], a[92:95], v[92:95]
    v_add_f32 v106, v106, v114
    v_add_f32 v107, v107, v115
    v_mfma_f32_16x16x32_bf16 v[92:95], v[140:143], a[124:127], v[92:95]
    v_cvt_pk_bf16_f32 v62, v104, v105
    v_cvt_pk_bf16_f32 v63, v106, v107
    v_mfma_f32_16x16x32_bf16 v[92:95], v[144:147], a[156:159], v[92:95]
    buffer_load_dwordx4 v10, s[24:27], s86 offen offset:1024 lds
    v_mfma_f32_16x16x32_bf16 v[92:95], v[148:151], a[188:191], v[92:95]
    buffer_store_dwordx2 v[62:63], v45, s[32:35], s37 offen offset:2560 sc1
    s_waitcnt lgkmcnt(2)
    v_add_f32 v116, v116, v120
    v_mfma_f32_16x16x32_bf16 v[92:95], v[152:155], a[220:223], v[92:95]
    ds_write_b128 v42, v[88:91] offset:36864
    v_mfma_f32_16x16x32_bf16 v[92:95], v[156:159], a[252:255], v[92:95]
    v_add_f32 v117, v117, v121
    v_add_f32 v118, v118, v122
    v_mfma_f32_16x16x32_bf16 v[100:103], v[128:131], a[16:19], 0
    v_add_f32 v119, v119, v123
    s_waitcnt lgkmcnt(2)
    v_add_f32 v124, v124, v80
    v_mfma_f32_16x16x32_bf16 v[100:103], v[132:135], a[48:51], v[100:103]
    v_add_f32 v125, v125, v81
    v_add_f32 v126, v126, v82
    v_mfma_f32_16x16x32_bf16 v[100:103], v[136:139], a[80:83], v[100:103]
    v_add_f32 v127, v127, v83
    v_add_f32 v244, v116, v124
    v_mfma_f32_16x16x32_bf16 v[100:103], v[140:143], a[112:115], v[100:103]
    v_add_f32 v245, v117, v125
    v_add_f32 v246, v118, v126
    v_mfma_f32_16x16x32_bf16 v[100:103], v[144:147], a[144:147], v[100:103]
    v_add_f32 v247, v119, v127
    v_mfma_f32_16x16x32_bf16 v[100:103], v[148:151], a[176:179], v[100:103]
    v_mfma_f32_16x16x32_bf16 v[100:103], v[152:155], a[208:211], v[100:103]
    ds_write_b128 v43, v[92:95] offset:36864
    v_mfma_f32_16x16x32_bf16 v[100:103], v[156:159], a[240:243], v[100:103]
    v_mfma_f32_16x16x32_bf16 v[64:67], v[192:195], a[4:7], 0
    buffer_load_dwordx4 v11, s[24:27], s86 offen offset:2048 lds
    v_mfma_f32_16x16x32_bf16 v[64:67], v[196:199], a[36:39], v[64:67]
    buffer_load_dword v57, v40, s[32:35], 0 offen offset:0 sc1
    v_mfma_f32_16x16x32_bf16 v[64:67], v[200:203], a[68:71], v[64:67]
    v_mfma_f32_16x16x32_bf16 v[64:67], v[204:207], a[100:103], v[64:67]
    s_waitcnt lgkmcnt(0)
    s_barrier
    v_mfma_f32_16x16x32_bf16 v[64:67], v[208:211], a[132:135], v[64:67]
    ds_read_b128 v[116:119], v44 offset:36864
    ds_read_b128 v[120:123], v44 offset:37888
    v_mfma_f32_16x16x32_bf16 v[64:67], v[212:215], a[164:167], v[64:67]
    ds_read_b128 v[124:127], v44 offset:38912
    v_mfma_f32_16x16x32_bf16 v[64:67], v[216:219], a[196:199], v[64:67]
    v_mfma_f32_16x16x32_bf16 v[64:67], v[220:223], a[228:231], v[64:67]
    v_mfma_f32_16x16x32_bf16 v[68:71], v[192:195], a[8:11], 0
    buffer_load_dwordx4 v12, s[24:27], s86 offen offset:3072 lds
    v_mfma_f32_16x16x32_bf16 v[68:71], v[196:199], a[40:43], v[68:71]
    v_mfma_f32_16x16x32_bf16 v[68:71], v[200:203], a[72:75], v[68:71]
    v_mfma_f32_16x16x32_bf16 v[68:71], v[204:207], a[104:107], v[68:71]
    s_add_u32 m0, s90, 73728
    s_add_u32 s86, s89, 196608
    v_mfma_f32_16x16x32_bf16 v[68:71], v[208:211], a[136:139], v[68:71]
    s_waitcnt lgkmcnt(1)
    v_add_f32 v116, v116, v120
    v_add_f32 v117, v117, v121
    v_mfma_f32_16x16x32_bf16 v[68:71], v[212:215], a[168:171], v[68:71]
    v_add_f32 v118, v118, v122
    v_add_f32 v119, v119, v123
    v_mfma_f32_16x16x32_bf16 v[68:71], v[216:219], a[200:203], v[68:71]
    ds_write_b128 v41, v[64:67] offset:0
    v_mfma_f32_16x16x32_bf16 v[68:71], v[220:223], a[232:235], v[68:71]
    s_waitcnt lgkmcnt(1)
    v_add_f32 v124, v124, v100
    v_add_f32 v125, v125, v101
    v_mfma_f32_16x16x32_bf16 v[72:75], v[192:195], a[12:15], 0
    v_add_f32 v126, v126, v102
    v_add_f32 v127, v127, v103
    v_mfma_f32_16x16x32_bf16 v[72:75], v[196:199], a[44:47], v[72:75]
    v_add_f32 v116, v116, v124
    v_add_f32 v117, v117, v125
    v_mfma_f32_16x16x32_bf16 v[72:75], v[200:203], a[76:79], v[72:75]
    v_add_f32 v118, v118, v126
    v_add_f32 v119, v119, v127
    v_mfma_f32_16x16x32_bf16 v[72:75], v[204:207], a[108:111], v[72:75]
    v_cvt_pk_bf16_f32 v62, v116, v117
    v_cvt_pk_bf16_f32 v63, v118, v119
    v_mfma_f32_16x16x32_bf16 v[72:75], v[208:211], a[140:143], v[72:75]
    buffer_load_dwordx4 v9, s[24:27], s86 offen lds
    v_mfma_f32_16x16x32_bf16 v[72:75], v[212:215], a[172:175], v[72:75]
    buffer_store_dwordx2 v[62:63], v45, s[32:35], s37 offen offset:3072 sc1
    s_waitcnt vmcnt(8)
    v_max_u32 v39, v52, v53
    v_mfma_f32_16x16x32_bf16 v[72:75], v[216:219], a[204:207], v[72:75]
    ds_write_b128 v42, v[68:71] offset:0
    v_mfma_f32_16x16x32_bf16 v[72:75], v[220:223], a[236:239], v[72:75]
    v_cmp_eq_u32 vcc, -1, v39
    v_lshlrev_b32 v46, 16, v232
    v_mfma_f32_16x16x32_bf16 v[76:79], v[192:195], a[0:3], v[48:51]
    v_and_b32 v47, 0xffff0000, v232
    v_lshlrev_b32 v238, 16, v233
    v_mfma_f32_16x16x32_bf16 v[76:79], v[196:199], a[32:35], v[76:79]
    v_and_b32 v239, 0xffff0000, v233
    s_cbranch_vccnz Lrt_104
Lrtd_105:
    v_mfma_f32_16x16x32_bf16 v[76:79], v[200:203], a[64:67], v[76:79]
    v_lshlrev_b32 v32, 16, v52
    v_and_b32 v33, 0xffff0000, v52
    v_mfma_f32_16x16x32_bf16 v[76:79], v[204:207], a[96:99], v[76:79]
    v_lshlrev_b32 v35, 16, v53
    v_and_b32 v38, 0xffff0000, v53
    v_mfma_f32_16x16x32_bf16 v[76:79], v[208:211], a[128:131], v[76:79]
    v_add_f32 v32, v32, v244
    v_add_f32 v33, v33, v245
    v_mfma_f32_16x16x32_bf16 v[76:79], v[212:215], a[160:163], v[76:79]
    v_add_f32 v35, v35, v246
    v_add_f32 v38, v38, v247
    v_mfma_f32_16x16x32_bf16 v[76:79], v[216:219], a[192:195], v[76:79]
    ds_write_b128 v43, v[72:75] offset:0
    v_mfma_f32_16x16x32_bf16 v[76:79], v[220:223], a[224:227], v[76:79]
    v_mul_f32 v32, v32, v46
    v_mul_f32 v33, v33, v47
    v_mfma_f32_16x16x32_bf16 v[84:87], v[128:131], a[4:7], 0
    buffer_load_dwordx4 v10, s[24:27], s86 offen offset:1024 lds
    v_mfma_f32_16x16x32_bf16 v[84:87], v[132:135], a[36:39], v[84:87]
    v_mul_f32 v35, v35, v238
    v_mul_f32 v38, v38, v239
    v_mfma_f32_16x16x32_bf16 v[84:87], v[136:139], a[68:71], v[84:87]
    v_cvt_pk_bf16_f32 v60, v32, v33
    v_cvt_pk_bf16_f32 v61, v35, v38
    v_mfma_f32_16x16x32_bf16 v[84:87], v[140:143], a[100:103], v[84:87]
    buffer_store_dwordx4 v[58:61], v1, s[32:35], s92 offen offset:1024 sc1
    s_waitcnt vmcnt(5)
    v_cmp_ne_u32 vcc, 1, v57
    s_waitcnt lgkmcnt(0)
    s_barrier
    v_mfma_f32_16x16x32_bf16 v[84:87], v[144:147], a[132:135], v[84:87]
    ds_read_b128 v[104:107], v44 offset:0
    ds_read_b128 v[108:111], v44 offset:1024
    v_mfma_f32_16x16x32_bf16 v[84:87], v[148:151], a[164:167], v[84:87]
    buffer_load_dwordx2 v[54:55], v45, s[32:35], s36 offen offset:2560 sc1
    v_mfma_f32_16x16x32_bf16 v[84:87], v[152:155], a[196:199], v[84:87]
    ds_read_b128 v[112:115], v44 offset:2048
    s_nop 0
    v_mfma_f32_16x16x32_bf16 v[84:87], v[156:159], a[228:231], v[84:87]
    s_cbranch_vccnz Lrt_107
Lrtd_108:
    v_mfma_f32_16x16x32_bf16 v[88:91], v[128:131], a[8:11], 0
    buffer_load_dwordx4 v11, s[24:27], s86 offen offset:2048 lds
    v_mfma_f32_16x16x32_bf16 v[88:91], v[132:135], a[40:43], v[88:91]
    s_add_u32 s59, s8, 0
    buffer_load_dwordx4 v[160:163], v1, s[32:35], s59 offen sc1
    v_mfma_f32_16x16x32_bf16 v[88:91], v[136:139], a[72:75], v[88:91]
    v_mfma_f32_16x16x32_bf16 v[88:91], v[140:143], a[104:107], v[88:91]
    v_mfma_f32_16x16x32_bf16 v[88:91], v[144:147], a[136:139], v[88:91]
    s_waitcnt lgkmcnt(1)
    v_add_f32 v104, v104, v108
    v_add_f32 v105, v105, v109
    v_mfma_f32_16x16x32_bf16 v[88:91], v[148:151], a[168:171], v[88:91]
    s_add_u32 s59, s9, 0
    buffer_load_dwordx4 v[164:167], v1, s[32:35], s59 offen sc1
    v_mfma_f32_16x16x32_bf16 v[88:91], v[152:155], a[200:203], v[88:91]
    ds_write_b128 v41, v[84:87] offset:12288
    v_mfma_f32_16x16x32_bf16 v[88:91], v[156:159], a[232:235], v[88:91]
    v_add_f32 v106, v106, v110
    v_add_f32 v107, v107, v111
    v_mfma_f32_16x16x32_bf16 v[92:95], v[128:131], a[12:15], 0
    s_waitcnt lgkmcnt(1)
    v_add_f32 v112, v112, v76
    v_add_f32 v113, v113, v77
    v_mfma_f32_16x16x32_bf16 v[92:95], v[132:135], a[44:47], v[92:95]
    s_add_u32 s59, s8, 3072
    buffer_load_dwordx4 v[168:171], v1, s[32:35], s59 offen sc1
    v_mfma_f32_16x16x32_bf16 v[92:95], v[136:139], a[76:79], v[92:95]
    v_add_f32 v114, v114, v78
    v_add_f32 v115, v115, v79
    v_mfma_f32_16x16x32_bf16 v[92:95], v[140:143], a[108:111], v[92:95]
    v_add_f32 v248, v104, v112
    v_add_f32 v249, v105, v113
    v_mfma_f32_16x16x32_bf16 v[92:95], v[144:147], a[140:143], v[92:95]
    buffer_load_dwordx4 v12, s[24:27], s86 offen offset:3072 lds
    v_mfma_f32_16x16x32_bf16 v[92:95], v[148:151], a[172:175], v[92:95]
    s_add_u32 s59, s9, 3072
    buffer_load_dwordx4 v[172:175], v1, s[32:35], s59 offen sc1
    v_mfma_f32_16x16x32_bf16 v[92:95], v[152:155], a[204:207], v[92:95]
    ds_write_b128 v42, v[88:91] offset:12288
    v_mfma_f32_16x16x32_bf16 v[92:95], v[156:159], a[236:239], v[92:95]
    v_add_f32 v250, v106, v114
    v_add_f32 v251, v107, v115
    v_mfma_f32_16x16x32_bf16 v[80:83], v[128:131], a[0:3], v[48:51]
    v_mfma_f32_16x16x32_bf16 v[80:83], v[132:135], a[32:35], v[80:83]
    v_mfma_f32_16x16x32_bf16 v[80:83], v[136:139], a[64:67], v[80:83]
    v_mfma_f32_16x16x32_bf16 v[80:83], v[140:143], a[96:99], v[80:83]
    v_mfma_f32_16x16x32_bf16 v[80:83], v[144:147], a[128:131], v[80:83]
    v_mfma_f32_16x16x32_bf16 v[80:83], v[148:151], a[160:163], v[80:83]
    v_mfma_f32_16x16x32_bf16 v[80:83], v[152:155], a[192:195], v[80:83]
    ds_write_b128 v43, v[92:95] offset:12288
    v_mfma_f32_16x16x32_bf16 v[80:83], v[156:159], a[224:227], v[80:83]
    buffer_load_dwordx2 v[52:53], v45, s[32:35], s36 offen offset:3072 sc1
    s_mov_b64 exec, 2
    s_waitcnt vmcnt(8)
    buffer_store_dword v0, off, s[32:35], s6 offset:32 sc1
    s_mov_b64 exec, -1
    s_waitcnt lgkmcnt(0)
    s_barrier
    ds_read_b128 v[116:119], v44 offset:12288
    ds_read_b128 v[120:123], v44 offset:13312
    ds_read_b128 v[124:127], v44 offset:14336
    s_add_u32 s59, s8, 4096
    buffer_load_dwordx4 v[176:179], v1, s[32:35], s59 offen sc1
    s_add_u32 s59, s9, 4096
    buffer_load_dwordx4 v[180:183], v1, s[32:35], s59 offen sc1
    s_add_u32 s59, s8, 7168
    buffer_load_dwordx4 v[184:187], v1, s[32:35], s59 offen sc1
    s_add_u32 s59, s9, 7168
    buffer_load_dwordx4 v[188:191], v1, s[32:35], s59 offen sc1
    v_lshlrev_b32 v64, 16, v24
    v_and_b32 v65, 0xffff0000, v24
    v_lshlrev_b32 v66, 16, v25
    v_and_b32 v67, 0xffff0000, v25
    v_lshlrev_b32 v68, 16, v26
    v_and_b32 v69, 0xffff0000, v26
    v_lshlrev_b32 v70, 16, v27
    v_and_b32 v71, 0xffff0000, v27
    v_lshlrev_b32 v72, 16, v28
    v_and_b32 v73, 0xffff0000, v28
    v_lshlrev_b32 v74, 16, v29
    v_and_b32 v75, 0xffff0000, v29
    v_lshlrev_b32 v76, 16, v30
    v_and_b32 v77, 0xffff0000, v30
    v_lshlrev_b32 v78, 16, v31
    v_and_b32 v79, 0xffff0000, v31
    s_waitcnt lgkmcnt(1)
    v_pk_add_f32 v[116:117], v[116:117], v[120:121]
    s_waitcnt lgkmcnt(0)
    v_pk_add_f32 v[124:125], v[124:125], v[80:81]
    v_pk_add_f32 v[118:119], v[118:119], v[122:123]
    v_pk_add_f32 v[126:127], v[126:127], v[82:83]
    v_pk_add_f32 v[240:241], v[116:117], v[124:125]
    v_pk_add_f32 v[242:243], v[118:119], v[126:127]
    s_waitcnt vmcnt(12)
    v_max_u32 v39, v54, v55
    v_cmp_eq_u32 vcc, -1, v39
    v_lshlrev_b32 v46, 16, v234
    v_and_b32 v47, 0xffff0000, v234
    v_lshlrev_b32 v238, 16, v235
    v_and_b32 v239, 0xffff0000, v235
    s_cbranch_vccnz Lrt_110
Lrtd_111:
    v_lshlrev_b32 v32, 16, v54
    v_and_b32 v33, 0xffff0000, v54
    v_lshlrev_b32 v35, 16, v55
    v_and_b32 v38, 0xffff0000, v55
    v_add_f32 v32, v32, v248
    v_add_f32 v33, v33, v249
    v_add_f32 v35, v35, v250
    v_add_f32 v38, v38, v251
    v_mul_f32 v32, v32, v46
    v_mul_f32 v33, v33, v47
    v_mul_f32 v35, v35, v238
    v_mul_f32 v38, v38, v239
    v_cvt_pk_bf16_f32 v58, v32, v33
    v_cvt_pk_bf16_f32 v59, v35, v38
    ds_read_b64_tr_b16 v[104:105], v13 offset:0
    ds_read_b64_tr_b16 v[106:107], v13 offset:2048
    ds_read_b64_tr_b16 v[108:109], v14 offset:0
    ds_read_b64_tr_b16 v[110:111], v14 offset:2048
    ds_read_b64_tr_b16 v[112:113], v15 offset:0
    ds_read_b64_tr_b16 v[114:115], v15 offset:2048
    ds_read_b64_tr_b16 v[116:117], v16 offset:0
    ds_read_b64_tr_b16 v[118:119], v16 offset:2048
    ds_read_b64_tr_b16 v[120:121], v13 offset:12288
    ds_read_b64_tr_b16 v[122:123], v13 offset:14336
    s_waitcnt vmcnt(9) lgkmcnt(6)
    v_mfma_f32_16x16x32_bf16 v[64:67], v[104:107], v[160:163], v[64:67]
    s_add_u32 s59, s8, 10240
    ds_read_b64_tr_b16 v[124:125], v14 offset:12288
    ds_read_b64_tr_b16 v[126:127], v14 offset:14336
    v_mfma_f32_16x16x32_bf16 v[84:87], v[104:107], v[164:167], 0
    buffer_load_dwordx4 v[192:195], v1, s[32:35], s59 offen sc1
    buffer_load_dword v57, v40, s[32:35], 0 offen offset:32 sc1
    v_mfma_f32_16x16x32_bf16 v[68:71], v[108:111], v[160:163], v[68:71]
    s_add_u32 s59, s9, 10240
    ds_read_b64_tr_b16 v[104:105], v15 offset:12288
    ds_read_b64_tr_b16 v[106:107], v15 offset:14336
    v_mfma_f32_16x16x32_bf16 v[88:91], v[108:111], v[164:167], 0
    s_waitcnt lgkmcnt(6)
    v_mfma_f32_16x16x32_bf16 v[72:75], v[112:115], v[160:163], v[72:75]
    buffer_load_dwordx4 v[196:199], v1, s[32:35], s59 offen sc1
    v_mfma_f32_16x16x32_bf16 v[92:95], v[112:115], v[164:167], 0
    ds_read_b64_tr_b16 v[108:109], v16 offset:12288
    ds_read_b64_tr_b16 v[110:111], v16 offset:14336
    v_mfma_f32_16x16x32_bf16 v[76:79], v[116:119], v[160:163], v[76:79]
    s_add_u32 s59, s8, 11264
    ds_read_b64_tr_b16 v[112:113], v13 offset:16384
    ds_read_b64_tr_b16 v[114:115], v13 offset:18432
    v_mfma_f32_16x16x32_bf16 v[96:99], v[116:119], v[164:167], 0
    s_waitcnt vmcnt(9) lgkmcnt(6)
    s_waitcnt vmcnt(8)
    v_max_u32 v39, v52, v53
    v_cmp_eq_u32 vcc, -1, v39
    v_lshlrev_b32 v46, 16, v236
    v_and_b32 v47, 0xffff0000, v236
    v_lshlrev_b32 v238, 16, v237
    v_and_b32 v239, 0xffff0000, v237
    s_cbranch_vccnz Lrt_113
Lrtd_114:
    v_lshlrev_b32 v32, 16, v52
    v_and_b32 v33, 0xffff0000, v52
    v_lshlrev_b32 v35, 16, v53
    v_and_b32 v38, 0xffff0000, v53
    v_add_f32 v32, v32, v240
    v_add_f32 v33, v33, v241
    v_add_f32 v35, v35, v242
    v_add_f32 v38, v38, v243
    v_mul_f32 v32, v32, v46
    v_mul_f32 v33, v33, v47
    v_mul_f32 v35, v35, v238
    v_mul_f32 v38, v38, v239
    v_cvt_pk_bf16_f32 v60, v32, v33
    v_cvt_pk_bf16_f32 v61, v35, v38
    buffer_store_dwordx4 v[58:61], v1, s[32:35], s92 offen offset:2048 sc1
    v_mfma_f32_16x16x32_bf16 v[64:67], v[120:123], v[168:171], v[64:67]
    buffer_load_dwordx4 v[200:203], v1, s[32:35], s59 offen sc1
    v_mfma_f32_16x16x32_bf16 v[84:87], v[120:123], v[172:175], v[84:87]
    s_mul_i32 s60, s54, 2304
    ds_read_b64_tr_b16 v[116:117], v14 offset:16384
    ds_read_b64_tr_b16 v[118:119], v14 offset:18432
    v_mfma_f32_16x16x32_bf16 v[68:71], v[124:127], v[168:171], v[68:71]
    s_add_u32 s59, s9, 11264
    ds_read_b64_tr_b16 v[120:121], v15 offset:16384
    ds_read_b64_tr_b16 v[122:123], v15 offset:18432
    v_mfma_f32_16x16x32_bf16 v[88:91], v[124:127], v[172:175], v[88:91]
    s_waitcnt lgkmcnt(6)
    v_mul_u32_u24 v20, 144, v3
    v_lshl_add_u32 v20, v4, 3, v20
    v_mfma_f32_16x16x32_bf16 v[72:75], v[104:107], v[168:171], v[72:75]
    buffer_load_dwordx4 v[204:207], v1, s[32:35], s59 offen sc1
    v_mfma_f32_16x16x32_bf16 v[92:95], v[104:107], v[172:175], v[92:95]
    ds_read_b64_tr_b16 v[124:125], v16 offset:16384
    ds_read_b64_tr_b16 v[126:127], v16 offset:18432
    s_barrier
    v_mfma_f32_16x16x32_bf16 v[76:79], v[108:111], v[168:171], v[76:79]
    ds_read_b64_tr_b16 v[104:105], v13 offset:28672
    ds_read_b64_tr_b16 v[106:107], v13 offset:30720
    v_mfma_f32_16x16x32_bf16 v[96:99], v[108:111], v[172:175], v[96:99]
    s_waitcnt vmcnt(8) lgkmcnt(6)
    v_add_u32 v20, s60, v20
    v_lshrrev_b32 v42, 3, v0
    v_mfma_f32_16x16x32_bf16 v[64:67], v[112:115], v[176:179], v[64:67]
    ds_read_b64_tr_b16 v[108:109], v14 offset:28672
    ds_read_b64_tr_b16 v[110:111], v14 offset:30720
    v_mfma_f32_16x16x32_bf16 v[84:87], v[112:115], v[180:183], v[84:87]
    v_and_b32 v43, 7, v0
    v_mul_u32_u24 v21, 144, v42
    s_waitcnt vmcnt(4)
    v_cmp_ne_u32 vcc, 1, v57
    v_mfma_f32_16x16x32_bf16 v[68:71], v[116:119], v[176:179], v[68:71]
    s_add_u32 s59, s8, 1024
    ds_read_b64_tr_b16 v[112:113], v15 offset:28672
    ds_read_b64_tr_b16 v[114:115], v15 offset:30720
    v_mfma_f32_16x16x32_bf16 v[88:91], v[116:119], v[180:183], v[88:91]
    s_waitcnt lgkmcnt(6)
    v_lshl_add_u32 v21, v43, 4, v21
    v_add_u32 v21, s60, v21
    s_cbranch_vccnz Lrt_116
Lrtd_117:
    v_mfma_f32_16x16x32_bf16 v[72:75], v[120:123], v[176:179], v[72:75]
    buffer_load_dwordx4 v[208:211], v1, s[32:35], s59 offen sc1
    v_mfma_f32_16x16x32_bf16 v[92:95], v[120:123], v[180:183], v[92:95]
    ds_read_b64_tr_b16 v[116:117], v16 offset:28672
    ds_read_b64_tr_b16 v[118:119], v16 offset:30720
    v_mfma_f32_16x16x32_bf16 v[76:79], v[124:127], v[176:179], v[76:79]
    s_add_u32 s59, s9, 1024
    ds_read_b64_tr_b16 v[120:121], v13 offset:40960
    ds_read_b64_tr_b16 v[122:123], v13 offset:43008
    v_mfma_f32_16x16x32_bf16 v[96:99], v[124:127], v[180:183], v[96:99]
    s_waitcnt lgkmcnt(6)
    v_lshrrev_b32 v44, 2, v42
    v_lshlrev_b32 v44, 3, v44
    v_mfma_f32_16x16x32_bf16 v[64:67], v[104:107], v[184:187], v[64:67]
    buffer_load_dwordx4 v[212:215], v1, s[32:35], s59 offen sc1
    v_mfma_f32_16x16x32_bf16 v[84:87], v[104:107], v[188:191], v[84:87]
    ds_read_b64_tr_b16 v[124:125], v14 offset:40960
    ds_read_b64_tr_b16 v[126:127], v14 offset:43008
    v_mfma_f32_16x16x32_bf16 v[68:71], v[108:111], v[184:187], v[68:71]
    s_add_u32 s59, s8, 5120
    ds_read_b64_tr_b16 v[104:105], v15 offset:40960
    ds_read_b64_tr_b16 v[106:107], v15 offset:43008
    v_mfma_f32_16x16x32_bf16 v[88:91], v[108:111], v[188:191], v[88:91]
    s_waitcnt lgkmcnt(6)
    v_and_or_b32 v44, v42, 3, v44
    v_lshlrev_b32 v44, 10, v44
    s_mov_b64 exec, 2
    s_waitcnt vmcnt(4)
    buffer_store_dword v0, off, s[32:35], s6 offset:64 sc1
    s_mov_b64 exec, -1
    v_mfma_f32_16x16x32_bf16 v[72:75], v[112:115], v[184:187], v[72:75]
    buffer_load_dwordx4 v[216:219], v1, s[32:35], s59 offen sc1
    v_mfma_f32_16x16x32_bf16 v[92:95], v[112:115], v[188:191], v[92:95]
    ds_read_b64_tr_b16 v[108:109], v16 offset:40960
    ds_read_b64_tr_b16 v[110:111], v16 offset:43008
    v_mfma_f32_16x16x32_bf16 v[76:79], v[116:119], v[184:187], v[76:79]
    s_add_u32 s59, s9, 5120
    ds_read_b64_tr_b16 v[112:113], v13 offset:45056
    ds_read_b64_tr_b16 v[114:115], v13 offset:47104
    v_mfma_f32_16x16x32_bf16 v[96:99], v[116:119], v[188:191], v[96:99]
    s_waitcnt lgkmcnt(6)
    v_lshl_add_u32 v44, v43, 4, v44
    s_lshr_b32 s61, s58, 1
    v_mfma_f32_16x16x32_bf16 v[64:67], v[120:123], v[192:195], v[64:67]
    buffer_load_dwordx4 v[220:223], v1, s[32:35], s59 offen sc1
    v_mfma_f32_16x16x32_bf16 v[84:87], v[120:123], v[196:199], v[84:87]
    s_lshl_b32 s61, s61, 15
    ds_read_b64_tr_b16 v[116:117], v14 offset:45056
    ds_read_b64_tr_b16 v[118:119], v14 offset:47104
    v_mfma_f32_16x16x32_bf16 v[68:71], v[124:127], v[192:195], v[68:71]
    s_add_u32 s59, s8, 8192
    ds_read_b64_tr_b16 v[120:121], v15 offset:45056
    ds_read_b64_tr_b16 v[122:123], v15 offset:47104
    v_mfma_f32_16x16x32_bf16 v[88:91], v[124:127], v[196:199], v[88:91]
    s_waitcnt lgkmcnt(6)
    s_and_b32 s62, s58, 1
    s_lshl_b32 s62, s62, 12
    v_mfma_f32_16x16x32_bf16 v[72:75], v[104:107], v[192:195], v[72:75]
    buffer_load_dwordx4 v[128:131], v1, s[32:35], s59 offen sc1
    v_mfma_f32_16x16x32_bf16 v[92:95], v[104:107], v[196:199], v[92:95]
    s_add_u32 s61, s61, s62
    ds_read_b64_tr_b16 v[124:125], v16 offset:45056
    ds_read_b64_tr_b16 v[126:127], v16 offset:47104
    v_mfma_f32_16x16x32_bf16 v[76:79], v[108:111], v[192:195], v[76:79]
    s_add_u32 s59, s9, 8192
    ds_read_b64_tr_b16 v[104:105], v13 offset:4096
    ds_read_b64_tr_b16 v[106:107], v13 offset:6144
    v_mfma_f32_16x16x32_bf16 v[96:99], v[108:111], v[196:199], v[96:99]
    s_waitcnt vmcnt(6) lgkmcnt(6)
    s_lshl_b32 s62, s53, 7
    s_add_u32 s61, s61, s62
    v_mfma_f32_16x16x32_bf16 v[64:67], v[112:115], v[200:203], v[64:67]
    buffer_load_dwordx4 v[132:135], v1, s[32:35], s59 offen sc1
    v_mfma_f32_16x16x32_bf16 v[84:87], v[112:115], v[204:207], v[84:87]
    s_add_u32 s62, s61, 16384
    ds_read_b64_tr_b16 v[108:109], v14 offset:4096
    ds_read_b64_tr_b16 v[110:111], v14 offset:6144
    v_mfma_f32_16x16x32_bf16 v[68:71], v[116:119], v[200:203], v[68:71]
    s_add_u32 s59, s8, 12288
    ds_read_b64_tr_b16 v[112:113], v15 offset:4096
    ds_read_b64_tr_b16 v[114:115], v15 offset:6144
    v_mfma_f32_16x16x32_bf16 v[88:91], v[116:119], v[204:207], v[88:91]
    s_waitcnt lgkmcnt(6)
    s_lshl_b32 s60, s54, 12
    s_add_u32 s60, s60, 24576
    buffer_load_dword v57, v40, s[32:35], 0 offen offset:64 sc1
    v_mfma_f32_16x16x32_bf16 v[72:75], v[120:123], v[200:203], v[72:75]
    buffer_load_dwordx4 v[136:139], v1, s[32:35], s59 offen sc1
    v_mfma_f32_16x16x32_bf16 v[92:95], v[120:123], v[204:207], v[92:95]
    ds_read_b64_tr_b16 v[116:117], v16 offset:4096
    ds_read_b64_tr_b16 v[118:119], v16 offset:6144
    v_mfma_f32_16x16x32_bf16 v[76:79], v[124:127], v[200:203], v[76:79]
    s_add_u32 s59, s9, 12288
    ds_read_b64_tr_b16 v[120:121], v13 offset:20480
    ds_read_b64_tr_b16 v[122:123], v13 offset:22528
    v_mfma_f32_16x16x32_bf16 v[96:99], v[124:127], v[204:207], v[96:99]
    s_waitcnt vmcnt(7) lgkmcnt(6)
    v_add_u32 v22, s60, v1
    v_xor_b32 v23, 4096, v22
    v_mfma_f32_16x16x32_bf16 v[64:67], v[104:107], v[208:211], v[64:67]
    buffer_load_dwordx4 v[140:143], v1, s[32:35], s59 offen sc1
    v_mfma_f32_16x16x32_bf16 v[84:87], v[104:107], v[212:215], v[84:87]
    ds_read_b64_tr_b16 v[124:125], v14 offset:20480
    ds_read_b64_tr_b16 v[126:127], v14 offset:22528
    v_mfma_f32_16x16x32_bf16 v[68:71], v[108:111], v[208:211], v[68:71]
    ds_read_b64_tr_b16 v[104:105], v15 offset:20480
    ds_read_b64_tr_b16 v[106:107], v15 offset:22528
    v_mfma_f32_16x16x32_bf16 v[88:91], v[108:111], v[212:215], v[88:91]
    s_waitcnt lgkmcnt(6)
    ds_read_b64_tr_b16 a[0:1], v13 offset:8192
    ds_read_b64_tr_b16 a[2:3], v13 offset:10240
    v_mfma_f32_16x16x32_bf16 v[72:75], v[112:115], v[208:211], v[72:75]
    ds_read_b64_tr_b16 v[108:109], v16 offset:20480
    ds_read_b64_tr_b16 v[110:111], v16 offset:22528
    v_mfma_f32_16x16x32_bf16 v[92:95], v[112:115], v[212:215], v[92:95]
    ds_read_b64_tr_b16 a[4:5], v14 offset:8192
    ds_read_b64_tr_b16 a[6:7], v14 offset:10240
    v_mfma_f32_16x16x32_bf16 v[76:79], v[116:119], v[208:211], v[76:79]
    ds_read_b64_tr_b16 v[112:113], v13 offset:32768
    ds_read_b64_tr_b16 v[114:115], v13 offset:34816
    v_mfma_f32_16x16x32_bf16 v[96:99], v[116:119], v[212:215], v[96:99]
    s_waitcnt vmcnt(5) lgkmcnt(10)
    ds_read_b64_tr_b16 a[8:9], v15 offset:8192
    ds_read_b64_tr_b16 a[10:11], v15 offset:10240
    v_mfma_f32_16x16x32_bf16 v[64:67], v[120:123], v[216:219], v[64:67]
    ds_read_b64_tr_b16 v[116:117], v14 offset:32768
    ds_read_b64_tr_b16 v[118:119], v14 offset:34816
    v_mfma_f32_16x16x32_bf16 v[84:87], v[120:123], v[220:223], v[84:87]
    ds_read_b64_tr_b16 a[12:13], v16 offset:8192
    ds_read_b64_tr_b16 a[14:15], v16 offset:10240
    v_mfma_f32_16x16x32_bf16 v[68:71], v[124:127], v[216:219], v[68:71]
    ds_read_b64_tr_b16 v[120:121], v15 offset:32768
    ds_read_b64_tr_b16 v[122:123], v15 offset:34816
    v_mfma_f32_16x16x32_bf16 v[88:91], v[124:127], v[220:223], v[88:91]
    s_waitcnt lgkmcnt(12)
    ds_read_b64_tr_b16 a[16:17], v13 offset:24576
    ds_read_b64_tr_b16 a[18:19], v13 offset:26624
    s_waitcnt vmcnt(2)
    v_cmp_ne_u32 vcc, 1, v57
    v_mfma_f32_16x16x32_bf16 v[72:75], v[104:107], v[216:219], v[72:75]
    ds_read_b64_tr_b16 v[124:125], v16 offset:32768
    ds_read_b64_tr_b16 v[126:127], v16 offset:34816
    v_mfma_f32_16x16x32_bf16 v[92:95], v[104:107], v[220:223], v[92:95]
    ds_read_b64_tr_b16 a[20:21], v14 offset:24576
    ds_read_b64_tr_b16 a[22:23], v14 offset:26624
    s_cbranch_vccnz Lrt_119
Lrtd_120:
    v_mfma_f32_16x16x32_bf16 v[76:79], v[108:111], v[216:219], v[76:79]
    s_add_u32 s59, s9, 2048
    ds_read_b64_tr_b16 v[104:105], v13 offset:49152
    ds_read_b64_tr_b16 v[106:107], v13 offset:51200
    v_mfma_f32_16x16x32_bf16 v[96:99], v[108:111], v[220:223], v[96:99]
    s_waitcnt lgkmcnt(12)
    ds_read_b64_tr_b16 a[24:25], v15 offset:24576
    ds_read_b64_tr_b16 a[26:27], v15 offset:26624
    v_mfma_f32_16x16x32_bf16 v[64:67], v[112:115], v[128:131], v[64:67]
    buffer_load_dwordx4 v[148:151], v1, s[32:35], s59 offen sc1
    v_mfma_f32_16x16x32_bf16 v[84:87], v[112:115], v[132:135], v[84:87]
    s_add_u32 s59, s9, 6144
    ds_read_b64_tr_b16 v[108:109], v14 offset:49152
    ds_read_b64_tr_b16 v[110:111], v14 offset:51200
    v_mfma_f32_16x16x32_bf16 v[68:71], v[116:119], v[128:131], v[68:71]
    buffer_load_dwordx4 v[156:159], v1, s[32:35], s59 offen sc1
    v_mfma_f32_16x16x32_bf16 v[88:91], v[116:119], v[132:135], v[88:91]
    s_waitcnt lgkmcnt(8)
    ds_read_b64_tr_b16 v[112:113], v15 offset:49152
    ds_read_b64_tr_b16 v[114:115], v15 offset:51200
    v_mfma_f32_16x16x32_bf16 v[72:75], v[120:123], v[128:131], v[72:75]
    s_add_u32 s59, s9, 9216
    ds_read_b64_tr_b16 v[116:117], v16 offset:49152
    ds_read_b64_tr_b16 v[118:119], v16 offset:51200
    v_mfma_f32_16x16x32_bf16 v[92:95], v[120:123], v[132:135], v[92:95]
    buffer_load_dwordx4 v[228:231], v1, s[32:35], s59 offen sc1
    v_mfma_f32_16x16x32_bf16 v[76:79], v[124:127], v[128:131], v[76:79]
    s_add_u32 s59, s9, 13312
    ds_read_b64_tr_b16 a[28:29], v16 offset:24576
    ds_read_b64_tr_b16 a[30:31], v16 offset:26624
    v_mfma_f32_16x16x32_bf16 v[96:99], v[124:127], v[132:135], v[96:99]
    s_waitcnt vmcnt(3) lgkmcnt(6)
    ds_read_b64_tr_b16 a[32:33], v13 offset:36864
    ds_read_b64_tr_b16 a[34:35], v13 offset:38912
    v_mfma_f32_16x16x32_bf16 v[64:67], v[104:107], v[136:139], v[64:67]
    buffer_load_dwordx4 v[236:239], v1, s[32:35], s59 offen sc1
    v_mfma_f32_16x16x32_bf16 v[84:87], v[104:107], v[140:143], v[84:87]
    s_add_u32 s59, s8, 2048
    ds_read_b64_tr_b16 a[36:37], v14 offset:36864
    ds_read_b64_tr_b16 a[38:39], v14 offset:38912
    v_mfma_f32_16x16x32_bf16 v[68:71], v[108:111], v[136:139], v[68:71]
    buffer_load_dwordx4 v[144:147], v1, s[32:35], s59 offen sc1
    v_mfma_f32_16x16x32_bf16 v[88:91], v[108:111], v[140:143], v[88:91]
    s_waitcnt lgkmcnt(6)
    ds_read_b64_tr_b16 a[40:41], v15 offset:36864
    ds_read_b64_tr_b16 a[42:43], v15 offset:38912
    v_mfma_f32_16x16x32_bf16 v[72:75], v[112:115], v[136:139], v[72:75]
    s_add_u32 s59, s8, 6144
    ds_read_b64_tr_b16 a[44:45], v16 offset:36864
    ds_read_b64_tr_b16 a[46:47], v16 offset:38912
    v_mfma_f32_16x16x32_bf16 v[92:95], v[112:115], v[140:143], v[92:95]
    buffer_load_dwordx4 v[152:155], v1, s[32:35], s59 offen sc1
    v_mfma_f32_16x16x32_bf16 v[76:79], v[116:119], v[136:139], v[76:79]
    s_add_u32 s59, s8, 9216
    ds_read_b64_tr_b16 a[48:49], v13 offset:53248
    ds_read_b64_tr_b16 a[50:51], v13 offset:55296
    v_mfma_f32_16x16x32_bf16 v[96:99], v[116:119], v[140:143], v[96:99]
    s_waitcnt vmcnt(5)
    ds_read_b64_tr_b16 a[52:53], v14 offset:53248
    ds_read_b64_tr_b16 a[54:55], v14 offset:55296
    ds_read_b64_tr_b16 a[56:57], v15 offset:53248
    ds_read_b64_tr_b16 a[58:59], v15 offset:55296
    ds_read_b64_tr_b16 a[60:61], v16 offset:53248
    ds_read_b64_tr_b16 a[62:63], v16 offset:55296
    v_mfma_f32_16x16x32_bf16 v[84:87], a[0:3], v[148:151], v[84:87]
    buffer_load_dwordx4 v[224:227], v1, s[32:35], s59 offen sc1
    v_mfma_f32_16x16x32_bf16 v[88:91], a[4:7], v[148:151], v[88:91]
    s_add_u32 s59, s8, 13312
    v_mfma_f32_16x16x32_bf16 v[92:95], a[8:11], v[148:151], v[92:95]
    buffer_load_dwordx4 v[232:235], v1, s[32:35], s59 offen sc1
    v_mfma_f32_16x16x32_bf16 v[96:99], a[12:15], v[148:151], v[96:99]
    s_waitcnt vmcnt(6)
    v_mfma_f32_16x16x32_bf16 v[84:87], a[16:19], v[156:159], v[84:87]
    v_mfma_f32_16x16x32_bf16 v[88:91], a[20:23], v[156:159], v[88:91]
    v_mfma_f32_16x16x32_bf16 v[92:95], a[24:27], v[156:159], v[92:95]
    s_waitcnt lgkmcnt(15)
    v_mfma_f32_16x16x32_bf16 v[96:99], a[28:31], v[156:159], v[96:99]
    s_waitcnt vmcnt(5)
    s_waitcnt lgkmcnt(14)
    v_mfma_f32_16x16x32_bf16 v[84:87], a[32:35], v[228:231], v[84:87]
    s_waitcnt lgkmcnt(12)
    v_mfma_f32_16x16x32_bf16 v[88:91], a[36:39], v[228:231], v[88:91]
    s_waitcnt lgkmcnt(10)
    v_mfma_f32_16x16x32_bf16 v[92:95], a[40:43], v[228:231], v[92:95]
    s_waitcnt lgkmcnt(8)
    v_mfma_f32_16x16x32_bf16 v[96:99], a[44:47], v[228:231], v[96:99]
    s_waitcnt vmcnt(4)
    s_waitcnt lgkmcnt(6)
    v_mfma_f32_16x16x32_bf16 v[84:87], a[48:51], v[236:239], v[84:87]
    s_waitcnt lgkmcnt(4)
    v_mfma_f32_16x16x32_bf16 v[88:91], a[52:55], v[236:239], v[88:91]
    s_waitcnt lgkmcnt(2)
    v_mfma_f32_16x16x32_bf16 v[92:95], a[56:59], v[236:239], v[92:95]
    s_waitcnt lgkmcnt(0)
    v_mfma_f32_16x16x32_bf16 v[96:99], a[60:63], v[236:239], v[96:99]
    s_waitcnt vmcnt(3)
    v_mfma_f32_16x16x32_bf16 v[64:67], a[0:3], v[144:147], v[64:67]
    v_mfma_f32_16x16x32_bf16 v[68:71], a[4:7], v[144:147], v[68:71]
    v_mfma_f32_16x16x32_bf16 v[72:75], a[8:11], v[144:147], v[72:75]
    ds_write_b128 v23, v[84:87] offset:0
    v_mfma_f32_16x16x32_bf16 v[76:79], a[12:15], v[144:147], v[76:79]
    s_waitcnt vmcnt(2)
    v_mfma_f32_16x16x32_bf16 v[64:67], a[16:19], v[152:155], v[64:67]
    ds_write_b128 v23, v[88:91] offset:1024
    v_mfma_f32_16x16x32_bf16 v[68:71], a[20:23], v[152:155], v[68:71]
    v_mfma_f32_16x16x32_bf16 v[72:75], a[24:27], v[152:155], v[72:75]
    ds_write_b128 v23, v[92:95] offset:2048
    v_mfma_f32_16x16x32_bf16 v[76:79], a[28:31], v[152:155], v[76:79]
    s_waitcnt vmcnt(1)
    v_mfma_f32_16x16x32_bf16 v[64:67], a[32:35], v[224:227], v[64:67]
    ds_write_b128 v23, v[96:99] offset:3072
    v_mfma_f32_16x16x32_bf16 v[68:71], a[36:39], v[224:227], v[68:71]
    v_mfma_f32_16x16x32_bf16 v[72:75], a[40:43], v[224:227], v[72:75]
    v_mfma_f32_16x16x32_bf16 v[76:79], a[44:47], v[224:227], v[76:79]
    s_waitcnt vmcnt(0)
    v_mfma_f32_16x16x32_bf16 v[64:67], a[48:51], v[232:235], v[64:67]
    s_waitcnt lgkmcnt(0)
    s_barrier
    ds_read_b128 v[104:107], v22 offset:0
    ds_read_b128 v[108:111], v22 offset:1024
    ds_read_b128 v[112:115], v22 offset:2048
    ds_read_b128 v[116:119], v22 offset:3072
    v_mfma_f32_16x16x32_bf16 v[68:71], a[52:55], v[232:235], v[68:71]
    v_mfma_f32_16x16x32_bf16 v[72:75], a[56:59], v[232:235], v[72:75]
    v_mfma_f32_16x16x32_bf16 v[76:79], a[60:63], v[232:235], v[76:79]
    s_waitcnt lgkmcnt(3)
    v_pk_add_f32 v[64:65], v[64:65], v[104:105]
    v_pk_add_f32 v[66:67], v[66:67], v[106:107]
    v_cvt_pk_bf16_f32 v84, v64, v65
    v_cvt_pk_bf16_f32 v85, v66, v67
    ds_write_b64 v20, v[84:85] offset:0
    s_waitcnt lgkmcnt(3)
    v_pk_add_f32 v[68:69], v[68:69], v[108:109]
    v_pk_add_f32 v[70:71], v[70:71], v[110:111]
    v_cvt_pk_bf16_f32 v86, v68, v69
    v_cvt_pk_bf16_f32 v87, v70, v71
    ds_write_b64 v20, v[86:87] offset:32
    s_waitcnt lgkmcnt(3)
    v_pk_add_f32 v[72:73], v[72:73], v[112:113]
    v_pk_add_f32 v[74:75], v[74:75], v[114:115]
    v_cvt_pk_bf16_f32 v88, v72, v73
    v_cvt_pk_bf16_f32 v89, v74, v75
    ds_write_b64 v20, v[88:89] offset:64
    s_waitcnt lgkmcnt(3)
    v_pk_add_f32 v[76:77], v[76:77], v[116:117]
    v_pk_add_f32 v[78:79], v[78:79], v[118:119]
    v_cvt_pk_bf16_f32 v90, v76, v77
    v_cvt_pk_bf16_f32 v91, v78, v79
    ds_write_b64 v20, v[90:91] offset:96
    ds_read_b128 v[92:95], v21 offset:0
    ds_read_b128 v[96:99], v21 offset:1152
    s_waitcnt lgkmcnt(1)
    buffer_store_dwordx4 v[92:95], v44, s[28:31], s61 offen nt
    s_waitcnt lgkmcnt(0)
    buffer_store_dwordx4 v[96:99], v44, s[28:31], s62 offen nt
    s_endpgm
Lrt_119:
    s_nop 1
    buffer_load_dword v57, v40, s[32:35], 0 offen offset:64 sc1
    s_sub_u32 s56, s56, 1
    s_cselect_b32 s56, 0, s56
    s_waitcnt vmcnt(0)
    s_cbranch_scc1 Lrte_121
    v_cmp_ne_u32 vcc, 1, v57
    s_cbranch_vccnz Lrt_119
Lrte_121:
    s_nop 1
    s_branch Lrtd_120
Lrt_116:
    s_nop 1
    buffer_load_dword v57, v40, s[32:35], 0 offen offset:32 sc1
    s_sub_u32 s56, s56, 1
    s_cselect_b32 s56, 0, s56
    s_waitcnt vmcnt(0)
    s_cbranch_scc1 Lrte_118
    v_cmp_ne_u32 vcc, 1, v57
    s_cbranch_vccnz Lrt_116
Lrte_118:
    s_nop 1
    s_branch Lrtd_117
Lrt_113:
    s_nop 1
    buffer_load_dwordx2 v[52:53], v45, s[32:35], s36 offen offset:3072 sc1
    s_sub_u32 s56, s56, 1
    s_cselect_b32 s56, 0, s56
    s_waitcnt vmcnt(0)
    s_cbranch_scc1 Lrte_115
    v_max_u32 v39, v52, v53
    v_cmp_eq_u32 vcc, -1, v39
    s_cbranch_vccnz Lrt_113
Lrte_115:
    s_nop 1
    s_branch Lrtd_114
Lrt_110:
    s_nop 1
    buffer_load_dwordx2 v[54:55], v45, s[32:35], s36 offen offset:2560 sc1
    s_sub_u32 s56, s56, 1
    s_cselect_b32 s56, 0, s56
    s_waitcnt vmcnt(0)
    s_cbranch_scc1 Lrte_112
    v_max_u32 v39, v54, v55
    v_cmp_eq_u32 vcc, -1, v39
    s_cbranch_vccnz Lrt_110
Lrte_112:
    s_nop 1
    s_branch Lrtd_111
Lrt_107:
    s_nop 1
    buffer_load_dword v57, v40, s[32:35], 0 offen offset:0 sc1
    s_sub_u32 s56, s56, 1
    s_cselect_b32 s56, 0, s56
    s_waitcnt vmcnt(0)
    s_cbranch_scc1 Lrte_109
    v_cmp_ne_u32 vcc, 1, v57
    s_cbranch_vccnz Lrt_107
Lrte_109:
    s_nop 1
    s_branch Lrtd_108
Lrt_104:
    s_nop 1
    buffer_load_dwordx2 v[52:53], v45, s[32:35], s36 offen offset:2048 sc1
    s_sub_u32 s56, s56, 1
    s_cselect_b32 s56, 0, s56
    s_waitcnt vmcnt(0)
    s_cbranch_scc1 Lrte_106
    v_max_u32 v39, v52, v53
    v_cmp_eq_u32 vcc, -1, v39
    s_cbranch_vccnz Lrt_104
Lrte_106:
    s_nop 1
    s_branch Lrtd_105
Lrt_101:
    s_nop 1
    buffer_load_dwordx2 v[54:55], v45, s[32:35], s36 offen offset:1536 sc1
    s_sub_u32 s56, s56, 1
    s_cselect_b32 s56, 0, s56
    s_waitcnt vmcnt(0)
    s_cbranch_scc1 Lrte_103
    v_max_u32 v39, v54, v55
    v_cmp_eq_u32 vcc, -1, v39
    s_cbranch_vccnz Lrt_101
Lrte_103:
    s_nop 1
    s_branch Lrtd_102
Lrt_98:
    s_nop 1
    buffer_load_dwordx2 v[52:53], v45, s[32:35], s36 offen offset:1024 sc1
    s_sub_u32 s56, s56, 1
    s_cselect_b32 s56, 0, s56
    s_waitcnt vmcnt(0)
    s_cbranch_scc1 Lrte_100
    v_max_u32 v39, v52, v53
    v_cmp_eq_u32 vcc, -1, v39
    s_cbranch_vccnz Lrt_98
Lrte_100:
    s_nop 1
    s_branch Lrtd_99
Lrt_95:
    s_nop 1
    buffer_load_dwordx2 v[54:55], v45, s[32:35], s36 offen offset:512 sc1
    s_sub_u32 s56, s56, 1
    s_cselect_b32 s56, 0, s56
    s_waitcnt vmcnt(0)
    s_cbranch_scc1 Lrte_97
    v_max_u32 v39, v54, v55
    v_cmp_eq_u32 vcc, -1, v39
    s_cbranch_vccnz Lrt_95
Lrte_97:
    s_nop 1
    s_branch Lrtd_96
Lrt_92:
    s_nop 1
    buffer_load_dwordx2 v[52:53], v45, s[32:35], s36 offen offset:0 sc1
    s_sub_u32 s56, s56, 1
    s_cselect_b32 s56, 0, s56
    s_waitcnt vmcnt(0)
    s_cbranch_scc1 Lrte_94
    v_max_u32 v39, v52, v53
    v_cmp_eq_u32 vcc, -1, v39
    s_cbranch_vccnz Lrt_92
Lrte_94:
    s_nop 1
    s_branch Lrtd_93
Lrt_89:
    s_nop 1
    buffer_load_dword v39, v40, s[32:35], 0 offen sc1
    s_sub_u32 s56, s56, 1
    s_cselect_b32 s56, 0, s56
    s_waitcnt vmcnt(0)
    s_cbranch_scc1 Lrte_91
    v_cmp_ne_u32 vcc, 1, v39
    s_cbranch_vccnz Lrt_89
Lrte_91:
    s_nop 1
    s_branch Lrtd_90
Lrt_86:
    s_nop 1
    s_sleep 3
    buffer_load_dword v39, v57, s[32:35], 0 offen sc1
    s_sub_u32 s56, s56, 1
    s_cselect_b32 s56, 0, s56
    s_waitcnt vmcnt(0)
    s_cbranch_scc1 Lrte_88
    v_cmp_ne_u32 vcc, s5, v39
    s_cbranch_vccnz Lrt_86
Lrte_88:
    s_nop 1
    s_branch Lrtd_87
Lrt_83:
    s_nop 1
    s_sleep 3
    buffer_load_dword v39, v57, s[32:35], 0 offen sc1
    s_sub_u32 s56, s56, 1
    s_cselect_b32 s56, 0, s56
    s_waitcnt vmcnt(0)
    s_cbranch_scc1 Lrte_85
    v_cmp_ne_u32 vcc, s5, v39
    s_cbranch_vccnz Lrt_83
Lrte_85:
    s_nop 1
    s_branch Lrtd_84
Lrt_80:
    s_nop 1
    buffer_load_dwordx4 v[128:131], v1, s[32:35], s44 offen offset:0 sc1
    buffer_load_dwordx4 v[132:135], v1, s[32:35], s44 offen offset:1024 sc1
    buffer_load_dwordx4 v[136:139], v1, s[32:35], s44 offen offset:2048 sc1
    buffer_load_dwordx4 v[140:143], v1, s[32:35], s44 offen offset:3072 sc1
    s_sub_u32 s56, s56, 1
    s_cselect_b32 s56, 0, s56
    s_waitcnt vmcnt(0)
    s_cbranch_scc1 Lrte_82
    v_max_u32 v39, v129, v131
    v_cndmask_b32_e64 v140, v140, 0, s[60:61]
    v_cndmask_b32_e64 v141, v141, 0, s[60:61]
    v_cndmask_b32_e64 v142, v142, 0, s[60:61]
    v_cndmask_b32_e64 v143, v143, 0, s[60:61]
    v_max3_u32 v39, v39, v133, v135
    v_max3_u32 v39, v39, v137, v139
    v_max3_u32 v39, v39, v141, v143
    v_cmp_eq_u32 vcc, -1, v39
    s_cbranch_vccnz Lrt_80
Lrte_82:
    s_nop 1
    s_branch Lrtd_81
Lrt_77:
    s_nop 1
    buffer_load_dword v39, v38, s[32:35], 0 offen offset:0 sc1
    s_sub_u32 s56, s56, 1
    s_cselect_b32 s56, 0, s56
    s_waitcnt vmcnt(0)
    s_cbranch_scc1 Lrte_79
    v_cmp_ne_u32 vcc, 1, v39
    s_cbranch_vccnz Lrt_77
Lrte_79:
    s_nop 1
    s_branch Lrtd_78
Lrt_72:
    s_nop 1
    buffer_load_dwordx4 v[84:87], v1, s[32:35], s6 offen sc1
    s_sub_u32 s56, s56, 1
    s_cselect_b32 s56, 0, s56
    s_waitcnt vmcnt(0)
    s_cbranch_scc1 Lrte_74
    v_max_u32 v39, v85, v87
    v_cmp_eq_u32 vcc, -1, v39
    s_cbranch_vccnz Lrt_72
Lrte_74:
    s_nop 1
    s_branch Lrtd_73
Lrt_69:
    s_nop 1
    buffer_load_dword v39, v38, s[32:35], 0 offen offset:0 sc1
    s_sub_u32 s56, s56, 1
    s_cselect_b32 s56, 0, s56
    s_waitcnt vmcnt(0)
    s_cbranch_scc1 Lrte_71
    v_cmp_ne_u32 vcc, 1, v39
    s_cbranch_vccnz Lrt_69
Lrte_71:
    s_nop 1
    s_branch Lrtd_70
Lrt_63:
    s_nop 1
    buffer_load_dword v177, v176, s[32:35], 0 offen offset:0 sc1
    s_sub_u32 s56, s56, 1
    s_cselect_b32 s56, 0, s56
    s_waitcnt vmcnt(0)
    s_cbranch_scc1 Lrte_65
    v_cmp_ne_u32 vcc, 1, v177
    s_cbranch_vccnz Lrt_63
Lrte_65:
    s_nop 1
    s_branch Lrtd_64
Lrt_66:
    s_nop 11
    buffer_load_dwordx4 v[188:191], v182, s[32:35], s62 offen offset:1024 sc1
    s_add_u32 s91, s62, 3456
    s_add_u32 s92, s62, 6912
    buffer_load_dwordx4 v[192:195], v1, s[32:35], s62 offen offset:0 sc1
    buffer_load_dwordx4 v[196:199], v1, s[32:35], s62 offen offset:1152 sc1
    buffer_load_dwordx4 v[200:203], v1, s[32:35], s62 offen offset:2304 sc1
    buffer_load_dwordx4 v[204:207], v1, s[32:35], s91 offen offset:0 sc1
    buffer_load_dwordx4 v[208:211], v1, s[32:35], s91 offen offset:1152 sc1
    buffer_load_dwordx4 v[212:215], v1, s[32:35], s91 offen offset:2304 sc1
    buffer_load_dwordx4 v[216:219], v1, s[32:35], s92 offen offset:0 sc1
    buffer_load_dwordx4 v[220:223], v1, s[32:35], s92 offen offset:1152 sc1
    s_sub_u32 s56, s56, 8
    s_cselect_b32 s56, 0, s56
    s_waitcnt vmcnt(0)
    s_cbranch_scc1 Lrte_68
    v_max_u32 v17, v188, v189
    v_max3_u32 v17, v17, v190, v191
    v_max3_u32 v17, v17, v192, v193
    v_max3_u32 v17, v17, v194, v195
    v_max3_u32 v17, v17, v196, v197
    v_max3_u32 v17, v17, v198, v199
    v_max3_u32 v17, v17, v200, v201
    v_max3_u32 v17, v17, v202, v203
    v_max3_u32 v17, v17, v204, v205
    v_max3_u32 v17, v17, v206, v207
    v_max3_u32 v17, v17, v208, v209
    v_max3_u32 v17, v17, v210, v211
    v_max3_u32 v17, v17, v212, v213
    v_max3_u32 v17, v17, v214, v215
    v_max3_u32 v17, v17, v216, v217
    v_max3_u32 v17, v17, v218, v219
    v_max3_u32 v17, v17, v220, v221
    v_max3_u32 v17, v17, v222, v223
    v_cmp_eq_u32 vcc, -1, v17
    s_cbranch_vccnz Lrt_66
Lrte_68:
    v_mfma_f32_16x16x32_bf16 v[80:83], v[188:191], v[96:99], 0
    v_mfma_f32_16x16x32_bf16 v[84:87], v[188:191], v[100:103], 0
    v_mfma_f32_16x16x32_bf16 v[88:91], v[188:191], v[104:107], 0
    v_mfma_f32_16x16x32_bf16 v[92:95], v[188:191], v[108:111], 0
    v_mfma_f32_16x16x32_bf16 v[164:167], v[160:163], v[192:195], 0
    v_mfma_f32_16x16x32_bf16 v[168:171], v[158:161], v[192:195], 0
    v_mfma_f32_16x16x32_bf16 v[164:167], v[160:163], v[196:199], v[164:167]
    v_mfma_f32_16x16x32_bf16 v[168:171], v[158:161], v[196:199], v[168:171]
    v_mfma_f32_16x16x32_bf16 v[164:167], v[160:163], v[200:203], v[164:167]
    v_add_f32 v80, v80, v81
    v_mfma_f32_16x16x32_bf16 v[168:171], v[158:161], v[200:203], v[168:171]
    v_add_f32 v82, v82, v83
    v_mfma_f32_16x16x32_bf16 v[164:167], v[160:163], v[204:207], v[164:167]
    v_add_f32 v84, v84, v85
    v_mfma_f32_16x16x32_bf16 v[168:171], v[158:161], v[204:207], v[168:171]
    v_add_f32 v86, v86, v87
    v_mfma_f32_16x16x32_bf16 v[164:167], v[160:163], v[208:211], v[164:167]
    v_add_f32 v88, v88, v89
    v_mfma_f32_16x16x32_bf16 v[168:171], v[158:161], v[208:211], v[168:171]
    v_add_f32 v90, v90, v91
    v_mfma_f32_16x16x32_bf16 v[164:167], v[160:163], v[212:215], v[164:167]
    v_add_f32 v92, v92, v93
    v_mfma_f32_16x16x32_bf16 v[168:171], v[158:161], v[212:215], v[168:171]
    v_add_f32 v94, v94, v95
    v_mfma_f32_16x16x32_bf16 v[164:167], v[160:163], v[216:219], v[164:167]
    v_add_f32 v80, v80, v82
    v_mfma_f32_16x16x32_bf16 v[168:171], v[158:161], v[216:219], v[168:171]
    v_add_f32 v84, v84, v86
    v_mfma_f32_16x16x32_bf16 v[164:167], v[160:163], v[220:223], v[164:167]
    v_add_f32 v88, v88, v90
    v_mfma_f32_16x16x32_bf16 v[168:171], v[158:161], v[220:223], v[168:171]
    v_add_f32 v92, v92, v94
    s_nop 11
    s_branch Lrtd_67
Lidle_75:
    s_waitcnt vmcnt(0) lgkmcnt(0)
    s_and_b32 s93, s58, 15
    s_mul_i32 s93, s93, 28672
    s_add_u32 s93, s93, 0
    s_add_u32 s86, s93, 14336
    v_min_u32 v36, 13, v3
    v_mul_u32_u24 v37, 28, v4
    v_add_lshl_u32 v36, v36, v37, 7
    buffer_load_dword v19, v36, s[16:19], s93 offen sc1
    buffer_load_dword v19, v36, s[16:19], s86 offen sc1
    s_xor_b32 s93, s87, 0
    s_add_u32 m0, s88, 32768
    s_add_u32 s86, s93, s77
    buffer_load_dwordx4 v5, s[20:23], s86 offen lds
    buffer_load_dwordx4 v6, s[20:23], s86 offen offset:1024 lds
    buffer_load_dwordx4 v7, s[20:23], s86 offen offset:2048 lds
    buffer_load_dwordx4 v8, s[20:23], s86 offen offset:3072 lds
    s_xor_b32 s93, s87, 131072
    s_add_u32 m0, s88, 36864
    s_add_u32 s86, s93, s77
    buffer_load_dwordx4 v5, s[20:23], s86 offen lds
    buffer_load_dwordx4 v6, s[20:23], s86 offen offset:1024 lds
    buffer_load_dwordx4 v7, s[20:23], s86 offen offset:2048 lds
    buffer_load_dwordx4 v8, s[20:23], s86 offen offset:3072 lds
    ds_read_b128 a[0:3], v20 offset:0
    ds_read_b128 a[4:7], v22 offset:0
    ds_read_b128 a[32:35], v21 offset:0
    ds_read_b128 a[36:39], v23 offset:0
    s_waitcnt lgkmcnt(0)
    s_xor_b32 s93, s87, 1048576
    s_add_u32 m0, s88, 0
    s_add_u32 s86, s93, s77
    buffer_load_dwordx4 v5, s[20:23], s86 offen lds
    buffer_load_dwordx4 v6, s[20:23], s86 offen offset:1024 lds
    buffer_load_dwordx4 v7, s[20:23], s86 offen offset:2048 lds
    buffer_load_dwordx4 v8, s[20:23], s86 offen offset:3072 lds
    ds_read_b128 a[8:11], v20 offset:4096
    ds_read_b128 a[12:15], v22 offset:4096
    ds_read_b128 a[40:43], v21 offset:4096
    ds_read_b128 a[44:47], v23 offset:4096
    s_waitcnt lgkmcnt(0)
    s_xor_b32 s93, s87, 1179648
    s_add_u32 m0, s88, 4096
    s_add_u32 s86, s93, s77
    buffer_load_dwordx4 v5, s[20:23], s86 offen lds
    buffer_load_dwordx4 v6, s[20:23], s86 offen offset:1024 lds
    buffer_load_dwordx4 v7, s[20:23], s86 offen offset:2048 lds
    buffer_load_dwordx4 v8, s[20:23], s86 offen offset:3072 lds
    s_waitcnt vmcnt(12)
    ds_read_b128 a[64:67], v20 offset:32768
    ds_read_b128 a[68:71], v22 offset:32768
    ds_read_b128 a[96:99], v21 offset:32768
    ds_read_b128 a[100:103], v23 offset:32768
    s_waitcnt lgkmcnt(0)
    s_xor_b32 s93, s87, 0
    s_add_u32 m0, s88, 32768
    s_add_u32 s86, s93, s78
    buffer_load_dwordx4 v5, s[20:23], s86 offen lds
    buffer_load_dwordx4 v6, s[20:23], s86 offen offset:1024 lds
    buffer_load_dwordx4 v7, s[20:23], s86 offen offset:2048 lds
    buffer_load_dwordx4 v8, s[20:23], s86 offen offset:3072 lds
    s_waitcnt vmcnt(12)
    ds_read_b128 a[72:75], v20 offset:36864
    ds_read_b128 a[76:79], v22 offset:36864
    ds_read_b128 a[104:107], v21 offset:36864
    ds_read_b128 a[108:111], v23 offset:36864
    s_waitcnt lgkmcnt(0)
    s_xor_b32 s93, s87, 131072
    s_add_u32 m0, s88, 36864
    s_add_u32 s86, s93, s78
    buffer_load_dwordx4 v5, s[20:23], s86 offen lds
    buffer_load_dwordx4 v6, s[20:23], s86 offen offset:1024 lds
    buffer_load_dwordx4 v7, s[20:23], s86 offen offset:2048 lds
    buffer_load_dwordx4 v8, s[20:23], s86 offen offset:3072 lds
    s_waitcnt vmcnt(12)
    ds_read_b128 a[80:83], v20 offset:0
    ds_read_b128 a[84:87], v22 offset:0
    ds_read_b128 a[112:115], v21 offset:0
    ds_read_b128 a[116:119], v23 offset:0
    s_waitcnt lgkmcnt(0)
    s_xor_b32 s93, s87, 1048576
    s_add_u32 m0, s88, 0
    s_add_u32 s86, s93, s78
    buffer_load_dwordx4 v5, s[20:23], s86 offen lds
    buffer_load_dwordx4 v6, s[20:23], s86 offen offset:1024 lds
    buffer_load_dwordx4 v7, s[20:23], s86 offen offset:2048 lds
    buffer_load_dwordx4 v8, s[20:23], s86 offen offset:3072 lds
    s_waitcnt vmcnt(12)
    ds_read_b128 a[88:91], v20 offset:4096
    ds_read_b128 a[92:95], v22 offset:4096
    ds_read_b128 a[120:123], v21 offset:4096
    ds_read_b128 a[124:127], v23 offset:4096
    s_waitcnt lgkmcnt(0)
    s_xor_b32 s93, s87, 1179648
    s_add_u32 m0, s88, 4096
    s_add_u32 s86, s93, s78
    buffer_load_dwordx4 v5, s[20:23], s86 offen lds
    buffer_load_dwordx4 v6, s[20:23], s86 offen offset:1024 lds
    buffer_load_dwordx4 v7, s[20:23], s86 offen offset:2048 lds
    buffer_load_dwordx4 v8, s[20:23], s86 offen offset:3072 lds
    s_waitcnt vmcnt(12)
    ds_read_b128 a[128:131], v20 offset:32768
    ds_read_b128 a[132:135], v22 offset:32768
    ds_read_b128 a[160:163], v21 offset:32768
    ds_read_b128 a[164:167], v23 offset:32768
    s_waitcnt lgkmcnt(0)
    s_xor_b32 s93, s87, 1048576
    s_add_u32 m0, s88, 32768
    s_add_u32 s86, s93, s76
    buffer_load_dwordx4 v5, s[20:23], s86 offen lds
    buffer_load_dwordx4 v6, s[20:23], s86 offen offset:1024 lds
    buffer_load_dwordx4 v7, s[20:23], s86 offen offset:2048 lds
    buffer_load_dwordx4 v8, s[20:23], s86 offen offset:3072 lds
    s_waitcnt vmcnt(12)
    ds_read_b128 a[136:139], v20 offset:36864
    ds_read_b128 a[140:143], v22 offset:36864
    ds_read_b128 a[168:171], v21 offset:36864
    ds_read_b128 a[172:175], v23 offset:36864
    s_waitcnt lgkmcnt(0)
    s_xor_b32 s93, s87, 1179648
    s_add_u32 m0, s88, 36864
    s_add_u32 s86, s93, s76
    buffer_load_dwordx4 v5, s[20:23], s86 offen lds
    buffer_load_dwordx4 v6, s[20:23], s86 offen offset:1024 lds
    buffer_load_dwordx4 v7, s[20:23], s86 offen offset:2048 lds
    buffer_load_dwordx4 v8, s[20:23], s86 offen offset:3072 lds
    s_waitcnt vmcnt(12)
    ds_read_b128 a[144:147], v20 offset:0
    ds_read_b128 a[148:151], v22 offset:0
    ds_read_b128 a[176:179], v21 offset:0
    ds_read_b128 a[180:183], v23 offset:0
    s_waitcnt vmcnt(8)
    ds_read_b128 a[152:155], v20 offset:4096
    ds_read_b128 a[156:159], v22 offset:4096
    ds_read_b128 a[184:187], v21 offset:4096
    ds_read_b128 a[188:191], v23 offset:4096
    s_waitcnt vmcnt(4)
    ds_read_b128 a[16:19], v20 offset:32768
    ds_read_b128 a[20:23], v22 offset:32768
    ds_read_b128 a[48:51], v21 offset:32768
    ds_read_b128 a[52:55], v23 offset:32768
    s_waitcnt vmcnt(0)
    ds_read_b128 a[24:27], v20 offset:36864
    ds_read_b128 a[28:31], v22 offset:36864
    ds_read_b128 a[56:59], v21 offset:36864
    ds_read_b128 a[60:63], v23 offset:36864
    s_mul_i32 s59, s53, 7
    v_min_u32 v46, 6, v0
    v_add_u32 v46, s59, v46
    v_lshrrev_b32 v46, 2, v46
    s_andn2_b32 s63, 1, s48
    s_lshl_b32 s59, s63, 7
    s_add_u32 s59, s59, 10780672
    s_lshl_b32 s62, s54, 28
    s_add_u32 s59, s59, s62
    v_lshl_add_u32 v57, v46, 8, s59
    s_min_u32 s5, s54, 1
    s_xor_b32 s5, s5, 1
    s_mul_i32 s5, s5, 7
    s_bfe_u32 s59, s58, 196609
    s_lshl_b32 s59, s59, 7
    s_add_u32 s59, s59, s3
    s_add_u32 s59, s59, 51200
    v_lshl_add_u32 v40, v46, 2, s59
    s_lshl_b32 s4, s63, 13
    s_lshl_b32 s59, s54, 14
    s_add_u32 s4, s4, s59
    s_add_u32 s4, s4, 6291456
    s_lshl_b32 s59, s64, 16
    s_add_u32 s59, s59, s4
    v_add_u32 v56, s59, v1
    s_xor_b32 s59, s54, 1
    s_mul_i32 s59, s59, 3072
    s_add_u32 s59, s59, 0
    v_add_u32 v41, s59, v1
    s_xor_b32 s59, s54, 2
    s_mul_i32 s59, s59, 3072
    s_add_u32 s59, s59, 1024
    v_add_u32 v42, s59, v1
    s_xor_b32 s59, s54, 3
    s_mul_i32 s59, s59, 3072
    s_add_u32 s59, s59, 2048
    v_add_u32 v43, s59, v1
    s_mul_i32 s59, s54, 3072
    v_add_u32 v44, s59, v1
    v_lshlrev_b32 v45, 3, v0
    v_lshlrev_b32 v48, 16, v34
    v_lshlrev_b32 v49, 16, v34
    v_lshlrev_b32 v50, 16, v34
    v_lshlrev_b32 v51, 16, v34
    s_lshr_b32 s91, s64, 1
    s_lshl_b32 s91, s91, 10
    s_and_b32 s59, s64, 1
    s_lshl_b32 s59, s59, 3
    s_add_u32 s91, s91, s59
    s_add_u32 s91, s91, s0
    s_lshl_b32 s92, s65, 9
    s_add_u32 s92, s92, s0
    s_lshl_b32 s36, s94, 12
    s_xor_b32 s37, s36, 524288
    s_add_u32 s36, s36, 11534336
    s_add_u32 s37, s37, 11534336
    s_bfe_u32 s38, s57, 196608
    s_lshl_b32 s38, s38, 7
    s_add_u32 s38, s38, s3
    s_add_u32 s38, s38, 51200
    s_lshl_b32 s59, s51, 2
    s_add_u32 s38, s38, s59
    s_bfe_u32 s39, s58, 262144
    s_lshl_b32 s39, s39, 7
    s_add_u32 s39, s39, s3
    s_add_u32 s39, s39, 52224
    s_lshl_b32 s6, s53, 2
    s_add_u32 s6, s6, s39
    buffer_load_dword v39, v57, s[32:35], 0 offen sc1
    s_waitcnt vmcnt(0)
    v_cmp_ne_u32 vcc, s5, v39
    s_cbranch_vccnz Lrt_86
Lrtd_87:
    s_waitcnt lgkmcnt(0)
    s_barrier
    buffer_load_dwordx4 v[128:131], v56, s[32:35], s72 offen offset:0 sc1
    buffer_load_dwordx4 v[132:135], v56, s[32:35], s72 offen offset:1024 sc1
    buffer_load_dwordx4 v[136:139], v56, s[32:35], s73 offen offset:0 sc1
    buffer_load_dwordx4 v[140:143], v56, s[32:35], s73 offen offset:1024 sc1
    buffer_load_dwordx4 v[144:147], v56, s[32:35], s74 offen offset:0 sc1
    buffer_load_dwordx4 v[148:151], v56, s[32:35], s74 offen offset:1024 sc1
    buffer_load_dwordx4 v[152:155], v56, s[32:35], s75 offen offset:0 sc1
    buffer_load_dwordx4 v[156:159], v56, s[32:35], s75 offen offset:1024 sc1
    s_lshl_b32 s7, s65, 16
    s_add_u32 s7, s7, s4
    v_add_u32 v56, s7, v1
    buffer_load_dwordx4 v[160:163], v56, s[32:35], s72 offen offset:0 sc1
    buffer_load_dwordx4 v[164:167], v56, s[32:35], s72 offen offset:1024 sc1
    buffer_load_dwordx4 v[168:171], v56, s[32:35], s73 offen offset:0 sc1
    buffer_load_dwordx4 v[172:175], v56, s[32:35], s73 offen offset:1024 sc1
    buffer_load_dwordx4 v[176:179], v56, s[32:35], s74 offen offset:0 sc1
    buffer_load_dword v19, off, s[32:35], s3 sc1
    buffer_load_dword v19, off, s[32:35], s3 sc1
    buffer_load_dword v19, off, s[32:35], s3 sc1
    buffer_load_dword v19, off, s[32:35], s3 sc1
    s_nop 7
    s_branch Lp3_76
L_end:
    s_endpgm
.section .rodata,"a"
.p2align 6
.amdhsa_kernel sequential_preLN__linear_kernel_hedgehog__mixer_gmlp__prompt_kernel
  .amdhsa_next_free_vgpr 512
  .amdhsa_next_free_sgpr 102
  .amdhsa_accum_offset 256
  .amdhsa_group_segment_fixed_size 0
  .amdhsa_kernarg_size 96
  .amdhsa_user_sgpr_count 2
  .amdhsa_user_sgpr_kernarg_segment_ptr 1
  .amdhsa_system_sgpr_workgroup_id_x 1
.end_amdhsa_kernel
```
